```python
import torch

def _softmax(x, axis=-1):
    return torch.softmax(x, dim=axis)
def _gelu(x):
    return torch.nn.functional.gelu(x, approximate="tanh")
def _silu(x):
    return torch.nn.functional.silu(x)
def _sigmoid(x):
    return torch.sigmoid(x)
def _layernorm(x, axis=-1, eps=1e-5):
    m = x.mean(dim=axis, keepdim=True)
    v = x.var(dim=axis, keepdim=True, unbiased=False)
    return (x - m) / torch.sqrt(v + eps)
def _scatter_add(tgt, idx, src, axis=0):
    return tgt.clone().index_add_(axis, idx, src)
def _segment_sum(src, seg, n):
    out = torch.zeros((n,) + src.shape[1:], dtype=src.dtype)
    return out.index_add_(0, seg, src)
def _pad(x, pw):
    flat = tuple(v for pair in reversed(pw) for v in pair)
    return torch.nn.functional.pad(x, flat)

kernel_name = 'concat_heads__mha_block_cached__mha_block_cached__near_ridge'

def setup_inputs():

    _w = (lambda a: (lambda t: t.to(torch.bfloat16) if t.is_floating_point() else t)(torch.as_tensor(a)))
    def _A_setup():
        B, Sq, D = 8, 256, 448
        H, Sk, Dh = 16, 1024, 256
        return {
            "x": _w((lambda *s: torch.randn(*s, dtype=torch.bfloat16) * 0.8)(B, Sq, D)),
            "k_cache": _w((lambda *s: torch.randn(*s, dtype=torch.bfloat16) * 0.8)(B, H, Sk, Dh)),
            "v_cache": _w((lambda *s: torch.randn(*s, dtype=torch.bfloat16) * 0.05)(B, H, Sk, Dh)),
            "wq": _w((lambda *s: torch.randn(*s, dtype=torch.bfloat16) * 0.8)(D, H * Dh) * (D ** -0.5)),
            "wo": _w((lambda *s: torch.randn(*s, dtype=torch.bfloat16) * 0.05)(H * Dh, D) * ((H * Dh) ** -0.5)),
        }
    _A_in = _A_setup()

    def _B_setup():
        B, Sq, D = 8, 256, 448
        H, Sk, Dh = 16, 1024, 256
        return {
            "x": _w((lambda *s: torch.randn(*s, dtype=torch.bfloat16) * 0.8)(B, Sq, D)),
            "k_cache": _w((lambda *s: torch.randn(*s, dtype=torch.bfloat16) * 0.8)(B, H, Sk, Dh)),
            "v_cache": _w((lambda *s: torch.randn(*s, dtype=torch.bfloat16) * 0.05)(B, H, Sk, Dh)),
            "wq": _w((lambda *s: torch.randn(*s, dtype=torch.bfloat16) * 0.8)(D, H * Dh) * (D ** -0.5)),
            "wo": _w((lambda *s: torch.randn(*s, dtype=torch.bfloat16) * 0.05)(H * Dh, D) * ((H * Dh) ** -0.5)),
        }
    _B_in = _B_setup()

    return {
        "A_x": _A_in["x"],
        "A_k_cache": _A_in["k_cache"],
        "A_v_cache": _A_in["v_cache"],
        "A_wq": _A_in["wq"],
        "A_wo": _A_in["wo"],
        "B_x": _B_in["x"],
        "B_k_cache": _B_in["k_cache"],
        "B_v_cache": _B_in["v_cache"],
        "B_wq": _B_in["wq"],
        "B_wo": _B_in["wo"],
    }

def reference(A_x, A_k_cache, A_v_cache, A_wq, A_wo, B_x, B_k_cache, B_v_cache, B_wq, B_wo):
    def _A_ref(x, k_cache, v_cache, wq, wo):
        B, Sq, D = x.shape
        H, Dh = 16, 256
        q = (lambda x, *d: x.permute(*d))((x @ wq).reshape(B, Sq, H, Dh), 0, 2, 1, 3)
        scores = torch.einsum("bhqd,bhkd->bhqk", q, k_cache) * (Dh ** -0.5)
        p = _softmax(scores, axis=-1)
        o = torch.einsum("bhqk,bhkd->bhqd", p, v_cache)
        return (lambda x, *d: x.permute(*d))(o, 0, 2, 1, 3).reshape(B, Sq, H * Dh) @ wo

    def _B_ref(x, k_cache, v_cache, wq, wo):
        B, Sq, D = x.shape
        H, Dh = 16, 256
        q = (lambda x, *d: x.permute(*d))((x @ wq).reshape(B, Sq, H, Dh), 0, 2, 1, 3)
        scores = torch.einsum("bhqd,bhkd->bhqk", q, k_cache) * (Dh ** -0.5)
        p = _softmax(scores, axis=-1)
        o = torch.einsum("bhqk,bhkd->bhqd", p, v_cache)
        return (lambda x, *d: x.permute(*d))(o, 0, 2, 1, 3).reshape(B, Sq, H * Dh) @ wo

    a = _A_ref(A_x, A_k_cache, A_v_cache, A_wq, A_wo)
    b = _B_ref(B_x, B_k_cache, B_v_cache, B_wq, B_wo)
    return torch.concatenate([a, b], axis=-1)
```

```asm
; @launch grid=(256,1,1) block=(256,1,1) lds=163840
.amdgcn_target "amdgcn-amd-amdhsa--gfx950"
.text
.globl concat_heads__mha_block_cached__mha_block_cached__near_ridge_kernel
.p2align 8
.type concat_heads__mha_block_cached__mha_block_cached__near_ridge_kernel,@function
concat_heads__mha_block_cached__mha_block_cached__near_ridge_kernel:
  s_cmp_ge_u32 s2, 256
  s_cbranch_scc1 L_end
  v_lshrrev_b32 v1, 6, v0
  v_and_b32 v0, 63, v0
  s_mov_b32 s3, 0
  v_readfirstlane_b32 s32, v1
  s_getpc_b64 s[50:51]
  s_and_b32 s50, s50, 0xffffff80
  s_lshr_b32 s52, s2, 3
  s_mul_i32 s52, s52, 16
  v_min_u32 v140, 15, v0
  v_add_u32 v140, s52, v140
  v_lshlrev_b32 v140, 7, v140
  global_load_dword v141, v140, s[50:51]
L_again:
  s_load_dwordx16 s[36:51], s[0:1], 0
  s_load_dwordx8 s[52:59], s[0:1], 64
  s_load_dwordx2 s[60:61], s[0:1], 96
  s_nop 3
  s_and_b32 s67, s2, 7
  s_lshr_b32 s68, s2, 3
  s_and_b32 s72, s68, 15
  s_lshr_b32 s68, s68, 4
  s_lshl_b32 s71, s67, 1
  s_add_u32 s71, s71, s68
  s_lshr_b32 s74, s71, 3
  s_and_b32 s73, s71, 7
  s_lshl_b32 s33, s32, 10
  s_mov_b32 s63, 0x3db8aa3b
  v_and_b32 v1, 15, v0
  v_lshrrev_b32 v2, 4, v0
  v_lshrrev_b32 v3, 1, v1
  v_add_u32 v4, 0, v2
  v_xor_b32 v4, v4, v3
  v_lshlrev_b32 v4, 4, v4
  v_lshl_add_u32 v4, v1, 7, v4
  v_add_u32 v5, 4, v2
  v_xor_b32 v5, v5, v3
  v_lshlrev_b32 v5, 4, v5
  v_lshl_add_u32 v5, v1, 7, v5
  v_lshrrev_b32 v1, 3, v0
  v_and_b32 v2, 7, v0
  v_lshl_add_u32 v3, s32, 3, v1
  v_bfe_u32 v28, v3, 1, 1
  v_lshlrev_b32 v28, 2, v28
  v_xor_b32 v28, v28, v2
  v_lshlrev_b32 v28, 4, v28
  v_lshl_add_u32 v21, v3, 13, v28
  s_waitcnt lgkmcnt(0)
  s_cmp_eq_u32 s74, 0
  s_cselect_b32 s36, s36, s46
  s_cselect_b32 s37, s37, s47
  s_cselect_b32 s38, s38, s48
  s_cselect_b32 s39, s39, s49
  s_cselect_b32 s40, s40, s50
  s_cselect_b32 s41, s41, s51
  s_cselect_b32 s42, s42, s52
  s_cselect_b32 s43, s43, s53
  s_cselect_b32 s44, s44, s54
  s_cselect_b32 s45, s45, s55
  s_mul_i32 s67, s73, 229376
  s_add_u32 s4, s36, s67
  s_addc_u32 s5, s37, 0
  s_mov_b32 s6, 229376
  s_mov_b32 s7, 0x20000
  s_lshl_b32 s67, s72, 9
  s_add_u32 s8, s42, s67
  s_addc_u32 s9, s43, 0
  s_mov_b32 s10, 0
  s_mov_b32 s11, 0x20000
  s_sub_u32 s10, 3670016, s67
  s_lshr_b32 s68, s2, 7
  s_and_b32 s68, s68, 0
  s_cmp_eq_u32 s68, 0
  s_cselect_b32 s78, 0, 3145728
  s_cselect_b32 s69, 1, -1
  s_cselect_b32 s35, 0, 768
  s_mul_i32 s79, s69, 524288
  s_mul_i32 s75, s69, 128
  s_and_b32 s68, s32, 1
  s_lshl_b32 s68, s68, 13
  s_cmp_lt_u32 s32, 2
  s_cselect_b32 s34, 2, 4
  s_lshl_b32 s34, s34, 14
  s_add_u32 s34, s34, s68
  v_lshrrev_b32 v1, 3, v0
  v_and_b32 v2, 7, v0
  v_lshl_add_u32 v3, s32, 6, v1
  v_mul_u32_u24 v3, 896, v3
  v_lshrrev_b32 v1, 1, v1
  v_or_b32 v128, 0, v1
  v_xor_b32 v128, v128, v2
  v_lshl_add_u32 v128, v128, 4, v3
  v_add_u32 v130, s34, v4
  v_or_b32 v129, 4, v1
  v_xor_b32 v129, v129, v2
  v_lshl_add_u32 v129, v129, 4, v3
  v_add_u32 v131, s34, v5
  v_lshlrev_b32 v132, 4, v0
  s_mul_i32 s67, s72, 14336
  s_lshl_b32 s68, s32, 12
  s_add_u32 s67, s67, s68
  s_add_u32 m0, s33, 131072
  s_nop 0
  buffer_load_dwordx4 v21, s[8:11], s78 offen lds
  s_add_u32 m0, s33, 135040
  s_nop 0
  buffer_load_dwordx4 v21, s[8:11], s78 offen offset:128 lds
  s_add_u32 m0, s33, 139008
  s_nop 0
  buffer_load_dwordx4 v21, s[8:11], s78 offen offset:256 lds
  s_add_u32 m0, s33, 142976
  s_nop 0
  buffer_load_dwordx4 v21, s[8:11], s78 offen offset:384 lds
  s_lshl_b32 s68, s32, 12
  s_add_u32 m0, s68, 0
  s_nop 0
  buffer_load_dwordx4 v132, s[4:7], s67 offen lds
  buffer_load_dwordx4 v132, s[4:7], s67 offen offset:1024 lds
  buffer_load_dwordx4 v132, s[4:7], s67 offen offset:2048 lds
  buffer_load_dwordx4 v132, s[4:7], s67 offen offset:3072 lds
  s_add_u32 s76, s78, 262144
  s_add_u32 m0, s33, 147456
  s_nop 0
  buffer_load_dwordx4 v21, s[8:11], s76 offen lds
  s_add_u32 m0, s33, 151424
  s_nop 0
  buffer_load_dwordx4 v21, s[8:11], s76 offen offset:128 lds
  s_add_u32 m0, s33, 155392
  s_nop 0
  buffer_load_dwordx4 v21, s[8:11], s76 offen offset:256 lds
  s_add_u32 m0, s33, 159360
  s_nop 0
  buffer_load_dwordx4 v21, s[8:11], s76 offen offset:384 lds
  s_add_u32 s69, s35, 0
  s_add_u32 m0, s34, 0
  s_nop 0
  buffer_load_dwordx4 v128, s[4:7], s69 offen lds
  s_add_u32 s70, s35, 7168
  s_add_u32 m0, s34, 1024
  s_nop 0
  buffer_load_dwordx4 v129, s[4:7], s70 offen lds
  s_add_u32 s69, s35, 14336
  s_add_u32 m0, s34, 2048
  s_nop 0
  buffer_load_dwordx4 v128, s[4:7], s69 offen lds
  s_add_u32 s70, s35, 21504
  s_add_u32 m0, s34, 3072
  s_nop 0
  buffer_load_dwordx4 v129, s[4:7], s70 offen lds
  s_add_u32 s69, s35, 28672
  s_add_u32 m0, s34, 4096
  s_nop 0
  buffer_load_dwordx4 v128, s[4:7], s69 offen lds
  s_add_u32 s70, s35, 35840
  s_add_u32 m0, s34, 5120
  s_nop 0
  buffer_load_dwordx4 v129, s[4:7], s70 offen lds
  s_add_u32 s69, s35, 43008
  s_add_u32 m0, s34, 6144
  s_nop 0
  buffer_load_dwordx4 v128, s[4:7], s69 offen lds
  s_add_u32 s70, s35, 50176
  s_add_u32 m0, s34, 7168
  s_nop 0
  buffer_load_dwordx4 v129, s[4:7], s70 offen lds
  v_lshrrev_b32 v2, 4, v0
  v_bfe_u32 v28, v0, 2, 2
  v_and_b32 v29, 3, v0
  v_lshl_add_u32 v30, v2, 2, v28
  v_bfe_u32 v31, v30, 1, 2
  v_xor_b32 v6, 0, v31
  v_lshlrev_b32 v6, 5, v6
  v_lshl_add_u32 v6, v30, 7, v6
  v_lshl_add_u32 v6, v29, 3, v6
  v_add_u32 v6, 65536, v6
  v_xor_b32 v7, 1, v31
  v_lshlrev_b32 v7, 5, v7
  v_lshl_add_u32 v7, v30, 7, v7
  v_lshl_add_u32 v7, v29, 3, v7
  v_add_u32 v7, 65536, v7
  v_xor_b32 v8, 2, v31
  v_lshlrev_b32 v8, 5, v8
  v_lshl_add_u32 v8, v30, 7, v8
  v_lshl_add_u32 v8, v29, 3, v8
  v_add_u32 v8, 65536, v8
  v_xor_b32 v9, 3, v31
  v_lshlrev_b32 v9, 5, v9
  v_lshl_add_u32 v9, v30, 7, v9
  v_lshl_add_u32 v9, v29, 3, v9
  v_add_u32 v9, 65536, v9
  v_lshl_add_u32 v30, v2, 3, v28
  v_lshrrev_b32 v31, 1, v28
  v_xor_b32 v22, 0, v31
  v_lshl_add_u32 v22, v22, 2, v29
  v_lshlrev_b32 v22, 4, v22
  v_lshl_add_u32 v22, v30, 7, v22
  v_add_u32 v24, 65536, v22
  v_add_u32 v26, 131072, v22
  v_xor_b32 v23, 1, v31
  v_lshl_add_u32 v23, v23, 2, v29
  v_lshlrev_b32 v23, 4, v23
  v_lshl_add_u32 v23, v30, 7, v23
  v_add_u32 v25, 65536, v23
  v_add_u32 v27, 131072, v23
  v_lshrrev_b32 v1, 3, v0
  v_and_b32 v2, 7, v0
  v_lshl_add_u32 v3, s32, 3, v1
  v_bfe_u32 v28, v3, 1, 3
  v_xor_b32 v28, v28, v2
  v_lshlrev_b32 v28, 4, v28
  v_lshl_add_u32 v10, v3, 9, v28
  v_bfe_u32 v28, v3, 1, 2
  v_lshlrev_b32 v28, 1, v28
  v_xor_b32 v28, v28, v2
  v_lshlrev_b32 v28, 4, v28
  v_lshl_add_u32 v11, v3, 9, v28
  s_lshl_b32 s67, s73, 4
  s_add_u32 s67, s67, s72
  s_lshl_b32 s67, s67, 19
  s_add_u32 s12, s38, s67
  s_addc_u32 s13, s39, 0
  s_mov_b32 s14, 524288
  s_mov_b32 s15, 0x20000
  s_add_u32 s16, s40, s67
  s_addc_u32 s17, s41, 0
  s_mov_b32 s18, 524288
  s_mov_b32 s19, 0x20000
  s_mul_i32 s67, s72, 229376
  s_add_u32 s20, s44, s67
  s_addc_u32 s21, s45, 0
  s_mov_b32 s22, 229376
  s_mov_b32 s23, 0x20000
  s_mov_b32 s24, s60
  s_mov_b32 s25, s61
  s_mov_b32 s26, 58720256
  s_mov_b32 s27, 0x20000
  s_mov_b32 s28, s56
  s_mov_b32 s29, s57
  s_mov_b32 s30, 3670016
  s_mov_b32 s31, 0x20000
  s_mov_b32 s40, s58
  s_mov_b32 s41, s59
  s_mov_b32 s42, 256
  s_mov_b32 s43, 0x20000
  s_mov_b32 s67, 58720256
  s_add_u32 s36, s60, s67
  s_addc_u32 s37, s61, 0
  s_mov_b32 s38, 32768
  s_mov_b32 s39, 0x20000
  s_mov_b32 s67, 59768832
  s_add_u32 s54, s60, s67
  s_addc_u32 s55, s61, 0
  s_mov_b32 s56, s54
  s_mov_b32 s57, s55
  s_mov_b32 s58, 33554432
  s_mov_b32 s59, 0x20000
  s_getreg_b32 s49, hwreg(HW_REG_XCC_ID, 0, 3)
  s_lshl_b32 s47, s71, 4
  s_add_u32 s47, s47, s72
  s_mul_i32 s67, s71, 896
  s_lshl_b32 s68, s32, 4
  s_add_u32 s68, s68, s72
  s_add_u32 s50, s67, s68
  s_lshl_b32 s68, s72, 2
  s_add_u32 s68, s68, s32
  s_add_u32 s51, s67, s68
  s_add_u32 s51, s51, 16384
  v_min_u32 v1, 13, v0
  v_lshlrev_b32 v1, 6, v1
  v_mov_b32 v2, 0
  buffer_store_byte v2, v1, s[36:39], s50 offen
  buffer_store_byte v2, v1, s[36:39], s51 offen
  v_mov_b32 v134, 0
  s_mul_i32 s50, s71, 1048576
  s_mul_i32 s51, s73, 458752
  buffer_load_dword v135, v134, s[12:15], 0 offen
  buffer_load_dword v136, v134, s[16:19], 0 offen
  buffer_load_dword v137, v134, s[20:23], 0 offen
  s_waitcnt vmcnt(5)
  ds_read_b128 v[64:67], v130 offset:0
  ds_read_b128 v[68:71], v130 offset:2048
  ds_read_b128 v[72:75], v130 offset:4096
  ds_read_b128 v[76:79], v130 offset:6144
  ds_read_b128 v[80:83], v131 offset:0
  ds_read_b128 v[84:87], v131 offset:2048
  ds_read_b128 v[88:91], v131 offset:4096
  ds_read_b128 v[92:95], v131 offset:6144
  s_waitcnt vmcnt(3)
  s_barrier
  s_or_b32 s67, s49, 0x80
  v_mov_b32 v1, s67
  v_mov_b32 v2, 0
  buffer_store_byte v1, v2, s[40:43], s47 offen
  ds_read_b64_tr_b16 v[32:33], v26 offset:0
  ds_read_b64_tr_b16 v[34:35], v26 offset:512
  ds_read_b64_tr_b16 v[36:37], v26 offset:8
  ds_read_b64_tr_b16 v[38:39], v26 offset:520
  ds_read_b64_tr_b16 v[40:41], v27 offset:0
  ds_read_b64_tr_b16 v[42:43], v27 offset:512
  s_waitcnt lgkmcnt(4)
  v_mfma_f32_16x16x32_bf16 a[0:3], v[32:35], v[64:67], 0
  s_add_u32 s35, s35, s75
  s_add_u32 s69, s35, 0
  s_add_u32 m0, s34, 0
  ds_read_b64_tr_b16 v[44:45], v27 offset:8
  v_mfma_f32_16x16x32_bf16 a[4:7], v[32:35], v[68:71], 0
  buffer_load_dwordx4 v128, s[4:7], s69 offen lds
  v_mfma_f32_16x16x32_bf16 a[8:11], v[32:35], v[72:75], 0
  s_add_u32 s70, s35, 7168
  s_add_u32 m0, s34, 1024
  ds_read_b64_tr_b16 v[46:47], v27 offset:520
  v_mfma_f32_16x16x32_bf16 a[12:15], v[32:35], v[76:79], 0
  s_waitcnt lgkmcnt(4)
  buffer_load_dwordx4 v129, s[4:7], s70 offen lds
  v_mfma_f32_16x16x32_bf16 a[16:19], v[36:39], v[64:67], 0
  s_add_u32 s69, s35, 14336
  s_add_u32 m0, s34, 2048
  ds_read_b64_tr_b16 v[48:49], v26 offset:4096
  v_mfma_f32_16x16x32_bf16 a[20:23], v[36:39], v[68:71], 0
  buffer_load_dwordx4 v128, s[4:7], s69 offen lds
  v_mfma_f32_16x16x32_bf16 a[24:27], v[36:39], v[72:75], 0
  s_add_u32 s70, s35, 21504
  s_add_u32 m0, s34, 3072
  ds_read_b64_tr_b16 v[50:51], v26 offset:4608
  v_mfma_f32_16x16x32_bf16 a[28:31], v[36:39], v[76:79], 0
  s_waitcnt lgkmcnt(4)
  buffer_load_dwordx4 v129, s[4:7], s70 offen lds
  v_mfma_f32_16x16x32_bf16 a[32:35], v[40:43], v[64:67], 0
  s_add_u32 s69, s35, 28672
  s_add_u32 m0, s34, 4096
  ds_read_b64_tr_b16 v[52:53], v26 offset:4104
  v_mfma_f32_16x16x32_bf16 a[36:39], v[40:43], v[68:71], 0
  buffer_load_dwordx4 v128, s[4:7], s69 offen lds
  v_mfma_f32_16x16x32_bf16 a[40:43], v[40:43], v[72:75], 0
  s_add_u32 s70, s35, 35840
  s_add_u32 m0, s34, 5120
  ds_read_b64_tr_b16 v[54:55], v26 offset:4616
  v_mfma_f32_16x16x32_bf16 a[44:47], v[40:43], v[76:79], 0
  s_waitcnt lgkmcnt(4)
  buffer_load_dwordx4 v129, s[4:7], s70 offen lds
  v_mfma_f32_16x16x32_bf16 a[48:51], v[44:47], v[64:67], 0
  s_add_u32 s69, s35, 43008
  s_add_u32 m0, s34, 6144
  ds_read_b64_tr_b16 v[56:57], v27 offset:4096
  v_mfma_f32_16x16x32_bf16 a[52:55], v[44:47], v[68:71], 0
  buffer_load_dwordx4 v128, s[4:7], s69 offen lds
  v_mfma_f32_16x16x32_bf16 a[56:59], v[44:47], v[72:75], 0
  s_add_u32 s70, s35, 50176
  s_add_u32 m0, s34, 7168
  ds_read_b64_tr_b16 v[58:59], v27 offset:4608
  v_mfma_f32_16x16x32_bf16 a[60:63], v[44:47], v[76:79], 0
  s_waitcnt lgkmcnt(4)
  buffer_load_dwordx4 v129, s[4:7], s70 offen lds
  v_mfma_f32_16x16x32_bf16 a[64:67], v[48:51], v[64:67], 0
  ds_read_b64_tr_b16 v[60:61], v27 offset:4104
  v_mfma_f32_16x16x32_bf16 a[68:71], v[48:51], v[68:71], 0
  s_add_u32 s78, s78, s79
  v_mfma_f32_16x16x32_bf16 a[72:75], v[48:51], v[72:75], 0
  s_add_u32 m0, s33, 81920
  ds_read_b64_tr_b16 v[62:63], v27 offset:4616
  v_mfma_f32_16x16x32_bf16 a[76:79], v[48:51], v[76:79], 0
  s_waitcnt lgkmcnt(4)
  buffer_load_dwordx4 v21, s[8:11], s78 offen lds
  v_mfma_f32_16x16x32_bf16 a[80:83], v[52:55], v[64:67], 0
  s_add_u32 m0, s33, 85888
  ds_read_b64_tr_b16 v[32:33], v26 offset:8192
  v_mfma_f32_16x16x32_bf16 a[84:87], v[52:55], v[68:71], 0
  buffer_load_dwordx4 v21, s[8:11], s78 offen offset:128 lds
  v_mfma_f32_16x16x32_bf16 a[88:91], v[52:55], v[72:75], 0
  s_add_u32 m0, s33, 89856
  ds_read_b64_tr_b16 v[34:35], v26 offset:8704
  v_mfma_f32_16x16x32_bf16 a[92:95], v[52:55], v[76:79], 0
  s_waitcnt lgkmcnt(4)
  buffer_load_dwordx4 v21, s[8:11], s78 offen offset:256 lds
  v_mfma_f32_16x16x32_bf16 a[96:99], v[56:59], v[64:67], 0
  s_add_u32 m0, s33, 93824
  ds_read_b64_tr_b16 v[36:37], v26 offset:8200
  v_mfma_f32_16x16x32_bf16 a[100:103], v[56:59], v[68:71], 0
  buffer_load_dwordx4 v21, s[8:11], s78 offen offset:384 lds
  v_mfma_f32_16x16x32_bf16 a[104:107], v[56:59], v[72:75], 0
  ds_read_b64_tr_b16 v[38:39], v26 offset:8712
  v_mfma_f32_16x16x32_bf16 a[108:111], v[56:59], v[76:79], 0
  s_waitcnt lgkmcnt(4)
  v_mfma_f32_16x16x32_bf16 a[112:115], v[60:63], v[64:67], 0
  ds_read_b64_tr_b16 v[40:41], v27 offset:8192
  v_mfma_f32_16x16x32_bf16 a[116:119], v[60:63], v[68:71], 0
  s_add_u32 s76, s78, 262144
  v_mfma_f32_16x16x32_bf16 a[120:123], v[60:63], v[72:75], 0
  s_add_u32 m0, s33, 49152
  ds_read_b64_tr_b16 v[42:43], v27 offset:8704
  v_mfma_f32_16x16x32_bf16 a[124:127], v[60:63], v[76:79], 0
  s_waitcnt lgkmcnt(4)
  buffer_load_dwordx4 v21, s[8:11], s76 offen lds
  v_mfma_f32_16x16x32_bf16 a[128:131], v[32:35], v[64:67], 0
  s_add_u32 m0, s33, 53120
  ds_read_b64_tr_b16 v[44:45], v27 offset:8200
  v_mfma_f32_16x16x32_bf16 a[132:135], v[32:35], v[68:71], 0
  buffer_load_dwordx4 v21, s[8:11], s76 offen offset:128 lds
  v_mfma_f32_16x16x32_bf16 a[136:139], v[32:35], v[72:75], 0
  s_add_u32 m0, s33, 57088
  ds_read_b64_tr_b16 v[46:47], v27 offset:8712
  v_mfma_f32_16x16x32_bf16 a[140:143], v[32:35], v[76:79], 0
  s_waitcnt lgkmcnt(4)
  buffer_load_dwordx4 v21, s[8:11], s76 offen offset:256 lds
  v_mfma_f32_16x16x32_bf16 a[144:147], v[36:39], v[64:67], 0
  s_add_u32 m0, s33, 61056
  ds_read_b64_tr_b16 v[48:49], v26 offset:12288
  v_mfma_f32_16x16x32_bf16 a[148:151], v[36:39], v[68:71], 0
  buffer_load_dwordx4 v21, s[8:11], s76 offen offset:384 lds
  v_mfma_f32_16x16x32_bf16 a[152:155], v[36:39], v[72:75], 0
  ds_read_b64_tr_b16 v[50:51], v26 offset:12800
  v_mfma_f32_16x16x32_bf16 a[156:159], v[36:39], v[76:79], 0
  s_waitcnt lgkmcnt(4)
  v_mfma_f32_16x16x32_bf16 a[160:163], v[40:43], v[64:67], 0
  ds_read_b64_tr_b16 v[52:53], v26 offset:12296
  v_mfma_f32_16x16x32_bf16 a[164:167], v[40:43], v[68:71], 0
  v_mfma_f32_16x16x32_bf16 a[168:171], v[40:43], v[72:75], 0
  ds_read_b64_tr_b16 v[54:55], v26 offset:12808
  v_mfma_f32_16x16x32_bf16 a[172:175], v[40:43], v[76:79], 0
  s_waitcnt lgkmcnt(4)
  v_mfma_f32_16x16x32_bf16 a[176:179], v[44:47], v[64:67], 0
  ds_read_b64_tr_b16 v[56:57], v27 offset:12288
  v_mfma_f32_16x16x32_bf16 a[180:183], v[44:47], v[68:71], 0
  v_mfma_f32_16x16x32_bf16 a[184:187], v[44:47], v[72:75], 0
  ds_read_b64_tr_b16 v[58:59], v27 offset:12800
  v_mfma_f32_16x16x32_bf16 a[188:191], v[44:47], v[76:79], 0
  s_waitcnt lgkmcnt(4)
  v_mfma_f32_16x16x32_bf16 a[192:195], v[48:51], v[64:67], 0
  s_waitcnt vmcnt(20)
  s_barrier
  ds_read_b64_tr_b16 v[60:61], v27 offset:12296
  v_mfma_f32_16x16x32_bf16 a[196:199], v[48:51], v[68:71], 0
  v_mfma_f32_16x16x32_bf16 a[200:203], v[48:51], v[72:75], 0
  ds_read_b64_tr_b16 v[62:63], v27 offset:12808
  v_mfma_f32_16x16x32_bf16 a[204:207], v[48:51], v[76:79], 0
  s_waitcnt lgkmcnt(4)
  v_mfma_f32_16x16x32_bf16 a[208:211], v[52:55], v[64:67], 0
  ds_read_b64_tr_b16 v[32:33], v26 offset:16384
  v_mfma_f32_16x16x32_bf16 a[212:215], v[52:55], v[68:71], 0
  v_mfma_f32_16x16x32_bf16 a[216:219], v[52:55], v[72:75], 0
  ds_read_b64_tr_b16 v[34:35], v26 offset:16896
  v_mfma_f32_16x16x32_bf16 a[220:223], v[52:55], v[76:79], 0
  s_waitcnt lgkmcnt(4)
  v_mfma_f32_16x16x32_bf16 a[224:227], v[56:59], v[64:67], 0
  ds_read_b64_tr_b16 v[36:37], v26 offset:16392
  v_mfma_f32_16x16x32_bf16 a[228:231], v[56:59], v[68:71], 0
  v_mfma_f32_16x16x32_bf16 a[232:235], v[56:59], v[72:75], 0
  ds_read_b64_tr_b16 v[38:39], v26 offset:16904
  v_mfma_f32_16x16x32_bf16 a[236:239], v[56:59], v[76:79], 0
  s_waitcnt lgkmcnt(4)
  v_mfma_f32_16x16x32_bf16 a[240:243], v[60:63], v[64:67], 0
  ds_read_b64_tr_b16 v[40:41], v27 offset:16384
  v_mfma_f32_16x16x32_bf16 a[244:247], v[60:63], v[68:71], 0
  v_mfma_f32_16x16x32_bf16 a[248:251], v[60:63], v[72:75], 0
  s_waitcnt vmcnt(8)
  ds_read_b64_tr_b16 v[42:43], v27 offset:16896
  v_mfma_f32_16x16x32_bf16 a[252:255], v[60:63], v[76:79], 0
  s_waitcnt lgkmcnt(4)
  v_mfma_f32_16x16x32_bf16 a[0:3], v[32:35], v[80:83], a[0:3]
  ds_read_b64_tr_b16 v[44:45], v27 offset:16392
  v_mfma_f32_16x16x32_bf16 a[4:7], v[32:35], v[84:87], a[4:7]
  ds_read_b128 v[96:99], v130 offset:0
  v_mfma_f32_16x16x32_bf16 a[8:11], v[32:35], v[88:91], a[8:11]
  ds_read_b64_tr_b16 v[46:47], v27 offset:16904
  v_mfma_f32_16x16x32_bf16 a[12:15], v[32:35], v[92:95], a[12:15]
  s_waitcnt lgkmcnt(5)
  ds_read_b128 v[100:103], v130 offset:2048
  v_mfma_f32_16x16x32_bf16 a[16:19], v[36:39], v[80:83], a[16:19]
  ds_read_b64_tr_b16 v[48:49], v26 offset:20480
  v_mfma_f32_16x16x32_bf16 a[20:23], v[36:39], v[84:87], a[20:23]
  ds_read_b128 v[104:107], v130 offset:4096
  v_mfma_f32_16x16x32_bf16 a[24:27], v[36:39], v[88:91], a[24:27]
  ds_read_b64_tr_b16 v[50:51], v26 offset:20992
  v_mfma_f32_16x16x32_bf16 a[28:31], v[36:39], v[92:95], a[28:31]
  s_waitcnt lgkmcnt(7)
  ds_read_b128 v[108:111], v130 offset:6144
  v_mfma_f32_16x16x32_bf16 a[32:35], v[40:43], v[80:83], a[32:35]
  ds_read_b64_tr_b16 v[52:53], v26 offset:20488
  v_mfma_f32_16x16x32_bf16 a[36:39], v[40:43], v[84:87], a[36:39]
  ds_read_b128 v[112:115], v131 offset:0
  v_mfma_f32_16x16x32_bf16 a[40:43], v[40:43], v[88:91], a[40:43]
  ds_read_b64_tr_b16 v[54:55], v26 offset:21000
  v_mfma_f32_16x16x32_bf16 a[44:47], v[40:43], v[92:95], a[44:47]
  s_waitcnt lgkmcnt(8)
  ds_read_b128 v[116:119], v131 offset:2048
  v_mfma_f32_16x16x32_bf16 a[48:51], v[44:47], v[80:83], a[48:51]
  ds_read_b64_tr_b16 v[56:57], v27 offset:20480
  v_mfma_f32_16x16x32_bf16 a[52:55], v[44:47], v[84:87], a[52:55]
  ds_read_b128 v[120:123], v131 offset:4096
  v_mfma_f32_16x16x32_bf16 a[56:59], v[44:47], v[88:91], a[56:59]
  ds_read_b64_tr_b16 v[58:59], v27 offset:20992
  v_mfma_f32_16x16x32_bf16 a[60:63], v[44:47], v[92:95], a[60:63]
  s_waitcnt lgkmcnt(8)
  ds_read_b128 v[124:127], v131 offset:6144
  v_mfma_f32_16x16x32_bf16 a[64:67], v[48:51], v[80:83], a[64:67]
  ds_read_b64_tr_b16 v[60:61], v27 offset:20488
  v_mfma_f32_16x16x32_bf16 a[68:71], v[48:51], v[84:87], a[68:71]
  v_mfma_f32_16x16x32_bf16 a[72:75], v[48:51], v[88:91], a[72:75]
  ds_read_b64_tr_b16 v[62:63], v27 offset:21000
  v_mfma_f32_16x16x32_bf16 a[76:79], v[48:51], v[92:95], a[76:79]
  s_waitcnt lgkmcnt(7)
  v_mfma_f32_16x16x32_bf16 a[80:83], v[52:55], v[80:83], a[80:83]
  ds_read_b64_tr_b16 v[32:33], v26 offset:24576
  v_mfma_f32_16x16x32_bf16 a[84:87], v[52:55], v[84:87], a[84:87]
  v_mfma_f32_16x16x32_bf16 a[88:91], v[52:55], v[88:91], a[88:91]
  ds_read_b64_tr_b16 v[34:35], v26 offset:25088
  v_mfma_f32_16x16x32_bf16 a[92:95], v[52:55], v[92:95], a[92:95]
  s_waitcnt lgkmcnt(5)
  v_mfma_f32_16x16x32_bf16 a[96:99], v[56:59], v[80:83], a[96:99]
  s_waitcnt lgkmcnt(4)
  ds_read_b64_tr_b16 v[36:37], v26 offset:24584
  v_mfma_f32_16x16x32_bf16 a[100:103], v[56:59], v[84:87], a[100:103]
  v_mfma_f32_16x16x32_bf16 a[104:107], v[56:59], v[88:91], a[104:107]
  s_add_u32 s35, s35, s75
  s_add_u32 s69, s35, 0
  s_add_u32 m0, s34, 0
  ds_read_b64_tr_b16 v[38:39], v26 offset:25096
  v_mfma_f32_16x16x32_bf16 a[108:111], v[56:59], v[92:95], a[108:111]
  s_waitcnt lgkmcnt(4)
  buffer_load_dwordx4 v128, s[4:7], s69 offen lds
  v_mfma_f32_16x16x32_bf16 a[112:115], v[60:63], v[80:83], a[112:115]
  s_add_u32 s70, s35, 7168
  s_add_u32 m0, s34, 1024
  ds_read_b64_tr_b16 v[40:41], v27 offset:24576
  v_mfma_f32_16x16x32_bf16 a[116:119], v[60:63], v[84:87], a[116:119]
  buffer_load_dwordx4 v129, s[4:7], s70 offen lds
  v_mfma_f32_16x16x32_bf16 a[120:123], v[60:63], v[88:91], a[120:123]
  s_add_u32 s69, s35, 14336
  s_add_u32 m0, s34, 2048
  ds_read_b64_tr_b16 v[42:43], v27 offset:25088
  v_mfma_f32_16x16x32_bf16 a[124:127], v[60:63], v[92:95], a[124:127]
  s_waitcnt lgkmcnt(4)
  buffer_load_dwordx4 v128, s[4:7], s69 offen lds
  v_mfma_f32_16x16x32_bf16 a[128:131], v[32:35], v[80:83], a[128:131]
  s_add_u32 s70, s35, 21504
  s_add_u32 m0, s34, 3072
  ds_read_b64_tr_b16 v[44:45], v27 offset:24584
  v_mfma_f32_16x16x32_bf16 a[132:135], v[32:35], v[84:87], a[132:135]
  buffer_load_dwordx4 v129, s[4:7], s70 offen lds
  v_mfma_f32_16x16x32_bf16 a[136:139], v[32:35], v[88:91], a[136:139]
  s_add_u32 s69, s35, 28672
  s_add_u32 m0, s34, 4096
  ds_read_b64_tr_b16 v[46:47], v27 offset:25096
  v_mfma_f32_16x16x32_bf16 a[140:143], v[32:35], v[92:95], a[140:143]
  s_waitcnt lgkmcnt(4)
  buffer_load_dwordx4 v128, s[4:7], s69 offen lds
  v_mfma_f32_16x16x32_bf16 a[144:147], v[36:39], v[80:83], a[144:147]
  s_waitcnt vmcnt(5)
  s_barrier
  ds_read_b64_tr_b16 v[48:49], v26 offset:28672
  v_mfma_f32_16x16x32_bf16 a[148:151], v[36:39], v[84:87], a[148:151]
  v_mfma_f32_16x16x32_bf16 a[152:155], v[36:39], v[88:91], a[152:155]
  s_add_u32 s70, s35, 35840
  s_add_u32 m0, s34, 5120
  ds_read_b64_tr_b16 v[50:51], v26 offset:29184
  v_mfma_f32_16x16x32_bf16 a[156:159], v[36:39], v[92:95], a[156:159]
  s_waitcnt lgkmcnt(4)
  buffer_load_dwordx4 v129, s[4:7], s70 offen lds
  v_mfma_f32_16x16x32_bf16 a[160:163], v[40:43], v[80:83], a[160:163]
  ds_read_b64_tr_b16 v[52:53], v26 offset:28680
  v_mfma_f32_16x16x32_bf16 a[164:167], v[40:43], v[84:87], a[164:167]
  ds_read_b64_tr_b16 v[32:33], v24 offset:16384
  v_mfma_f32_16x16x32_bf16 a[168:171], v[40:43], v[88:91], a[168:171]
  ds_read_b64_tr_b16 v[54:55], v26 offset:29192
  v_mfma_f32_16x16x32_bf16 a[172:175], v[40:43], v[92:95], a[172:175]
  s_waitcnt lgkmcnt(5)
  ds_read_b64_tr_b16 v[34:35], v24 offset:16896
  v_mfma_f32_16x16x32_bf16 a[176:179], v[44:47], v[80:83], a[176:179]
  ds_read_b64_tr_b16 v[56:57], v27 offset:28672
  v_mfma_f32_16x16x32_bf16 a[180:183], v[44:47], v[84:87], a[180:183]
  ds_read_b64_tr_b16 v[36:37], v22 offset:49152
  v_mfma_f32_16x16x32_bf16 a[184:187], v[44:47], v[88:91], a[184:187]
  ds_read_b64_tr_b16 v[58:59], v27 offset:29184
  v_mfma_f32_16x16x32_bf16 a[188:191], v[44:47], v[92:95], a[188:191]
  s_waitcnt lgkmcnt(7)
  ds_read_b64_tr_b16 v[38:39], v22 offset:49664
  v_mfma_f32_16x16x32_bf16 a[192:195], v[48:51], v[80:83], a[192:195]
  ds_read_b64_tr_b16 v[60:61], v27 offset:28680
  v_mfma_f32_16x16x32_bf16 a[196:199], v[48:51], v[84:87], a[196:199]
  ds_read_b64_tr_b16 v[40:41], v24 offset:16392
  v_mfma_f32_16x16x32_bf16 a[200:203], v[48:51], v[88:91], a[200:203]
  ds_read_b64_tr_b16 v[62:63], v27 offset:29192
  v_mfma_f32_16x16x32_bf16 a[204:207], v[48:51], v[92:95], a[204:207]
  s_waitcnt lgkmcnt(8)
  s_add_u32 s69, s35, 43008
  s_add_u32 m0, s34, 6144
  ds_read_b64_tr_b16 v[42:43], v24 offset:16904
  v_mfma_f32_16x16x32_bf16 a[208:211], v[52:55], v[80:83], a[208:211]
  buffer_load_dwordx4 v128, s[4:7], s69 offen lds
  v_mfma_f32_16x16x32_bf16 a[212:215], v[52:55], v[84:87], a[212:215]
  s_add_u32 s70, s35, 50176
  s_add_u32 m0, s34, 7168
  ds_read_b64_tr_b16 v[44:45], v22 offset:49160
  v_mfma_f32_16x16x32_bf16 a[216:219], v[52:55], v[88:91], a[216:219]
  buffer_load_dwordx4 v129, s[4:7], s70 offen lds
  v_mfma_f32_16x16x32_bf16 a[220:223], v[52:55], v[92:95], a[220:223]
  s_waitcnt lgkmcnt(6)
  ds_read_b64_tr_b16 v[46:47], v22 offset:49672
  v_mfma_f32_16x16x32_bf16 a[224:227], v[56:59], v[80:83], a[224:227]
  v_mfma_f32_16x16x32_bf16 a[228:231], v[56:59], v[84:87], a[228:231]
  ds_read_b64_tr_b16 v[48:49], v25 offset:16384
  v_mfma_f32_16x16x32_bf16 a[232:235], v[56:59], v[88:91], a[232:235]
  v_mfma_f32_16x16x32_bf16 a[236:239], v[56:59], v[92:95], a[236:239]
  s_waitcnt lgkmcnt(4)
  ds_read_b64_tr_b16 v[50:51], v25 offset:16896
  v_mfma_f32_16x16x32_bf16 a[240:243], v[60:63], v[80:83], a[240:243]
  v_mfma_f32_16x16x32_bf16 a[244:247], v[60:63], v[84:87], a[244:247]
  ds_read_b64_tr_b16 v[52:53], v23 offset:49152
  v_mfma_f32_16x16x32_bf16 a[248:251], v[60:63], v[88:91], a[248:251]
  v_mfma_f32_16x16x32_bf16 a[252:255], v[60:63], v[92:95], a[252:255]
  ds_read_b64_tr_b16 v[54:55], v23 offset:49664
  s_waitcnt lgkmcnt(8)
  v_mfma_f32_16x16x32_bf16 a[0:3], v[32:35], v[96:99], a[0:3]
  ds_read_b64_tr_b16 v[56:57], v25 offset:16392
  v_mfma_f32_16x16x32_bf16 a[0:3], v[36:39], v[112:115], a[0:3]
  s_add_u32 s78, s78, s79
  v_mfma_f32_16x16x32_bf16 a[4:7], v[32:35], v[100:103], a[4:7]
  s_add_u32 m0, s33, 98304
  ds_read_b64_tr_b16 v[58:59], v25 offset:16904
  v_mfma_f32_16x16x32_bf16 a[4:7], v[36:39], v[116:119], a[4:7]
  buffer_load_dwordx4 v21, s[8:11], s78 offen lds
  v_mfma_f32_16x16x32_bf16 a[8:11], v[32:35], v[104:107], a[8:11]
  s_add_u32 m0, s33, 102272
  ds_read_b64_tr_b16 v[60:61], v23 offset:49160
  v_mfma_f32_16x16x32_bf16 a[8:11], v[36:39], v[120:123], a[8:11]
  buffer_load_dwordx4 v21, s[8:11], s78 offen offset:128 lds
  v_mfma_f32_16x16x32_bf16 a[12:15], v[32:35], v[108:111], a[12:15]
  s_add_u32 m0, s33, 106240
  ds_read_b64_tr_b16 v[62:63], v23 offset:49672
  v_mfma_f32_16x16x32_bf16 a[12:15], v[36:39], v[124:127], a[12:15]
  s_waitcnt lgkmcnt(8)
  buffer_load_dwordx4 v21, s[8:11], s78 offen offset:256 lds
  v_mfma_f32_16x16x32_bf16 a[16:19], v[40:43], v[96:99], a[16:19]
  s_add_u32 m0, s33, 110208
  ds_read_b64_tr_b16 v[32:33], v24 offset:20480
  v_mfma_f32_16x16x32_bf16 a[16:19], v[44:47], v[112:115], a[16:19]
  buffer_load_dwordx4 v21, s[8:11], s78 offen offset:384 lds
  v_mfma_f32_16x16x32_bf16 a[20:23], v[40:43], v[100:103], a[20:23]
  ds_read_b64_tr_b16 v[34:35], v24 offset:20992
  v_mfma_f32_16x16x32_bf16 a[20:23], v[44:47], v[116:119], a[20:23]
  s_add_u32 s76, s78, 262144
  v_mfma_f32_16x16x32_bf16 a[24:27], v[40:43], v[104:107], a[24:27]
  s_add_u32 m0, s33, 114688
  ds_read_b64_tr_b16 v[36:37], v22 offset:53248
  v_mfma_f32_16x16x32_bf16 a[24:27], v[44:47], v[120:123], a[24:27]
  buffer_load_dwordx4 v21, s[8:11], s76 offen lds
  v_mfma_f32_16x16x32_bf16 a[28:31], v[40:43], v[108:111], a[28:31]
  s_add_u32 m0, s33, 118656
  ds_read_b64_tr_b16 v[38:39], v22 offset:53760
  v_mfma_f32_16x16x32_bf16 a[28:31], v[44:47], v[124:127], a[28:31]
  s_waitcnt lgkmcnt(8)
  buffer_load_dwordx4 v21, s[8:11], s76 offen offset:128 lds
  v_mfma_f32_16x16x32_bf16 a[32:35], v[48:51], v[96:99], a[32:35]
  s_add_u32 m0, s33, 122624
  ds_read_b64_tr_b16 v[40:41], v24 offset:20488
  v_mfma_f32_16x16x32_bf16 a[32:35], v[52:55], v[112:115], a[32:35]
  buffer_load_dwordx4 v21, s[8:11], s76 offen offset:256 lds
  v_mfma_f32_16x16x32_bf16 a[36:39], v[48:51], v[100:103], a[36:39]
  s_add_u32 m0, s33, 126592
  ds_read_b64_tr_b16 v[42:43], v24 offset:21000
  v_mfma_f32_16x16x32_bf16 a[36:39], v[52:55], v[116:119], a[36:39]
  buffer_load_dwordx4 v21, s[8:11], s76 offen offset:384 lds
  v_mfma_f32_16x16x32_bf16 a[40:43], v[48:51], v[104:107], a[40:43]
  ds_read_b64_tr_b16 v[44:45], v22 offset:53256
  v_mfma_f32_16x16x32_bf16 a[40:43], v[52:55], v[120:123], a[40:43]
  v_mfma_f32_16x16x32_bf16 a[44:47], v[48:51], v[108:111], a[44:47]
  ds_read_b64_tr_b16 v[46:47], v22 offset:53768
  v_mfma_f32_16x16x32_bf16 a[44:47], v[52:55], v[124:127], a[44:47]
  s_waitcnt lgkmcnt(8)
  v_mfma_f32_16x16x32_bf16 a[48:51], v[56:59], v[96:99], a[48:51]
  ds_read_b64_tr_b16 v[48:49], v25 offset:20480
  v_mfma_f32_16x16x32_bf16 a[48:51], v[60:63], v[112:115], a[48:51]
  v_mfma_f32_16x16x32_bf16 a[52:55], v[56:59], v[100:103], a[52:55]
  ds_read_b64_tr_b16 v[50:51], v25 offset:20992
  v_mfma_f32_16x16x32_bf16 a[52:55], v[60:63], v[116:119], a[52:55]
  v_mfma_f32_16x16x32_bf16 a[56:59], v[56:59], v[104:107], a[56:59]
  ds_read_b64_tr_b16 v[52:53], v23 offset:53248
  v_mfma_f32_16x16x32_bf16 a[56:59], v[60:63], v[120:123], a[56:59]
  v_mfma_f32_16x16x32_bf16 a[60:63], v[56:59], v[108:111], a[60:63]
  s_waitcnt vmcnt(8)
  ds_read_b64_tr_b16 v[54:55], v23 offset:53760
  v_mfma_f32_16x16x32_bf16 a[60:63], v[60:63], v[124:127], a[60:63]
  s_waitcnt lgkmcnt(8)
  v_mfma_f32_16x16x32_bf16 a[64:67], v[32:35], v[96:99], a[64:67]
  ds_read_b64_tr_b16 v[56:57], v25 offset:20488
  v_mfma_f32_16x16x32_bf16 a[64:67], v[36:39], v[112:115], a[64:67]
  ds_read_b128 v[64:67], v130 offset:0
  v_mfma_f32_16x16x32_bf16 a[68:71], v[32:35], v[100:103], a[68:71]
  ds_read_b64_tr_b16 v[58:59], v25 offset:21000
  v_mfma_f32_16x16x32_bf16 a[68:71], v[36:39], v[116:119], a[68:71]
  ds_read_b128 v[68:71], v130 offset:2048
  v_mfma_f32_16x16x32_bf16 a[72:75], v[32:35], v[104:107], a[72:75]
  ds_read_b64_tr_b16 v[60:61], v23 offset:53256
  v_mfma_f32_16x16x32_bf16 a[72:75], v[36:39], v[120:123], a[72:75]
  ds_read_b128 v[72:75], v130 offset:4096
  v_mfma_f32_16x16x32_bf16 a[76:79], v[32:35], v[108:111], a[76:79]
  s_waitcnt lgkmcnt(8)
  ds_read_b64_tr_b16 v[62:63], v23 offset:53768
  v_mfma_f32_16x16x32_bf16 a[76:79], v[36:39], v[124:127], a[76:79]
  s_waitcnt lgkmcnt(11)
  ds_read_b128 v[76:79], v130 offset:6144
  v_mfma_f32_16x16x32_bf16 a[80:83], v[40:43], v[96:99], a[80:83]
  ds_read_b64_tr_b16 v[32:33], v24 offset:24576
  v_mfma_f32_16x16x32_bf16 a[80:83], v[44:47], v[112:115], a[80:83]
  ds_read_b128 v[80:83], v131 offset:0
  v_mfma_f32_16x16x32_bf16 a[84:87], v[40:43], v[100:103], a[84:87]
  ds_read_b64_tr_b16 v[34:35], v24 offset:25088
  v_mfma_f32_16x16x32_bf16 a[84:87], v[44:47], v[116:119], a[84:87]
  ds_read_b128 v[84:87], v131 offset:2048
  v_mfma_f32_16x16x32_bf16 a[88:91], v[40:43], v[104:107], a[88:91]
  s_waitcnt lgkmcnt(8)
  ds_read_b64_tr_b16 v[36:37], v22 offset:57344
  v_mfma_f32_16x16x32_bf16 a[88:91], v[44:47], v[120:123], a[88:91]
  ds_read_b128 v[88:91], v131 offset:4096
  v_mfma_f32_16x16x32_bf16 a[92:95], v[40:43], v[108:111], a[92:95]
  ds_read_b64_tr_b16 v[38:39], v22 offset:57856
  v_mfma_f32_16x16x32_bf16 a[92:95], v[44:47], v[124:127], a[92:95]
  s_waitcnt lgkmcnt(15)
  ds_read_b128 v[92:95], v131 offset:6144
  v_mfma_f32_16x16x32_bf16 a[96:99], v[48:51], v[96:99], a[96:99]
  ds_read_b64_tr_b16 v[40:41], v24 offset:24584
  v_mfma_f32_16x16x32_bf16 a[96:99], v[52:55], v[112:115], a[96:99]
  v_mfma_f32_16x16x32_bf16 a[100:103], v[48:51], v[100:103], a[100:103]
  ds_read_b64_tr_b16 v[42:43], v24 offset:25096
  v_mfma_f32_16x16x32_bf16 a[100:103], v[52:55], v[116:119], a[100:103]
  v_mfma_f32_16x16x32_bf16 a[104:107], v[48:51], v[104:107], a[104:107]
  s_waitcnt lgkmcnt(8)
  ds_read_b64_tr_b16 v[44:45], v22 offset:57352
  v_mfma_f32_16x16x32_bf16 a[104:107], v[52:55], v[120:123], a[104:107]
  v_mfma_f32_16x16x32_bf16 a[108:111], v[48:51], v[108:111], a[108:111]
  ds_read_b64_tr_b16 v[46:47], v22 offset:57864
  v_mfma_f32_16x16x32_bf16 a[108:111], v[52:55], v[124:127], a[108:111]
  s_waitcnt lgkmcnt(13)
  v_mfma_f32_16x16x32_bf16 a[112:115], v[56:59], v[96:99], a[112:115]
  s_waitcnt lgkmcnt(4)
  ds_read_b64_tr_b16 v[48:49], v25 offset:24576
  v_mfma_f32_16x16x32_bf16 a[112:115], v[60:63], v[112:115], a[112:115]
  v_mfma_f32_16x16x32_bf16 a[116:119], v[56:59], v[100:103], a[116:119]
  s_add_u32 s35, s35, s75
  s_add_u32 s69, s35, 0
  s_add_u32 m0, s34, 0
  ds_read_b64_tr_b16 v[50:51], v25 offset:25088
  v_mfma_f32_16x16x32_bf16 a[116:119], v[60:63], v[116:119], a[116:119]
  buffer_load_dwordx4 v128, s[4:7], s69 offen lds
  v_mfma_f32_16x16x32_bf16 a[120:123], v[56:59], v[104:107], a[120:123]
  s_add_u32 s70, s35, 7168
  s_add_u32 m0, s34, 1024
  ds_read_b64_tr_b16 v[52:53], v23 offset:57344
  v_mfma_f32_16x16x32_bf16 a[120:123], v[60:63], v[120:123], a[120:123]
  buffer_load_dwordx4 v129, s[4:7], s70 offen lds
  v_mfma_f32_16x16x32_bf16 a[124:127], v[56:59], v[108:111], a[124:127]
  s_add_u32 s69, s35, 14336
  s_add_u32 m0, s34, 2048
  ds_read_b64_tr_b16 v[54:55], v23 offset:57856
  v_mfma_f32_16x16x32_bf16 a[124:127], v[60:63], v[124:127], a[124:127]
  s_waitcnt lgkmcnt(9)
  buffer_load_dwordx4 v128, s[4:7], s69 offen lds
  v_mfma_f32_16x16x32_bf16 a[128:131], v[32:35], v[96:99], a[128:131]
  s_add_u32 s70, s35, 21504
  s_add_u32 m0, s34, 3072
  ds_read_b64_tr_b16 v[56:57], v25 offset:24584
  v_mfma_f32_16x16x32_bf16 a[128:131], v[36:39], v[112:115], a[128:131]
  buffer_load_dwordx4 v129, s[4:7], s70 offen lds
  v_mfma_f32_16x16x32_bf16 a[132:135], v[32:35], v[100:103], a[132:135]
  s_add_u32 s69, s35, 28672
  s_add_u32 m0, s34, 4096
  ds_read_b64_tr_b16 v[58:59], v25 offset:25096
  v_mfma_f32_16x16x32_bf16 a[132:135], v[36:39], v[116:119], a[132:135]
  buffer_load_dwordx4 v128, s[4:7], s69 offen lds
  v_mfma_f32_16x16x32_bf16 a[136:139], v[32:35], v[104:107], a[136:139]
  s_add_u32 s70, s35, 35840
  s_add_u32 m0, s34, 5120
  ds_read_b64_tr_b16 v[60:61], v23 offset:57352
  v_mfma_f32_16x16x32_bf16 a[136:139], v[36:39], v[120:123], a[136:139]
  buffer_load_dwordx4 v129, s[4:7], s70 offen lds
  v_mfma_f32_16x16x32_bf16 a[140:143], v[32:35], v[108:111], a[140:143]
  s_add_u32 s69, s35, 43008
  s_add_u32 m0, s34, 6144
  ds_read_b64_tr_b16 v[62:63], v23 offset:57864
  v_mfma_f32_16x16x32_bf16 a[140:143], v[36:39], v[124:127], a[140:143]
  s_waitcnt lgkmcnt(8)
  buffer_load_dwordx4 v128, s[4:7], s69 offen lds
  v_mfma_f32_16x16x32_bf16 a[144:147], v[40:43], v[96:99], a[144:147]
  s_add_u32 s70, s35, 50176
  s_add_u32 m0, s34, 7168
  ds_read_b64_tr_b16 v[32:33], v24 offset:28672
  v_mfma_f32_16x16x32_bf16 a[144:147], v[44:47], v[112:115], a[144:147]
  buffer_load_dwordx4 v129, s[4:7], s70 offen lds
  v_mfma_f32_16x16x32_bf16 a[148:151], v[40:43], v[100:103], a[148:151]
  ds_read_b64_tr_b16 v[34:35], v24 offset:29184
  v_mfma_f32_16x16x32_bf16 a[148:151], v[44:47], v[116:119], a[148:151]
  v_mfma_f32_16x16x32_bf16 a[152:155], v[40:43], v[104:107], a[152:155]
  ds_read_b64_tr_b16 v[36:37], v22 offset:61440
  v_mfma_f32_16x16x32_bf16 a[152:155], v[44:47], v[120:123], a[152:155]
  v_mfma_f32_16x16x32_bf16 a[156:159], v[40:43], v[108:111], a[156:159]
  ds_read_b64_tr_b16 v[38:39], v22 offset:61952
  v_mfma_f32_16x16x32_bf16 a[156:159], v[44:47], v[124:127], a[156:159]
  s_waitcnt lgkmcnt(8)
  v_mfma_f32_16x16x32_bf16 a[160:163], v[48:51], v[96:99], a[160:163]
  ds_read_b64_tr_b16 v[40:41], v24 offset:28680
  v_mfma_f32_16x16x32_bf16 a[160:163], v[52:55], v[112:115], a[160:163]
  v_mfma_f32_16x16x32_bf16 a[164:167], v[48:51], v[100:103], a[164:167]
  ds_read_b64_tr_b16 v[42:43], v24 offset:29192
  v_mfma_f32_16x16x32_bf16 a[164:167], v[52:55], v[116:119], a[164:167]
  v_mfma_f32_16x16x32_bf16 a[168:171], v[48:51], v[104:107], a[168:171]
  ds_read_b64_tr_b16 v[44:45], v22 offset:61448
  v_mfma_f32_16x16x32_bf16 a[168:171], v[52:55], v[120:123], a[168:171]
  v_mfma_f32_16x16x32_bf16 a[172:175], v[48:51], v[108:111], a[172:175]
  ds_read_b64_tr_b16 v[46:47], v22 offset:61960
  v_mfma_f32_16x16x32_bf16 a[172:175], v[52:55], v[124:127], a[172:175]
  s_waitcnt lgkmcnt(8)
  v_mfma_f32_16x16x32_bf16 a[176:179], v[56:59], v[96:99], a[176:179]
  ds_read_b64_tr_b16 v[48:49], v25 offset:28672
  v_mfma_f32_16x16x32_bf16 a[176:179], v[60:63], v[112:115], a[176:179]
  v_mfma_f32_16x16x32_bf16 a[180:183], v[56:59], v[100:103], a[180:183]
  ds_read_b64_tr_b16 v[50:51], v25 offset:29184
  v_mfma_f32_16x16x32_bf16 a[180:183], v[60:63], v[116:119], a[180:183]
  v_mfma_f32_16x16x32_bf16 a[184:187], v[56:59], v[104:107], a[184:187]
  ds_read_b64_tr_b16 v[52:53], v23 offset:61440
  v_mfma_f32_16x16x32_bf16 a[184:187], v[60:63], v[120:123], a[184:187]
  v_mfma_f32_16x16x32_bf16 a[188:191], v[56:59], v[108:111], a[188:191]
  ds_read_b64_tr_b16 v[54:55], v23 offset:61952
  v_mfma_f32_16x16x32_bf16 a[188:191], v[60:63], v[124:127], a[188:191]
  s_waitcnt lgkmcnt(8)
  v_mfma_f32_16x16x32_bf16 a[192:195], v[32:35], v[96:99], a[192:195]
  ds_read_b64_tr_b16 v[56:57], v25 offset:28680
  v_mfma_f32_16x16x32_bf16 a[192:195], v[36:39], v[112:115], a[192:195]
  v_mfma_f32_16x16x32_bf16 a[196:199], v[32:35], v[100:103], a[196:199]
  ds_read_b64_tr_b16 v[58:59], v25 offset:29192
  v_mfma_f32_16x16x32_bf16 a[196:199], v[36:39], v[116:119], a[196:199]
  v_mfma_f32_16x16x32_bf16 a[200:203], v[32:35], v[104:107], a[200:203]
  s_waitcnt vmcnt(8)
  s_barrier
  ds_read_b64_tr_b16 v[60:61], v23 offset:61448
  v_mfma_f32_16x16x32_bf16 a[200:203], v[36:39], v[120:123], a[200:203]
  v_mfma_f32_16x16x32_bf16 a[204:207], v[32:35], v[108:111], a[204:207]
  s_add_u32 s78, s78, s79
  s_add_u32 m0, s33, 131072
  ds_read_b64_tr_b16 v[62:63], v23 offset:61960
  v_mfma_f32_16x16x32_bf16 a[204:207], v[36:39], v[124:127], a[204:207]
  s_waitcnt lgkmcnt(8)
  buffer_load_dwordx4 v21, s[8:11], s78 offen lds
  v_mfma_f32_16x16x32_bf16 a[208:211], v[40:43], v[96:99], a[208:211]
  s_add_u32 m0, s33, 135040
  ds_read_b64_tr_b16 v[32:33], v24 offset:32768
  v_mfma_f32_16x16x32_bf16 a[208:211], v[44:47], v[112:115], a[208:211]
  buffer_load_dwordx4 v21, s[8:11], s78 offen offset:128 lds
  v_mfma_f32_16x16x32_bf16 a[212:215], v[40:43], v[100:103], a[212:215]
  s_add_u32 m0, s33, 139008
  ds_read_b64_tr_b16 v[34:35], v24 offset:33280
  v_mfma_f32_16x16x32_bf16 a[212:215], v[44:47], v[116:119], a[212:215]
  buffer_load_dwordx4 v21, s[8:11], s78 offen offset:256 lds
  v_mfma_f32_16x16x32_bf16 a[216:219], v[40:43], v[104:107], a[216:219]
  s_add_u32 m0, s33, 142976
  ds_read_b64_tr_b16 v[36:37], v24 offset:49152
  v_mfma_f32_16x16x32_bf16 a[216:219], v[44:47], v[120:123], a[216:219]
  buffer_load_dwordx4 v21, s[8:11], s78 offen offset:384 lds
  v_mfma_f32_16x16x32_bf16 a[220:223], v[40:43], v[108:111], a[220:223]
  s_add_u32 s76, s78, 262144
  s_add_u32 m0, s33, 147456
  ds_read_b64_tr_b16 v[38:39], v24 offset:49664
  v_mfma_f32_16x16x32_bf16 a[220:223], v[44:47], v[124:127], a[220:223]
  s_waitcnt lgkmcnt(8)
  buffer_load_dwordx4 v21, s[8:11], s76 offen lds
  v_mfma_f32_16x16x32_bf16 a[224:227], v[48:51], v[96:99], a[224:227]
  s_add_u32 m0, s33, 151424
  ds_read_b64_tr_b16 v[40:41], v24 offset:32776
  v_mfma_f32_16x16x32_bf16 a[224:227], v[52:55], v[112:115], a[224:227]
  buffer_load_dwordx4 v21, s[8:11], s76 offen offset:128 lds
  v_mfma_f32_16x16x32_bf16 a[228:231], v[48:51], v[100:103], a[228:231]
  s_add_u32 m0, s33, 155392
  ds_read_b64_tr_b16 v[42:43], v24 offset:33288
  v_mfma_f32_16x16x32_bf16 a[228:231], v[52:55], v[116:119], a[228:231]
  buffer_load_dwordx4 v21, s[8:11], s76 offen offset:256 lds
  v_mfma_f32_16x16x32_bf16 a[232:235], v[48:51], v[104:107], a[232:235]
  s_add_u32 m0, s33, 159360
  ds_read_b64_tr_b16 v[44:45], v24 offset:49160
  v_mfma_f32_16x16x32_bf16 a[232:235], v[52:55], v[120:123], a[232:235]
  buffer_load_dwordx4 v21, s[8:11], s76 offen offset:384 lds
  v_mfma_f32_16x16x32_bf16 a[236:239], v[48:51], v[108:111], a[236:239]
  ds_read_b64_tr_b16 v[46:47], v24 offset:49672
  v_mfma_f32_16x16x32_bf16 a[236:239], v[52:55], v[124:127], a[236:239]
  s_waitcnt lgkmcnt(8)
  v_mfma_f32_16x16x32_bf16 a[240:243], v[56:59], v[96:99], a[240:243]
  ds_read_b64_tr_b16 v[48:49], v25 offset:32768
  v_mfma_f32_16x16x32_bf16 a[240:243], v[60:63], v[112:115], a[240:243]
  v_mfma_f32_16x16x32_bf16 a[244:247], v[56:59], v[100:103], a[244:247]
  ds_read_b64_tr_b16 v[50:51], v25 offset:33280
  v_mfma_f32_16x16x32_bf16 a[244:247], v[60:63], v[116:119], a[244:247]
  v_mfma_f32_16x16x32_bf16 a[248:251], v[56:59], v[104:107], a[248:251]
  ds_read_b64_tr_b16 v[52:53], v25 offset:49152
  v_mfma_f32_16x16x32_bf16 a[248:251], v[60:63], v[120:123], a[248:251]
  v_mfma_f32_16x16x32_bf16 a[252:255], v[56:59], v[108:111], a[252:255]
  ds_read_b64_tr_b16 v[54:55], v25 offset:49664
  v_mfma_f32_16x16x32_bf16 a[252:255], v[60:63], v[124:127], a[252:255]
  s_waitcnt lgkmcnt(8)
  v_mfma_f32_16x16x32_bf16 a[0:3], v[32:35], v[64:67], a[0:3]
  ds_read_b64_tr_b16 v[56:57], v25 offset:32776
  v_mfma_f32_16x16x32_bf16 a[0:3], v[36:39], v[80:83], a[0:3]
  v_mfma_f32_16x16x32_bf16 a[4:7], v[32:35], v[68:71], a[4:7]
  ds_read_b64_tr_b16 v[58:59], v25 offset:33288
  v_mfma_f32_16x16x32_bf16 a[4:7], v[36:39], v[84:87], a[4:7]
  v_mfma_f32_16x16x32_bf16 a[8:11], v[32:35], v[72:75], a[8:11]
  ds_read_b64_tr_b16 v[60:61], v25 offset:49160
  v_mfma_f32_16x16x32_bf16 a[8:11], v[36:39], v[88:91], a[8:11]
  v_mfma_f32_16x16x32_bf16 a[12:15], v[32:35], v[76:79], a[12:15]
  ds_read_b64_tr_b16 v[62:63], v25 offset:49672
  v_mfma_f32_16x16x32_bf16 a[12:15], v[36:39], v[92:95], a[12:15]
  s_waitcnt lgkmcnt(8)
  v_mfma_f32_16x16x32_bf16 a[16:19], v[40:43], v[64:67], a[16:19]
  ds_read_b64_tr_b16 v[32:33], v24 offset:36864
  v_mfma_f32_16x16x32_bf16 a[16:19], v[44:47], v[80:83], a[16:19]
  v_mfma_f32_16x16x32_bf16 a[20:23], v[40:43], v[68:71], a[20:23]
  ds_read_b64_tr_b16 v[34:35], v24 offset:37376
  v_mfma_f32_16x16x32_bf16 a[20:23], v[44:47], v[84:87], a[20:23]
  v_mfma_f32_16x16x32_bf16 a[24:27], v[40:43], v[72:75], a[24:27]
  ds_read_b64_tr_b16 v[36:37], v24 offset:53248
  v_mfma_f32_16x16x32_bf16 a[24:27], v[44:47], v[88:91], a[24:27]
  v_mfma_f32_16x16x32_bf16 a[28:31], v[40:43], v[76:79], a[28:31]
  ds_read_b64_tr_b16 v[38:39], v24 offset:53760
  v_mfma_f32_16x16x32_bf16 a[28:31], v[44:47], v[92:95], a[28:31]
  s_waitcnt lgkmcnt(8)
  v_mfma_f32_16x16x32_bf16 a[32:35], v[48:51], v[64:67], a[32:35]
  ds_read_b64_tr_b16 v[40:41], v24 offset:36872
  v_mfma_f32_16x16x32_bf16 a[32:35], v[52:55], v[80:83], a[32:35]
  v_mfma_f32_16x16x32_bf16 a[36:39], v[48:51], v[68:71], a[36:39]
  ds_read_b64_tr_b16 v[42:43], v24 offset:37384
  v_mfma_f32_16x16x32_bf16 a[36:39], v[52:55], v[84:87], a[36:39]
  v_mfma_f32_16x16x32_bf16 a[40:43], v[48:51], v[72:75], a[40:43]
  ds_read_b64_tr_b16 v[44:45], v24 offset:53256
  v_mfma_f32_16x16x32_bf16 a[40:43], v[52:55], v[88:91], a[40:43]
  v_mfma_f32_16x16x32_bf16 a[44:47], v[48:51], v[76:79], a[44:47]
  ds_read_b64_tr_b16 v[46:47], v24 offset:53768
  v_mfma_f32_16x16x32_bf16 a[44:47], v[52:55], v[92:95], a[44:47]
  s_waitcnt lgkmcnt(8)
  v_mfma_f32_16x16x32_bf16 a[48:51], v[56:59], v[64:67], a[48:51]
  ds_read_b64_tr_b16 v[48:49], v25 offset:36864
  v_mfma_f32_16x16x32_bf16 a[48:51], v[60:63], v[80:83], a[48:51]
  v_mfma_f32_16x16x32_bf16 a[52:55], v[56:59], v[68:71], a[52:55]
  ds_read_b64_tr_b16 v[50:51], v25 offset:37376
  v_mfma_f32_16x16x32_bf16 a[52:55], v[60:63], v[84:87], a[52:55]
  v_mfma_f32_16x16x32_bf16 a[56:59], v[56:59], v[72:75], a[56:59]
  ds_read_b64_tr_b16 v[52:53], v25 offset:53248
  v_mfma_f32_16x16x32_bf16 a[56:59], v[60:63], v[88:91], a[56:59]
  v_mfma_f32_16x16x32_bf16 a[60:63], v[56:59], v[76:79], a[60:63]
  s_waitcnt vmcnt(8)
  ds_read_b64_tr_b16 v[54:55], v25 offset:53760
  v_mfma_f32_16x16x32_bf16 a[60:63], v[60:63], v[92:95], a[60:63]
  s_waitcnt lgkmcnt(8)
  v_mfma_f32_16x16x32_bf16 a[64:67], v[32:35], v[64:67], a[64:67]
  ds_read_b64_tr_b16 v[56:57], v25 offset:36872
  v_mfma_f32_16x16x32_bf16 a[64:67], v[36:39], v[80:83], a[64:67]
  ds_read_b128 v[96:99], v130 offset:0
  v_mfma_f32_16x16x32_bf16 a[68:71], v[32:35], v[68:71], a[68:71]
  ds_read_b64_tr_b16 v[58:59], v25 offset:37384
  v_mfma_f32_16x16x32_bf16 a[68:71], v[36:39], v[84:87], a[68:71]
  ds_read_b128 v[100:103], v130 offset:2048
  v_mfma_f32_16x16x32_bf16 a[72:75], v[32:35], v[72:75], a[72:75]
  ds_read_b64_tr_b16 v[60:61], v25 offset:53256
  v_mfma_f32_16x16x32_bf16 a[72:75], v[36:39], v[88:91], a[72:75]
  ds_read_b128 v[104:107], v130 offset:4096
  v_mfma_f32_16x16x32_bf16 a[76:79], v[32:35], v[76:79], a[76:79]
  s_waitcnt lgkmcnt(8)
  ds_read_b64_tr_b16 v[62:63], v25 offset:53768
  v_mfma_f32_16x16x32_bf16 a[76:79], v[36:39], v[92:95], a[76:79]
  s_waitcnt lgkmcnt(11)
  ds_read_b128 v[108:111], v130 offset:6144
  v_mfma_f32_16x16x32_bf16 a[80:83], v[40:43], v[64:67], a[80:83]
  ds_read_b64_tr_b16 v[32:33], v24 offset:40960
  v_mfma_f32_16x16x32_bf16 a[80:83], v[44:47], v[80:83], a[80:83]
  ds_read_b128 v[112:115], v131 offset:0
  v_mfma_f32_16x16x32_bf16 a[84:87], v[40:43], v[68:71], a[84:87]
  ds_read_b64_tr_b16 v[34:35], v24 offset:41472
  v_mfma_f32_16x16x32_bf16 a[84:87], v[44:47], v[84:87], a[84:87]
  ds_read_b128 v[116:119], v131 offset:2048
  v_mfma_f32_16x16x32_bf16 a[88:91], v[40:43], v[72:75], a[88:91]
  s_waitcnt lgkmcnt(8)
  ds_read_b64_tr_b16 v[36:37], v24 offset:57344
  v_mfma_f32_16x16x32_bf16 a[88:91], v[44:47], v[88:91], a[88:91]
  ds_read_b128 v[120:123], v131 offset:4096
  v_mfma_f32_16x16x32_bf16 a[92:95], v[40:43], v[76:79], a[92:95]
  ds_read_b64_tr_b16 v[38:39], v24 offset:57856
  v_mfma_f32_16x16x32_bf16 a[92:95], v[44:47], v[92:95], a[92:95]
  s_waitcnt lgkmcnt(15)
  ds_read_b128 v[124:127], v131 offset:6144
  v_mfma_f32_16x16x32_bf16 a[96:99], v[48:51], v[64:67], a[96:99]
  ds_read_b64_tr_b16 v[40:41], v24 offset:40968
  v_mfma_f32_16x16x32_bf16 a[96:99], v[52:55], v[80:83], a[96:99]
  v_mfma_f32_16x16x32_bf16 a[100:103], v[48:51], v[68:71], a[100:103]
  ds_read_b64_tr_b16 v[42:43], v24 offset:41480
  v_mfma_f32_16x16x32_bf16 a[100:103], v[52:55], v[84:87], a[100:103]
  v_mfma_f32_16x16x32_bf16 a[104:107], v[48:51], v[72:75], a[104:107]
  s_waitcnt lgkmcnt(8)
  ds_read_b64_tr_b16 v[44:45], v24 offset:57352
  v_mfma_f32_16x16x32_bf16 a[104:107], v[52:55], v[88:91], a[104:107]
  v_mfma_f32_16x16x32_bf16 a[108:111], v[48:51], v[76:79], a[108:111]
  ds_read_b64_tr_b16 v[46:47], v24 offset:57864
  v_mfma_f32_16x16x32_bf16 a[108:111], v[52:55], v[92:95], a[108:111]
  s_waitcnt lgkmcnt(13)
  v_mfma_f32_16x16x32_bf16 a[112:115], v[56:59], v[64:67], a[112:115]
  s_waitcnt lgkmcnt(4)
  ds_read_b64_tr_b16 v[48:49], v25 offset:40960
  v_mfma_f32_16x16x32_bf16 a[112:115], v[60:63], v[80:83], a[112:115]
  v_mfma_f32_16x16x32_bf16 a[116:119], v[56:59], v[68:71], a[116:119]
  s_add_u32 s35, s35, s75
  s_add_u32 s69, s35, 0
  s_add_u32 m0, s34, 0
  ds_read_b64_tr_b16 v[50:51], v25 offset:41472
  v_mfma_f32_16x16x32_bf16 a[116:119], v[60:63], v[84:87], a[116:119]
  buffer_load_dwordx4 v128, s[4:7], s69 offen lds
  v_mfma_f32_16x16x32_bf16 a[120:123], v[56:59], v[72:75], a[120:123]
  s_add_u32 s70, s35, 7168
  s_add_u32 m0, s34, 1024
  ds_read_b64_tr_b16 v[52:53], v25 offset:57344
  v_mfma_f32_16x16x32_bf16 a[120:123], v[60:63], v[88:91], a[120:123]
  buffer_load_dwordx4 v129, s[4:7], s70 offen lds
  v_mfma_f32_16x16x32_bf16 a[124:127], v[56:59], v[76:79], a[124:127]
  s_add_u32 s69, s35, 14336
  s_add_u32 m0, s34, 2048
  ds_read_b64_tr_b16 v[54:55], v25 offset:57856
  v_mfma_f32_16x16x32_bf16 a[124:127], v[60:63], v[92:95], a[124:127]
  s_waitcnt lgkmcnt(9)
  buffer_load_dwordx4 v128, s[4:7], s69 offen lds
  v_mfma_f32_16x16x32_bf16 a[128:131], v[32:35], v[64:67], a[128:131]
  s_add_u32 s70, s35, 21504
  s_add_u32 m0, s34, 3072
  ds_read_b64_tr_b16 v[56:57], v25 offset:40968
  v_mfma_f32_16x16x32_bf16 a[128:131], v[36:39], v[80:83], a[128:131]
  buffer_load_dwordx4 v129, s[4:7], s70 offen lds
  v_mfma_f32_16x16x32_bf16 a[132:135], v[32:35], v[68:71], a[132:135]
  s_add_u32 s69, s35, 28672
  s_add_u32 m0, s34, 4096
  ds_read_b64_tr_b16 v[58:59], v25 offset:41480
  v_mfma_f32_16x16x32_bf16 a[132:135], v[36:39], v[84:87], a[132:135]
  buffer_load_dwordx4 v128, s[4:7], s69 offen lds
  v_mfma_f32_16x16x32_bf16 a[136:139], v[32:35], v[72:75], a[136:139]
  s_add_u32 s70, s35, 35840
  s_add_u32 m0, s34, 5120
  ds_read_b64_tr_b16 v[60:61], v25 offset:57352
  v_mfma_f32_16x16x32_bf16 a[136:139], v[36:39], v[88:91], a[136:139]
  buffer_load_dwordx4 v129, s[4:7], s70 offen lds
  v_mfma_f32_16x16x32_bf16 a[140:143], v[32:35], v[76:79], a[140:143]
  s_add_u32 s69, s35, 43008
  s_add_u32 m0, s34, 6144
  ds_read_b64_tr_b16 v[62:63], v25 offset:57864
  v_mfma_f32_16x16x32_bf16 a[140:143], v[36:39], v[92:95], a[140:143]
  s_waitcnt lgkmcnt(8)
  buffer_load_dwordx4 v128, s[4:7], s69 offen lds
  v_mfma_f32_16x16x32_bf16 a[144:147], v[40:43], v[64:67], a[144:147]
  s_add_u32 s70, s35, 50176
  s_add_u32 m0, s34, 7168
  ds_read_b64_tr_b16 v[32:33], v24 offset:45056
  v_mfma_f32_16x16x32_bf16 a[144:147], v[44:47], v[80:83], a[144:147]
  buffer_load_dwordx4 v129, s[4:7], s70 offen lds
  v_mfma_f32_16x16x32_bf16 a[148:151], v[40:43], v[68:71], a[148:151]
  ds_read_b64_tr_b16 v[34:35], v24 offset:45568
  v_mfma_f32_16x16x32_bf16 a[148:151], v[44:47], v[84:87], a[148:151]
  v_mfma_f32_16x16x32_bf16 a[152:155], v[40:43], v[72:75], a[152:155]
  ds_read_b64_tr_b16 v[36:37], v24 offset:61440
  v_mfma_f32_16x16x32_bf16 a[152:155], v[44:47], v[88:91], a[152:155]
  v_mfma_f32_16x16x32_bf16 a[156:159], v[40:43], v[76:79], a[156:159]
  ds_read_b64_tr_b16 v[38:39], v24 offset:61952
  v_mfma_f32_16x16x32_bf16 a[156:159], v[44:47], v[92:95], a[156:159]
  s_waitcnt lgkmcnt(8)
  v_mfma_f32_16x16x32_bf16 a[160:163], v[48:51], v[64:67], a[160:163]
  ds_read_b64_tr_b16 v[40:41], v24 offset:45064
  v_mfma_f32_16x16x32_bf16 a[160:163], v[52:55], v[80:83], a[160:163]
  v_mfma_f32_16x16x32_bf16 a[164:167], v[48:51], v[68:71], a[164:167]
  ds_read_b64_tr_b16 v[42:43], v24 offset:45576
  v_mfma_f32_16x16x32_bf16 a[164:167], v[52:55], v[84:87], a[164:167]
  v_mfma_f32_16x16x32_bf16 a[168:171], v[48:51], v[72:75], a[168:171]
  ds_read_b64_tr_b16 v[44:45], v24 offset:61448
  v_mfma_f32_16x16x32_bf16 a[168:171], v[52:55], v[88:91], a[168:171]
  v_mfma_f32_16x16x32_bf16 a[172:175], v[48:51], v[76:79], a[172:175]
  ds_read_b64_tr_b16 v[46:47], v24 offset:61960
  v_mfma_f32_16x16x32_bf16 a[172:175], v[52:55], v[92:95], a[172:175]
  s_waitcnt lgkmcnt(8)
  v_mfma_f32_16x16x32_bf16 a[176:179], v[56:59], v[64:67], a[176:179]
  ds_read_b64_tr_b16 v[48:49], v25 offset:45056
  v_mfma_f32_16x16x32_bf16 a[176:179], v[60:63], v[80:83], a[176:179]
  v_mfma_f32_16x16x32_bf16 a[180:183], v[56:59], v[68:71], a[180:183]
  ds_read_b64_tr_b16 v[50:51], v25 offset:45568
  v_mfma_f32_16x16x32_bf16 a[180:183], v[60:63], v[84:87], a[180:183]
  v_mfma_f32_16x16x32_bf16 a[184:187], v[56:59], v[72:75], a[184:187]
  ds_read_b64_tr_b16 v[52:53], v25 offset:61440
  v_mfma_f32_16x16x32_bf16 a[184:187], v[60:63], v[88:91], a[184:187]
  v_mfma_f32_16x16x32_bf16 a[188:191], v[56:59], v[76:79], a[188:191]
  ds_read_b64_tr_b16 v[54:55], v25 offset:61952
  v_mfma_f32_16x16x32_bf16 a[188:191], v[60:63], v[92:95], a[188:191]
  s_waitcnt lgkmcnt(8)
  v_mfma_f32_16x16x32_bf16 a[192:195], v[32:35], v[64:67], a[192:195]
  ds_read_b64_tr_b16 v[56:57], v25 offset:45064
  v_mfma_f32_16x16x32_bf16 a[192:195], v[36:39], v[80:83], a[192:195]
  v_mfma_f32_16x16x32_bf16 a[196:199], v[32:35], v[68:71], a[196:199]
  ds_read_b64_tr_b16 v[58:59], v25 offset:45576
  v_mfma_f32_16x16x32_bf16 a[196:199], v[36:39], v[84:87], a[196:199]
  v_mfma_f32_16x16x32_bf16 a[200:203], v[32:35], v[72:75], a[200:203]
  s_waitcnt vmcnt(8)
  s_barrier
  ds_read_b64_tr_b16 v[60:61], v25 offset:61448
  v_mfma_f32_16x16x32_bf16 a[200:203], v[36:39], v[88:91], a[200:203]
  v_mfma_f32_16x16x32_bf16 a[204:207], v[32:35], v[76:79], a[204:207]
  s_add_u32 s78, s78, s79
  s_add_u32 m0, s33, 81920
  ds_read_b64_tr_b16 v[62:63], v25 offset:61960
  v_mfma_f32_16x16x32_bf16 a[204:207], v[36:39], v[92:95], a[204:207]
  s_waitcnt lgkmcnt(8)
  buffer_load_dwordx4 v21, s[8:11], s78 offen lds
  v_mfma_f32_16x16x32_bf16 a[208:211], v[40:43], v[64:67], a[208:211]
  s_add_u32 m0, s33, 85888
  ds_read_b64_tr_b16 v[32:33], v26 offset:0
  v_mfma_f32_16x16x32_bf16 a[208:211], v[44:47], v[80:83], a[208:211]
  buffer_load_dwordx4 v21, s[8:11], s78 offen offset:128 lds
  v_mfma_f32_16x16x32_bf16 a[212:215], v[40:43], v[68:71], a[212:215]
  s_add_u32 m0, s33, 89856
  ds_read_b64_tr_b16 v[34:35], v26 offset:512
  v_mfma_f32_16x16x32_bf16 a[212:215], v[44:47], v[84:87], a[212:215]
  buffer_load_dwordx4 v21, s[8:11], s78 offen offset:256 lds
  v_mfma_f32_16x16x32_bf16 a[216:219], v[40:43], v[72:75], a[216:219]
  s_add_u32 m0, s33, 93824
  ds_read_b64_tr_b16 v[36:37], v26 offset:16384
  v_mfma_f32_16x16x32_bf16 a[216:219], v[44:47], v[88:91], a[216:219]
  buffer_load_dwordx4 v21, s[8:11], s78 offen offset:384 lds
  v_mfma_f32_16x16x32_bf16 a[220:223], v[40:43], v[76:79], a[220:223]
  s_add_u32 s76, s78, 262144
  s_add_u32 m0, s33, 49152
  ds_read_b64_tr_b16 v[38:39], v26 offset:16896
  v_mfma_f32_16x16x32_bf16 a[220:223], v[44:47], v[92:95], a[220:223]
  s_waitcnt lgkmcnt(8)
  buffer_load_dwordx4 v21, s[8:11], s76 offen lds
  v_mfma_f32_16x16x32_bf16 a[224:227], v[48:51], v[64:67], a[224:227]
  s_add_u32 m0, s33, 53120
  ds_read_b64_tr_b16 v[40:41], v26 offset:8
  v_mfma_f32_16x16x32_bf16 a[224:227], v[52:55], v[80:83], a[224:227]
  buffer_load_dwordx4 v21, s[8:11], s76 offen offset:128 lds
  v_mfma_f32_16x16x32_bf16 a[228:231], v[48:51], v[68:71], a[228:231]
  s_add_u32 m0, s33, 57088
  ds_read_b64_tr_b16 v[42:43], v26 offset:520
  v_mfma_f32_16x16x32_bf16 a[228:231], v[52:55], v[84:87], a[228:231]
  buffer_load_dwordx4 v21, s[8:11], s76 offen offset:256 lds
  v_mfma_f32_16x16x32_bf16 a[232:235], v[48:51], v[72:75], a[232:235]
  s_add_u32 m0, s33, 61056
  ds_read_b64_tr_b16 v[44:45], v26 offset:16392
  v_mfma_f32_16x16x32_bf16 a[232:235], v[52:55], v[88:91], a[232:235]
  buffer_load_dwordx4 v21, s[8:11], s76 offen offset:384 lds
  v_mfma_f32_16x16x32_bf16 a[236:239], v[48:51], v[76:79], a[236:239]
  ds_read_b64_tr_b16 v[46:47], v26 offset:16904
  v_mfma_f32_16x16x32_bf16 a[236:239], v[52:55], v[92:95], a[236:239]
  s_waitcnt lgkmcnt(8)
  v_mfma_f32_16x16x32_bf16 a[240:243], v[56:59], v[64:67], a[240:243]
  ds_read_b64_tr_b16 v[48:49], v27 offset:0
  v_mfma_f32_16x16x32_bf16 a[240:243], v[60:63], v[80:83], a[240:243]
  v_mfma_f32_16x16x32_bf16 a[244:247], v[56:59], v[68:71], a[244:247]
  ds_read_b64_tr_b16 v[50:51], v27 offset:512
  v_mfma_f32_16x16x32_bf16 a[244:247], v[60:63], v[84:87], a[244:247]
  v_mfma_f32_16x16x32_bf16 a[248:251], v[56:59], v[72:75], a[248:251]
  ds_read_b64_tr_b16 v[52:53], v27 offset:16384
  v_mfma_f32_16x16x32_bf16 a[248:251], v[60:63], v[88:91], a[248:251]
  v_mfma_f32_16x16x32_bf16 a[252:255], v[56:59], v[76:79], a[252:255]
  ds_read_b64_tr_b16 v[54:55], v27 offset:16896
  v_mfma_f32_16x16x32_bf16 a[252:255], v[60:63], v[92:95], a[252:255]
  s_waitcnt lgkmcnt(8)
  v_mfma_f32_16x16x32_bf16 a[0:3], v[32:35], v[96:99], a[0:3]
  ds_read_b64_tr_b16 v[56:57], v27 offset:8
  v_mfma_f32_16x16x32_bf16 a[0:3], v[36:39], v[112:115], a[0:3]
  s_mov_b32 s67, 0
  v_mfma_f32_16x16x32_bf16 a[4:7], v[32:35], v[100:103], a[4:7]
  s_add_u32 m0, s33, 0
  ds_read_b64_tr_b16 v[58:59], v27 offset:520
  v_mfma_f32_16x16x32_bf16 a[4:7], v[36:39], v[116:119], a[4:7]
  buffer_load_dwordx4 v10, s[12:15], s67 offen nt lds
  v_mfma_f32_16x16x32_bf16 a[8:11], v[32:35], v[104:107], a[8:11]
  s_add_u32 m0, s33, 3968
  ds_read_b64_tr_b16 v[60:61], v27 offset:16392
  v_mfma_f32_16x16x32_bf16 a[8:11], v[36:39], v[120:123], a[8:11]
  buffer_load_dwordx4 v10, s[12:15], s67 offen offset:128 nt lds
  v_mfma_f32_16x16x32_bf16 a[12:15], v[32:35], v[108:111], a[12:15]
  s_add_u32 m0, s33, 7936
  ds_read_b64_tr_b16 v[62:63], v27 offset:16904
  v_mfma_f32_16x16x32_bf16 a[12:15], v[36:39], v[124:127], a[12:15]
  s_waitcnt lgkmcnt(8)
  buffer_load_dwordx4 v10, s[12:15], s67 offen offset:256 nt lds
  v_mfma_f32_16x16x32_bf16 a[16:19], v[40:43], v[96:99], a[16:19]
  s_add_u32 m0, s33, 11904
  ds_read_b64_tr_b16 v[32:33], v26 offset:4096
  v_mfma_f32_16x16x32_bf16 a[16:19], v[44:47], v[112:115], a[16:19]
  buffer_load_dwordx4 v10, s[12:15], s67 offen offset:384 nt lds
  v_mfma_f32_16x16x32_bf16 a[20:23], v[40:43], v[100:103], a[20:23]
  ds_read_b64_tr_b16 v[34:35], v26 offset:4608
  v_mfma_f32_16x16x32_bf16 a[20:23], v[44:47], v[116:119], a[20:23]
  v_mfma_f32_16x16x32_bf16 a[24:27], v[40:43], v[104:107], a[24:27]
  ds_read_b64_tr_b16 v[36:37], v26 offset:20480
  v_mfma_f32_16x16x32_bf16 a[24:27], v[44:47], v[120:123], a[24:27]
  v_mfma_f32_16x16x32_bf16 a[28:31], v[40:43], v[108:111], a[28:31]
  ds_read_b64_tr_b16 v[38:39], v26 offset:20992
  v_mfma_f32_16x16x32_bf16 a[28:31], v[44:47], v[124:127], a[28:31]
  s_waitcnt lgkmcnt(8)
  v_mfma_f32_16x16x32_bf16 a[32:35], v[48:51], v[96:99], a[32:35]
  ds_read_b64_tr_b16 v[40:41], v26 offset:4104
  v_mfma_f32_16x16x32_bf16 a[32:35], v[52:55], v[112:115], a[32:35]
  v_mfma_f32_16x16x32_bf16 a[36:39], v[48:51], v[100:103], a[36:39]
  ds_read_b64_tr_b16 v[42:43], v26 offset:4616
  v_mfma_f32_16x16x32_bf16 a[36:39], v[52:55], v[116:119], a[36:39]
  v_mfma_f32_16x16x32_bf16 a[40:43], v[48:51], v[104:107], a[40:43]
  ds_read_b64_tr_b16 v[44:45], v26 offset:20488
  v_mfma_f32_16x16x32_bf16 a[40:43], v[52:55], v[120:123], a[40:43]
  v_mfma_f32_16x16x32_bf16 a[44:47], v[48:51], v[108:111], a[44:47]
  ds_read_b64_tr_b16 v[46:47], v26 offset:21000
  v_mfma_f32_16x16x32_bf16 a[44:47], v[52:55], v[124:127], a[44:47]
  s_waitcnt lgkmcnt(8)
  v_mfma_f32_16x16x32_bf16 a[48:51], v[56:59], v[96:99], a[48:51]
  ds_read_b64_tr_b16 v[48:49], v27 offset:4096
  v_mfma_f32_16x16x32_bf16 a[48:51], v[60:63], v[112:115], a[48:51]
  v_mfma_f32_16x16x32_bf16 a[52:55], v[56:59], v[100:103], a[52:55]
  ds_read_b64_tr_b16 v[50:51], v27 offset:4608
  v_mfma_f32_16x16x32_bf16 a[52:55], v[60:63], v[116:119], a[52:55]
  v_mfma_f32_16x16x32_bf16 a[56:59], v[56:59], v[104:107], a[56:59]
  ds_read_b64_tr_b16 v[52:53], v27 offset:20480
  v_mfma_f32_16x16x32_bf16 a[56:59], v[60:63], v[120:123], a[56:59]
  v_mfma_f32_16x16x32_bf16 a[60:63], v[56:59], v[108:111], a[60:63]
  s_waitcnt vmcnt(12)
  ds_read_b64_tr_b16 v[54:55], v27 offset:20992
  v_mfma_f32_16x16x32_bf16 a[60:63], v[60:63], v[124:127], a[60:63]
  s_waitcnt lgkmcnt(8)
  v_mfma_f32_16x16x32_bf16 a[64:67], v[32:35], v[96:99], a[64:67]
  ds_read_b64_tr_b16 v[56:57], v27 offset:4104
  v_mfma_f32_16x16x32_bf16 a[64:67], v[36:39], v[112:115], a[64:67]
  ds_read_b128 v[64:67], v130 offset:0
  v_mfma_f32_16x16x32_bf16 a[68:71], v[32:35], v[100:103], a[68:71]
  ds_read_b64_tr_b16 v[58:59], v27 offset:4616
  v_mfma_f32_16x16x32_bf16 a[68:71], v[36:39], v[116:119], a[68:71]
  ds_read_b128 v[68:71], v130 offset:2048
  v_mfma_f32_16x16x32_bf16 a[72:75], v[32:35], v[104:107], a[72:75]
  ds_read_b64_tr_b16 v[60:61], v27 offset:20488
  v_mfma_f32_16x16x32_bf16 a[72:75], v[36:39], v[120:123], a[72:75]
  ds_read_b128 v[72:75], v130 offset:4096
  v_mfma_f32_16x16x32_bf16 a[76:79], v[32:35], v[108:111], a[76:79]
  s_waitcnt lgkmcnt(8)
  ds_read_b64_tr_b16 v[62:63], v27 offset:21000
  v_mfma_f32_16x16x32_bf16 a[76:79], v[36:39], v[124:127], a[76:79]
  s_waitcnt lgkmcnt(11)
  ds_read_b128 v[76:79], v130 offset:6144
  v_mfma_f32_16x16x32_bf16 a[80:83], v[40:43], v[96:99], a[80:83]
  ds_read_b64_tr_b16 v[32:33], v26 offset:8192
  v_mfma_f32_16x16x32_bf16 a[80:83], v[44:47], v[112:115], a[80:83]
  ds_read_b128 v[80:83], v131 offset:0
  v_mfma_f32_16x16x32_bf16 a[84:87], v[40:43], v[100:103], a[84:87]
  ds_read_b64_tr_b16 v[34:35], v26 offset:8704
  v_mfma_f32_16x16x32_bf16 a[84:87], v[44:47], v[116:119], a[84:87]
  ds_read_b128 v[84:87], v131 offset:2048
  v_mfma_f32_16x16x32_bf16 a[88:91], v[40:43], v[104:107], a[88:91]
  s_waitcnt lgkmcnt(8)
  ds_read_b64_tr_b16 v[36:37], v26 offset:24576
  v_mfma_f32_16x16x32_bf16 a[88:91], v[44:47], v[120:123], a[88:91]
  ds_read_b128 v[88:91], v131 offset:4096
  v_mfma_f32_16x16x32_bf16 a[92:95], v[40:43], v[108:111], a[92:95]
  ds_read_b64_tr_b16 v[38:39], v26 offset:25088
  v_mfma_f32_16x16x32_bf16 a[92:95], v[44:47], v[124:127], a[92:95]
  s_waitcnt lgkmcnt(15)
  ds_read_b128 v[92:95], v131 offset:6144
  v_mfma_f32_16x16x32_bf16 a[96:99], v[48:51], v[96:99], a[96:99]
  ds_read_b64_tr_b16 v[40:41], v26 offset:8200
  v_mfma_f32_16x16x32_bf16 a[96:99], v[52:55], v[112:115], a[96:99]
  v_mfma_f32_16x16x32_bf16 a[100:103], v[48:51], v[100:103], a[100:103]
  ds_read_b64_tr_b16 v[42:43], v26 offset:8712
  v_mfma_f32_16x16x32_bf16 a[100:103], v[52:55], v[116:119], a[100:103]
  v_mfma_f32_16x16x32_bf16 a[104:107], v[48:51], v[104:107], a[104:107]
  s_waitcnt lgkmcnt(8)
  ds_read_b64_tr_b16 v[44:45], v26 offset:24584
  v_mfma_f32_16x16x32_bf16 a[104:107], v[52:55], v[120:123], a[104:107]
  v_mfma_f32_16x16x32_bf16 a[108:111], v[48:51], v[108:111], a[108:111]
  ds_read_b64_tr_b16 v[46:47], v26 offset:25096
  v_mfma_f32_16x16x32_bf16 a[108:111], v[52:55], v[124:127], a[108:111]
  s_waitcnt lgkmcnt(13)
  v_mfma_f32_16x16x32_bf16 a[112:115], v[56:59], v[96:99], a[112:115]
  s_waitcnt lgkmcnt(4)
  ds_read_b64_tr_b16 v[48:49], v27 offset:8192
  v_mfma_f32_16x16x32_bf16 a[112:115], v[60:63], v[112:115], a[112:115]
  v_mfma_f32_16x16x32_bf16 a[116:119], v[56:59], v[100:103], a[116:119]
  s_add_u32 s35, s35, s75
  s_add_u32 s69, s35, 0
  s_add_u32 m0, s34, 0
  ds_read_b64_tr_b16 v[50:51], v27 offset:8704
  v_mfma_f32_16x16x32_bf16 a[116:119], v[60:63], v[116:119], a[116:119]
  buffer_load_dwordx4 v128, s[4:7], s69 offen lds
  v_mfma_f32_16x16x32_bf16 a[120:123], v[56:59], v[104:107], a[120:123]
  s_add_u32 s70, s35, 7168
  s_add_u32 m0, s34, 1024
  ds_read_b64_tr_b16 v[52:53], v27 offset:24576
  v_mfma_f32_16x16x32_bf16 a[120:123], v[60:63], v[120:123], a[120:123]
  buffer_load_dwordx4 v129, s[4:7], s70 offen lds
  v_mfma_f32_16x16x32_bf16 a[124:127], v[56:59], v[108:111], a[124:127]
  s_add_u32 s69, s35, 14336
  s_add_u32 m0, s34, 2048
  ds_read_b64_tr_b16 v[54:55], v27 offset:25088
  v_mfma_f32_16x16x32_bf16 a[124:127], v[60:63], v[124:127], a[124:127]
  s_waitcnt lgkmcnt(9)
  buffer_load_dwordx4 v128, s[4:7], s69 offen lds
  v_mfma_f32_16x16x32_bf16 a[128:131], v[32:35], v[96:99], a[128:131]
  s_add_u32 s70, s35, 21504
  s_add_u32 m0, s34, 3072
  ds_read_b64_tr_b16 v[56:57], v27 offset:8200
  v_mfma_f32_16x16x32_bf16 a[128:131], v[36:39], v[112:115], a[128:131]
  buffer_load_dwordx4 v129, s[4:7], s70 offen lds
  v_mfma_f32_16x16x32_bf16 a[132:135], v[32:35], v[100:103], a[132:135]
  s_add_u32 s69, s35, 28672
  s_add_u32 m0, s34, 4096
  ds_read_b64_tr_b16 v[58:59], v27 offset:8712
  v_mfma_f32_16x16x32_bf16 a[132:135], v[36:39], v[116:119], a[132:135]
  buffer_load_dwordx4 v128, s[4:7], s69 offen lds
  v_mfma_f32_16x16x32_bf16 a[136:139], v[32:35], v[104:107], a[136:139]
  s_add_u32 s70, s35, 35840
  s_add_u32 m0, s34, 5120
  ds_read_b64_tr_b16 v[60:61], v27 offset:24584
  v_mfma_f32_16x16x32_bf16 a[136:139], v[36:39], v[120:123], a[136:139]
  buffer_load_dwordx4 v129, s[4:7], s70 offen lds
  v_mfma_f32_16x16x32_bf16 a[140:143], v[32:35], v[108:111], a[140:143]
  s_add_u32 s69, s35, 43008
  s_add_u32 m0, s34, 6144
  ds_read_b64_tr_b16 v[62:63], v27 offset:25096
  v_mfma_f32_16x16x32_bf16 a[140:143], v[36:39], v[124:127], a[140:143]
  s_waitcnt lgkmcnt(8)
  buffer_load_dwordx4 v128, s[4:7], s69 offen lds
  v_mfma_f32_16x16x32_bf16 a[144:147], v[40:43], v[96:99], a[144:147]
  s_add_u32 s70, s35, 50176
  s_add_u32 m0, s34, 7168
  ds_read_b64_tr_b16 v[32:33], v26 offset:12288
  v_mfma_f32_16x16x32_bf16 a[144:147], v[44:47], v[112:115], a[144:147]
  buffer_load_dwordx4 v129, s[4:7], s70 offen lds
  v_mfma_f32_16x16x32_bf16 a[148:151], v[40:43], v[100:103], a[148:151]
  ds_read_b64_tr_b16 v[34:35], v26 offset:12800
  v_mfma_f32_16x16x32_bf16 a[148:151], v[44:47], v[116:119], a[148:151]
  v_mfma_f32_16x16x32_bf16 a[152:155], v[40:43], v[104:107], a[152:155]
  ds_read_b64_tr_b16 v[36:37], v26 offset:28672
  v_mfma_f32_16x16x32_bf16 a[152:155], v[44:47], v[120:123], a[152:155]
  v_mfma_f32_16x16x32_bf16 a[156:159], v[40:43], v[108:111], a[156:159]
  ds_read_b64_tr_b16 v[38:39], v26 offset:29184
  v_mfma_f32_16x16x32_bf16 a[156:159], v[44:47], v[124:127], a[156:159]
  s_waitcnt lgkmcnt(8)
  v_mfma_f32_16x16x32_bf16 a[160:163], v[48:51], v[96:99], a[160:163]
  ds_read_b64_tr_b16 v[40:41], v26 offset:12296
  v_mfma_f32_16x16x32_bf16 a[160:163], v[52:55], v[112:115], a[160:163]
  v_mfma_f32_16x16x32_bf16 a[164:167], v[48:51], v[100:103], a[164:167]
  ds_read_b64_tr_b16 v[42:43], v26 offset:12808
  v_mfma_f32_16x16x32_bf16 a[164:167], v[52:55], v[116:119], a[164:167]
  v_mfma_f32_16x16x32_bf16 a[168:171], v[48:51], v[104:107], a[168:171]
  ds_read_b64_tr_b16 v[44:45], v26 offset:28680
  v_mfma_f32_16x16x32_bf16 a[168:171], v[52:55], v[120:123], a[168:171]
  v_mfma_f32_16x16x32_bf16 a[172:175], v[48:51], v[108:111], a[172:175]
  ds_read_b64_tr_b16 v[46:47], v26 offset:29192
  v_mfma_f32_16x16x32_bf16 a[172:175], v[52:55], v[124:127], a[172:175]
  s_waitcnt lgkmcnt(8)
  v_mfma_f32_16x16x32_bf16 a[176:179], v[56:59], v[96:99], a[176:179]
  ds_read_b64_tr_b16 v[48:49], v27 offset:12288
  v_mfma_f32_16x16x32_bf16 a[176:179], v[60:63], v[112:115], a[176:179]
  v_mfma_f32_16x16x32_bf16 a[180:183], v[56:59], v[100:103], a[180:183]
  ds_read_b64_tr_b16 v[50:51], v27 offset:12800
  v_mfma_f32_16x16x32_bf16 a[180:183], v[60:63], v[116:119], a[180:183]
  v_mfma_f32_16x16x32_bf16 a[184:187], v[56:59], v[104:107], a[184:187]
  ds_read_b64_tr_b16 v[52:53], v27 offset:28672
  v_mfma_f32_16x16x32_bf16 a[184:187], v[60:63], v[120:123], a[184:187]
  v_mfma_f32_16x16x32_bf16 a[188:191], v[56:59], v[108:111], a[188:191]
  ds_read_b64_tr_b16 v[54:55], v27 offset:29184
  v_mfma_f32_16x16x32_bf16 a[188:191], v[60:63], v[124:127], a[188:191]
  s_waitcnt lgkmcnt(8)
  v_mfma_f32_16x16x32_bf16 a[192:195], v[32:35], v[96:99], a[192:195]
  ds_read_b64_tr_b16 v[56:57], v27 offset:12296
  v_mfma_f32_16x16x32_bf16 a[192:195], v[36:39], v[112:115], a[192:195]
  v_mfma_f32_16x16x32_bf16 a[196:199], v[32:35], v[100:103], a[196:199]
  ds_read_b64_tr_b16 v[58:59], v27 offset:12808
  v_mfma_f32_16x16x32_bf16 a[196:199], v[36:39], v[116:119], a[196:199]
  v_mfma_f32_16x16x32_bf16 a[200:203], v[32:35], v[104:107], a[200:203]
  s_waitcnt vmcnt(12)
  s_barrier
  ds_read_b64_tr_b16 v[60:61], v27 offset:28680
  v_mfma_f32_16x16x32_bf16 a[200:203], v[36:39], v[120:123], a[200:203]
  v_mfma_f32_16x16x32_bf16 a[204:207], v[32:35], v[108:111], a[204:207]
  s_add_u32 s78, s78, s79
  s_add_u32 m0, s33, 98304
  ds_read_b64_tr_b16 v[62:63], v27 offset:29192
  v_mfma_f32_16x16x32_bf16 a[204:207], v[36:39], v[124:127], a[204:207]
  s_waitcnt lgkmcnt(8)
  buffer_load_dwordx4 v21, s[8:11], s78 offen lds
  v_mfma_f32_16x16x32_bf16 a[208:211], v[40:43], v[96:99], a[208:211]
  s_add_u32 m0, s33, 102272
  ds_read_b64_tr_b16 v[32:33], v24 offset:16384
  v_mfma_f32_16x16x32_bf16 a[208:211], v[44:47], v[112:115], a[208:211]
  buffer_load_dwordx4 v21, s[8:11], s78 offen offset:128 lds
  v_mfma_f32_16x16x32_bf16 a[212:215], v[40:43], v[100:103], a[212:215]
  s_add_u32 m0, s33, 106240
  ds_read_b64_tr_b16 v[34:35], v24 offset:16896
  v_mfma_f32_16x16x32_bf16 a[212:215], v[44:47], v[116:119], a[212:215]
  buffer_load_dwordx4 v21, s[8:11], s78 offen offset:256 lds
  v_mfma_f32_16x16x32_bf16 a[216:219], v[40:43], v[104:107], a[216:219]
  s_add_u32 m0, s33, 110208
  ds_read_b64_tr_b16 v[36:37], v22 offset:49152
  v_mfma_f32_16x16x32_bf16 a[216:219], v[44:47], v[120:123], a[216:219]
  buffer_load_dwordx4 v21, s[8:11], s78 offen offset:384 lds
  v_mfma_f32_16x16x32_bf16 a[220:223], v[40:43], v[108:111], a[220:223]
  s_add_u32 s76, s78, 262144
  s_add_u32 m0, s33, 114688
  ds_read_b64_tr_b16 v[38:39], v22 offset:49664
  v_mfma_f32_16x16x32_bf16 a[220:223], v[44:47], v[124:127], a[220:223]
  s_waitcnt lgkmcnt(8)
  buffer_load_dwordx4 v21, s[8:11], s76 offen lds
  v_mfma_f32_16x16x32_bf16 a[224:227], v[48:51], v[96:99], a[224:227]
  s_add_u32 m0, s33, 118656
  ds_read_b64_tr_b16 v[40:41], v24 offset:16392
  v_mfma_f32_16x16x32_bf16 a[224:227], v[52:55], v[112:115], a[224:227]
  buffer_load_dwordx4 v21, s[8:11], s76 offen offset:128 lds
  v_mfma_f32_16x16x32_bf16 a[228:231], v[48:51], v[100:103], a[228:231]
  s_add_u32 m0, s33, 122624
  ds_read_b64_tr_b16 v[42:43], v24 offset:16904
  v_mfma_f32_16x16x32_bf16 a[228:231], v[52:55], v[116:119], a[228:231]
  buffer_load_dwordx4 v21, s[8:11], s76 offen offset:256 lds
  v_mfma_f32_16x16x32_bf16 a[232:235], v[48:51], v[104:107], a[232:235]
  s_add_u32 m0, s33, 126592
  ds_read_b64_tr_b16 v[44:45], v22 offset:49160
  v_mfma_f32_16x16x32_bf16 a[232:235], v[52:55], v[120:123], a[232:235]
  buffer_load_dwordx4 v21, s[8:11], s76 offen offset:384 lds
  v_mfma_f32_16x16x32_bf16 a[236:239], v[48:51], v[108:111], a[236:239]
  ds_read_b64_tr_b16 v[46:47], v22 offset:49672
  v_mfma_f32_16x16x32_bf16 a[236:239], v[52:55], v[124:127], a[236:239]
  s_waitcnt lgkmcnt(8)
  v_mfma_f32_16x16x32_bf16 a[240:243], v[56:59], v[96:99], a[240:243]
  ds_read_b64_tr_b16 v[48:49], v25 offset:16384
  v_mfma_f32_16x16x32_bf16 a[240:243], v[60:63], v[112:115], a[240:243]
  v_mfma_f32_16x16x32_bf16 a[244:247], v[56:59], v[100:103], a[244:247]
  ds_read_b64_tr_b16 v[50:51], v25 offset:16896
  v_mfma_f32_16x16x32_bf16 a[244:247], v[60:63], v[116:119], a[244:247]
  v_mfma_f32_16x16x32_bf16 a[248:251], v[56:59], v[104:107], a[248:251]
  ds_read_b64_tr_b16 v[52:53], v23 offset:49152
  v_mfma_f32_16x16x32_bf16 a[248:251], v[60:63], v[120:123], a[248:251]
  v_mfma_f32_16x16x32_bf16 a[252:255], v[56:59], v[108:111], a[252:255]
  ds_read_b64_tr_b16 v[54:55], v23 offset:49664
  v_mfma_f32_16x16x32_bf16 a[252:255], v[60:63], v[124:127], a[252:255]
  s_waitcnt lgkmcnt(8)
  v_mfma_f32_16x16x32_bf16 a[0:3], v[32:35], v[64:67], a[0:3]
  ds_read_b64_tr_b16 v[56:57], v25 offset:16392
  v_mfma_f32_16x16x32_bf16 a[0:3], v[36:39], v[80:83], a[0:3]
  s_mov_b32 s67, 16384
  v_mfma_f32_16x16x32_bf16 a[4:7], v[32:35], v[68:71], a[4:7]
  s_add_u32 m0, s33, 16384
  ds_read_b64_tr_b16 v[58:59], v25 offset:16904
  v_mfma_f32_16x16x32_bf16 a[4:7], v[36:39], v[84:87], a[4:7]
  buffer_load_dwordx4 v10, s[12:15], s67 offen nt lds
  v_mfma_f32_16x16x32_bf16 a[8:11], v[32:35], v[72:75], a[8:11]
  s_add_u32 m0, s33, 20352
  ds_read_b64_tr_b16 v[60:61], v23 offset:49160
  v_mfma_f32_16x16x32_bf16 a[8:11], v[36:39], v[88:91], a[8:11]
  buffer_load_dwordx4 v10, s[12:15], s67 offen offset:128 nt lds
  v_mfma_f32_16x16x32_bf16 a[12:15], v[32:35], v[76:79], a[12:15]
  s_add_u32 m0, s33, 24320
  ds_read_b64_tr_b16 v[62:63], v23 offset:49672
  v_mfma_f32_16x16x32_bf16 a[12:15], v[36:39], v[92:95], a[12:15]
  s_waitcnt lgkmcnt(8)
  buffer_load_dwordx4 v10, s[12:15], s67 offen offset:256 nt lds
  v_mfma_f32_16x16x32_bf16 a[16:19], v[40:43], v[64:67], a[16:19]
  s_add_u32 m0, s33, 28288
  ds_read_b64_tr_b16 v[32:33], v24 offset:20480
  v_mfma_f32_16x16x32_bf16 a[16:19], v[44:47], v[80:83], a[16:19]
  buffer_load_dwordx4 v10, s[12:15], s67 offen offset:384 nt lds
  v_mfma_f32_16x16x32_bf16 a[20:23], v[40:43], v[68:71], a[20:23]
  ds_read_b64_tr_b16 v[34:35], v24 offset:20992
  v_mfma_f32_16x16x32_bf16 a[20:23], v[44:47], v[84:87], a[20:23]
  v_mfma_f32_16x16x32_bf16 a[24:27], v[40:43], v[72:75], a[24:27]
  ds_read_b64_tr_b16 v[36:37], v22 offset:53248
  v_mfma_f32_16x16x32_bf16 a[24:27], v[44:47], v[88:91], a[24:27]
  v_mfma_f32_16x16x32_bf16 a[28:31], v[40:43], v[76:79], a[28:31]
  ds_read_b64_tr_b16 v[38:39], v22 offset:53760
  v_mfma_f32_16x16x32_bf16 a[28:31], v[44:47], v[92:95], a[28:31]
  s_waitcnt lgkmcnt(8)
  v_mfma_f32_16x16x32_bf16 a[32:35], v[48:51], v[64:67], a[32:35]
  ds_read_b64_tr_b16 v[40:41], v24 offset:20488
  v_mfma_f32_16x16x32_bf16 a[32:35], v[52:55], v[80:83], a[32:35]
  v_mfma_f32_16x16x32_bf16 a[36:39], v[48:51], v[68:71], a[36:39]
  ds_read_b64_tr_b16 v[42:43], v24 offset:21000
  v_mfma_f32_16x16x32_bf16 a[36:39], v[52:55], v[84:87], a[36:39]
  v_mfma_f32_16x16x32_bf16 a[40:43], v[48:51], v[72:75], a[40:43]
  ds_read_b64_tr_b16 v[44:45], v22 offset:53256
  v_mfma_f32_16x16x32_bf16 a[40:43], v[52:55], v[88:91], a[40:43]
  v_mfma_f32_16x16x32_bf16 a[44:47], v[48:51], v[76:79], a[44:47]
  ds_read_b64_tr_b16 v[46:47], v22 offset:53768
  v_mfma_f32_16x16x32_bf16 a[44:47], v[52:55], v[92:95], a[44:47]
  s_waitcnt lgkmcnt(8)
  v_mfma_f32_16x16x32_bf16 a[48:51], v[56:59], v[64:67], a[48:51]
  ds_read_b64_tr_b16 v[48:49], v25 offset:20480
  v_mfma_f32_16x16x32_bf16 a[48:51], v[60:63], v[80:83], a[48:51]
  v_mfma_f32_16x16x32_bf16 a[52:55], v[56:59], v[68:71], a[52:55]
  ds_read_b64_tr_b16 v[50:51], v25 offset:20992
  v_mfma_f32_16x16x32_bf16 a[52:55], v[60:63], v[84:87], a[52:55]
  v_mfma_f32_16x16x32_bf16 a[56:59], v[56:59], v[72:75], a[56:59]
  ds_read_b64_tr_b16 v[52:53], v23 offset:53248
  v_mfma_f32_16x16x32_bf16 a[56:59], v[60:63], v[88:91], a[56:59]
  v_mfma_f32_16x16x32_bf16 a[60:63], v[56:59], v[76:79], a[60:63]
  s_waitcnt vmcnt(12)
  ds_read_b64_tr_b16 v[54:55], v23 offset:53760
  v_mfma_f32_16x16x32_bf16 a[60:63], v[60:63], v[92:95], a[60:63]
  s_waitcnt lgkmcnt(8)
  v_mfma_f32_16x16x32_bf16 a[64:67], v[32:35], v[64:67], a[64:67]
  ds_read_b64_tr_b16 v[56:57], v25 offset:20488
  v_mfma_f32_16x16x32_bf16 a[64:67], v[36:39], v[80:83], a[64:67]
  ds_read_b128 v[96:99], v130 offset:0
  v_mfma_f32_16x16x32_bf16 a[68:71], v[32:35], v[68:71], a[68:71]
  ds_read_b64_tr_b16 v[58:59], v25 offset:21000
  v_mfma_f32_16x16x32_bf16 a[68:71], v[36:39], v[84:87], a[68:71]
  ds_read_b128 v[100:103], v130 offset:2048
  v_mfma_f32_16x16x32_bf16 a[72:75], v[32:35], v[72:75], a[72:75]
  ds_read_b64_tr_b16 v[60:61], v23 offset:53256
  v_mfma_f32_16x16x32_bf16 a[72:75], v[36:39], v[88:91], a[72:75]
  ds_read_b128 v[104:107], v130 offset:4096
  v_mfma_f32_16x16x32_bf16 a[76:79], v[32:35], v[76:79], a[76:79]
  s_waitcnt lgkmcnt(8)
  ds_read_b64_tr_b16 v[62:63], v23 offset:53768
  v_mfma_f32_16x16x32_bf16 a[76:79], v[36:39], v[92:95], a[76:79]
  s_waitcnt lgkmcnt(11)
  ds_read_b128 v[108:111], v130 offset:6144
  v_mfma_f32_16x16x32_bf16 a[80:83], v[40:43], v[64:67], a[80:83]
  ds_read_b64_tr_b16 v[32:33], v24 offset:24576
  v_mfma_f32_16x16x32_bf16 a[80:83], v[44:47], v[80:83], a[80:83]
  ds_read_b128 v[112:115], v131 offset:0
  v_mfma_f32_16x16x32_bf16 a[84:87], v[40:43], v[68:71], a[84:87]
  ds_read_b64_tr_b16 v[34:35], v24 offset:25088
  v_mfma_f32_16x16x32_bf16 a[84:87], v[44:47], v[84:87], a[84:87]
  ds_read_b128 v[116:119], v131 offset:2048
  v_mfma_f32_16x16x32_bf16 a[88:91], v[40:43], v[72:75], a[88:91]
  s_waitcnt lgkmcnt(8)
  ds_read_b64_tr_b16 v[36:37], v22 offset:57344
  v_mfma_f32_16x16x32_bf16 a[88:91], v[44:47], v[88:91], a[88:91]
  ds_read_b128 v[120:123], v131 offset:4096
  v_mfma_f32_16x16x32_bf16 a[92:95], v[40:43], v[76:79], a[92:95]
  ds_read_b64_tr_b16 v[38:39], v22 offset:57856
  v_mfma_f32_16x16x32_bf16 a[92:95], v[44:47], v[92:95], a[92:95]
  s_waitcnt lgkmcnt(15)
  ds_read_b128 v[124:127], v131 offset:6144
  v_mfma_f32_16x16x32_bf16 a[96:99], v[48:51], v[64:67], a[96:99]
  ds_read_b64_tr_b16 v[40:41], v24 offset:24584
  v_mfma_f32_16x16x32_bf16 a[96:99], v[52:55], v[80:83], a[96:99]
  v_mfma_f32_16x16x32_bf16 a[100:103], v[48:51], v[68:71], a[100:103]
  ds_read_b64_tr_b16 v[42:43], v24 offset:25096
  v_mfma_f32_16x16x32_bf16 a[100:103], v[52:55], v[84:87], a[100:103]
  v_mfma_f32_16x16x32_bf16 a[104:107], v[48:51], v[72:75], a[104:107]
  s_waitcnt lgkmcnt(8)
  ds_read_b64_tr_b16 v[44:45], v22 offset:57352
  v_mfma_f32_16x16x32_bf16 a[104:107], v[52:55], v[88:91], a[104:107]
  v_mfma_f32_16x16x32_bf16 a[108:111], v[48:51], v[76:79], a[108:111]
  ds_read_b64_tr_b16 v[46:47], v22 offset:57864
  v_mfma_f32_16x16x32_bf16 a[108:111], v[52:55], v[92:95], a[108:111]
  s_waitcnt lgkmcnt(13)
  v_mfma_f32_16x16x32_bf16 a[112:115], v[56:59], v[64:67], a[112:115]
  s_waitcnt lgkmcnt(4)
  ds_read_b64_tr_b16 v[48:49], v25 offset:24576
  v_mfma_f32_16x16x32_bf16 a[112:115], v[60:63], v[80:83], a[112:115]
  v_mfma_f32_16x16x32_bf16 a[116:119], v[56:59], v[68:71], a[116:119]
  s_add_u32 s35, s35, s75
  s_add_u32 s69, s35, 0
  s_add_u32 m0, s34, 0
  ds_read_b64_tr_b16 v[50:51], v25 offset:25088
  v_mfma_f32_16x16x32_bf16 a[116:119], v[60:63], v[84:87], a[116:119]
  buffer_load_dwordx4 v128, s[4:7], s69 offen lds
  v_mfma_f32_16x16x32_bf16 a[120:123], v[56:59], v[72:75], a[120:123]
  s_add_u32 s70, s35, 7168
  s_add_u32 m0, s34, 1024
  ds_read_b64_tr_b16 v[52:53], v23 offset:57344
  v_mfma_f32_16x16x32_bf16 a[120:123], v[60:63], v[88:91], a[120:123]
  buffer_load_dwordx4 v129, s[4:7], s70 offen lds
  v_mfma_f32_16x16x32_bf16 a[124:127], v[56:59], v[76:79], a[124:127]
  s_add_u32 s69, s35, 14336
  s_add_u32 m0, s34, 2048
  ds_read_b64_tr_b16 v[54:55], v23 offset:57856
  v_mfma_f32_16x16x32_bf16 a[124:127], v[60:63], v[92:95], a[124:127]
  s_waitcnt lgkmcnt(9)
  buffer_load_dwordx4 v128, s[4:7], s69 offen lds
  v_mfma_f32_16x16x32_bf16 a[128:131], v[32:35], v[64:67], a[128:131]
  s_add_u32 s70, s35, 21504
  s_add_u32 m0, s34, 3072
  ds_read_b64_tr_b16 v[56:57], v25 offset:24584
  v_mfma_f32_16x16x32_bf16 a[128:131], v[36:39], v[80:83], a[128:131]
  buffer_load_dwordx4 v129, s[4:7], s70 offen lds
  v_mfma_f32_16x16x32_bf16 a[132:135], v[32:35], v[68:71], a[132:135]
  s_add_u32 s69, s35, 28672
  s_add_u32 m0, s34, 4096
  ds_read_b64_tr_b16 v[58:59], v25 offset:25096
  v_mfma_f32_16x16x32_bf16 a[132:135], v[36:39], v[84:87], a[132:135]
  buffer_load_dwordx4 v128, s[4:7], s69 offen lds
  v_mfma_f32_16x16x32_bf16 a[136:139], v[32:35], v[72:75], a[136:139]
  s_add_u32 s70, s35, 35840
  s_add_u32 m0, s34, 5120
  ds_read_b64_tr_b16 v[60:61], v23 offset:57352
  v_mfma_f32_16x16x32_bf16 a[136:139], v[36:39], v[88:91], a[136:139]
  buffer_load_dwordx4 v129, s[4:7], s70 offen lds
  v_mfma_f32_16x16x32_bf16 a[140:143], v[32:35], v[76:79], a[140:143]
  s_add_u32 s69, s35, 43008
  s_add_u32 m0, s34, 6144
  ds_read_b64_tr_b16 v[62:63], v23 offset:57864
  v_mfma_f32_16x16x32_bf16 a[140:143], v[36:39], v[92:95], a[140:143]
  s_waitcnt lgkmcnt(8)
  buffer_load_dwordx4 v128, s[4:7], s69 offen lds
  v_mfma_f32_16x16x32_bf16 a[144:147], v[40:43], v[64:67], a[144:147]
  s_add_u32 s70, s35, 50176
  s_add_u32 m0, s34, 7168
  ds_read_b64_tr_b16 v[32:33], v24 offset:28672
  v_mfma_f32_16x16x32_bf16 a[144:147], v[44:47], v[80:83], a[144:147]
  buffer_load_dwordx4 v129, s[4:7], s70 offen lds
  v_mfma_f32_16x16x32_bf16 a[148:151], v[40:43], v[68:71], a[148:151]
  ds_read_b64_tr_b16 v[34:35], v24 offset:29184
  v_mfma_f32_16x16x32_bf16 a[148:151], v[44:47], v[84:87], a[148:151]
  v_mfma_f32_16x16x32_bf16 a[152:155], v[40:43], v[72:75], a[152:155]
  ds_read_b64_tr_b16 v[36:37], v22 offset:61440
  v_mfma_f32_16x16x32_bf16 a[152:155], v[44:47], v[88:91], a[152:155]
  v_mfma_f32_16x16x32_bf16 a[156:159], v[40:43], v[76:79], a[156:159]
  ds_read_b64_tr_b16 v[38:39], v22 offset:61952
  v_mfma_f32_16x16x32_bf16 a[156:159], v[44:47], v[92:95], a[156:159]
  s_waitcnt lgkmcnt(8)
  v_mfma_f32_16x16x32_bf16 a[160:163], v[48:51], v[64:67], a[160:163]
  ds_read_b64_tr_b16 v[40:41], v24 offset:28680
  v_mfma_f32_16x16x32_bf16 a[160:163], v[52:55], v[80:83], a[160:163]
  v_mfma_f32_16x16x32_bf16 a[164:167], v[48:51], v[68:71], a[164:167]
  ds_read_b64_tr_b16 v[42:43], v24 offset:29192
  v_mfma_f32_16x16x32_bf16 a[164:167], v[52:55], v[84:87], a[164:167]
  v_mfma_f32_16x16x32_bf16 a[168:171], v[48:51], v[72:75], a[168:171]
  ds_read_b64_tr_b16 v[44:45], v22 offset:61448
  v_mfma_f32_16x16x32_bf16 a[168:171], v[52:55], v[88:91], a[168:171]
  v_mfma_f32_16x16x32_bf16 a[172:175], v[48:51], v[76:79], a[172:175]
  ds_read_b64_tr_b16 v[46:47], v22 offset:61960
  v_mfma_f32_16x16x32_bf16 a[172:175], v[52:55], v[92:95], a[172:175]
  s_waitcnt lgkmcnt(8)
  v_mfma_f32_16x16x32_bf16 a[176:179], v[56:59], v[64:67], a[176:179]
  ds_read_b64_tr_b16 v[48:49], v25 offset:28672
  v_mfma_f32_16x16x32_bf16 a[176:179], v[60:63], v[80:83], a[176:179]
  v_mfma_f32_16x16x32_bf16 a[180:183], v[56:59], v[68:71], a[180:183]
  ds_read_b64_tr_b16 v[50:51], v25 offset:29184
  v_mfma_f32_16x16x32_bf16 a[180:183], v[60:63], v[84:87], a[180:183]
  v_mfma_f32_16x16x32_bf16 a[184:187], v[56:59], v[72:75], a[184:187]
  ds_read_b64_tr_b16 v[52:53], v23 offset:61440
  v_mfma_f32_16x16x32_bf16 a[184:187], v[60:63], v[88:91], a[184:187]
  v_mfma_f32_16x16x32_bf16 a[188:191], v[56:59], v[76:79], a[188:191]
  ds_read_b64_tr_b16 v[54:55], v23 offset:61952
  v_mfma_f32_16x16x32_bf16 a[188:191], v[60:63], v[92:95], a[188:191]
  s_waitcnt lgkmcnt(8)
  v_mfma_f32_16x16x32_bf16 a[192:195], v[32:35], v[64:67], a[192:195]
  ds_read_b64_tr_b16 v[56:57], v25 offset:28680
  v_mfma_f32_16x16x32_bf16 a[192:195], v[36:39], v[80:83], a[192:195]
  v_mfma_f32_16x16x32_bf16 a[196:199], v[32:35], v[68:71], a[196:199]
  ds_read_b64_tr_b16 v[58:59], v25 offset:29192
  v_mfma_f32_16x16x32_bf16 a[196:199], v[36:39], v[84:87], a[196:199]
  v_mfma_f32_16x16x32_bf16 a[200:203], v[32:35], v[72:75], a[200:203]
  s_waitcnt vmcnt(12)
  s_barrier
  ds_read_b64_tr_b16 v[60:61], v23 offset:61448
  v_mfma_f32_16x16x32_bf16 a[200:203], v[36:39], v[88:91], a[200:203]
  v_mfma_f32_16x16x32_bf16 a[204:207], v[32:35], v[76:79], a[204:207]
  s_add_u32 s78, s78, s79
  s_add_u32 m0, s33, 131072
  ds_read_b64_tr_b16 v[62:63], v23 offset:61960
  v_mfma_f32_16x16x32_bf16 a[204:207], v[36:39], v[92:95], a[204:207]
  s_waitcnt lgkmcnt(8)
  buffer_load_dwordx4 v21, s[8:11], s78 offen lds
  v_mfma_f32_16x16x32_bf16 a[208:211], v[40:43], v[64:67], a[208:211]
  s_add_u32 m0, s33, 135040
  ds_read_b64_tr_b16 v[32:33], v24 offset:32768
  v_mfma_f32_16x16x32_bf16 a[208:211], v[44:47], v[80:83], a[208:211]
  buffer_load_dwordx4 v21, s[8:11], s78 offen offset:128 lds
  v_mfma_f32_16x16x32_bf16 a[212:215], v[40:43], v[68:71], a[212:215]
  s_add_u32 m0, s33, 139008
  ds_read_b64_tr_b16 v[34:35], v24 offset:33280
  v_mfma_f32_16x16x32_bf16 a[212:215], v[44:47], v[84:87], a[212:215]
  buffer_load_dwordx4 v21, s[8:11], s78 offen offset:256 lds
  v_mfma_f32_16x16x32_bf16 a[216:219], v[40:43], v[72:75], a[216:219]
  s_add_u32 m0, s33, 142976
  ds_read_b64_tr_b16 v[36:37], v24 offset:49152
  v_mfma_f32_16x16x32_bf16 a[216:219], v[44:47], v[88:91], a[216:219]
  buffer_load_dwordx4 v21, s[8:11], s78 offen offset:384 lds
  v_mfma_f32_16x16x32_bf16 a[220:223], v[40:43], v[76:79], a[220:223]
  s_add_u32 s76, s78, 262144
  s_add_u32 m0, s33, 147456
  ds_read_b64_tr_b16 v[38:39], v24 offset:49664
  v_mfma_f32_16x16x32_bf16 a[220:223], v[44:47], v[92:95], a[220:223]
  s_waitcnt lgkmcnt(8)
  buffer_load_dwordx4 v21, s[8:11], s76 offen lds
  v_mfma_f32_16x16x32_bf16 a[224:227], v[48:51], v[64:67], a[224:227]
  s_add_u32 m0, s33, 151424
  ds_read_b64_tr_b16 v[40:41], v24 offset:32776
  v_mfma_f32_16x16x32_bf16 a[224:227], v[52:55], v[80:83], a[224:227]
  buffer_load_dwordx4 v21, s[8:11], s76 offen offset:128 lds
  v_mfma_f32_16x16x32_bf16 a[228:231], v[48:51], v[68:71], a[228:231]
  s_add_u32 m0, s33, 155392
  ds_read_b64_tr_b16 v[42:43], v24 offset:33288
  v_mfma_f32_16x16x32_bf16 a[228:231], v[52:55], v[84:87], a[228:231]
  buffer_load_dwordx4 v21, s[8:11], s76 offen offset:256 lds
  v_mfma_f32_16x16x32_bf16 a[232:235], v[48:51], v[72:75], a[232:235]
  s_add_u32 m0, s33, 159360
  ds_read_b64_tr_b16 v[44:45], v24 offset:49160
  v_mfma_f32_16x16x32_bf16 a[232:235], v[52:55], v[88:91], a[232:235]
  buffer_load_dwordx4 v21, s[8:11], s76 offen offset:384 lds
  v_mfma_f32_16x16x32_bf16 a[236:239], v[48:51], v[76:79], a[236:239]
  ds_read_b64_tr_b16 v[46:47], v24 offset:49672
  v_mfma_f32_16x16x32_bf16 a[236:239], v[52:55], v[92:95], a[236:239]
  s_waitcnt lgkmcnt(8)
  v_mfma_f32_16x16x32_bf16 a[240:243], v[56:59], v[64:67], a[240:243]
  ds_read_b64_tr_b16 v[48:49], v25 offset:32768
  v_mfma_f32_16x16x32_bf16 a[240:243], v[60:63], v[80:83], a[240:243]
  v_mfma_f32_16x16x32_bf16 a[244:247], v[56:59], v[68:71], a[244:247]
  ds_read_b64_tr_b16 v[50:51], v25 offset:33280
  v_mfma_f32_16x16x32_bf16 a[244:247], v[60:63], v[84:87], a[244:247]
  v_mfma_f32_16x16x32_bf16 a[248:251], v[56:59], v[72:75], a[248:251]
  ds_read_b64_tr_b16 v[52:53], v25 offset:49152
  v_mfma_f32_16x16x32_bf16 a[248:251], v[60:63], v[88:91], a[248:251]
  v_mfma_f32_16x16x32_bf16 a[252:255], v[56:59], v[76:79], a[252:255]
  ds_read_b64_tr_b16 v[54:55], v25 offset:49664
  v_mfma_f32_16x16x32_bf16 a[252:255], v[60:63], v[92:95], a[252:255]
  s_waitcnt lgkmcnt(8)
  v_mfma_f32_16x16x32_bf16 a[0:3], v[32:35], v[96:99], a[0:3]
  ds_read_b64_tr_b16 v[56:57], v25 offset:32776
  v_mfma_f32_16x16x32_bf16 a[0:3], v[36:39], v[112:115], a[0:3]
  v_mfma_f32_16x16x32_bf16 a[4:7], v[32:35], v[100:103], a[4:7]
  ds_read_b64_tr_b16 v[58:59], v25 offset:33288
  v_mfma_f32_16x16x32_bf16 a[4:7], v[36:39], v[116:119], a[4:7]
  v_mfma_f32_16x16x32_bf16 a[8:11], v[32:35], v[104:107], a[8:11]
  ds_read_b64_tr_b16 v[60:61], v25 offset:49160
  v_mfma_f32_16x16x32_bf16 a[8:11], v[36:39], v[120:123], a[8:11]
  v_mfma_f32_16x16x32_bf16 a[12:15], v[32:35], v[108:111], a[12:15]
  ds_read_b64_tr_b16 v[62:63], v25 offset:49672
  v_mfma_f32_16x16x32_bf16 a[12:15], v[36:39], v[124:127], a[12:15]
  s_waitcnt lgkmcnt(8)
  v_mfma_f32_16x16x32_bf16 a[16:19], v[40:43], v[96:99], a[16:19]
  ds_read_b64_tr_b16 v[32:33], v24 offset:36864
  v_mfma_f32_16x16x32_bf16 a[16:19], v[44:47], v[112:115], a[16:19]
  v_mfma_f32_16x16x32_bf16 a[20:23], v[40:43], v[100:103], a[20:23]
  ds_read_b64_tr_b16 v[34:35], v24 offset:37376
  v_mfma_f32_16x16x32_bf16 a[20:23], v[44:47], v[116:119], a[20:23]
  v_mfma_f32_16x16x32_bf16 a[24:27], v[40:43], v[104:107], a[24:27]
  ds_read_b64_tr_b16 v[36:37], v24 offset:53248
  v_mfma_f32_16x16x32_bf16 a[24:27], v[44:47], v[120:123], a[24:27]
  v_mfma_f32_16x16x32_bf16 a[28:31], v[40:43], v[108:111], a[28:31]
  ds_read_b64_tr_b16 v[38:39], v24 offset:53760
  v_mfma_f32_16x16x32_bf16 a[28:31], v[44:47], v[124:127], a[28:31]
  s_waitcnt lgkmcnt(8)
  v_mfma_f32_16x16x32_bf16 a[32:35], v[48:51], v[96:99], a[32:35]
  ds_read_b64_tr_b16 v[40:41], v24 offset:36872
  v_mfma_f32_16x16x32_bf16 a[32:35], v[52:55], v[112:115], a[32:35]
  v_mfma_f32_16x16x32_bf16 a[36:39], v[48:51], v[100:103], a[36:39]
  ds_read_b64_tr_b16 v[42:43], v24 offset:37384
  v_mfma_f32_16x16x32_bf16 a[36:39], v[52:55], v[116:119], a[36:39]
  v_mfma_f32_16x16x32_bf16 a[40:43], v[48:51], v[104:107], a[40:43]
  ds_read_b64_tr_b16 v[44:45], v24 offset:53256
  v_mfma_f32_16x16x32_bf16 a[40:43], v[52:55], v[120:123], a[40:43]
  v_mfma_f32_16x16x32_bf16 a[44:47], v[48:51], v[108:111], a[44:47]
  ds_read_b64_tr_b16 v[46:47], v24 offset:53768
  v_mfma_f32_16x16x32_bf16 a[44:47], v[52:55], v[124:127], a[44:47]
  s_waitcnt lgkmcnt(8)
  v_mfma_f32_16x16x32_bf16 a[48:51], v[56:59], v[96:99], a[48:51]
  ds_read_b64_tr_b16 v[48:49], v25 offset:36864
  v_mfma_f32_16x16x32_bf16 a[48:51], v[60:63], v[112:115], a[48:51]
  v_mfma_f32_16x16x32_bf16 a[52:55], v[56:59], v[100:103], a[52:55]
  ds_read_b64_tr_b16 v[50:51], v25 offset:37376
  v_mfma_f32_16x16x32_bf16 a[52:55], v[60:63], v[116:119], a[52:55]
  v_mfma_f32_16x16x32_bf16 a[56:59], v[56:59], v[104:107], a[56:59]
  ds_read_b64_tr_b16 v[52:53], v25 offset:53248
  v_mfma_f32_16x16x32_bf16 a[56:59], v[60:63], v[120:123], a[56:59]
  v_mfma_f32_16x16x32_bf16 a[60:63], v[56:59], v[108:111], a[60:63]
  s_waitcnt vmcnt(8)
  ds_read_b64_tr_b16 v[54:55], v25 offset:53760
  v_mfma_f32_16x16x32_bf16 a[60:63], v[60:63], v[124:127], a[60:63]
  s_waitcnt lgkmcnt(8)
  v_mfma_f32_16x16x32_bf16 a[64:67], v[32:35], v[96:99], a[64:67]
  ds_read_b64_tr_b16 v[56:57], v25 offset:36872
  v_mfma_f32_16x16x32_bf16 a[64:67], v[36:39], v[112:115], a[64:67]
  ds_read_b128 v[64:67], v130 offset:0
  v_mfma_f32_16x16x32_bf16 a[68:71], v[32:35], v[100:103], a[68:71]
  ds_read_b64_tr_b16 v[58:59], v25 offset:37384
  v_mfma_f32_16x16x32_bf16 a[68:71], v[36:39], v[116:119], a[68:71]
  ds_read_b128 v[68:71], v130 offset:2048
  v_mfma_f32_16x16x32_bf16 a[72:75], v[32:35], v[104:107], a[72:75]
  ds_read_b64_tr_b16 v[60:61], v25 offset:53256
  v_mfma_f32_16x16x32_bf16 a[72:75], v[36:39], v[120:123], a[72:75]
  ds_read_b128 v[72:75], v130 offset:4096
  v_mfma_f32_16x16x32_bf16 a[76:79], v[32:35], v[108:111], a[76:79]
  s_waitcnt lgkmcnt(8)
  ds_read_b64_tr_b16 v[62:63], v25 offset:53768
  v_mfma_f32_16x16x32_bf16 a[76:79], v[36:39], v[124:127], a[76:79]
  s_waitcnt lgkmcnt(11)
  ds_read_b128 v[76:79], v130 offset:6144
  v_mfma_f32_16x16x32_bf16 a[80:83], v[40:43], v[96:99], a[80:83]
  ds_read_b64_tr_b16 v[32:33], v24 offset:40960
  v_mfma_f32_16x16x32_bf16 a[80:83], v[44:47], v[112:115], a[80:83]
  ds_read_b128 v[80:83], v131 offset:0
  v_mfma_f32_16x16x32_bf16 a[84:87], v[40:43], v[100:103], a[84:87]
  ds_read_b64_tr_b16 v[34:35], v24 offset:41472
  v_mfma_f32_16x16x32_bf16 a[84:87], v[44:47], v[116:119], a[84:87]
  ds_read_b128 v[84:87], v131 offset:2048
  v_mfma_f32_16x16x32_bf16 a[88:91], v[40:43], v[104:107], a[88:91]
  s_waitcnt lgkmcnt(8)
  ds_read_b64_tr_b16 v[36:37], v24 offset:57344
  v_mfma_f32_16x16x32_bf16 a[88:91], v[44:47], v[120:123], a[88:91]
  ds_read_b128 v[88:91], v131 offset:4096
  v_mfma_f32_16x16x32_bf16 a[92:95], v[40:43], v[108:111], a[92:95]
  ds_read_b64_tr_b16 v[38:39], v24 offset:57856
  v_mfma_f32_16x16x32_bf16 a[92:95], v[44:47], v[124:127], a[92:95]
  s_waitcnt lgkmcnt(15)
  ds_read_b128 v[92:95], v131 offset:6144
  v_mfma_f32_16x16x32_bf16 a[96:99], v[48:51], v[96:99], a[96:99]
  ds_read_b64_tr_b16 v[40:41], v24 offset:40968
  v_mfma_f32_16x16x32_bf16 a[96:99], v[52:55], v[112:115], a[96:99]
  v_mfma_f32_16x16x32_bf16 a[100:103], v[48:51], v[100:103], a[100:103]
  ds_read_b64_tr_b16 v[42:43], v24 offset:41480
  v_mfma_f32_16x16x32_bf16 a[100:103], v[52:55], v[116:119], a[100:103]
  v_mfma_f32_16x16x32_bf16 a[104:107], v[48:51], v[104:107], a[104:107]
  s_waitcnt lgkmcnt(8)
  ds_read_b64_tr_b16 v[44:45], v24 offset:57352
  v_mfma_f32_16x16x32_bf16 a[104:107], v[52:55], v[120:123], a[104:107]
  v_mfma_f32_16x16x32_bf16 a[108:111], v[48:51], v[108:111], a[108:111]
  ds_read_b64_tr_b16 v[46:47], v24 offset:57864
  v_mfma_f32_16x16x32_bf16 a[108:111], v[52:55], v[124:127], a[108:111]
  s_waitcnt lgkmcnt(13)
  v_mfma_f32_16x16x32_bf16 a[112:115], v[56:59], v[96:99], a[112:115]
  s_waitcnt lgkmcnt(4)
  ds_read_b64_tr_b16 v[48:49], v25 offset:40960
  v_mfma_f32_16x16x32_bf16 a[112:115], v[60:63], v[112:115], a[112:115]
  v_mfma_f32_16x16x32_bf16 a[116:119], v[56:59], v[100:103], a[116:119]
  ds_read_b64_tr_b16 v[50:51], v25 offset:41472
  v_mfma_f32_16x16x32_bf16 a[116:119], v[60:63], v[116:119], a[116:119]
  v_mfma_f32_16x16x32_bf16 a[120:123], v[56:59], v[104:107], a[120:123]
  ds_read_b64_tr_b16 v[52:53], v25 offset:57344
  v_mfma_f32_16x16x32_bf16 a[120:123], v[60:63], v[120:123], a[120:123]
  v_mfma_f32_16x16x32_bf16 a[124:127], v[56:59], v[108:111], a[124:127]
  ds_read_b64_tr_b16 v[54:55], v25 offset:57856
  v_mfma_f32_16x16x32_bf16 a[124:127], v[60:63], v[124:127], a[124:127]
  s_waitcnt lgkmcnt(9)
  v_mfma_f32_16x16x32_bf16 a[128:131], v[32:35], v[96:99], a[128:131]
  ds_read_b64_tr_b16 v[56:57], v25 offset:40968
  v_mfma_f32_16x16x32_bf16 a[128:131], v[36:39], v[112:115], a[128:131]
  v_mfma_f32_16x16x32_bf16 a[132:135], v[32:35], v[100:103], a[132:135]
  ds_read_b64_tr_b16 v[58:59], v25 offset:41480
  v_mfma_f32_16x16x32_bf16 a[132:135], v[36:39], v[116:119], a[132:135]
  v_mfma_f32_16x16x32_bf16 a[136:139], v[32:35], v[104:107], a[136:139]
  ds_read_b64_tr_b16 v[60:61], v25 offset:57352
  v_mfma_f32_16x16x32_bf16 a[136:139], v[36:39], v[120:123], a[136:139]
  v_mfma_f32_16x16x32_bf16 a[140:143], v[32:35], v[108:111], a[140:143]
  ds_read_b64_tr_b16 v[62:63], v25 offset:57864
  v_mfma_f32_16x16x32_bf16 a[140:143], v[36:39], v[124:127], a[140:143]
  s_waitcnt lgkmcnt(8)
  v_mfma_f32_16x16x32_bf16 a[144:147], v[40:43], v[96:99], a[144:147]
  ds_read_b64_tr_b16 v[32:33], v24 offset:45056
  v_mfma_f32_16x16x32_bf16 a[144:147], v[44:47], v[112:115], a[144:147]
  v_mfma_f32_16x16x32_bf16 a[148:151], v[40:43], v[100:103], a[148:151]
  ds_read_b64_tr_b16 v[34:35], v24 offset:45568
  v_mfma_f32_16x16x32_bf16 a[148:151], v[44:47], v[116:119], a[148:151]
  v_mfma_f32_16x16x32_bf16 a[152:155], v[40:43], v[104:107], a[152:155]
  ds_read_b64_tr_b16 v[36:37], v24 offset:61440
  v_mfma_f32_16x16x32_bf16 a[152:155], v[44:47], v[120:123], a[152:155]
  v_mfma_f32_16x16x32_bf16 a[156:159], v[40:43], v[108:111], a[156:159]
  ds_read_b64_tr_b16 v[38:39], v24 offset:61952
  v_mfma_f32_16x16x32_bf16 a[156:159], v[44:47], v[124:127], a[156:159]
  s_waitcnt lgkmcnt(8)
  v_mfma_f32_16x16x32_bf16 a[160:163], v[48:51], v[96:99], a[160:163]
  ds_read_b64_tr_b16 v[40:41], v24 offset:45064
  v_mfma_f32_16x16x32_bf16 a[160:163], v[52:55], v[112:115], a[160:163]
  v_mfma_f32_16x16x32_bf16 a[164:167], v[48:51], v[100:103], a[164:167]
  ds_read_b64_tr_b16 v[42:43], v24 offset:45576
  v_mfma_f32_16x16x32_bf16 a[164:167], v[52:55], v[116:119], a[164:167]
  v_mfma_f32_16x16x32_bf16 a[168:171], v[48:51], v[104:107], a[168:171]
  ds_read_b64_tr_b16 v[44:45], v24 offset:61448
  v_mfma_f32_16x16x32_bf16 a[168:171], v[52:55], v[120:123], a[168:171]
  v_mfma_f32_16x16x32_bf16 a[172:175], v[48:51], v[108:111], a[172:175]
  ds_read_b64_tr_b16 v[46:47], v24 offset:61960
  v_mfma_f32_16x16x32_bf16 a[172:175], v[52:55], v[124:127], a[172:175]
  s_waitcnt lgkmcnt(8)
  v_mfma_f32_16x16x32_bf16 a[176:179], v[56:59], v[96:99], a[176:179]
  ds_read_b64_tr_b16 v[48:49], v25 offset:45056
  v_mfma_f32_16x16x32_bf16 a[176:179], v[60:63], v[112:115], a[176:179]
  v_mfma_f32_16x16x32_bf16 a[180:183], v[56:59], v[100:103], a[180:183]
  ds_read_b64_tr_b16 v[50:51], v25 offset:45568
  v_mfma_f32_16x16x32_bf16 a[180:183], v[60:63], v[116:119], a[180:183]
  v_mfma_f32_16x16x32_bf16 a[184:187], v[56:59], v[104:107], a[184:187]
  ds_read_b64_tr_b16 v[52:53], v25 offset:61440
  v_mfma_f32_16x16x32_bf16 a[184:187], v[60:63], v[120:123], a[184:187]
  v_mfma_f32_16x16x32_bf16 a[188:191], v[56:59], v[108:111], a[188:191]
  ds_read_b64_tr_b16 v[54:55], v25 offset:61952
  v_mfma_f32_16x16x32_bf16 a[188:191], v[60:63], v[124:127], a[188:191]
  s_waitcnt lgkmcnt(8)
  v_mfma_f32_16x16x32_bf16 a[192:195], v[32:35], v[96:99], a[192:195]
  ds_read_b64_tr_b16 v[56:57], v25 offset:45064
  v_mfma_f32_16x16x32_bf16 a[192:195], v[36:39], v[112:115], a[192:195]
  v_mfma_f32_16x16x32_bf16 a[196:199], v[32:35], v[100:103], a[196:199]
  ds_read_b64_tr_b16 v[58:59], v25 offset:45576
  v_mfma_f32_16x16x32_bf16 a[196:199], v[36:39], v[116:119], a[196:199]
  v_mfma_f32_16x16x32_bf16 a[200:203], v[32:35], v[104:107], a[200:203]
  s_waitcnt vmcnt(0)
  s_barrier
  ds_read_b64_tr_b16 v[60:61], v25 offset:61448
  v_mfma_f32_16x16x32_bf16 a[200:203], v[36:39], v[120:123], a[200:203]
  v_mfma_f32_16x16x32_bf16 a[204:207], v[32:35], v[108:111], a[204:207]
  s_mov_b32 s67, 0
  s_add_u32 m0, s33, 65536
  ds_read_b64_tr_b16 v[62:63], v25 offset:61960
  v_mfma_f32_16x16x32_bf16 a[204:207], v[36:39], v[124:127], a[204:207]
  s_waitcnt lgkmcnt(8)
  buffer_load_dwordx4 v11, s[16:19], s67 offen nt lds
  v_mfma_f32_16x16x32_bf16 a[208:211], v[40:43], v[96:99], a[208:211]
  s_add_u32 m0, s33, 69504
  ds_read_b64_tr_b16 v[32:33], v26 offset:0
  v_mfma_f32_16x16x32_bf16 a[208:211], v[44:47], v[112:115], a[208:211]
  buffer_load_dwordx4 v11, s[16:19], s67 offen offset:128 nt lds
  v_mfma_f32_16x16x32_bf16 a[212:215], v[40:43], v[100:103], a[212:215]
  s_add_u32 m0, s33, 73472
  ds_read_b64_tr_b16 v[34:35], v26 offset:512
  v_mfma_f32_16x16x32_bf16 a[212:215], v[44:47], v[116:119], a[212:215]
  buffer_load_dwordx4 v11, s[16:19], s67 offen offset:256 nt lds
  v_mfma_f32_16x16x32_bf16 a[216:219], v[40:43], v[104:107], a[216:219]
  s_add_u32 m0, s33, 77440
  ds_read_b64_tr_b16 v[36:37], v26 offset:16384
  v_mfma_f32_16x16x32_bf16 a[216:219], v[44:47], v[120:123], a[216:219]
  buffer_load_dwordx4 v11, s[16:19], s67 offen offset:384 nt lds
  v_mfma_f32_16x16x32_bf16 a[220:223], v[40:43], v[108:111], a[220:223]
  ds_read_b64_tr_b16 v[38:39], v26 offset:16896
  v_mfma_f32_16x16x32_bf16 a[220:223], v[44:47], v[124:127], a[220:223]
  s_waitcnt lgkmcnt(8)
  v_mfma_f32_16x16x32_bf16 a[224:227], v[48:51], v[96:99], a[224:227]
  ds_read_b64_tr_b16 v[40:41], v26 offset:8
  v_mfma_f32_16x16x32_bf16 a[224:227], v[52:55], v[112:115], a[224:227]
  v_mfma_f32_16x16x32_bf16 a[228:231], v[48:51], v[100:103], a[228:231]
  ds_read_b64_tr_b16 v[42:43], v26 offset:520
  v_mfma_f32_16x16x32_bf16 a[228:231], v[52:55], v[116:119], a[228:231]
  v_mfma_f32_16x16x32_bf16 a[232:235], v[48:51], v[104:107], a[232:235]
  ds_read_b64_tr_b16 v[44:45], v26 offset:16392
  v_mfma_f32_16x16x32_bf16 a[232:235], v[52:55], v[120:123], a[232:235]
  v_mfma_f32_16x16x32_bf16 a[236:239], v[48:51], v[108:111], a[236:239]
  ds_read_b64_tr_b16 v[46:47], v26 offset:16904
  v_mfma_f32_16x16x32_bf16 a[236:239], v[52:55], v[124:127], a[236:239]
  s_waitcnt lgkmcnt(8)
  v_mfma_f32_16x16x32_bf16 a[240:243], v[56:59], v[96:99], a[240:243]
  ds_read_b64_tr_b16 v[48:49], v27 offset:0
  v_mfma_f32_16x16x32_bf16 a[240:243], v[60:63], v[112:115], a[240:243]
  v_mfma_f32_16x16x32_bf16 a[244:247], v[56:59], v[100:103], a[244:247]
  ds_read_b64_tr_b16 v[50:51], v27 offset:512
  v_mfma_f32_16x16x32_bf16 a[244:247], v[60:63], v[116:119], a[244:247]
  v_mfma_f32_16x16x32_bf16 a[248:251], v[56:59], v[104:107], a[248:251]
  ds_read_b64_tr_b16 v[52:53], v27 offset:16384
  v_mfma_f32_16x16x32_bf16 a[248:251], v[60:63], v[120:123], a[248:251]
  v_mfma_f32_16x16x32_bf16 a[252:255], v[56:59], v[108:111], a[252:255]
  ds_read_b64_tr_b16 v[54:55], v27 offset:16896
  v_mfma_f32_16x16x32_bf16 a[252:255], v[60:63], v[124:127], a[252:255]
  s_waitcnt lgkmcnt(8)
  v_mfma_f32_16x16x32_bf16 a[0:3], v[32:35], v[64:67], a[0:3]
  ds_read_b64_tr_b16 v[56:57], v27 offset:8
  v_mfma_f32_16x16x32_bf16 a[0:3], v[36:39], v[80:83], a[0:3]
  s_mov_b32 s67, 32768
  v_mfma_f32_16x16x32_bf16 a[4:7], v[32:35], v[68:71], a[4:7]
  s_add_u32 m0, s33, 32768
  ds_read_b64_tr_b16 v[58:59], v27 offset:520
  v_mfma_f32_16x16x32_bf16 a[4:7], v[36:39], v[84:87], a[4:7]
  buffer_load_dwordx4 v10, s[12:15], s67 offen nt lds
  v_mfma_f32_16x16x32_bf16 a[8:11], v[32:35], v[72:75], a[8:11]
  ds_read_b64_tr_b16 v[60:61], v27 offset:16392
  v_mfma_f32_16x16x32_bf16 a[8:11], v[36:39], v[88:91], a[8:11]
  v_mfma_f32_16x16x32_bf16 a[12:15], v[32:35], v[76:79], a[12:15]
  ds_read_b64_tr_b16 v[62:63], v27 offset:16904
  v_accvgpr_read_b32 v128, a0
  v_mfma_f32_16x16x32_bf16 a[12:15], v[36:39], v[92:95], a[12:15]
  s_waitcnt lgkmcnt(8)
  v_accvgpr_read_b32 v28, a1
  v_accvgpr_read_b32 v129, a2
  v_mfma_f32_16x16x32_bf16 a[16:19], v[40:43], v[64:67], a[16:19]
  ds_read_b64_tr_b16 v[32:33], v26 offset:4096
  v_accvgpr_read_b32 v29, a3
  v_mfma_f32_16x16x32_bf16 a[16:19], v[44:47], v[80:83], a[16:19]
  v_cvt_pk_bf16_f32 v128, v128, v28
  v_cvt_pk_bf16_f32 v129, v129, v29
  v_mfma_f32_16x16x32_bf16 a[20:23], v[40:43], v[68:71], a[20:23]
  s_add_u32 m0, s33, 36736
  ds_read_b64_tr_b16 v[34:35], v26 offset:4608
  v_accvgpr_read_b32 v160, a4
  v_mfma_f32_16x16x32_bf16 a[20:23], v[44:47], v[84:87], a[20:23]
  buffer_load_dwordx4 v10, s[12:15], s67 offen offset:128 nt lds
  v_mfma_f32_16x16x32_bf16 a[24:27], v[40:43], v[72:75], a[24:27]
  ds_read_b64_tr_b16 v[36:37], v26 offset:20480
  v_accvgpr_read_b32 v30, a5
  v_mfma_f32_16x16x32_bf16 a[24:27], v[44:47], v[88:91], a[24:27]
  v_accvgpr_read_b32 v161, a6
  v_accvgpr_read_b32 v31, a7
  v_mfma_f32_16x16x32_bf16 a[28:31], v[40:43], v[76:79], a[28:31]
  ds_read_b64_tr_b16 v[38:39], v26 offset:20992
  v_cvt_pk_bf16_f32 v160, v160, v30
  v_mfma_f32_16x16x32_bf16 a[28:31], v[44:47], v[92:95], a[28:31]
  s_waitcnt lgkmcnt(8)
  v_cvt_pk_bf16_f32 v161, v161, v31
  v_accvgpr_read_b32 v192, a8
  v_mfma_f32_16x16x32_bf16 a[32:35], v[48:51], v[64:67], a[32:35]
  ds_read_b64_tr_b16 v[40:41], v26 offset:4104
  v_accvgpr_read_b32 v28, a9
  v_mfma_f32_16x16x32_bf16 a[32:35], v[52:55], v[80:83], a[32:35]
  v_accvgpr_read_b32 v193, a10
  v_accvgpr_read_b32 v29, a11
  v_mfma_f32_16x16x32_bf16 a[36:39], v[48:51], v[68:71], a[36:39]
  s_add_u32 m0, s33, 40704
  ds_read_b64_tr_b16 v[42:43], v26 offset:4616
  v_cvt_pk_bf16_f32 v192, v192, v28
  v_mfma_f32_16x16x32_bf16 a[36:39], v[52:55], v[84:87], a[36:39]
  buffer_load_dwordx4 v10, s[12:15], s67 offen offset:256 nt lds
  v_mfma_f32_16x16x32_bf16 a[40:43], v[48:51], v[72:75], a[40:43]
  ds_read_b64_tr_b16 v[44:45], v26 offset:20488
  v_cvt_pk_bf16_f32 v193, v193, v29
  v_mfma_f32_16x16x32_bf16 a[40:43], v[52:55], v[88:91], a[40:43]
  v_accvgpr_read_b32 v224, a12
  v_accvgpr_read_b32 v30, a13
  v_mfma_f32_16x16x32_bf16 a[44:47], v[48:51], v[76:79], a[44:47]
  ds_read_b64_tr_b16 v[46:47], v26 offset:21000
  v_accvgpr_read_b32 v225, a14
  v_mfma_f32_16x16x32_bf16 a[44:47], v[52:55], v[92:95], a[44:47]
  s_waitcnt lgkmcnt(8)
  v_accvgpr_read_b32 v31, a15
  v_cvt_pk_bf16_f32 v224, v224, v30
  v_mfma_f32_16x16x32_bf16 a[48:51], v[56:59], v[64:67], a[48:51]
  ds_read_b64_tr_b16 v[48:49], v27 offset:4096
  v_cvt_pk_bf16_f32 v225, v225, v31
  v_mfma_f32_16x16x32_bf16 a[48:51], v[60:63], v[80:83], a[48:51]
  v_accvgpr_read_b32 v130, a16
  v_accvgpr_read_b32 v28, a17
  v_mfma_f32_16x16x32_bf16 a[52:55], v[56:59], v[68:71], a[52:55]
  s_add_u32 m0, s33, 44672
  ds_read_b64_tr_b16 v[50:51], v27 offset:4608
  v_accvgpr_read_b32 v131, a18
  v_mfma_f32_16x16x32_bf16 a[52:55], v[60:63], v[84:87], a[52:55]
  buffer_load_dwordx4 v10, s[12:15], s67 offen offset:384 nt lds
  v_mfma_f32_16x16x32_bf16 a[56:59], v[56:59], v[72:75], a[56:59]
  ds_read_b64_tr_b16 v[52:53], v27 offset:20480
  v_accvgpr_read_b32 v29, a19
  v_mfma_f32_16x16x32_bf16 a[56:59], v[60:63], v[88:91], a[56:59]
  v_cvt_pk_bf16_f32 v130, v130, v28
  v_cvt_pk_bf16_f32 v131, v131, v29
  v_mfma_f32_16x16x32_bf16 a[60:63], v[56:59], v[76:79], a[60:63]
  ds_read_b64_tr_b16 v[54:55], v27 offset:20992
  v_accvgpr_read_b32 v162, a20
  v_mfma_f32_16x16x32_bf16 a[60:63], v[60:63], v[92:95], a[60:63]
  s_waitcnt lgkmcnt(8)
  v_accvgpr_read_b32 v30, a21
  v_accvgpr_read_b32 v163, a22
  v_mfma_f32_16x16x32_bf16 a[64:67], v[32:35], v[64:67], a[64:67]
  ds_read_b64_tr_b16 v[56:57], v27 offset:4104
  v_accvgpr_read_b32 v31, a23
  v_mfma_f32_16x16x32_bf16 a[64:67], v[36:39], v[80:83], a[64:67]
  s_mov_b32 s67, 16384
  v_cvt_pk_bf16_f32 v162, v162, v30
  v_cvt_pk_bf16_f32 v163, v163, v31
  v_mfma_f32_16x16x32_bf16 a[68:71], v[32:35], v[68:71], a[68:71]
  s_add_u32 m0, s33, 81920
  ds_read_b64_tr_b16 v[58:59], v27 offset:4616
  v_accvgpr_read_b32 v194, a24
  v_mfma_f32_16x16x32_bf16 a[68:71], v[36:39], v[84:87], a[68:71]
  buffer_load_dwordx4 v11, s[16:19], s67 offen nt lds
  v_mfma_f32_16x16x32_bf16 a[72:75], v[32:35], v[72:75], a[72:75]
  ds_read_b64_tr_b16 v[60:61], v27 offset:20488
  v_accvgpr_read_b32 v28, a25
  v_mfma_f32_16x16x32_bf16 a[72:75], v[36:39], v[88:91], a[72:75]
  v_accvgpr_read_b32 v195, a26
  v_accvgpr_read_b32 v29, a27
  v_mfma_f32_16x16x32_bf16 a[76:79], v[32:35], v[76:79], a[76:79]
  ds_read_b64_tr_b16 v[62:63], v27 offset:21000
  v_cvt_pk_bf16_f32 v194, v194, v28
  v_mfma_f32_16x16x32_bf16 a[76:79], v[36:39], v[92:95], a[76:79]
  s_waitcnt lgkmcnt(8)
  v_cvt_pk_bf16_f32 v195, v195, v29
  v_accvgpr_read_b32 v226, a28
  v_mfma_f32_16x16x32_bf16 a[80:83], v[40:43], v[64:67], a[80:83]
  ds_read_b64_tr_b16 v[32:33], v26 offset:8192
  v_accvgpr_read_b32 v30, a29
  v_mfma_f32_16x16x32_bf16 a[80:83], v[44:47], v[80:83], a[80:83]
  v_accvgpr_read_b32 v227, a30
  v_accvgpr_read_b32 v31, a31
  v_mfma_f32_16x16x32_bf16 a[84:87], v[40:43], v[68:71], a[84:87]
  s_add_u32 m0, s33, 85888
  ds_read_b64_tr_b16 v[34:35], v26 offset:8704
  v_cvt_pk_bf16_f32 v226, v226, v30
  v_mfma_f32_16x16x32_bf16 a[84:87], v[44:47], v[84:87], a[84:87]
  buffer_load_dwordx4 v11, s[16:19], s67 offen offset:128 nt lds
  v_mfma_f32_16x16x32_bf16 a[88:91], v[40:43], v[72:75], a[88:91]
  ds_read_b64_tr_b16 v[36:37], v26 offset:24576
  v_cvt_pk_bf16_f32 v227, v227, v31
  v_mfma_f32_16x16x32_bf16 a[88:91], v[44:47], v[88:91], a[88:91]
  v_accvgpr_read_b32 v132, a32
  v_accvgpr_read_b32 v28, a33
  v_mfma_f32_16x16x32_bf16 a[92:95], v[40:43], v[76:79], a[92:95]
  ds_read_b64_tr_b16 v[38:39], v26 offset:25088
  v_accvgpr_read_b32 v133, a34
  v_mfma_f32_16x16x32_bf16 a[92:95], v[44:47], v[92:95], a[92:95]
  s_waitcnt lgkmcnt(8)
  v_accvgpr_read_b32 v29, a35
  v_cvt_pk_bf16_f32 v132, v132, v28
  v_mfma_f32_16x16x32_bf16 a[96:99], v[48:51], v[64:67], a[96:99]
  ds_read_b64_tr_b16 v[40:41], v26 offset:8200
  v_cvt_pk_bf16_f32 v133, v133, v29
  v_mfma_f32_16x16x32_bf16 a[96:99], v[52:55], v[80:83], a[96:99]
  v_accvgpr_read_b32 v164, a36
  v_accvgpr_read_b32 v30, a37
  v_mfma_f32_16x16x32_bf16 a[100:103], v[48:51], v[68:71], a[100:103]
  s_add_u32 m0, s33, 89856
  ds_read_b64_tr_b16 v[42:43], v26 offset:8712
  v_accvgpr_read_b32 v165, a38
  v_mfma_f32_16x16x32_bf16 a[100:103], v[52:55], v[84:87], a[100:103]
  buffer_load_dwordx4 v11, s[16:19], s67 offen offset:256 nt lds
  v_mfma_f32_16x16x32_bf16 a[104:107], v[48:51], v[72:75], a[104:107]
  ds_read_b64_tr_b16 v[44:45], v26 offset:24584
  v_accvgpr_read_b32 v31, a39
  v_mfma_f32_16x16x32_bf16 a[104:107], v[52:55], v[88:91], a[104:107]
  v_cvt_pk_bf16_f32 v164, v164, v30
  v_cvt_pk_bf16_f32 v165, v165, v31
  v_mfma_f32_16x16x32_bf16 a[108:111], v[48:51], v[76:79], a[108:111]
  ds_read_b64_tr_b16 v[46:47], v26 offset:25096
  v_accvgpr_read_b32 v196, a40
  v_mfma_f32_16x16x32_bf16 a[108:111], v[52:55], v[92:95], a[108:111]
  s_waitcnt lgkmcnt(8)
  v_accvgpr_read_b32 v28, a41
  v_accvgpr_read_b32 v197, a42
  v_mfma_f32_16x16x32_bf16 a[112:115], v[56:59], v[64:67], a[112:115]
  ds_read_b64_tr_b16 v[48:49], v27 offset:8192
  v_accvgpr_read_b32 v29, a43
  v_mfma_f32_16x16x32_bf16 a[112:115], v[60:63], v[80:83], a[112:115]
  v_cvt_pk_bf16_f32 v196, v196, v28
  v_cvt_pk_bf16_f32 v197, v197, v29
  v_mfma_f32_16x16x32_bf16 a[116:119], v[56:59], v[68:71], a[116:119]
  s_add_u32 m0, s33, 93824
  ds_read_b64_tr_b16 v[50:51], v27 offset:8704
  v_accvgpr_read_b32 v228, a44
  v_mfma_f32_16x16x32_bf16 a[116:119], v[60:63], v[84:87], a[116:119]
  buffer_load_dwordx4 v11, s[16:19], s67 offen offset:384 nt lds
  v_mfma_f32_16x16x32_bf16 a[120:123], v[56:59], v[72:75], a[120:123]
  ds_read_b64_tr_b16 v[52:53], v27 offset:24576
  v_accvgpr_read_b32 v30, a45
  v_mfma_f32_16x16x32_bf16 a[120:123], v[60:63], v[88:91], a[120:123]
  v_accvgpr_read_b32 v229, a46
  v_accvgpr_read_b32 v31, a47
  v_mfma_f32_16x16x32_bf16 a[124:127], v[56:59], v[76:79], a[124:127]
  ds_read_b64_tr_b16 v[54:55], v27 offset:25088
  v_cvt_pk_bf16_f32 v228, v228, v30
  v_mfma_f32_16x16x32_bf16 a[124:127], v[60:63], v[92:95], a[124:127]
  s_waitcnt lgkmcnt(8)
  v_cvt_pk_bf16_f32 v229, v229, v31
  v_accvgpr_read_b32 v134, a48
  v_mfma_f32_16x16x32_bf16 a[128:131], v[32:35], v[64:67], a[128:131]
  ds_read_b64_tr_b16 v[56:57], v27 offset:8200
  v_accvgpr_read_b32 v28, a49
  v_mfma_f32_16x16x32_bf16 a[128:131], v[36:39], v[80:83], a[128:131]
  s_mov_b32 s67, 49152
  v_accvgpr_read_b32 v135, a50
  v_accvgpr_read_b32 v29, a51
  v_mfma_f32_16x16x32_bf16 a[132:135], v[32:35], v[68:71], a[132:135]
  s_add_u32 m0, s33, 49152
  ds_read_b64_tr_b16 v[58:59], v27 offset:8712
  v_cvt_pk_bf16_f32 v134, v134, v28
  v_mfma_f32_16x16x32_bf16 a[132:135], v[36:39], v[84:87], a[132:135]
  buffer_load_dwordx4 v10, s[12:15], s67 offen nt lds
  v_mfma_f32_16x16x32_bf16 a[136:139], v[32:35], v[72:75], a[136:139]
  ds_read_b64_tr_b16 v[60:61], v27 offset:24584
  v_cvt_pk_bf16_f32 v135, v135, v29
  v_mfma_f32_16x16x32_bf16 a[136:139], v[36:39], v[88:91], a[136:139]
  v_accvgpr_read_b32 v166, a52
  v_accvgpr_read_b32 v30, a53
  v_mfma_f32_16x16x32_bf16 a[140:143], v[32:35], v[76:79], a[140:143]
  ds_read_b64_tr_b16 v[62:63], v27 offset:25096
  v_accvgpr_read_b32 v167, a54
  v_mfma_f32_16x16x32_bf16 a[140:143], v[36:39], v[92:95], a[140:143]
  s_waitcnt lgkmcnt(8)
  v_accvgpr_read_b32 v31, a55
  v_cvt_pk_bf16_f32 v166, v166, v30
  v_mfma_f32_16x16x32_bf16 a[144:147], v[40:43], v[64:67], a[144:147]
  ds_read_b64_tr_b16 v[32:33], v26 offset:12288
  v_cvt_pk_bf16_f32 v167, v167, v31
  v_mfma_f32_16x16x32_bf16 a[144:147], v[44:47], v[80:83], a[144:147]
  v_accvgpr_read_b32 v198, a56
  v_accvgpr_read_b32 v28, a57
  v_mfma_f32_16x16x32_bf16 a[148:151], v[40:43], v[68:71], a[148:151]
  s_add_u32 m0, s33, 53120
  ds_read_b64_tr_b16 v[34:35], v26 offset:12800
  v_accvgpr_read_b32 v199, a58
  v_mfma_f32_16x16x32_bf16 a[148:151], v[44:47], v[84:87], a[148:151]
  buffer_load_dwordx4 v10, s[12:15], s67 offen offset:128 nt lds
  v_mfma_f32_16x16x32_bf16 a[152:155], v[40:43], v[72:75], a[152:155]
  ds_read_b64_tr_b16 v[36:37], v26 offset:28672
  v_accvgpr_read_b32 v29, a59
  v_mfma_f32_16x16x32_bf16 a[152:155], v[44:47], v[88:91], a[152:155]
  v_cvt_pk_bf16_f32 v198, v198, v28
  v_cvt_pk_bf16_f32 v199, v199, v29
  v_mfma_f32_16x16x32_bf16 a[156:159], v[40:43], v[76:79], a[156:159]
  ds_read_b64_tr_b16 v[38:39], v26 offset:29184
  v_accvgpr_read_b32 v230, a60
  v_mfma_f32_16x16x32_bf16 a[156:159], v[44:47], v[92:95], a[156:159]
  s_waitcnt lgkmcnt(8)
  v_accvgpr_read_b32 v30, a61
  v_accvgpr_read_b32 v231, a62
  v_mfma_f32_16x16x32_bf16 a[160:163], v[48:51], v[64:67], a[160:163]
  ds_read_b64_tr_b16 v[40:41], v26 offset:12296
  v_accvgpr_read_b32 v31, a63
  v_mfma_f32_16x16x32_bf16 a[160:163], v[52:55], v[80:83], a[160:163]
  v_cvt_pk_bf16_f32 v230, v230, v30
  v_cvt_pk_bf16_f32 v231, v231, v31
  v_mfma_f32_16x16x32_bf16 a[164:167], v[48:51], v[68:71], a[164:167]
  s_add_u32 m0, s33, 57088
  ds_read_b64_tr_b16 v[42:43], v26 offset:12808
  v_accvgpr_read_b32 v136, a64
  v_mfma_f32_16x16x32_bf16 a[164:167], v[52:55], v[84:87], a[164:167]
  buffer_load_dwordx4 v10, s[12:15], s67 offen offset:256 nt lds
  v_mfma_f32_16x16x32_bf16 a[168:171], v[48:51], v[72:75], a[168:171]
  ds_read_b64_tr_b16 v[44:45], v26 offset:28680
  v_accvgpr_read_b32 v28, a65
  v_mfma_f32_16x16x32_bf16 a[168:171], v[52:55], v[88:91], a[168:171]
  v_accvgpr_read_b32 v137, a66
  v_accvgpr_read_b32 v29, a67
  v_mfma_f32_16x16x32_bf16 a[172:175], v[48:51], v[76:79], a[172:175]
  ds_read_b64_tr_b16 v[46:47], v26 offset:29192
  v_cvt_pk_bf16_f32 v136, v136, v28
  v_mfma_f32_16x16x32_bf16 a[172:175], v[52:55], v[92:95], a[172:175]
  s_waitcnt lgkmcnt(8)
  v_cvt_pk_bf16_f32 v137, v137, v29
  v_accvgpr_read_b32 v168, a68
  v_mfma_f32_16x16x32_bf16 a[176:179], v[56:59], v[64:67], a[176:179]
  ds_read_b64_tr_b16 v[48:49], v27 offset:12288
  v_accvgpr_read_b32 v30, a69
  v_mfma_f32_16x16x32_bf16 a[176:179], v[60:63], v[80:83], a[176:179]
  v_accvgpr_read_b32 v169, a70
  v_accvgpr_read_b32 v31, a71
  v_mfma_f32_16x16x32_bf16 a[180:183], v[56:59], v[68:71], a[180:183]
  s_add_u32 m0, s33, 61056
  ds_read_b64_tr_b16 v[50:51], v27 offset:12800
  v_cvt_pk_bf16_f32 v168, v168, v30
  v_mfma_f32_16x16x32_bf16 a[180:183], v[60:63], v[84:87], a[180:183]
  buffer_load_dwordx4 v10, s[12:15], s67 offen offset:384 nt lds
  v_mfma_f32_16x16x32_bf16 a[184:187], v[56:59], v[72:75], a[184:187]
  ds_read_b64_tr_b16 v[52:53], v27 offset:28672
  v_cvt_pk_bf16_f32 v169, v169, v31
  v_mfma_f32_16x16x32_bf16 a[184:187], v[60:63], v[88:91], a[184:187]
  v_accvgpr_read_b32 v200, a72
  v_accvgpr_read_b32 v28, a73
  v_mfma_f32_16x16x32_bf16 a[188:191], v[56:59], v[76:79], a[188:191]
  ds_read_b64_tr_b16 v[54:55], v27 offset:29184
  v_accvgpr_read_b32 v201, a74
  v_mfma_f32_16x16x32_bf16 a[188:191], v[60:63], v[92:95], a[188:191]
  s_waitcnt lgkmcnt(8)
  v_accvgpr_read_b32 v29, a75
  v_cvt_pk_bf16_f32 v200, v200, v28
  v_mfma_f32_16x16x32_bf16 a[192:195], v[32:35], v[64:67], a[192:195]
  ds_read_b64_tr_b16 v[56:57], v27 offset:12296
  v_cvt_pk_bf16_f32 v201, v201, v29
  v_mfma_f32_16x16x32_bf16 a[192:195], v[36:39], v[80:83], a[192:195]
  v_accvgpr_read_b32 v232, a76
  v_accvgpr_read_b32 v30, a77
  v_mfma_f32_16x16x32_bf16 a[196:199], v[32:35], v[68:71], a[196:199]
  ds_read_b64_tr_b16 v[58:59], v27 offset:12808
  v_accvgpr_read_b32 v233, a78
  v_mfma_f32_16x16x32_bf16 a[196:199], v[36:39], v[84:87], a[196:199]
  v_accvgpr_read_b32 v31, a79
  v_cvt_pk_bf16_f32 v232, v232, v30
  v_mfma_f32_16x16x32_bf16 a[200:203], v[32:35], v[72:75], a[200:203]
  s_waitcnt vmcnt(16)
  s_barrier
  ds_read_b64_tr_b16 v[60:61], v27 offset:28680
  v_mfma_f32_16x16x32_bf16 a[200:203], v[36:39], v[88:91], a[200:203]
  v_cvt_pk_bf16_f32 v233, v233, v31
  v_accvgpr_read_b32 v138, a80
  v_mfma_f32_16x16x32_bf16 a[204:207], v[32:35], v[76:79], a[204:207]
  s_mov_b32 s67, 32768
  s_add_u32 m0, s33, 98304
  ds_read_b64_tr_b16 v[62:63], v27 offset:29192
  v_mfma_f32_16x16x32_bf16 a[204:207], v[36:39], v[92:95], a[204:207]
  s_waitcnt lgkmcnt(8)
  buffer_load_dwordx4 v11, s[16:19], s67 offen nt lds
  v_mfma_f32_16x16x32_bf16 a[208:211], v[40:43], v[64:67], a[208:211]
  s_add_u32 m0, s33, 102272
  v_accvgpr_read_b32 v28, a81
  v_accvgpr_read_b32 v139, a82
  v_mfma_f32_16x16x32_bf16 a[208:211], v[44:47], v[80:83], a[208:211]
  buffer_load_dwordx4 v11, s[16:19], s67 offen offset:128 nt lds
  v_mfma_f32_16x16x32_bf16 a[212:215], v[40:43], v[68:71], a[212:215]
  s_add_u32 m0, s33, 106240
  v_accvgpr_read_b32 v29, a83
  v_cvt_pk_bf16_f32 v138, v138, v28
  v_mfma_f32_16x16x32_bf16 a[212:215], v[44:47], v[84:87], a[212:215]
  buffer_load_dwordx4 v11, s[16:19], s67 offen offset:256 nt lds
  v_mfma_f32_16x16x32_bf16 a[216:219], v[40:43], v[72:75], a[216:219]
  s_add_u32 m0, s33, 110208
  v_cvt_pk_bf16_f32 v139, v139, v29
  v_accvgpr_read_b32 v170, a84
  v_mfma_f32_16x16x32_bf16 a[216:219], v[44:47], v[88:91], a[216:219]
  buffer_load_dwordx4 v11, s[16:19], s67 offen offset:384 nt lds
  v_mfma_f32_16x16x32_bf16 a[220:223], v[40:43], v[76:79], a[220:223]
  v_accvgpr_read_b32 v30, a85
  v_accvgpr_read_b32 v171, a86
  v_mfma_f32_16x16x32_bf16 a[220:223], v[44:47], v[92:95], a[220:223]
  s_waitcnt lgkmcnt(4)
  v_accvgpr_read_b32 v31, a87
  v_cvt_pk_bf16_f32 v170, v170, v30
  v_mfma_f32_16x16x32_bf16 a[224:227], v[48:51], v[64:67], a[224:227]
  v_cvt_pk_bf16_f32 v171, v171, v31
  v_accvgpr_read_b32 v202, a88
  v_mfma_f32_16x16x32_bf16 a[224:227], v[52:55], v[80:83], a[224:227]
  v_accvgpr_read_b32 v28, a89
  v_accvgpr_read_b32 v203, a90
  v_mfma_f32_16x16x32_bf16 a[228:231], v[48:51], v[68:71], a[228:231]
  v_accvgpr_read_b32 v29, a91
  v_cvt_pk_bf16_f32 v202, v202, v28
  v_mfma_f32_16x16x32_bf16 a[228:231], v[52:55], v[84:87], a[228:231]
  v_cvt_pk_bf16_f32 v203, v203, v29
  v_accvgpr_read_b32 v234, a92
  v_mfma_f32_16x16x32_bf16 a[232:235], v[48:51], v[72:75], a[232:235]
  v_accvgpr_read_b32 v30, a93
  v_accvgpr_read_b32 v235, a94
  v_mfma_f32_16x16x32_bf16 a[232:235], v[52:55], v[88:91], a[232:235]
  v_accvgpr_read_b32 v31, a95
  v_cvt_pk_bf16_f32 v234, v234, v30
  v_mfma_f32_16x16x32_bf16 a[236:239], v[48:51], v[76:79], a[236:239]
  v_cvt_pk_bf16_f32 v235, v235, v31
  v_accvgpr_read_b32 v140, a96
  v_mfma_f32_16x16x32_bf16 a[236:239], v[52:55], v[92:95], a[236:239]
  s_waitcnt lgkmcnt(0)
  v_accvgpr_read_b32 v28, a97
  v_accvgpr_read_b32 v141, a98
  v_mfma_f32_16x16x32_bf16 a[240:243], v[56:59], v[64:67], a[240:243]
  v_accvgpr_read_b32 v29, a99
  v_cvt_pk_bf16_f32 v140, v140, v28
  v_mfma_f32_16x16x32_bf16 a[240:243], v[60:63], v[80:83], a[240:243]
  v_cvt_pk_bf16_f32 v141, v141, v29
  v_accvgpr_read_b32 v172, a100
  v_mfma_f32_16x16x32_bf16 a[244:247], v[56:59], v[68:71], a[244:247]
  v_accvgpr_read_b32 v30, a101
  v_accvgpr_read_b32 v173, a102
  v_mfma_f32_16x16x32_bf16 a[244:247], v[60:63], v[84:87], a[244:247]
  v_accvgpr_read_b32 v31, a103
  v_cvt_pk_bf16_f32 v172, v172, v30
  v_mfma_f32_16x16x32_bf16 a[248:251], v[56:59], v[72:75], a[248:251]
  v_cvt_pk_bf16_f32 v173, v173, v31
  v_accvgpr_read_b32 v204, a104
  v_mfma_f32_16x16x32_bf16 a[248:251], v[60:63], v[88:91], a[248:251]
  v_accvgpr_read_b32 v28, a105
  v_accvgpr_read_b32 v205, a106
  v_mfma_f32_16x16x32_bf16 a[252:255], v[56:59], v[76:79], a[252:255]
  v_accvgpr_read_b32 v29, a107
  v_cvt_pk_bf16_f32 v204, v204, v28
  v_mfma_f32_16x16x32_bf16 a[252:255], v[60:63], v[92:95], a[252:255]
  v_cvt_pk_bf16_f32 v205, v205, v29
  v_accvgpr_read_b32 v236, a108
  s_nop 7
  v_accvgpr_read_b32 v30, a109
  v_accvgpr_read_b32 v237, a110
  v_accvgpr_read_b32 v31, a111
  v_cvt_pk_bf16_f32 v236, v236, v30
  v_cvt_pk_bf16_f32 v237, v237, v31
  v_accvgpr_read_b32 v142, a112
  v_accvgpr_read_b32 v28, a113
  v_accvgpr_read_b32 v143, a114
  v_accvgpr_read_b32 v29, a115
  v_cvt_pk_bf16_f32 v142, v142, v28
  v_cvt_pk_bf16_f32 v143, v143, v29
  v_accvgpr_read_b32 v174, a116
  v_accvgpr_read_b32 v30, a117
  v_accvgpr_read_b32 v175, a118
  v_accvgpr_read_b32 v31, a119
  v_cvt_pk_bf16_f32 v174, v174, v30
  v_cvt_pk_bf16_f32 v175, v175, v31
  v_accvgpr_read_b32 v206, a120
  v_accvgpr_read_b32 v28, a121
  v_accvgpr_read_b32 v207, a122
  v_accvgpr_read_b32 v29, a123
  v_cvt_pk_bf16_f32 v206, v206, v28
  v_cvt_pk_bf16_f32 v207, v207, v29
  v_accvgpr_read_b32 v238, a124
  v_accvgpr_read_b32 v30, a125
  v_accvgpr_read_b32 v239, a126
  v_accvgpr_read_b32 v31, a127
  v_cvt_pk_bf16_f32 v238, v238, v30
  v_cvt_pk_bf16_f32 v239, v239, v31
  v_accvgpr_read_b32 v144, a128
  v_accvgpr_read_b32 v28, a129
  v_accvgpr_read_b32 v145, a130
  v_accvgpr_read_b32 v29, a131
  v_cvt_pk_bf16_f32 v144, v144, v28
  v_cvt_pk_bf16_f32 v145, v145, v29
  v_accvgpr_read_b32 v176, a132
  v_accvgpr_read_b32 v30, a133
  v_accvgpr_read_b32 v177, a134
  v_accvgpr_read_b32 v31, a135
  v_cvt_pk_bf16_f32 v176, v176, v30
  v_cvt_pk_bf16_f32 v177, v177, v31
  v_accvgpr_read_b32 v208, a136
  v_accvgpr_read_b32 v28, a137
  v_accvgpr_read_b32 v209, a138
  v_accvgpr_read_b32 v29, a139
  v_cvt_pk_bf16_f32 v208, v208, v28
  v_cvt_pk_bf16_f32 v209, v209, v29
  v_accvgpr_read_b32 v240, a140
  v_accvgpr_read_b32 v30, a141
  v_accvgpr_read_b32 v241, a142
  v_accvgpr_read_b32 v31, a143
  v_cvt_pk_bf16_f32 v240, v240, v30
  v_cvt_pk_bf16_f32 v241, v241, v31
  v_accvgpr_read_b32 v146, a144
  v_accvgpr_read_b32 v28, a145
  v_accvgpr_read_b32 v147, a146
  v_accvgpr_read_b32 v29, a147
  v_cvt_pk_bf16_f32 v146, v146, v28
  v_cvt_pk_bf16_f32 v147, v147, v29
  v_accvgpr_read_b32 v178, a148
  v_accvgpr_read_b32 v30, a149
  v_accvgpr_read_b32 v179, a150
  v_accvgpr_read_b32 v31, a151
  v_cvt_pk_bf16_f32 v178, v178, v30
  v_cvt_pk_bf16_f32 v179, v179, v31
  v_accvgpr_read_b32 v210, a152
  v_accvgpr_read_b32 v28, a153
  v_accvgpr_read_b32 v211, a154
  v_accvgpr_read_b32 v29, a155
  v_cvt_pk_bf16_f32 v210, v210, v28
  v_cvt_pk_bf16_f32 v211, v211, v29
  v_accvgpr_read_b32 v242, a156
  v_accvgpr_read_b32 v30, a157
  v_accvgpr_read_b32 v243, a158
  v_accvgpr_read_b32 v31, a159
  v_cvt_pk_bf16_f32 v242, v242, v30
  v_cvt_pk_bf16_f32 v243, v243, v31
  v_accvgpr_read_b32 v148, a160
  v_accvgpr_read_b32 v28, a161
  v_accvgpr_read_b32 v149, a162
  v_accvgpr_read_b32 v29, a163
  v_cvt_pk_bf16_f32 v148, v148, v28
  v_cvt_pk_bf16_f32 v149, v149, v29
  v_accvgpr_read_b32 v180, a164
  v_accvgpr_read_b32 v30, a165
  v_accvgpr_read_b32 v181, a166
  v_accvgpr_read_b32 v31, a167
  v_cvt_pk_bf16_f32 v180, v180, v30
  v_cvt_pk_bf16_f32 v181, v181, v31
  v_accvgpr_read_b32 v212, a168
  v_accvgpr_read_b32 v28, a169
  v_accvgpr_read_b32 v213, a170
  v_accvgpr_read_b32 v29, a171
  v_cvt_pk_bf16_f32 v212, v212, v28
  v_cvt_pk_bf16_f32 v213, v213, v29
  v_accvgpr_read_b32 v244, a172
  v_accvgpr_read_b32 v30, a173
  v_accvgpr_read_b32 v245, a174
  v_accvgpr_read_b32 v31, a175
  v_cvt_pk_bf16_f32 v244, v244, v30
  v_cvt_pk_bf16_f32 v245, v245, v31
  v_accvgpr_read_b32 v150, a176
  v_accvgpr_read_b32 v28, a177
  v_accvgpr_read_b32 v151, a178
  v_accvgpr_read_b32 v29, a179
  v_cvt_pk_bf16_f32 v150, v150, v28
  v_cvt_pk_bf16_f32 v151, v151, v29
  v_accvgpr_read_b32 v182, a180
  v_accvgpr_read_b32 v30, a181
  v_accvgpr_read_b32 v183, a182
  v_accvgpr_read_b32 v31, a183
  v_cvt_pk_bf16_f32 v182, v182, v30
  v_cvt_pk_bf16_f32 v183, v183, v31
  v_accvgpr_read_b32 v214, a184
  v_accvgpr_read_b32 v28, a185
  v_accvgpr_read_b32 v215, a186
  v_accvgpr_read_b32 v29, a187
  v_cvt_pk_bf16_f32 v214, v214, v28
  v_cvt_pk_bf16_f32 v215, v215, v29
  v_accvgpr_read_b32 v246, a188
  v_accvgpr_read_b32 v30, a189
  v_accvgpr_read_b32 v247, a190
  v_accvgpr_read_b32 v31, a191
  v_cvt_pk_bf16_f32 v246, v246, v30
  v_cvt_pk_bf16_f32 v247, v247, v31
  v_accvgpr_read_b32 v152, a192
  v_accvgpr_read_b32 v28, a193
  v_accvgpr_read_b32 v153, a194
  v_accvgpr_read_b32 v29, a195
  v_cvt_pk_bf16_f32 v152, v152, v28
  v_cvt_pk_bf16_f32 v153, v153, v29
  v_accvgpr_read_b32 v184, a196
  v_accvgpr_read_b32 v30, a197
  v_accvgpr_read_b32 v185, a198
  v_accvgpr_read_b32 v31, a199
  v_cvt_pk_bf16_f32 v184, v184, v30
  v_cvt_pk_bf16_f32 v185, v185, v31
  v_accvgpr_read_b32 v216, a200
  v_accvgpr_read_b32 v28, a201
  v_accvgpr_read_b32 v217, a202
  v_accvgpr_read_b32 v29, a203
  v_cvt_pk_bf16_f32 v216, v216, v28
  v_cvt_pk_bf16_f32 v217, v217, v29
  v_accvgpr_read_b32 v248, a204
  v_accvgpr_read_b32 v30, a205
  v_accvgpr_read_b32 v249, a206
  v_accvgpr_read_b32 v31, a207
  v_cvt_pk_bf16_f32 v248, v248, v30
  v_cvt_pk_bf16_f32 v249, v249, v31
  v_accvgpr_read_b32 v154, a208
  v_accvgpr_read_b32 v28, a209
  v_accvgpr_read_b32 v155, a210
  v_accvgpr_read_b32 v29, a211
  v_cvt_pk_bf16_f32 v154, v154, v28
  v_cvt_pk_bf16_f32 v155, v155, v29
  v_accvgpr_read_b32 v186, a212
  v_accvgpr_read_b32 v30, a213
  v_accvgpr_read_b32 v187, a214
  v_accvgpr_read_b32 v31, a215
  v_cvt_pk_bf16_f32 v186, v186, v30
  v_cvt_pk_bf16_f32 v187, v187, v31
  v_accvgpr_read_b32 v218, a216
  v_accvgpr_read_b32 v28, a217
  v_accvgpr_read_b32 v219, a218
  v_accvgpr_read_b32 v29, a219
  v_cvt_pk_bf16_f32 v218, v218, v28
  v_cvt_pk_bf16_f32 v219, v219, v29
  v_accvgpr_read_b32 v250, a220
  v_accvgpr_read_b32 v30, a221
  v_accvgpr_read_b32 v251, a222
  v_accvgpr_read_b32 v31, a223
  v_cvt_pk_bf16_f32 v250, v250, v30
  v_cvt_pk_bf16_f32 v251, v251, v31
  v_accvgpr_read_b32 v156, a224
  v_accvgpr_read_b32 v28, a225
  v_accvgpr_read_b32 v157, a226
  v_accvgpr_read_b32 v29, a227
  v_cvt_pk_bf16_f32 v156, v156, v28
  v_cvt_pk_bf16_f32 v157, v157, v29
  v_accvgpr_read_b32 v188, a228
  v_accvgpr_read_b32 v30, a229
  v_accvgpr_read_b32 v189, a230
  v_accvgpr_read_b32 v31, a231
  v_cvt_pk_bf16_f32 v188, v188, v30
  v_cvt_pk_bf16_f32 v189, v189, v31
  v_accvgpr_read_b32 v220, a232
  v_accvgpr_read_b32 v28, a233
  v_accvgpr_read_b32 v221, a234
  v_accvgpr_read_b32 v29, a235
  v_cvt_pk_bf16_f32 v220, v220, v28
  v_cvt_pk_bf16_f32 v221, v221, v29
  v_accvgpr_read_b32 v252, a236
  v_accvgpr_read_b32 v30, a237
  v_accvgpr_read_b32 v253, a238
  v_accvgpr_read_b32 v31, a239
  v_cvt_pk_bf16_f32 v252, v252, v30
  v_cvt_pk_bf16_f32 v253, v253, v31
  v_accvgpr_read_b32 v158, a240
  v_accvgpr_read_b32 v28, a241
  v_accvgpr_read_b32 v159, a242
  v_accvgpr_read_b32 v29, a243
  v_cvt_pk_bf16_f32 v158, v158, v28
  v_cvt_pk_bf16_f32 v159, v159, v29
  v_accvgpr_read_b32 v190, a244
  v_accvgpr_read_b32 v30, a245
  v_accvgpr_read_b32 v191, a246
  v_accvgpr_read_b32 v31, a247
  v_cvt_pk_bf16_f32 v190, v190, v30
  v_cvt_pk_bf16_f32 v191, v191, v31
  v_accvgpr_read_b32 v222, a248
  v_accvgpr_read_b32 v28, a249
  v_accvgpr_read_b32 v223, a250
  v_accvgpr_read_b32 v29, a251
  v_cvt_pk_bf16_f32 v222, v222, v28
  v_cvt_pk_bf16_f32 v223, v223, v29
  v_accvgpr_read_b32 v254, a252
  v_accvgpr_read_b32 v30, a253
  v_accvgpr_read_b32 v255, a254
  v_accvgpr_read_b32 v31, a255
  v_cvt_pk_bf16_f32 v254, v254, v30
  v_cvt_pk_bf16_f32 v255, v255, v31
  s_cmp_lg_u32 s3, 0
  s_cbranch_scc1 L_safe_attn
  ds_read_b128 v[32:35], v4 offset:0
  ds_read_b128 v[36:39], v5 offset:0
  ds_read_b128 v[40:43], v4 offset:4096
  ds_read_b128 v[44:47], v5 offset:4096
  ds_read_b128 v[48:51], v4 offset:8192
  ds_read_b128 v[52:55], v5 offset:8192
  ds_read_b128 v[56:59], v4 offset:12288
  ds_read_b128 v[60:63], v5 offset:12288
  s_waitcnt lgkmcnt(6)
  v_mfma_f32_16x16x32_bf16 v[64:67], v[32:35], v[128:131], 0
  v_mfma_f32_16x16x32_bf16 v[64:67], v[36:39], v[132:135], v[64:67]
  v_mfma_f32_16x16x32_bf16 v[68:71], v[32:35], v[160:163], 0
  v_mfma_f32_16x16x32_bf16 v[68:71], v[36:39], v[164:167], v[68:71]
  v_mfma_f32_16x16x32_bf16 v[72:75], v[32:35], v[192:195], 0
  v_mfma_f32_16x16x32_bf16 v[72:75], v[36:39], v[196:199], v[72:75]
  v_mfma_f32_16x16x32_bf16 v[76:79], v[32:35], v[224:227], 0
  v_mfma_f32_16x16x32_bf16 v[76:79], v[36:39], v[228:231], v[76:79]
  s_waitcnt lgkmcnt(4)
  v_mfma_f32_16x16x32_bf16 v[64:67], v[40:43], v[136:139], v[64:67]
  v_mfma_f32_16x16x32_bf16 v[64:67], v[44:47], v[140:143], v[64:67]
  v_mfma_f32_16x16x32_bf16 v[68:71], v[40:43], v[168:171], v[68:71]
  ds_read_b128 v[32:35], v4 offset:2048
  v_mfma_f32_16x16x32_bf16 v[68:71], v[44:47], v[172:175], v[68:71]
  v_mfma_f32_16x16x32_bf16 v[72:75], v[40:43], v[200:203], v[72:75]
  v_mfma_f32_16x16x32_bf16 v[72:75], v[44:47], v[204:207], v[72:75]
  v_mfma_f32_16x16x32_bf16 v[76:79], v[40:43], v[232:235], v[76:79]
  ds_read_b128 v[36:39], v5 offset:2048
  v_mfma_f32_16x16x32_bf16 v[76:79], v[44:47], v[236:239], v[76:79]
  s_waitcnt lgkmcnt(4)
  v_mfma_f32_16x16x32_bf16 v[64:67], v[48:51], v[144:147], v[64:67]
  v_mfma_f32_16x16x32_bf16 v[64:67], v[52:55], v[148:151], v[64:67]
  v_mfma_f32_16x16x32_bf16 v[68:71], v[48:51], v[176:179], v[68:71]
  ds_read_b128 v[40:43], v4 offset:6144
  v_mfma_f32_16x16x32_bf16 v[68:71], v[52:55], v[180:183], v[68:71]
  v_mfma_f32_16x16x32_bf16 v[72:75], v[48:51], v[208:211], v[72:75]
  v_mfma_f32_16x16x32_bf16 v[72:75], v[52:55], v[212:215], v[72:75]
  v_mfma_f32_16x16x32_bf16 v[76:79], v[48:51], v[240:243], v[76:79]
  ds_read_b128 v[44:47], v5 offset:6144
  v_mfma_f32_16x16x32_bf16 v[76:79], v[52:55], v[244:247], v[76:79]
  s_waitcnt lgkmcnt(4)
  v_mfma_f32_16x16x32_bf16 v[64:67], v[56:59], v[152:155], v[64:67]
  v_mfma_f32_16x16x32_bf16 v[64:67], v[60:63], v[156:159], v[64:67]
  v_mfma_f32_16x16x32_bf16 v[68:71], v[56:59], v[184:187], v[68:71]
  ds_read_b128 v[48:51], v4 offset:10240
  v_mfma_f32_16x16x32_bf16 v[68:71], v[60:63], v[188:191], v[68:71]
  v_mfma_f32_16x16x32_bf16 v[72:75], v[56:59], v[216:219], v[72:75]
  v_mfma_f32_16x16x32_bf16 v[72:75], v[60:63], v[220:223], v[72:75]
  v_mfma_f32_16x16x32_bf16 v[76:79], v[56:59], v[248:251], v[76:79]
  ds_read_b128 v[52:55], v5 offset:10240
  v_mfma_f32_16x16x32_bf16 v[76:79], v[60:63], v[252:255], v[76:79]
  s_waitcnt lgkmcnt(4)
  v_mfma_f32_16x16x32_bf16 v[80:83], v[32:35], v[128:131], 0
  v_mfma_f32_16x16x32_bf16 v[80:83], v[36:39], v[132:135], v[80:83]
  v_mfma_f32_16x16x32_bf16 v[84:87], v[32:35], v[160:163], 0
  ds_read_b128 v[56:59], v4 offset:14336
  v_mfma_f32_16x16x32_bf16 v[84:87], v[36:39], v[164:167], v[84:87]
  v_mfma_f32_16x16x32_bf16 v[88:91], v[32:35], v[192:195], 0
  v_mfma_f32_16x16x32_bf16 v[88:91], v[36:39], v[196:199], v[88:91]
  v_mfma_f32_16x16x32_bf16 v[92:95], v[32:35], v[224:227], 0
  ds_read_b128 v[60:63], v5 offset:14336
  v_mfma_f32_16x16x32_bf16 v[92:95], v[36:39], v[228:231], v[92:95]
  s_waitcnt lgkmcnt(4)
  v_mfma_f32_16x16x32_bf16 v[80:83], v[40:43], v[136:139], v[80:83]
  v_mfma_f32_16x16x32_bf16 v[80:83], v[44:47], v[140:143], v[80:83]
  v_mfma_f32_16x16x32_bf16 v[84:87], v[40:43], v[168:171], v[84:87]
  v_mfma_f32_16x16x32_bf16 v[84:87], v[44:47], v[172:175], v[84:87]
  v_mfma_f32_16x16x32_bf16 v[88:91], v[40:43], v[200:203], v[88:91]
  v_mfma_f32_16x16x32_bf16 v[88:91], v[44:47], v[204:207], v[88:91]
  v_mfma_f32_16x16x32_bf16 v[92:95], v[40:43], v[232:235], v[92:95]
  v_mfma_f32_16x16x32_bf16 v[92:95], v[44:47], v[236:239], v[92:95]
  s_waitcnt lgkmcnt(2)
  v_mfma_f32_16x16x32_bf16 v[80:83], v[48:51], v[144:147], v[80:83]
  v_mfma_f32_16x16x32_bf16 v[80:83], v[52:55], v[148:151], v[80:83]
  v_mfma_f32_16x16x32_bf16 v[84:87], v[48:51], v[176:179], v[84:87]
  v_mfma_f32_16x16x32_bf16 v[84:87], v[52:55], v[180:183], v[84:87]
  v_mfma_f32_16x16x32_bf16 v[88:91], v[48:51], v[208:211], v[88:91]
  v_mfma_f32_16x16x32_bf16 v[88:91], v[52:55], v[212:215], v[88:91]
  v_mfma_f32_16x16x32_bf16 v[92:95], v[48:51], v[240:243], v[92:95]
  v_mfma_f32_16x16x32_bf16 v[92:95], v[52:55], v[244:247], v[92:95]
  s_waitcnt lgkmcnt(0)
  v_mfma_f32_16x16x32_bf16 v[80:83], v[56:59], v[152:155], v[80:83]
  v_mfma_f32_16x16x32_bf16 v[80:83], v[60:63], v[156:159], v[80:83]
  v_mfma_f32_16x16x32_bf16 v[84:87], v[56:59], v[184:187], v[84:87]
  v_mfma_f32_16x16x32_bf16 v[84:87], v[60:63], v[188:191], v[84:87]
  v_mfma_f32_16x16x32_bf16 v[88:91], v[56:59], v[216:219], v[88:91]
  v_mfma_f32_16x16x32_bf16 v[88:91], v[60:63], v[220:223], v[88:91]
  v_mfma_f32_16x16x32_bf16 v[92:95], v[56:59], v[248:251], v[92:95]
  v_mfma_f32_16x16x32_bf16 v[92:95], v[60:63], v[252:255], v[92:95]
  s_waitcnt vmcnt(16)
  s_barrier
  s_mov_b32 s64, 65536
  s_add_u32 m0, s33, 0
  s_nop 0
  buffer_load_dwordx4 v10, s[12:15], s64 offen nt lds
  s_add_u32 m0, s33, 3968
  s_nop 0
  buffer_load_dwordx4 v10, s[12:15], s64 offen offset:128 nt lds
  s_add_u32 m0, s33, 7936
  s_nop 0
  buffer_load_dwordx4 v10, s[12:15], s64 offen offset:256 nt lds
  s_add_u32 m0, s33, 11904
  s_nop 0
  buffer_load_dwordx4 v10, s[12:15], s64 offen offset:384 nt lds
  s_mov_b32 s64, 81920
  s_mov_b32 s65, 49152
  ds_read_b128 v[32:35], v4 offset:16384
  ds_read_b128 v[36:39], v5 offset:16384
  ds_read_b128 v[40:43], v4 offset:20480
  ds_read_b128 v[44:47], v5 offset:20480
  ds_read_b128 v[48:51], v4 offset:24576
  ds_read_b128 v[52:55], v5 offset:24576
  ds_read_b128 v[56:59], v4 offset:28672
  ds_read_b128 v[60:63], v5 offset:28672
  v_max3_f32 v16, v64, v65, v66
  v_max3_f32 v16, v16, v67, v80
  v_max3_f32 v16, v16, v81, v82
  v_max_f32 v16, v16, v83
  v_max3_f32 v17, v68, v69, v70
  v_max3_f32 v17, v17, v71, v84
  v_max3_f32 v17, v17, v85, v86
  v_max_f32 v17, v17, v87
  v_max3_f32 v18, v72, v73, v74
  v_max3_f32 v18, v18, v75, v88
  v_max3_f32 v18, v18, v89, v90
  v_max_f32 v18, v18, v91
  v_max3_f32 v19, v76, v77, v78
  v_max3_f32 v19, v19, v79, v92
  v_max3_f32 v19, v19, v93, v94
  v_max_f32 v19, v19, v95
  v_mov_b32 v20, v16
  v_mov_b32 v21, v17
  v_mov_b32 v22, v18
  v_mov_b32 v23, v19
  s_nop 1
  v_permlane32_swap_b32 v16, v20
  v_permlane32_swap_b32 v17, v21
  v_permlane32_swap_b32 v18, v22
  v_permlane32_swap_b32 v19, v23
  s_nop 1
  v_max_f32 v16, v16, v20
  v_max_f32 v17, v17, v21
  v_max_f32 v18, v18, v22
  v_max_f32 v19, v19, v23
  v_mov_b32 v20, v16
  v_mov_b32 v21, v17
  v_mov_b32 v22, v18
  v_mov_b32 v23, v19
  s_nop 1
  v_permlane16_swap_b32 v16, v20
  v_permlane16_swap_b32 v17, v21
  v_permlane16_swap_b32 v18, v22
  v_permlane16_swap_b32 v19, v23
  s_nop 1
  v_max_f32 v16, v16, v20
  v_max_f32 v17, v17, v21
  v_max_f32 v18, v18, v22
  v_max_f32 v19, v19, v23
  v_mul_f32 v16, s63, v16
  v_sub_f32 v16, 0, v16
  v_mov_b32 v12, 0
  v_mul_f32 v17, s63, v17
  v_sub_f32 v17, 0, v17
  v_mov_b32 v13, 0
  v_mul_f32 v18, s63, v18
  v_sub_f32 v18, 0, v18
  v_mov_b32 v14, 0
  v_mul_f32 v19, s63, v19
  v_sub_f32 v19, 0, v19
  v_mov_b32 v15, 0
  v_fma_f32 v64, v64, s63, v16
  v_fma_f32 v65, v65, s63, v16
  v_exp_f32 v64, v64
  v_exp_f32 v65, v65
  s_nop 0
  v_fma_f32 v66, v66, s63, v16
  v_fma_f32 v67, v67, s63, v16
  v_exp_f32 v66, v66
  v_exp_f32 v67, v67
  s_nop 0
  v_add_f32 v12, v12, v64
  v_add_f32 v12, v12, v65
  v_cvt_pk_bf16_f32 v96, v64, v65
  v_add_f32 v12, v12, v66
  v_add_f32 v12, v12, v67
  v_cvt_pk_bf16_f32 v97, v66, v67
  v_fma_f32 v68, v68, s63, v17
  v_fma_f32 v69, v69, s63, v17
  v_exp_f32 v68, v68
  v_exp_f32 v69, v69
  s_nop 0
  v_fma_f32 v70, v70, s63, v17
  v_fma_f32 v71, v71, s63, v17
  v_exp_f32 v70, v70
  v_exp_f32 v71, v71
  s_nop 0
  v_add_f32 v13, v13, v68
  v_add_f32 v13, v13, v69
  v_cvt_pk_bf16_f32 v100, v68, v69
  v_add_f32 v13, v13, v70
  v_add_f32 v13, v13, v71
  v_cvt_pk_bf16_f32 v101, v70, v71
  v_fma_f32 v72, v72, s63, v18
  v_fma_f32 v73, v73, s63, v18
  v_exp_f32 v72, v72
  v_exp_f32 v73, v73
  s_nop 0
  v_fma_f32 v74, v74, s63, v18
  v_fma_f32 v75, v75, s63, v18
  v_exp_f32 v74, v74
  v_exp_f32 v75, v75
  s_nop 0
  v_add_f32 v14, v14, v72
  v_add_f32 v14, v14, v73
  v_cvt_pk_bf16_f32 v104, v72, v73
  v_add_f32 v14, v14, v74
  v_add_f32 v14, v14, v75
  v_cvt_pk_bf16_f32 v105, v74, v75
  v_fma_f32 v76, v76, s63, v19
  v_fma_f32 v77, v77, s63, v19
  v_exp_f32 v76, v76
  v_exp_f32 v77, v77
  s_nop 0
  v_fma_f32 v78, v78, s63, v19
  v_fma_f32 v79, v79, s63, v19
  v_exp_f32 v78, v78
  v_exp_f32 v79, v79
  s_nop 0
  v_add_f32 v15, v15, v76
  v_add_f32 v15, v15, v77
  v_cvt_pk_bf16_f32 v108, v76, v77
  v_add_f32 v15, v15, v78
  v_add_f32 v15, v15, v79
  v_cvt_pk_bf16_f32 v109, v78, v79
  v_fma_f32 v80, v80, s63, v16
  v_fma_f32 v81, v81, s63, v16
  v_exp_f32 v80, v80
  v_exp_f32 v81, v81
  s_nop 0
  v_fma_f32 v82, v82, s63, v16
  v_fma_f32 v83, v83, s63, v16
  v_exp_f32 v82, v82
  v_exp_f32 v83, v83
  s_nop 0
  v_add_f32 v12, v12, v80
  v_add_f32 v12, v12, v81
  v_cvt_pk_bf16_f32 v98, v80, v81
  v_add_f32 v12, v12, v82
  v_add_f32 v12, v12, v83
  v_cvt_pk_bf16_f32 v99, v82, v83
  v_fma_f32 v84, v84, s63, v17
  v_fma_f32 v85, v85, s63, v17
  v_exp_f32 v84, v84
  v_exp_f32 v85, v85
  s_nop 0
  v_fma_f32 v86, v86, s63, v17
  v_fma_f32 v87, v87, s63, v17
  v_exp_f32 v86, v86
  v_exp_f32 v87, v87
  s_nop 0
  v_add_f32 v13, v13, v84
  v_add_f32 v13, v13, v85
  v_cvt_pk_bf16_f32 v102, v84, v85
  v_add_f32 v13, v13, v86
  v_add_f32 v13, v13, v87
  v_cvt_pk_bf16_f32 v103, v86, v87
  v_lshrrev_b32 v1, 3, v0
  v_and_b32 v2, 7, v0
  v_lshl_add_u32 v3, s32, 3, v1
  v_bfe_u32 v1, v1, 1, 2
  v_lshlrev_b32 v1, 1, v1
  v_xor_b32 v1, v1, v2
  v_lshlrev_b32 v1, 4, v1
  v_mul_u32_u24 v3, 896, v3
  v_add_u32 v3, v3, v1
  s_lshl_b32 s67, s71, 4
  v_and_b32 v26, 3, v0
  v_lshlrev_b32 v26, 2, v26
  v_add_u32 v26, s67, v26
  s_waitcnt lgkmcnt(6)
  v_mfma_f32_16x16x32_bf16 v[64:67], v[32:35], v[128:131], 0
  v_fma_f32 v88, v88, s63, v18
  v_fma_f32 v89, v89, s63, v18
  v_mfma_f32_16x16x32_bf16 v[64:67], v[36:39], v[132:135], v[64:67]
  s_mov_b32 s67, 0
  v_exp_f32 v88, v88
  v_mfma_f32_16x16x32_bf16 v[68:71], v[32:35], v[160:163], 0
  s_add_u32 m0, s33, 131072
  v_exp_f32 v89, v89
  v_mfma_f32_16x16x32_bf16 v[68:71], v[36:39], v[164:167], v[68:71]
  buffer_load_dwordx4 v3, s[20:23], s67 offen nt lds
  v_mfma_f32_16x16x32_bf16 v[72:75], v[32:35], v[192:195], 0
  v_fma_f32 v90, v90, s63, v18
  v_fma_f32 v91, v91, s63, v18
  v_mfma_f32_16x16x32_bf16 v[72:75], v[36:39], v[196:199], v[72:75]
  v_exp_f32 v90, v90
  v_mfma_f32_16x16x32_bf16 v[76:79], v[32:35], v[224:227], 0
  v_exp_f32 v91, v91
  v_mfma_f32_16x16x32_bf16 v[76:79], v[36:39], v[228:231], v[76:79]
  s_waitcnt lgkmcnt(4)
  v_fma_f32 v92, v92, s63, v19
  v_fma_f32 v93, v93, s63, v19
  v_mfma_f32_16x16x32_bf16 v[64:67], v[40:43], v[136:139], v[64:67]
  v_exp_f32 v92, v92
  v_mfma_f32_16x16x32_bf16 v[64:67], v[44:47], v[140:143], v[64:67]
  s_mov_b32 s68, 28672
  v_exp_f32 v93, v93
  v_mfma_f32_16x16x32_bf16 v[68:71], v[40:43], v[168:171], v[68:71]
  s_add_u32 m0, s33, 135168
  v_fma_f32 v94, v94, s63, v19
  ds_read_b128 v[32:35], v4 offset:18432
  v_mfma_f32_16x16x32_bf16 v[68:71], v[44:47], v[172:175], v[68:71]
  buffer_load_dwordx4 v3, s[20:23], s68 offen nt lds
  v_mfma_f32_16x16x32_bf16 v[72:75], v[40:43], v[200:203], v[72:75]
  v_exp_f32 v94, v94
  v_mfma_f32_16x16x32_bf16 v[72:75], v[44:47], v[204:207], v[72:75]
  v_fma_f32 v95, v95, s63, v19
  v_add_f32 v14, v14, v88
  v_mfma_f32_16x16x32_bf16 v[76:79], v[40:43], v[232:235], v[76:79]
  v_add_f32 v14, v14, v89
  ds_read_b128 v[36:39], v5 offset:18432
  v_mfma_f32_16x16x32_bf16 v[76:79], v[44:47], v[236:239], v[76:79]
  s_waitcnt lgkmcnt(4)
  v_exp_f32 v95, v95
  v_mfma_f32_16x16x32_bf16 v[64:67], v[48:51], v[144:147], v[64:67]
  v_add_f32 v14, v14, v90
  v_add_f32 v14, v14, v91
  v_mfma_f32_16x16x32_bf16 v[64:67], v[52:55], v[148:151], v[64:67]
  s_mov_b32 s67, 57344
  v_cvt_pk_bf16_f32 v106, v88, v89
  v_cvt_pk_bf16_f32 v107, v90, v91
  v_mfma_f32_16x16x32_bf16 v[68:71], v[48:51], v[176:179], v[68:71]
  s_add_u32 m0, s33, 139264
  v_add_f32 v15, v15, v92
  ds_read_b128 v[40:43], v4 offset:22528
  v_mfma_f32_16x16x32_bf16 v[68:71], v[52:55], v[180:183], v[68:71]
  buffer_load_dwordx4 v3, s[20:23], s67 offen nt lds
  v_mfma_f32_16x16x32_bf16 v[72:75], v[48:51], v[208:211], v[72:75]
  v_add_f32 v15, v15, v93
  v_add_f32 v15, v15, v94
  v_mfma_f32_16x16x32_bf16 v[72:75], v[52:55], v[212:215], v[72:75]
  v_add_f32 v15, v15, v95
  v_cvt_pk_bf16_f32 v110, v92, v93
  v_mfma_f32_16x16x32_bf16 v[76:79], v[48:51], v[240:243], v[76:79]
  v_cvt_pk_bf16_f32 v111, v94, v95
  ds_read_b128 v[44:47], v5 offset:22528
  v_mfma_f32_16x16x32_bf16 v[76:79], v[52:55], v[244:247], v[76:79]
  s_waitcnt lgkmcnt(4)
  v_mfma_f32_16x16x32_bf16 v[64:67], v[56:59], v[152:155], v[64:67]
  v_mfma_f32_16x16x32_bf16 v[64:67], v[60:63], v[156:159], v[64:67]
  s_mov_b32 s68, 86016
  v_mfma_f32_16x16x32_bf16 v[68:71], v[56:59], v[184:187], v[68:71]
  s_add_u32 m0, s33, 143360
  ds_read_b128 v[48:51], v4 offset:26624
  v_mfma_f32_16x16x32_bf16 v[68:71], v[60:63], v[188:191], v[68:71]
  buffer_load_dwordx4 v3, s[20:23], s68 offen nt lds
  v_mfma_f32_16x16x32_bf16 v[72:75], v[56:59], v[216:219], v[72:75]
  v_mfma_f32_16x16x32_bf16 v[72:75], v[60:63], v[220:223], v[72:75]
  v_mfma_f32_16x16x32_bf16 v[76:79], v[56:59], v[248:251], v[76:79]
  ds_read_b128 v[52:55], v5 offset:26624
  v_mfma_f32_16x16x32_bf16 v[76:79], v[60:63], v[252:255], v[76:79]
  s_waitcnt lgkmcnt(4)
  v_fma_f32 v64, v64, s63, v16
  v_fma_f32 v65, v65, s63, v16
  v_mfma_f32_16x16x32_bf16 v[80:83], v[32:35], v[128:131], 0
  v_exp_f32 v64, v64
  v_mfma_f32_16x16x32_bf16 v[80:83], v[36:39], v[132:135], v[80:83]
  s_mov_b32 s67, 114688
  v_exp_f32 v65, v65
  v_mfma_f32_16x16x32_bf16 v[84:87], v[32:35], v[160:163], 0
  s_add_u32 m0, s33, 147456
  v_fma_f32 v66, v66, s63, v16
  ds_read_b128 v[56:59], v4 offset:30720
  v_mfma_f32_16x16x32_bf16 v[84:87], v[36:39], v[164:167], v[84:87]
  buffer_load_dwordx4 v3, s[20:23], s67 offen nt lds
  v_mfma_f32_16x16x32_bf16 v[88:91], v[32:35], v[192:195], 0
  v_exp_f32 v66, v66
  v_mfma_f32_16x16x32_bf16 v[88:91], v[36:39], v[196:199], v[88:91]
  v_fma_f32 v67, v67, s63, v16
  v_add_f32 v12, v12, v64
  v_mfma_f32_16x16x32_bf16 v[92:95], v[32:35], v[224:227], 0
  v_add_f32 v12, v12, v65
  ds_read_b128 v[60:63], v5 offset:30720
  v_mfma_f32_16x16x32_bf16 v[92:95], v[36:39], v[228:231], v[92:95]
  s_waitcnt lgkmcnt(4)
  v_exp_f32 v67, v67
  v_mfma_f32_16x16x32_bf16 v[80:83], v[40:43], v[136:139], v[80:83]
  v_add_f32 v12, v12, v66
  v_add_f32 v12, v12, v67
  v_mfma_f32_16x16x32_bf16 v[80:83], v[44:47], v[140:143], v[80:83]
  s_mov_b32 s68, 143360
  v_cvt_pk_bf16_f32 v112, v64, v65
  v_cvt_pk_bf16_f32 v113, v66, v67
  v_mfma_f32_16x16x32_bf16 v[84:87], v[40:43], v[168:171], v[84:87]
  s_add_u32 m0, s33, 151552
  v_fma_f32 v68, v68, s63, v17
  v_fma_f32 v69, v69, s63, v17
  v_mfma_f32_16x16x32_bf16 v[84:87], v[44:47], v[172:175], v[84:87]
  buffer_load_dwordx4 v3, s[20:23], s68 offen nt lds
  v_mfma_f32_16x16x32_bf16 v[88:91], v[40:43], v[200:203], v[88:91]
  v_fma_f32 v70, v70, s63, v17
  ds_read_b64_tr_b16 v[32:33], v6 offset:0
  v_mfma_f32_16x16x32_bf16 v[88:91], v[44:47], v[204:207], v[88:91]
  v_exp_f32 v68, v68
  v_mfma_f32_16x16x32_bf16 v[92:95], v[40:43], v[232:235], v[92:95]
  v_fma_f32 v71, v71, s63, v17
  ds_read_b64_tr_b16 v[34:35], v6 offset:2048
  v_mfma_f32_16x16x32_bf16 v[92:95], v[44:47], v[236:239], v[92:95]
  s_waitcnt lgkmcnt(4)
  v_exp_f32 v69, v69
  v_mfma_f32_16x16x32_bf16 v[80:83], v[48:51], v[144:147], v[80:83]
  v_add_f32 v13, v13, v68
  ds_read_b64_tr_b16 v[36:37], v7 offset:0
  v_mfma_f32_16x16x32_bf16 v[80:83], v[52:55], v[148:151], v[80:83]
  s_mov_b32 s67, 172032
  v_exp_f32 v70, v70
  v_mfma_f32_16x16x32_bf16 v[84:87], v[48:51], v[176:179], v[84:87]
  s_add_u32 m0, s33, 155648
  v_add_f32 v13, v13, v69
  ds_read_b64_tr_b16 v[38:39], v7 offset:2048
  v_mfma_f32_16x16x32_bf16 v[84:87], v[52:55], v[180:183], v[84:87]
  buffer_load_dwordx4 v3, s[20:23], s67 offen nt lds
  v_mfma_f32_16x16x32_bf16 v[88:91], v[48:51], v[208:211], v[88:91]
  v_add_f32 v13, v13, v70
  ds_read_b64_tr_b16 v[40:41], v8 offset:0
  v_mfma_f32_16x16x32_bf16 v[88:91], v[52:55], v[212:215], v[88:91]
  v_exp_f32 v71, v71
  v_mfma_f32_16x16x32_bf16 v[92:95], v[48:51], v[240:243], v[92:95]
  v_add_f32 v13, v13, v71
  ds_read_b64_tr_b16 v[42:43], v8 offset:2048
  v_mfma_f32_16x16x32_bf16 v[92:95], v[52:55], v[244:247], v[92:95]
  s_waitcnt lgkmcnt(6)
  v_cvt_pk_bf16_f32 v116, v68, v69
  v_cvt_pk_bf16_f32 v117, v70, v71
  v_mfma_f32_16x16x32_bf16 v[80:83], v[56:59], v[152:155], v[80:83]
  v_fma_f32 v72, v72, s63, v18
  ds_read_b64_tr_b16 v[44:45], v9 offset:0
  v_mfma_f32_16x16x32_bf16 v[80:83], v[60:63], v[156:159], v[80:83]
  s_mov_b32 s68, 200704
  v_exp_f32 v72, v72
  v_mfma_f32_16x16x32_bf16 v[84:87], v[56:59], v[184:187], v[84:87]
  s_add_u32 m0, s33, 159744
  v_fma_f32 v73, v73, s63, v18
  ds_read_b64_tr_b16 v[46:47], v9 offset:2048
  v_mfma_f32_16x16x32_bf16 v[84:87], v[60:63], v[188:191], v[84:87]
  buffer_load_dwordx4 v3, s[20:23], s68 offen nt lds
  v_mfma_f32_16x16x32_bf16 v[88:91], v[56:59], v[216:219], v[88:91]
  v_fma_f32 v74, v74, s63, v18
  ds_read_b64_tr_b16 v[48:49], v6 offset:4096
  v_mfma_f32_16x16x32_bf16 v[88:91], v[60:63], v[220:223], v[88:91]
  v_exp_f32 v73, v73
  v_mfma_f32_16x16x32_bf16 v[92:95], v[56:59], v[248:251], v[92:95]
  v_fma_f32 v75, v75, s63, v18
  ds_read_b64_tr_b16 v[50:51], v6 offset:6144
  v_mfma_f32_16x16x32_bf16 v[92:95], v[60:63], v[252:255], v[92:95]
  s_waitcnt lgkmcnt(8)
  v_exp_f32 v74, v74
  v_mfma_f32_16x16x32_bf16 a[0:3], v[32:35], v[96:99], 0
  v_add_f32 v14, v14, v72
  ds_read_b64_tr_b16 v[52:53], v7 offset:4096
  v_mfma_f32_16x16x32_bf16 a[4:7], v[32:35], v[100:103], 0
  v_exp_f32 v75, v75
  v_mfma_f32_16x16x32_bf16 a[8:11], v[32:35], v[104:107], 0
  v_add_f32 v14, v14, v73
  ds_read_b64_tr_b16 v[54:55], v7 offset:6144
  v_mfma_f32_16x16x32_bf16 a[12:15], v[32:35], v[108:111], 0
  s_waitcnt lgkmcnt(8)
  v_add_f32 v14, v14, v74
  v_add_f32 v14, v14, v75
  v_mfma_f32_16x16x32_bf16 a[16:19], v[36:39], v[96:99], 0
  v_cvt_pk_bf16_f32 v120, v72, v73
  ds_read_b64_tr_b16 v[56:57], v8 offset:4096
  v_mfma_f32_16x16x32_bf16 a[20:23], v[36:39], v[100:103], 0
  v_cvt_pk_bf16_f32 v121, v74, v75
  v_fma_f32 v76, v76, s63, v19
  v_mfma_f32_16x16x32_bf16 a[24:27], v[36:39], v[104:107], 0
  v_fma_f32 v77, v77, s63, v19
  ds_read_b64_tr_b16 v[58:59], v8 offset:6144
  v_mfma_f32_16x16x32_bf16 a[28:31], v[36:39], v[108:111], 0
  s_waitcnt lgkmcnt(8)
  v_exp_f32 v76, v76
  v_mfma_f32_16x16x32_bf16 a[32:35], v[40:43], v[96:99], 0
  v_fma_f32 v78, v78, s63, v19
  ds_read_b64_tr_b16 v[60:61], v9 offset:4096
  v_mfma_f32_16x16x32_bf16 a[36:39], v[40:43], v[100:103], 0
  v_exp_f32 v77, v77
  v_mfma_f32_16x16x32_bf16 a[40:43], v[40:43], v[104:107], 0
  v_fma_f32 v79, v79, s63, v19
  ds_read_b64_tr_b16 v[62:63], v9 offset:6144
  v_mfma_f32_16x16x32_bf16 a[44:47], v[40:43], v[108:111], 0
  s_waitcnt lgkmcnt(8)
  v_exp_f32 v78, v78
  v_mfma_f32_16x16x32_bf16 a[48:51], v[44:47], v[96:99], 0
  v_add_f32 v15, v15, v76
  ds_read_b64_tr_b16 v[32:33], v6 offset:8192
  v_mfma_f32_16x16x32_bf16 a[52:55], v[44:47], v[100:103], 0
  v_exp_f32 v79, v79
  v_mfma_f32_16x16x32_bf16 a[56:59], v[44:47], v[104:107], 0
  v_add_f32 v15, v15, v77
  ds_read_b64_tr_b16 v[34:35], v6 offset:10240
  v_mfma_f32_16x16x32_bf16 a[60:63], v[44:47], v[108:111], 0
  s_waitcnt lgkmcnt(8)
  v_add_f32 v15, v15, v78
  v_add_f32 v15, v15, v79
  v_mfma_f32_16x16x32_bf16 a[64:67], v[48:51], v[96:99], 0
  v_cvt_pk_bf16_f32 v124, v76, v77
  ds_read_b64_tr_b16 v[36:37], v7 offset:8192
  v_mfma_f32_16x16x32_bf16 a[68:71], v[48:51], v[100:103], 0
  v_cvt_pk_bf16_f32 v125, v78, v79
  v_fma_f32 v80, v80, s63, v16
  v_mfma_f32_16x16x32_bf16 a[72:75], v[48:51], v[104:107], 0
  v_fma_f32 v81, v81, s63, v16
  ds_read_b64_tr_b16 v[38:39], v7 offset:10240
  v_mfma_f32_16x16x32_bf16 a[76:79], v[48:51], v[108:111], 0
  s_waitcnt lgkmcnt(8)
  v_exp_f32 v80, v80
  v_mfma_f32_16x16x32_bf16 a[80:83], v[52:55], v[96:99], 0
  v_fma_f32 v82, v82, s63, v16
  ds_read_b64_tr_b16 v[40:41], v8 offset:8192
  v_mfma_f32_16x16x32_bf16 a[84:87], v[52:55], v[100:103], 0
  v_exp_f32 v81, v81
  v_mfma_f32_16x16x32_bf16 a[88:91], v[52:55], v[104:107], 0
  v_fma_f32 v83, v83, s63, v16
  ds_read_b64_tr_b16 v[42:43], v8 offset:10240
  v_mfma_f32_16x16x32_bf16 a[92:95], v[52:55], v[108:111], 0
  s_waitcnt lgkmcnt(8)
  v_exp_f32 v82, v82
  v_mfma_f32_16x16x32_bf16 a[96:99], v[56:59], v[96:99], 0
  v_fma_f32 v84, v84, s63, v17
  ds_read_b64_tr_b16 v[44:45], v9 offset:8192
  v_mfma_f32_16x16x32_bf16 a[100:103], v[56:59], v[100:103], 0
  v_exp_f32 v83, v83
  v_mfma_f32_16x16x32_bf16 a[104:107], v[56:59], v[104:107], 0
  v_fma_f32 v85, v85, s63, v17
  ds_read_b64_tr_b16 v[46:47], v9 offset:10240
  v_mfma_f32_16x16x32_bf16 a[108:111], v[56:59], v[108:111], 0
  s_waitcnt lgkmcnt(8)
  v_exp_f32 v84, v84
  v_mfma_f32_16x16x32_bf16 a[112:115], v[60:63], v[96:99], 0
  v_fma_f32 v86, v86, s63, v17
  ds_read_b64_tr_b16 v[48:49], v6 offset:12288
  v_mfma_f32_16x16x32_bf16 a[116:119], v[60:63], v[100:103], 0
  v_exp_f32 v85, v85
  v_mfma_f32_16x16x32_bf16 a[120:123], v[60:63], v[104:107], 0
  v_fma_f32 v87, v87, s63, v17
  ds_read_b64_tr_b16 v[50:51], v6 offset:14336
  v_mfma_f32_16x16x32_bf16 a[124:127], v[60:63], v[108:111], 0
  s_waitcnt lgkmcnt(8)
  v_exp_f32 v86, v86
  v_mfma_f32_16x16x32_bf16 a[128:131], v[32:35], v[96:99], 0
  v_add_f32 v12, v12, v80
  ds_read_b64_tr_b16 v[52:53], v7 offset:12288
  v_mfma_f32_16x16x32_bf16 a[132:135], v[32:35], v[100:103], 0
  v_exp_f32 v87, v87
  v_mfma_f32_16x16x32_bf16 a[136:139], v[32:35], v[104:107], 0
  s_waitcnt vmcnt(20)
  s_barrier
  ds_read_b64_tr_b16 v[54:55], v7 offset:14336
  v_mfma_f32_16x16x32_bf16 a[140:143], v[32:35], v[108:111], 0
  s_waitcnt lgkmcnt(8)
  v_add_f32 v12, v12, v81
  v_add_f32 v12, v12, v82
  v_mfma_f32_16x16x32_bf16 a[144:147], v[36:39], v[96:99], 0
  s_add_u32 m0, s33, 114688
  v_add_f32 v12, v12, v83
  ds_read_b64_tr_b16 v[56:57], v8 offset:12288
  v_mfma_f32_16x16x32_bf16 a[148:151], v[36:39], v[100:103], 0
  buffer_load_dwordx4 v11, s[16:19], s65 offen nt lds
  v_mfma_f32_16x16x32_bf16 a[152:155], v[36:39], v[104:107], 0
  v_cvt_pk_bf16_f32 v114, v80, v81
  ds_read_b64_tr_b16 v[58:59], v8 offset:14336
  v_mfma_f32_16x16x32_bf16 a[156:159], v[36:39], v[108:111], 0
  s_waitcnt lgkmcnt(8)
  v_cvt_pk_bf16_f32 v115, v82, v83
  v_add_f32 v13, v13, v84
  v_mfma_f32_16x16x32_bf16 a[160:163], v[40:43], v[96:99], 0
  v_add_f32 v13, v13, v85
  ds_read_b64_tr_b16 v[60:61], v9 offset:12288
  v_mfma_f32_16x16x32_bf16 a[164:167], v[40:43], v[100:103], 0
  v_add_f32 v13, v13, v86
  v_add_f32 v13, v13, v87
  v_mfma_f32_16x16x32_bf16 a[168:171], v[40:43], v[104:107], 0
  v_cvt_pk_bf16_f32 v118, v84, v85
  ds_read_b64_tr_b16 v[62:63], v9 offset:14336
  v_mfma_f32_16x16x32_bf16 a[172:175], v[40:43], v[108:111], 0
  s_waitcnt lgkmcnt(8)
  v_cvt_pk_bf16_f32 v119, v86, v87
  v_mfma_f32_16x16x32_bf16 a[176:179], v[44:47], v[96:99], 0
  ds_read_b128 v[32:35], v4 offset:32768
  v_mfma_f32_16x16x32_bf16 a[180:183], v[44:47], v[100:103], 0
  v_mfma_f32_16x16x32_bf16 a[184:187], v[44:47], v[104:107], 0
  ds_read_b128 v[36:39], v5 offset:32768
  v_mfma_f32_16x16x32_bf16 a[188:191], v[44:47], v[108:111], 0
  s_waitcnt lgkmcnt(8)
  v_mfma_f32_16x16x32_bf16 a[192:195], v[48:51], v[96:99], 0
  ds_read_b128 v[40:43], v4 offset:36864
  v_mfma_f32_16x16x32_bf16 a[196:199], v[48:51], v[100:103], 0
  v_mfma_f32_16x16x32_bf16 a[200:203], v[48:51], v[104:107], 0
  ds_read_b128 v[44:47], v5 offset:36864
  v_mfma_f32_16x16x32_bf16 a[204:207], v[48:51], v[108:111], 0
  s_waitcnt lgkmcnt(8)
  v_mfma_f32_16x16x32_bf16 a[208:211], v[52:55], v[96:99], 0
  s_add_u32 m0, s33, 118656
  ds_read_b128 v[48:51], v4 offset:40960
  v_mfma_f32_16x16x32_bf16 a[212:215], v[52:55], v[100:103], 0
  buffer_load_dwordx4 v11, s[16:19], s65 offen offset:128 nt lds
  v_mfma_f32_16x16x32_bf16 a[216:219], v[52:55], v[104:107], 0
  v_mfma_f32_16x16x32_bf16 a[220:223], v[52:55], v[108:111], 0
  s_waitcnt lgkmcnt(7)
  v_mfma_f32_16x16x32_bf16 a[224:227], v[56:59], v[96:99], 0
  ds_read_b128 v[52:55], v5 offset:40960
  v_mfma_f32_16x16x32_bf16 a[228:231], v[56:59], v[100:103], 0
  v_mfma_f32_16x16x32_bf16 a[232:235], v[56:59], v[104:107], 0
  v_mfma_f32_16x16x32_bf16 a[236:239], v[56:59], v[108:111], 0
  s_waitcnt lgkmcnt(6)
  v_mfma_f32_16x16x32_bf16 a[240:243], v[60:63], v[96:99], 0
  ds_read_b128 v[56:59], v4 offset:45056
  v_mfma_f32_16x16x32_bf16 a[244:247], v[60:63], v[100:103], 0
  v_mfma_f32_16x16x32_bf16 a[248:251], v[60:63], v[104:107], 0
  v_mfma_f32_16x16x32_bf16 a[252:255], v[60:63], v[108:111], 0
  ds_read_b128 v[60:63], v5 offset:45056
  s_mov_b32 s66, 7
L_attn:
  s_waitcnt lgkmcnt(6)
  v_mfma_f32_16x16x32_bf16 v[64:67], v[32:35], v[128:131], 0
  v_fma_f32 v88, v88, s63, v18
  v_fma_f32 v89, v89, s63, v18
  v_mfma_f32_16x16x32_bf16 v[64:67], v[36:39], v[132:135], v[64:67]
  v_exp_f32 v88, v88
  v_mfma_f32_16x16x32_bf16 v[68:71], v[32:35], v[160:163], 0
  v_exp_f32 v89, v89
  v_mfma_f32_16x16x32_bf16 v[68:71], v[36:39], v[164:167], v[68:71]
  v_fma_f32 v90, v90, s63, v18
  v_fma_f32 v91, v91, s63, v18
  v_mfma_f32_16x16x32_bf16 v[72:75], v[32:35], v[192:195], 0
  s_add_u32 m0, s33, 122624
  v_exp_f32 v90, v90
  v_mfma_f32_16x16x32_bf16 v[72:75], v[36:39], v[196:199], v[72:75]
  buffer_load_dwordx4 v11, s[16:19], s65 offen offset:256 nt lds
  v_mfma_f32_16x16x32_bf16 v[76:79], v[32:35], v[224:227], 0
  v_exp_f32 v91, v91
  v_mfma_f32_16x16x32_bf16 v[76:79], v[36:39], v[228:231], v[76:79]
  s_waitcnt lgkmcnt(4)
  v_fma_f32 v92, v92, s63, v19
  v_fma_f32 v93, v93, s63, v19
  v_mfma_f32_16x16x32_bf16 v[64:67], v[40:43], v[136:139], v[64:67]
  v_exp_f32 v92, v92
  v_mfma_f32_16x16x32_bf16 v[64:67], v[44:47], v[140:143], v[64:67]
  v_exp_f32 v93, v93
  v_mfma_f32_16x16x32_bf16 v[68:71], v[40:43], v[168:171], v[68:71]
  v_fma_f32 v94, v94, s63, v19
  ds_read_b128 v[32:35], v4 offset:34816
  v_mfma_f32_16x16x32_bf16 v[68:71], v[44:47], v[172:175], v[68:71]
  v_exp_f32 v94, v94
  v_mfma_f32_16x16x32_bf16 v[72:75], v[40:43], v[200:203], v[72:75]
  v_fma_f32 v95, v95, s63, v19
  v_add_f32 v14, v14, v88
  v_mfma_f32_16x16x32_bf16 v[72:75], v[44:47], v[204:207], v[72:75]
  v_exp_f32 v95, v95
  v_mfma_f32_16x16x32_bf16 v[76:79], v[40:43], v[232:235], v[76:79]
  v_add_f32 v14, v14, v89
  ds_read_b128 v[36:39], v5 offset:34816
  v_mfma_f32_16x16x32_bf16 v[76:79], v[44:47], v[236:239], v[76:79]
  s_waitcnt lgkmcnt(4)
  v_add_f32 v14, v14, v90
  v_add_f32 v14, v14, v91
  v_mfma_f32_16x16x32_bf16 v[64:67], v[48:51], v[144:147], v[64:67]
  v_cvt_pk_bf16_f32 v122, v88, v89
  v_cvt_pk_bf16_f32 v123, v90, v91
  v_mfma_f32_16x16x32_bf16 v[64:67], v[52:55], v[148:151], v[64:67]
  v_add_f32 v15, v15, v92
  v_add_f32 v15, v15, v93
  v_mfma_f32_16x16x32_bf16 v[68:71], v[48:51], v[176:179], v[68:71]
  v_add_f32 v15, v15, v94
  ds_read_b128 v[40:43], v4 offset:38912
  v_mfma_f32_16x16x32_bf16 v[68:71], v[52:55], v[180:183], v[68:71]
  v_add_f32 v15, v15, v95
  v_cvt_pk_bf16_f32 v126, v92, v93
  v_mfma_f32_16x16x32_bf16 v[72:75], v[48:51], v[208:211], v[72:75]
  s_add_u32 m0, s33, 126592
  v_cvt_pk_bf16_f32 v127, v94, v95
  v_mfma_f32_16x16x32_bf16 v[72:75], v[52:55], v[212:215], v[72:75]
  buffer_load_dwordx4 v11, s[16:19], s65 offen offset:384 nt lds
  v_mfma_f32_16x16x32_bf16 v[76:79], v[48:51], v[240:243], v[76:79]
  s_add_u32 s65, s65, 16384
  ds_read_b128 v[44:47], v5 offset:38912
  v_mfma_f32_16x16x32_bf16 v[76:79], v[52:55], v[244:247], v[76:79]
  s_waitcnt lgkmcnt(4)
  v_mfma_f32_16x16x32_bf16 v[64:67], v[56:59], v[152:155], v[64:67]
  s_and_b32 s65, s65, 0x7ffff
  v_mfma_f32_16x16x32_bf16 v[64:67], v[60:63], v[156:159], v[64:67]
  v_mfma_f32_16x16x32_bf16 v[68:71], v[56:59], v[184:187], v[68:71]
  ds_read_b128 v[48:51], v4 offset:43008
  v_mfma_f32_16x16x32_bf16 v[68:71], v[60:63], v[188:191], v[68:71]
  v_mfma_f32_16x16x32_bf16 v[72:75], v[56:59], v[216:219], v[72:75]
  v_mfma_f32_16x16x32_bf16 v[72:75], v[60:63], v[220:223], v[72:75]
  v_mfma_f32_16x16x32_bf16 v[76:79], v[56:59], v[248:251], v[76:79]
  ds_read_b128 v[52:55], v5 offset:43008
  v_mfma_f32_16x16x32_bf16 v[76:79], v[60:63], v[252:255], v[76:79]
  s_waitcnt lgkmcnt(4)
  v_fma_f32 v64, v64, s63, v16
  v_fma_f32 v65, v65, s63, v16
  v_mfma_f32_16x16x32_bf16 v[80:83], v[32:35], v[128:131], 0
  v_exp_f32 v64, v64
  v_mfma_f32_16x16x32_bf16 v[80:83], v[36:39], v[132:135], v[80:83]
  v_exp_f32 v65, v65
  v_mfma_f32_16x16x32_bf16 v[84:87], v[32:35], v[160:163], 0
  v_fma_f32 v66, v66, s63, v16
  ds_read_b128 v[56:59], v4 offset:47104
  v_mfma_f32_16x16x32_bf16 v[84:87], v[36:39], v[164:167], v[84:87]
  v_exp_f32 v66, v66
  v_mfma_f32_16x16x32_bf16 v[88:91], v[32:35], v[192:195], 0
  s_add_u32 m0, s33, 16384
  v_fma_f32 v67, v67, s63, v16
  v_add_f32 v12, v12, v64
  v_mfma_f32_16x16x32_bf16 v[88:91], v[36:39], v[196:199], v[88:91]
  buffer_load_dwordx4 v10, s[12:15], s64 offen nt lds
  v_mfma_f32_16x16x32_bf16 v[92:95], v[32:35], v[224:227], 0
  v_add_f32 v12, v12, v65
  ds_read_b128 v[60:63], v5 offset:47104
  v_mfma_f32_16x16x32_bf16 v[92:95], v[36:39], v[228:231], v[92:95]
  s_waitcnt lgkmcnt(4)
  v_exp_f32 v67, v67
  v_mfma_f32_16x16x32_bf16 v[80:83], v[40:43], v[136:139], v[80:83]
  v_add_f32 v12, v12, v66
  v_add_f32 v12, v12, v67
  v_mfma_f32_16x16x32_bf16 v[80:83], v[44:47], v[140:143], v[80:83]
  v_cvt_pk_bf16_f32 v96, v64, v65
  v_cvt_pk_bf16_f32 v97, v66, v67
  v_mfma_f32_16x16x32_bf16 v[84:87], v[40:43], v[168:171], v[84:87]
  v_fma_f32 v68, v68, s63, v17
  v_fma_f32 v69, v69, s63, v17
  v_mfma_f32_16x16x32_bf16 v[84:87], v[44:47], v[172:175], v[84:87]
  v_exp_f32 v68, v68
  v_mfma_f32_16x16x32_bf16 v[88:91], v[40:43], v[200:203], v[88:91]
  v_fma_f32 v70, v70, s63, v17
  ds_read_b64_tr_b16 v[32:33], v6 offset:16384
  v_mfma_f32_16x16x32_bf16 v[88:91], v[44:47], v[204:207], v[88:91]
  v_exp_f32 v69, v69
  v_mfma_f32_16x16x32_bf16 v[92:95], v[40:43], v[232:235], v[92:95]
  v_fma_f32 v71, v71, s63, v17
  ds_read_b64_tr_b16 v[34:35], v6 offset:18432
  v_mfma_f32_16x16x32_bf16 v[92:95], v[44:47], v[236:239], v[92:95]
  s_waitcnt lgkmcnt(4)
  v_exp_f32 v70, v70
  v_mfma_f32_16x16x32_bf16 v[80:83], v[48:51], v[144:147], v[80:83]
  v_add_f32 v13, v13, v68
  ds_read_b64_tr_b16 v[36:37], v7 offset:16384
  v_mfma_f32_16x16x32_bf16 v[80:83], v[52:55], v[148:151], v[80:83]
  v_exp_f32 v71, v71
  v_mfma_f32_16x16x32_bf16 v[84:87], v[48:51], v[176:179], v[84:87]
  v_add_f32 v13, v13, v69
  ds_read_b64_tr_b16 v[38:39], v7 offset:18432
  v_mfma_f32_16x16x32_bf16 v[84:87], v[52:55], v[180:183], v[84:87]
  v_add_f32 v13, v13, v70
  v_add_f32 v13, v13, v71
  v_mfma_f32_16x16x32_bf16 v[88:91], v[48:51], v[208:211], v[88:91]
  s_add_u32 m0, s33, 20352
  v_cvt_pk_bf16_f32 v100, v68, v69
  ds_read_b64_tr_b16 v[40:41], v8 offset:16384
  v_mfma_f32_16x16x32_bf16 v[88:91], v[52:55], v[212:215], v[88:91]
  buffer_load_dwordx4 v10, s[12:15], s64 offen offset:128 nt lds
  v_mfma_f32_16x16x32_bf16 v[92:95], v[48:51], v[240:243], v[92:95]
  v_cvt_pk_bf16_f32 v101, v70, v71
  ds_read_b64_tr_b16 v[42:43], v8 offset:18432
  v_mfma_f32_16x16x32_bf16 v[92:95], v[52:55], v[244:247], v[92:95]
  s_waitcnt lgkmcnt(6)
  v_fma_f32 v72, v72, s63, v18
  v_fma_f32 v73, v73, s63, v18
  v_mfma_f32_16x16x32_bf16 v[80:83], v[56:59], v[152:155], v[80:83]
  v_fma_f32 v74, v74, s63, v18
  ds_read_b64_tr_b16 v[44:45], v9 offset:16384
  v_mfma_f32_16x16x32_bf16 v[80:83], v[60:63], v[156:159], v[80:83]
  v_exp_f32 v72, v72
  v_mfma_f32_16x16x32_bf16 v[84:87], v[56:59], v[184:187], v[84:87]
  v_fma_f32 v75, v75, s63, v18
  ds_read_b64_tr_b16 v[46:47], v9 offset:18432
  v_mfma_f32_16x16x32_bf16 v[84:87], v[60:63], v[188:191], v[84:87]
  v_exp_f32 v73, v73
  v_mfma_f32_16x16x32_bf16 v[88:91], v[56:59], v[216:219], v[88:91]
  v_add_f32 v14, v14, v72
  ds_read_b64_tr_b16 v[48:49], v6 offset:20480
  v_mfma_f32_16x16x32_bf16 v[88:91], v[60:63], v[220:223], v[88:91]
  v_exp_f32 v74, v74
  v_mfma_f32_16x16x32_bf16 v[92:95], v[56:59], v[248:251], v[92:95]
  v_add_f32 v14, v14, v73
  ds_read_b64_tr_b16 v[50:51], v6 offset:22528
  v_mfma_f32_16x16x32_bf16 v[92:95], v[60:63], v[252:255], v[92:95]
  s_waitcnt lgkmcnt(8)
  v_exp_f32 v75, v75
  v_mfma_f32_16x16x32_bf16 a[0:3], v[32:35], v[112:115], a[0:3]
  v_add_f32 v14, v14, v74
  ds_read_b64_tr_b16 v[52:53], v7 offset:20480
  v_mfma_f32_16x16x32_bf16 a[4:7], v[32:35], v[116:119], a[4:7]
  v_add_f32 v14, v14, v75
  v_cvt_pk_bf16_f32 v104, v72, v73
  v_mfma_f32_16x16x32_bf16 a[8:11], v[32:35], v[120:123], a[8:11]
  v_cvt_pk_bf16_f32 v105, v74, v75
  ds_read_b64_tr_b16 v[54:55], v7 offset:22528
  v_mfma_f32_16x16x32_bf16 a[12:15], v[32:35], v[124:127], a[12:15]
  s_waitcnt lgkmcnt(8)
  v_fma_f32 v76, v76, s63, v19
  v_fma_f32 v77, v77, s63, v19
  v_mfma_f32_16x16x32_bf16 a[16:19], v[36:39], v[112:115], a[16:19]
  s_add_u32 m0, s33, 24320
  v_fma_f32 v78, v78, s63, v19
  ds_read_b64_tr_b16 v[56:57], v8 offset:20480
  v_mfma_f32_16x16x32_bf16 a[20:23], v[36:39], v[116:119], a[20:23]
  buffer_load_dwordx4 v10, s[12:15], s64 offen offset:256 nt lds
  v_mfma_f32_16x16x32_bf16 a[24:27], v[36:39], v[120:123], a[24:27]
  v_fma_f32 v79, v79, s63, v19
  ds_read_b64_tr_b16 v[58:59], v8 offset:22528
  v_mfma_f32_16x16x32_bf16 a[28:31], v[36:39], v[124:127], a[28:31]
  s_waitcnt lgkmcnt(8)
  v_exp_f32 v76, v76
  v_mfma_f32_16x16x32_bf16 a[32:35], v[40:43], v[112:115], a[32:35]
  v_add_f32 v15, v15, v76
  ds_read_b64_tr_b16 v[60:61], v9 offset:20480
  v_mfma_f32_16x16x32_bf16 a[36:39], v[40:43], v[116:119], a[36:39]
  v_exp_f32 v77, v77
  v_mfma_f32_16x16x32_bf16 a[40:43], v[40:43], v[120:123], a[40:43]
  v_add_f32 v15, v15, v77
  ds_read_b64_tr_b16 v[62:63], v9 offset:22528
  v_mfma_f32_16x16x32_bf16 a[44:47], v[40:43], v[124:127], a[44:47]
  s_waitcnt lgkmcnt(8)
  v_exp_f32 v78, v78
  v_mfma_f32_16x16x32_bf16 a[48:51], v[44:47], v[112:115], a[48:51]
  v_add_f32 v15, v15, v78
  ds_read_b64_tr_b16 v[32:33], v6 offset:24576
  v_mfma_f32_16x16x32_bf16 a[52:55], v[44:47], v[116:119], a[52:55]
  v_exp_f32 v79, v79
  v_mfma_f32_16x16x32_bf16 a[56:59], v[44:47], v[120:123], a[56:59]
  v_add_f32 v15, v15, v79
  ds_read_b64_tr_b16 v[34:35], v6 offset:26624
  v_mfma_f32_16x16x32_bf16 a[60:63], v[44:47], v[124:127], a[60:63]
  s_waitcnt lgkmcnt(8)
  v_cvt_pk_bf16_f32 v108, v76, v77
  v_cvt_pk_bf16_f32 v109, v78, v79
  v_mfma_f32_16x16x32_bf16 a[64:67], v[48:51], v[112:115], a[64:67]
  v_fma_f32 v80, v80, s63, v16
  ds_read_b64_tr_b16 v[36:37], v7 offset:24576
  v_mfma_f32_16x16x32_bf16 a[68:71], v[48:51], v[116:119], a[68:71]
  v_exp_f32 v80, v80
  v_mfma_f32_16x16x32_bf16 a[72:75], v[48:51], v[120:123], a[72:75]
  v_fma_f32 v81, v81, s63, v16
  ds_read_b64_tr_b16 v[38:39], v7 offset:26624
  v_mfma_f32_16x16x32_bf16 a[76:79], v[48:51], v[124:127], a[76:79]
  s_waitcnt lgkmcnt(8)
  v_exp_f32 v81, v81
  v_mfma_f32_16x16x32_bf16 a[80:83], v[52:55], v[112:115], a[80:83]
  s_add_u32 m0, s33, 28288
  v_fma_f32 v82, v82, s63, v16
  ds_read_b64_tr_b16 v[40:41], v8 offset:24576
  v_mfma_f32_16x16x32_bf16 a[84:87], v[52:55], v[116:119], a[84:87]
  buffer_load_dwordx4 v10, s[12:15], s64 offen offset:384 nt lds
  v_mfma_f32_16x16x32_bf16 a[88:91], v[52:55], v[120:123], a[88:91]
  s_add_u32 s64, s64, 16384
  v_fma_f32 v83, v83, s63, v16
  ds_read_b64_tr_b16 v[42:43], v8 offset:26624
  v_mfma_f32_16x16x32_bf16 a[92:95], v[52:55], v[124:127], a[92:95]
  s_waitcnt lgkmcnt(8)
  v_exp_f32 v82, v82
  v_mfma_f32_16x16x32_bf16 a[96:99], v[56:59], v[112:115], a[96:99]
  s_and_b32 s64, s64, 0x7ffff
  v_fma_f32 v84, v84, s63, v17
  ds_read_b64_tr_b16 v[44:45], v9 offset:24576
  v_mfma_f32_16x16x32_bf16 a[100:103], v[56:59], v[116:119], a[100:103]
  v_exp_f32 v83, v83
  v_mfma_f32_16x16x32_bf16 a[104:107], v[56:59], v[120:123], a[104:107]
  v_fma_f32 v85, v85, s63, v17
  ds_read_b64_tr_b16 v[46:47], v9 offset:26624
  v_mfma_f32_16x16x32_bf16 a[108:111], v[56:59], v[124:127], a[108:111]
  s_waitcnt lgkmcnt(8)
  v_exp_f32 v84, v84
  v_mfma_f32_16x16x32_bf16 a[112:115], v[60:63], v[112:115], a[112:115]
  v_fma_f32 v86, v86, s63, v17
  ds_read_b64_tr_b16 v[48:49], v6 offset:28672
  v_mfma_f32_16x16x32_bf16 a[116:119], v[60:63], v[116:119], a[116:119]
  v_exp_f32 v85, v85
  v_mfma_f32_16x16x32_bf16 a[120:123], v[60:63], v[120:123], a[120:123]
  v_fma_f32 v87, v87, s63, v17
  ds_read_b64_tr_b16 v[50:51], v6 offset:30720
  v_mfma_f32_16x16x32_bf16 a[124:127], v[60:63], v[124:127], a[124:127]
  s_waitcnt lgkmcnt(8)
  v_exp_f32 v86, v86
  v_mfma_f32_16x16x32_bf16 a[128:131], v[32:35], v[112:115], a[128:131]
  v_add_f32 v12, v12, v80
  ds_read_b64_tr_b16 v[52:53], v7 offset:28672
  v_mfma_f32_16x16x32_bf16 a[132:135], v[32:35], v[116:119], a[132:135]
  v_exp_f32 v87, v87
  v_mfma_f32_16x16x32_bf16 a[136:139], v[32:35], v[120:123], a[136:139]
  s_waitcnt vmcnt(12)
  s_barrier
  ds_read_b64_tr_b16 v[54:55], v7 offset:30720
  v_mfma_f32_16x16x32_bf16 a[140:143], v[32:35], v[124:127], a[140:143]
  s_waitcnt lgkmcnt(8)
  v_add_f32 v12, v12, v81
  v_add_f32 v12, v12, v82
  v_mfma_f32_16x16x32_bf16 a[144:147], v[36:39], v[112:115], a[144:147]
  s_add_u32 m0, s33, 65536
  v_add_f32 v12, v12, v83
  ds_read_b64_tr_b16 v[56:57], v8 offset:28672
  v_mfma_f32_16x16x32_bf16 a[148:151], v[36:39], v[116:119], a[148:151]
  buffer_load_dwordx4 v11, s[16:19], s65 offen nt lds
  v_mfma_f32_16x16x32_bf16 a[152:155], v[36:39], v[120:123], a[152:155]
  v_cvt_pk_bf16_f32 v98, v80, v81
  ds_read_b64_tr_b16 v[58:59], v8 offset:30720
  v_mfma_f32_16x16x32_bf16 a[156:159], v[36:39], v[124:127], a[156:159]
  s_waitcnt lgkmcnt(8)
  v_cvt_pk_bf16_f32 v99, v82, v83
  v_add_f32 v13, v13, v84
  v_mfma_f32_16x16x32_bf16 a[160:163], v[40:43], v[112:115], a[160:163]
  v_add_f32 v13, v13, v85
  ds_read_b64_tr_b16 v[60:61], v9 offset:28672
  v_mfma_f32_16x16x32_bf16 a[164:167], v[40:43], v[116:119], a[164:167]
  v_add_f32 v13, v13, v86
  v_add_f32 v13, v13, v87
  v_mfma_f32_16x16x32_bf16 a[168:171], v[40:43], v[120:123], a[168:171]
  v_cvt_pk_bf16_f32 v102, v84, v85
  ds_read_b64_tr_b16 v[62:63], v9 offset:30720
  v_mfma_f32_16x16x32_bf16 a[172:175], v[40:43], v[124:127], a[172:175]
  s_waitcnt lgkmcnt(8)
  v_cvt_pk_bf16_f32 v103, v86, v87
  v_mfma_f32_16x16x32_bf16 a[176:179], v[44:47], v[112:115], a[176:179]
  ds_read_b128 v[32:35], v4 offset:49152
  v_mfma_f32_16x16x32_bf16 a[180:183], v[44:47], v[116:119], a[180:183]
  v_mfma_f32_16x16x32_bf16 a[184:187], v[44:47], v[120:123], a[184:187]
  ds_read_b128 v[36:39], v5 offset:49152
  v_mfma_f32_16x16x32_bf16 a[188:191], v[44:47], v[124:127], a[188:191]
  s_waitcnt lgkmcnt(8)
  v_mfma_f32_16x16x32_bf16 a[192:195], v[48:51], v[112:115], a[192:195]
  ds_read_b128 v[40:43], v4 offset:53248
  v_mfma_f32_16x16x32_bf16 a[196:199], v[48:51], v[116:119], a[196:199]
  v_mfma_f32_16x16x32_bf16 a[200:203], v[48:51], v[120:123], a[200:203]
  ds_read_b128 v[44:47], v5 offset:53248
  v_mfma_f32_16x16x32_bf16 a[204:207], v[48:51], v[124:127], a[204:207]
  s_waitcnt lgkmcnt(8)
  v_mfma_f32_16x16x32_bf16 a[208:211], v[52:55], v[112:115], a[208:211]
  s_add_u32 m0, s33, 69504
  ds_read_b128 v[48:51], v4 offset:57344
  v_mfma_f32_16x16x32_bf16 a[212:215], v[52:55], v[116:119], a[212:215]
  buffer_load_dwordx4 v11, s[16:19], s65 offen offset:128 nt lds
  v_mfma_f32_16x16x32_bf16 a[216:219], v[52:55], v[120:123], a[216:219]
  v_mfma_f32_16x16x32_bf16 a[220:223], v[52:55], v[124:127], a[220:223]
  s_waitcnt lgkmcnt(7)
  v_mfma_f32_16x16x32_bf16 a[224:227], v[56:59], v[112:115], a[224:227]
  ds_read_b128 v[52:55], v5 offset:57344
  v_mfma_f32_16x16x32_bf16 a[228:231], v[56:59], v[116:119], a[228:231]
  v_mfma_f32_16x16x32_bf16 a[232:235], v[56:59], v[120:123], a[232:235]
  v_mfma_f32_16x16x32_bf16 a[236:239], v[56:59], v[124:127], a[236:239]
  s_waitcnt lgkmcnt(6)
  v_mfma_f32_16x16x32_bf16 a[240:243], v[60:63], v[112:115], a[240:243]
  ds_read_b128 v[56:59], v4 offset:61440
  v_mfma_f32_16x16x32_bf16 a[244:247], v[60:63], v[116:119], a[244:247]
  v_mfma_f32_16x16x32_bf16 a[248:251], v[60:63], v[120:123], a[248:251]
  v_mfma_f32_16x16x32_bf16 a[252:255], v[60:63], v[124:127], a[252:255]
  ds_read_b128 v[60:63], v5 offset:61440
  s_waitcnt lgkmcnt(6)
  v_mfma_f32_16x16x32_bf16 v[64:67], v[32:35], v[128:131], 0
  v_fma_f32 v88, v88, s63, v18
  v_fma_f32 v89, v89, s63, v18
  v_mfma_f32_16x16x32_bf16 v[64:67], v[36:39], v[132:135], v[64:67]
  v_exp_f32 v88, v88
  v_mfma_f32_16x16x32_bf16 v[68:71], v[32:35], v[160:163], 0
  v_exp_f32 v89, v89
  v_mfma_f32_16x16x32_bf16 v[68:71], v[36:39], v[164:167], v[68:71]
  v_fma_f32 v90, v90, s63, v18
  v_fma_f32 v91, v91, s63, v18
  v_mfma_f32_16x16x32_bf16 v[72:75], v[32:35], v[192:195], 0
  s_add_u32 m0, s33, 73472
  v_exp_f32 v90, v90
  v_mfma_f32_16x16x32_bf16 v[72:75], v[36:39], v[196:199], v[72:75]
  buffer_load_dwordx4 v11, s[16:19], s65 offen offset:256 nt lds
  v_mfma_f32_16x16x32_bf16 v[76:79], v[32:35], v[224:227], 0
  v_exp_f32 v91, v91
  v_mfma_f32_16x16x32_bf16 v[76:79], v[36:39], v[228:231], v[76:79]
  s_waitcnt lgkmcnt(4)
  v_fma_f32 v92, v92, s63, v19
  v_fma_f32 v93, v93, s63, v19
  v_mfma_f32_16x16x32_bf16 v[64:67], v[40:43], v[136:139], v[64:67]
  v_exp_f32 v92, v92
  v_mfma_f32_16x16x32_bf16 v[64:67], v[44:47], v[140:143], v[64:67]
  v_exp_f32 v93, v93
  v_mfma_f32_16x16x32_bf16 v[68:71], v[40:43], v[168:171], v[68:71]
  v_fma_f32 v94, v94, s63, v19
  ds_read_b128 v[32:35], v4 offset:51200
  v_mfma_f32_16x16x32_bf16 v[68:71], v[44:47], v[172:175], v[68:71]
  v_exp_f32 v94, v94
  v_mfma_f32_16x16x32_bf16 v[72:75], v[40:43], v[200:203], v[72:75]
  v_fma_f32 v95, v95, s63, v19
  v_add_f32 v14, v14, v88
  v_mfma_f32_16x16x32_bf16 v[72:75], v[44:47], v[204:207], v[72:75]
  v_exp_f32 v95, v95
  v_mfma_f32_16x16x32_bf16 v[76:79], v[40:43], v[232:235], v[76:79]
  v_add_f32 v14, v14, v89
  ds_read_b128 v[36:39], v5 offset:51200
  v_mfma_f32_16x16x32_bf16 v[76:79], v[44:47], v[236:239], v[76:79]
  s_waitcnt lgkmcnt(4)
  v_add_f32 v14, v14, v90
  v_add_f32 v14, v14, v91
  v_mfma_f32_16x16x32_bf16 v[64:67], v[48:51], v[144:147], v[64:67]
  v_cvt_pk_bf16_f32 v106, v88, v89
  v_cvt_pk_bf16_f32 v107, v90, v91
  v_mfma_f32_16x16x32_bf16 v[64:67], v[52:55], v[148:151], v[64:67]
  v_add_f32 v15, v15, v92
  v_add_f32 v15, v15, v93
  v_mfma_f32_16x16x32_bf16 v[68:71], v[48:51], v[176:179], v[68:71]
  v_add_f32 v15, v15, v94
  ds_read_b128 v[40:43], v4 offset:55296
  v_mfma_f32_16x16x32_bf16 v[68:71], v[52:55], v[180:183], v[68:71]
  v_add_f32 v15, v15, v95
  v_cvt_pk_bf16_f32 v110, v92, v93
  v_mfma_f32_16x16x32_bf16 v[72:75], v[48:51], v[208:211], v[72:75]
  s_add_u32 m0, s33, 77440
  v_cvt_pk_bf16_f32 v111, v94, v95
  v_mfma_f32_16x16x32_bf16 v[72:75], v[52:55], v[212:215], v[72:75]
  buffer_load_dwordx4 v11, s[16:19], s65 offen offset:384 nt lds
  v_mfma_f32_16x16x32_bf16 v[76:79], v[48:51], v[240:243], v[76:79]
  s_add_u32 s65, s65, 16384
  ds_read_b128 v[44:47], v5 offset:55296
  v_mfma_f32_16x16x32_bf16 v[76:79], v[52:55], v[244:247], v[76:79]
  s_waitcnt lgkmcnt(4)
  v_mfma_f32_16x16x32_bf16 v[64:67], v[56:59], v[152:155], v[64:67]
  s_and_b32 s65, s65, 0x7ffff
  v_mfma_f32_16x16x32_bf16 v[64:67], v[60:63], v[156:159], v[64:67]
  v_mfma_f32_16x16x32_bf16 v[68:71], v[56:59], v[184:187], v[68:71]
  ds_read_b128 v[48:51], v4 offset:59392
  v_mfma_f32_16x16x32_bf16 v[68:71], v[60:63], v[188:191], v[68:71]
  v_mfma_f32_16x16x32_bf16 v[72:75], v[56:59], v[216:219], v[72:75]
  v_mfma_f32_16x16x32_bf16 v[72:75], v[60:63], v[220:223], v[72:75]
  v_mfma_f32_16x16x32_bf16 v[76:79], v[56:59], v[248:251], v[76:79]
  ds_read_b128 v[52:55], v5 offset:59392
  v_mfma_f32_16x16x32_bf16 v[76:79], v[60:63], v[252:255], v[76:79]
  s_waitcnt lgkmcnt(4)
  v_fma_f32 v64, v64, s63, v16
  v_fma_f32 v65, v65, s63, v16
  v_mfma_f32_16x16x32_bf16 v[80:83], v[32:35], v[128:131], 0
  v_exp_f32 v64, v64
  v_mfma_f32_16x16x32_bf16 v[80:83], v[36:39], v[132:135], v[80:83]
  v_exp_f32 v65, v65
  v_mfma_f32_16x16x32_bf16 v[84:87], v[32:35], v[160:163], 0
  v_fma_f32 v66, v66, s63, v16
  ds_read_b128 v[56:59], v4 offset:63488
  v_mfma_f32_16x16x32_bf16 v[84:87], v[36:39], v[164:167], v[84:87]
  v_exp_f32 v66, v66
  v_mfma_f32_16x16x32_bf16 v[88:91], v[32:35], v[192:195], 0
  s_add_u32 m0, s33, 32768
  v_fma_f32 v67, v67, s63, v16
  v_add_f32 v12, v12, v64
  v_mfma_f32_16x16x32_bf16 v[88:91], v[36:39], v[196:199], v[88:91]
  buffer_load_dwordx4 v10, s[12:15], s64 offen nt lds
  v_mfma_f32_16x16x32_bf16 v[92:95], v[32:35], v[224:227], 0
  v_add_f32 v12, v12, v65
  ds_read_b128 v[60:63], v5 offset:63488
  v_mfma_f32_16x16x32_bf16 v[92:95], v[36:39], v[228:231], v[92:95]
  s_waitcnt lgkmcnt(4)
  v_exp_f32 v67, v67
  v_mfma_f32_16x16x32_bf16 v[80:83], v[40:43], v[136:139], v[80:83]
  v_add_f32 v12, v12, v66
  v_add_f32 v12, v12, v67
  v_mfma_f32_16x16x32_bf16 v[80:83], v[44:47], v[140:143], v[80:83]
  v_cvt_pk_bf16_f32 v112, v64, v65
  v_cvt_pk_bf16_f32 v113, v66, v67
  v_mfma_f32_16x16x32_bf16 v[84:87], v[40:43], v[168:171], v[84:87]
  v_fma_f32 v68, v68, s63, v17
  v_fma_f32 v69, v69, s63, v17
  v_mfma_f32_16x16x32_bf16 v[84:87], v[44:47], v[172:175], v[84:87]
  v_exp_f32 v68, v68
  v_mfma_f32_16x16x32_bf16 v[88:91], v[40:43], v[200:203], v[88:91]
  v_fma_f32 v70, v70, s63, v17
  ds_read_b64_tr_b16 v[32:33], v6 offset:32768
  v_mfma_f32_16x16x32_bf16 v[88:91], v[44:47], v[204:207], v[88:91]
  v_exp_f32 v69, v69
  v_mfma_f32_16x16x32_bf16 v[92:95], v[40:43], v[232:235], v[92:95]
  v_fma_f32 v71, v71, s63, v17
  ds_read_b64_tr_b16 v[34:35], v6 offset:34816
  v_mfma_f32_16x16x32_bf16 v[92:95], v[44:47], v[236:239], v[92:95]
  s_waitcnt lgkmcnt(4)
  v_exp_f32 v70, v70
  v_mfma_f32_16x16x32_bf16 v[80:83], v[48:51], v[144:147], v[80:83]
  v_add_f32 v13, v13, v68
  ds_read_b64_tr_b16 v[36:37], v7 offset:32768
  v_mfma_f32_16x16x32_bf16 v[80:83], v[52:55], v[148:151], v[80:83]
  v_exp_f32 v71, v71
  v_mfma_f32_16x16x32_bf16 v[84:87], v[48:51], v[176:179], v[84:87]
  v_add_f32 v13, v13, v69
  ds_read_b64_tr_b16 v[38:39], v7 offset:34816
  v_mfma_f32_16x16x32_bf16 v[84:87], v[52:55], v[180:183], v[84:87]
  v_add_f32 v13, v13, v70
  v_add_f32 v13, v13, v71
  v_mfma_f32_16x16x32_bf16 v[88:91], v[48:51], v[208:211], v[88:91]
  s_add_u32 m0, s33, 36736
  v_cvt_pk_bf16_f32 v116, v68, v69
  ds_read_b64_tr_b16 v[40:41], v8 offset:32768
  v_mfma_f32_16x16x32_bf16 v[88:91], v[52:55], v[212:215], v[88:91]
  buffer_load_dwordx4 v10, s[12:15], s64 offen offset:128 nt lds
  v_mfma_f32_16x16x32_bf16 v[92:95], v[48:51], v[240:243], v[92:95]
  v_cvt_pk_bf16_f32 v117, v70, v71
  ds_read_b64_tr_b16 v[42:43], v8 offset:34816
  v_mfma_f32_16x16x32_bf16 v[92:95], v[52:55], v[244:247], v[92:95]
  s_waitcnt lgkmcnt(6)
  v_fma_f32 v72, v72, s63, v18
  v_fma_f32 v73, v73, s63, v18
  v_mfma_f32_16x16x32_bf16 v[80:83], v[56:59], v[152:155], v[80:83]
  v_fma_f32 v74, v74, s63, v18
  ds_read_b64_tr_b16 v[44:45], v9 offset:32768
  v_mfma_f32_16x16x32_bf16 v[80:83], v[60:63], v[156:159], v[80:83]
  v_exp_f32 v72, v72
  v_mfma_f32_16x16x32_bf16 v[84:87], v[56:59], v[184:187], v[84:87]
  v_fma_f32 v75, v75, s63, v18
  ds_read_b64_tr_b16 v[46:47], v9 offset:34816
  v_mfma_f32_16x16x32_bf16 v[84:87], v[60:63], v[188:191], v[84:87]
  v_exp_f32 v73, v73
  v_mfma_f32_16x16x32_bf16 v[88:91], v[56:59], v[216:219], v[88:91]
  v_add_f32 v14, v14, v72
  ds_read_b64_tr_b16 v[48:49], v6 offset:36864
  v_mfma_f32_16x16x32_bf16 v[88:91], v[60:63], v[220:223], v[88:91]
  v_exp_f32 v74, v74
  v_mfma_f32_16x16x32_bf16 v[92:95], v[56:59], v[248:251], v[92:95]
  v_add_f32 v14, v14, v73
  ds_read_b64_tr_b16 v[50:51], v6 offset:38912
  v_mfma_f32_16x16x32_bf16 v[92:95], v[60:63], v[252:255], v[92:95]
  s_waitcnt lgkmcnt(8)
  v_exp_f32 v75, v75
  v_mfma_f32_16x16x32_bf16 a[0:3], v[32:35], v[96:99], a[0:3]
  v_add_f32 v14, v14, v74
  ds_read_b64_tr_b16 v[52:53], v7 offset:36864
  v_mfma_f32_16x16x32_bf16 a[4:7], v[32:35], v[100:103], a[4:7]
  v_add_f32 v14, v14, v75
  v_cvt_pk_bf16_f32 v120, v72, v73
  v_mfma_f32_16x16x32_bf16 a[8:11], v[32:35], v[104:107], a[8:11]
  v_cvt_pk_bf16_f32 v121, v74, v75
  ds_read_b64_tr_b16 v[54:55], v7 offset:38912
  v_mfma_f32_16x16x32_bf16 a[12:15], v[32:35], v[108:111], a[12:15]
  s_waitcnt lgkmcnt(8)
  v_fma_f32 v76, v76, s63, v19
  v_fma_f32 v77, v77, s63, v19
  v_mfma_f32_16x16x32_bf16 a[16:19], v[36:39], v[96:99], a[16:19]
  s_add_u32 m0, s33, 40704
  v_fma_f32 v78, v78, s63, v19
  ds_read_b64_tr_b16 v[56:57], v8 offset:36864
  v_mfma_f32_16x16x32_bf16 a[20:23], v[36:39], v[100:103], a[20:23]
  buffer_load_dwordx4 v10, s[12:15], s64 offen offset:256 nt lds
  v_mfma_f32_16x16x32_bf16 a[24:27], v[36:39], v[104:107], a[24:27]
  v_fma_f32 v79, v79, s63, v19
  ds_read_b64_tr_b16 v[58:59], v8 offset:38912
  v_mfma_f32_16x16x32_bf16 a[28:31], v[36:39], v[108:111], a[28:31]
  s_waitcnt lgkmcnt(8)
  v_exp_f32 v76, v76
  v_mfma_f32_16x16x32_bf16 a[32:35], v[40:43], v[96:99], a[32:35]
  v_add_f32 v15, v15, v76
  ds_read_b64_tr_b16 v[60:61], v9 offset:36864
  v_mfma_f32_16x16x32_bf16 a[36:39], v[40:43], v[100:103], a[36:39]
  v_exp_f32 v77, v77
  v_mfma_f32_16x16x32_bf16 a[40:43], v[40:43], v[104:107], a[40:43]
  v_add_f32 v15, v15, v77
  ds_read_b64_tr_b16 v[62:63], v9 offset:38912
  v_mfma_f32_16x16x32_bf16 a[44:47], v[40:43], v[108:111], a[44:47]
  s_waitcnt lgkmcnt(8)
  v_exp_f32 v78, v78
  v_mfma_f32_16x16x32_bf16 a[48:51], v[44:47], v[96:99], a[48:51]
  v_add_f32 v15, v15, v78
  ds_read_b64_tr_b16 v[32:33], v6 offset:40960
  v_mfma_f32_16x16x32_bf16 a[52:55], v[44:47], v[100:103], a[52:55]
  v_exp_f32 v79, v79
  v_mfma_f32_16x16x32_bf16 a[56:59], v[44:47], v[104:107], a[56:59]
  v_add_f32 v15, v15, v79
  ds_read_b64_tr_b16 v[34:35], v6 offset:43008
  v_mfma_f32_16x16x32_bf16 a[60:63], v[44:47], v[108:111], a[60:63]
  s_waitcnt lgkmcnt(8)
  v_cvt_pk_bf16_f32 v124, v76, v77
  v_cvt_pk_bf16_f32 v125, v78, v79
  v_mfma_f32_16x16x32_bf16 a[64:67], v[48:51], v[96:99], a[64:67]
  v_fma_f32 v80, v80, s63, v16
  ds_read_b64_tr_b16 v[36:37], v7 offset:40960
  v_mfma_f32_16x16x32_bf16 a[68:71], v[48:51], v[100:103], a[68:71]
  v_exp_f32 v80, v80
  v_mfma_f32_16x16x32_bf16 a[72:75], v[48:51], v[104:107], a[72:75]
  v_fma_f32 v81, v81, s63, v16
  ds_read_b64_tr_b16 v[38:39], v7 offset:43008
  v_mfma_f32_16x16x32_bf16 a[76:79], v[48:51], v[108:111], a[76:79]
  s_waitcnt lgkmcnt(8)
  v_exp_f32 v81, v81
  v_mfma_f32_16x16x32_bf16 a[80:83], v[52:55], v[96:99], a[80:83]
  s_add_u32 m0, s33, 44672
  v_fma_f32 v82, v82, s63, v16
  ds_read_b64_tr_b16 v[40:41], v8 offset:40960
  v_mfma_f32_16x16x32_bf16 a[84:87], v[52:55], v[100:103], a[84:87]
  buffer_load_dwordx4 v10, s[12:15], s64 offen offset:384 nt lds
  v_mfma_f32_16x16x32_bf16 a[88:91], v[52:55], v[104:107], a[88:91]
  s_add_u32 s64, s64, 16384
  v_fma_f32 v83, v83, s63, v16
  ds_read_b64_tr_b16 v[42:43], v8 offset:43008
  v_mfma_f32_16x16x32_bf16 a[92:95], v[52:55], v[108:111], a[92:95]
  s_waitcnt lgkmcnt(8)
  v_exp_f32 v82, v82
  v_mfma_f32_16x16x32_bf16 a[96:99], v[56:59], v[96:99], a[96:99]
  s_and_b32 s64, s64, 0x7ffff
  v_fma_f32 v84, v84, s63, v17
  ds_read_b64_tr_b16 v[44:45], v9 offset:40960
  v_mfma_f32_16x16x32_bf16 a[100:103], v[56:59], v[100:103], a[100:103]
  v_exp_f32 v83, v83
  v_mfma_f32_16x16x32_bf16 a[104:107], v[56:59], v[104:107], a[104:107]
  v_fma_f32 v85, v85, s63, v17
  ds_read_b64_tr_b16 v[46:47], v9 offset:43008
  v_mfma_f32_16x16x32_bf16 a[108:111], v[56:59], v[108:111], a[108:111]
  s_waitcnt lgkmcnt(8)
  v_exp_f32 v84, v84
  v_mfma_f32_16x16x32_bf16 a[112:115], v[60:63], v[96:99], a[112:115]
  v_fma_f32 v86, v86, s63, v17
  ds_read_b64_tr_b16 v[48:49], v6 offset:45056
  v_mfma_f32_16x16x32_bf16 a[116:119], v[60:63], v[100:103], a[116:119]
  v_exp_f32 v85, v85
  v_mfma_f32_16x16x32_bf16 a[120:123], v[60:63], v[104:107], a[120:123]
  v_fma_f32 v87, v87, s63, v17
  ds_read_b64_tr_b16 v[50:51], v6 offset:47104
  v_mfma_f32_16x16x32_bf16 a[124:127], v[60:63], v[108:111], a[124:127]
  s_waitcnt lgkmcnt(8)
  v_exp_f32 v86, v86
  v_mfma_f32_16x16x32_bf16 a[128:131], v[32:35], v[96:99], a[128:131]
  v_add_f32 v12, v12, v80
  ds_read_b64_tr_b16 v[52:53], v7 offset:45056
  v_mfma_f32_16x16x32_bf16 a[132:135], v[32:35], v[100:103], a[132:135]
  v_exp_f32 v87, v87
  v_mfma_f32_16x16x32_bf16 a[136:139], v[32:35], v[104:107], a[136:139]
  s_waitcnt vmcnt(12)
  s_barrier
  ds_read_b64_tr_b16 v[54:55], v7 offset:47104
  v_mfma_f32_16x16x32_bf16 a[140:143], v[32:35], v[108:111], a[140:143]
  s_waitcnt lgkmcnt(8)
  v_add_f32 v12, v12, v81
  v_add_f32 v12, v12, v82
  v_mfma_f32_16x16x32_bf16 a[144:147], v[36:39], v[96:99], a[144:147]
  s_add_u32 m0, s33, 81920
  v_add_f32 v12, v12, v83
  ds_read_b64_tr_b16 v[56:57], v8 offset:45056
  v_mfma_f32_16x16x32_bf16 a[148:151], v[36:39], v[100:103], a[148:151]
  buffer_load_dwordx4 v11, s[16:19], s65 offen nt lds
  v_mfma_f32_16x16x32_bf16 a[152:155], v[36:39], v[104:107], a[152:155]
  v_cvt_pk_bf16_f32 v114, v80, v81
  ds_read_b64_tr_b16 v[58:59], v8 offset:47104
  v_mfma_f32_16x16x32_bf16 a[156:159], v[36:39], v[108:111], a[156:159]
  s_waitcnt lgkmcnt(8)
  v_cvt_pk_bf16_f32 v115, v82, v83
  v_add_f32 v13, v13, v84
  v_mfma_f32_16x16x32_bf16 a[160:163], v[40:43], v[96:99], a[160:163]
  v_add_f32 v13, v13, v85
  ds_read_b64_tr_b16 v[60:61], v9 offset:45056
  v_mfma_f32_16x16x32_bf16 a[164:167], v[40:43], v[100:103], a[164:167]
  v_add_f32 v13, v13, v86
  v_add_f32 v13, v13, v87
  v_mfma_f32_16x16x32_bf16 a[168:171], v[40:43], v[104:107], a[168:171]
  v_cvt_pk_bf16_f32 v118, v84, v85
  ds_read_b64_tr_b16 v[62:63], v9 offset:47104
  v_mfma_f32_16x16x32_bf16 a[172:175], v[40:43], v[108:111], a[172:175]
  s_waitcnt lgkmcnt(8)
  v_cvt_pk_bf16_f32 v119, v86, v87
  v_mfma_f32_16x16x32_bf16 a[176:179], v[44:47], v[96:99], a[176:179]
  ds_read_b128 v[32:35], v4 offset:0
  v_mfma_f32_16x16x32_bf16 a[180:183], v[44:47], v[100:103], a[180:183]
  v_mfma_f32_16x16x32_bf16 a[184:187], v[44:47], v[104:107], a[184:187]
  ds_read_b128 v[36:39], v5 offset:0
  v_mfma_f32_16x16x32_bf16 a[188:191], v[44:47], v[108:111], a[188:191]
  s_waitcnt lgkmcnt(8)
  v_mfma_f32_16x16x32_bf16 a[192:195], v[48:51], v[96:99], a[192:195]
  ds_read_b128 v[40:43], v4 offset:4096
  v_mfma_f32_16x16x32_bf16 a[196:199], v[48:51], v[100:103], a[196:199]
  v_mfma_f32_16x16x32_bf16 a[200:203], v[48:51], v[104:107], a[200:203]
  ds_read_b128 v[44:47], v5 offset:4096
  v_mfma_f32_16x16x32_bf16 a[204:207], v[48:51], v[108:111], a[204:207]
  s_waitcnt lgkmcnt(8)
  v_mfma_f32_16x16x32_bf16 a[208:211], v[52:55], v[96:99], a[208:211]
  s_add_u32 m0, s33, 85888
  ds_read_b128 v[48:51], v4 offset:8192
  v_mfma_f32_16x16x32_bf16 a[212:215], v[52:55], v[100:103], a[212:215]
  buffer_load_dwordx4 v11, s[16:19], s65 offen offset:128 nt lds
  v_mfma_f32_16x16x32_bf16 a[216:219], v[52:55], v[104:107], a[216:219]
  v_mfma_f32_16x16x32_bf16 a[220:223], v[52:55], v[108:111], a[220:223]
  s_waitcnt lgkmcnt(7)
  v_mfma_f32_16x16x32_bf16 a[224:227], v[56:59], v[96:99], a[224:227]
  ds_read_b128 v[52:55], v5 offset:8192
  v_mfma_f32_16x16x32_bf16 a[228:231], v[56:59], v[100:103], a[228:231]
  v_mfma_f32_16x16x32_bf16 a[232:235], v[56:59], v[104:107], a[232:235]
  v_mfma_f32_16x16x32_bf16 a[236:239], v[56:59], v[108:111], a[236:239]
  s_waitcnt lgkmcnt(6)
  v_mfma_f32_16x16x32_bf16 a[240:243], v[60:63], v[96:99], a[240:243]
  ds_read_b128 v[56:59], v4 offset:12288
  v_mfma_f32_16x16x32_bf16 a[244:247], v[60:63], v[100:103], a[244:247]
  v_mfma_f32_16x16x32_bf16 a[248:251], v[60:63], v[104:107], a[248:251]
  v_mfma_f32_16x16x32_bf16 a[252:255], v[60:63], v[108:111], a[252:255]
  ds_read_b128 v[60:63], v5 offset:12288
  s_waitcnt lgkmcnt(6)
  v_mfma_f32_16x16x32_bf16 v[64:67], v[32:35], v[128:131], 0
  v_fma_f32 v88, v88, s63, v18
  v_fma_f32 v89, v89, s63, v18
  v_mfma_f32_16x16x32_bf16 v[64:67], v[36:39], v[132:135], v[64:67]
  v_exp_f32 v88, v88
  v_mfma_f32_16x16x32_bf16 v[68:71], v[32:35], v[160:163], 0
  v_exp_f32 v89, v89
  v_mfma_f32_16x16x32_bf16 v[68:71], v[36:39], v[164:167], v[68:71]
  v_fma_f32 v90, v90, s63, v18
  v_fma_f32 v91, v91, s63, v18
  v_mfma_f32_16x16x32_bf16 v[72:75], v[32:35], v[192:195], 0
  s_add_u32 m0, s33, 89856
  v_exp_f32 v90, v90
  v_mfma_f32_16x16x32_bf16 v[72:75], v[36:39], v[196:199], v[72:75]
  buffer_load_dwordx4 v11, s[16:19], s65 offen offset:256 nt lds
  v_mfma_f32_16x16x32_bf16 v[76:79], v[32:35], v[224:227], 0
  v_exp_f32 v91, v91
  v_mfma_f32_16x16x32_bf16 v[76:79], v[36:39], v[228:231], v[76:79]
  s_waitcnt lgkmcnt(4)
  v_fma_f32 v92, v92, s63, v19
  v_fma_f32 v93, v93, s63, v19
  v_mfma_f32_16x16x32_bf16 v[64:67], v[40:43], v[136:139], v[64:67]
  v_exp_f32 v92, v92
  v_mfma_f32_16x16x32_bf16 v[64:67], v[44:47], v[140:143], v[64:67]
  v_exp_f32 v93, v93
  v_mfma_f32_16x16x32_bf16 v[68:71], v[40:43], v[168:171], v[68:71]
  v_fma_f32 v94, v94, s63, v19
  ds_read_b128 v[32:35], v4 offset:2048
  v_mfma_f32_16x16x32_bf16 v[68:71], v[44:47], v[172:175], v[68:71]
  v_exp_f32 v94, v94
  v_mfma_f32_16x16x32_bf16 v[72:75], v[40:43], v[200:203], v[72:75]
  v_fma_f32 v95, v95, s63, v19
  v_add_f32 v14, v14, v88
  v_mfma_f32_16x16x32_bf16 v[72:75], v[44:47], v[204:207], v[72:75]
  v_exp_f32 v95, v95
  v_mfma_f32_16x16x32_bf16 v[76:79], v[40:43], v[232:235], v[76:79]
  v_add_f32 v14, v14, v89
  ds_read_b128 v[36:39], v5 offset:2048
  v_mfma_f32_16x16x32_bf16 v[76:79], v[44:47], v[236:239], v[76:79]
  s_waitcnt lgkmcnt(4)
  v_add_f32 v14, v14, v90
  v_add_f32 v14, v14, v91
  v_mfma_f32_16x16x32_bf16 v[64:67], v[48:51], v[144:147], v[64:67]
  v_cvt_pk_bf16_f32 v122, v88, v89
  v_cvt_pk_bf16_f32 v123, v90, v91
  v_mfma_f32_16x16x32_bf16 v[64:67], v[52:55], v[148:151], v[64:67]
  v_add_f32 v15, v15, v92
  v_add_f32 v15, v15, v93
  v_mfma_f32_16x16x32_bf16 v[68:71], v[48:51], v[176:179], v[68:71]
  v_add_f32 v15, v15, v94
  ds_read_b128 v[40:43], v4 offset:6144
  v_mfma_f32_16x16x32_bf16 v[68:71], v[52:55], v[180:183], v[68:71]
  v_add_f32 v15, v15, v95
  v_cvt_pk_bf16_f32 v126, v92, v93
  v_mfma_f32_16x16x32_bf16 v[72:75], v[48:51], v[208:211], v[72:75]
  s_add_u32 m0, s33, 93824
  v_cvt_pk_bf16_f32 v127, v94, v95
  v_mfma_f32_16x16x32_bf16 v[72:75], v[52:55], v[212:215], v[72:75]
  buffer_load_dwordx4 v11, s[16:19], s65 offen offset:384 nt lds
  v_mfma_f32_16x16x32_bf16 v[76:79], v[48:51], v[240:243], v[76:79]
  s_add_u32 s65, s65, 16384
  ds_read_b128 v[44:47], v5 offset:6144
  v_mfma_f32_16x16x32_bf16 v[76:79], v[52:55], v[244:247], v[76:79]
  s_waitcnt lgkmcnt(4)
  v_mfma_f32_16x16x32_bf16 v[64:67], v[56:59], v[152:155], v[64:67]
  s_and_b32 s65, s65, 0x7ffff
  v_mfma_f32_16x16x32_bf16 v[64:67], v[60:63], v[156:159], v[64:67]
  v_mfma_f32_16x16x32_bf16 v[68:71], v[56:59], v[184:187], v[68:71]
  ds_read_b128 v[48:51], v4 offset:10240
  v_mfma_f32_16x16x32_bf16 v[68:71], v[60:63], v[188:191], v[68:71]
  v_mfma_f32_16x16x32_bf16 v[72:75], v[56:59], v[216:219], v[72:75]
  v_mfma_f32_16x16x32_bf16 v[72:75], v[60:63], v[220:223], v[72:75]
  v_mfma_f32_16x16x32_bf16 v[76:79], v[56:59], v[248:251], v[76:79]
  ds_read_b128 v[52:55], v5 offset:10240
  v_mfma_f32_16x16x32_bf16 v[76:79], v[60:63], v[252:255], v[76:79]
  s_waitcnt lgkmcnt(4)
  v_fma_f32 v64, v64, s63, v16
  v_fma_f32 v65, v65, s63, v16
  v_mfma_f32_16x16x32_bf16 v[80:83], v[32:35], v[128:131], 0
  v_exp_f32 v64, v64
  v_mfma_f32_16x16x32_bf16 v[80:83], v[36:39], v[132:135], v[80:83]
  v_exp_f32 v65, v65
  v_mfma_f32_16x16x32_bf16 v[84:87], v[32:35], v[160:163], 0
  v_fma_f32 v66, v66, s63, v16
  ds_read_b128 v[56:59], v4 offset:14336
  v_mfma_f32_16x16x32_bf16 v[84:87], v[36:39], v[164:167], v[84:87]
  v_exp_f32 v66, v66
  v_mfma_f32_16x16x32_bf16 v[88:91], v[32:35], v[192:195], 0
  s_add_u32 m0, s33, 49152
  v_fma_f32 v67, v67, s63, v16
  v_add_f32 v12, v12, v64
  v_mfma_f32_16x16x32_bf16 v[88:91], v[36:39], v[196:199], v[88:91]
  buffer_load_dwordx4 v10, s[12:15], s64 offen nt lds
  v_mfma_f32_16x16x32_bf16 v[92:95], v[32:35], v[224:227], 0
  v_add_f32 v12, v12, v65
  ds_read_b128 v[60:63], v5 offset:14336
  v_mfma_f32_16x16x32_bf16 v[92:95], v[36:39], v[228:231], v[92:95]
  s_waitcnt lgkmcnt(4)
  v_exp_f32 v67, v67
  v_mfma_f32_16x16x32_bf16 v[80:83], v[40:43], v[136:139], v[80:83]
  v_add_f32 v12, v12, v66
  v_add_f32 v12, v12, v67
  v_mfma_f32_16x16x32_bf16 v[80:83], v[44:47], v[140:143], v[80:83]
  v_cvt_pk_bf16_f32 v96, v64, v65
  v_cvt_pk_bf16_f32 v97, v66, v67
  v_mfma_f32_16x16x32_bf16 v[84:87], v[40:43], v[168:171], v[84:87]
  v_fma_f32 v68, v68, s63, v17
  v_fma_f32 v69, v69, s63, v17
  v_mfma_f32_16x16x32_bf16 v[84:87], v[44:47], v[172:175], v[84:87]
  v_exp_f32 v68, v68
  v_mfma_f32_16x16x32_bf16 v[88:91], v[40:43], v[200:203], v[88:91]
  v_fma_f32 v70, v70, s63, v17
  ds_read_b64_tr_b16 v[32:33], v6 offset:49152
  v_mfma_f32_16x16x32_bf16 v[88:91], v[44:47], v[204:207], v[88:91]
  v_exp_f32 v69, v69
  v_mfma_f32_16x16x32_bf16 v[92:95], v[40:43], v[232:235], v[92:95]
  v_fma_f32 v71, v71, s63, v17
  ds_read_b64_tr_b16 v[34:35], v6 offset:51200
  v_mfma_f32_16x16x32_bf16 v[92:95], v[44:47], v[236:239], v[92:95]
  s_waitcnt lgkmcnt(4)
  v_exp_f32 v70, v70
  v_mfma_f32_16x16x32_bf16 v[80:83], v[48:51], v[144:147], v[80:83]
  v_add_f32 v13, v13, v68
  ds_read_b64_tr_b16 v[36:37], v7 offset:49152
  v_mfma_f32_16x16x32_bf16 v[80:83], v[52:55], v[148:151], v[80:83]
  v_exp_f32 v71, v71
  v_mfma_f32_16x16x32_bf16 v[84:87], v[48:51], v[176:179], v[84:87]
  v_add_f32 v13, v13, v69
  ds_read_b64_tr_b16 v[38:39], v7 offset:51200
  v_mfma_f32_16x16x32_bf16 v[84:87], v[52:55], v[180:183], v[84:87]
  v_add_f32 v13, v13, v70
  v_add_f32 v13, v13, v71
  v_mfma_f32_16x16x32_bf16 v[88:91], v[48:51], v[208:211], v[88:91]
  s_add_u32 m0, s33, 53120
  v_cvt_pk_bf16_f32 v100, v68, v69
  ds_read_b64_tr_b16 v[40:41], v8 offset:49152
  v_mfma_f32_16x16x32_bf16 v[88:91], v[52:55], v[212:215], v[88:91]
  buffer_load_dwordx4 v10, s[12:15], s64 offen offset:128 nt lds
  v_mfma_f32_16x16x32_bf16 v[92:95], v[48:51], v[240:243], v[92:95]
  v_cvt_pk_bf16_f32 v101, v70, v71
  ds_read_b64_tr_b16 v[42:43], v8 offset:51200
  v_mfma_f32_16x16x32_bf16 v[92:95], v[52:55], v[244:247], v[92:95]
  s_waitcnt lgkmcnt(6)
  v_fma_f32 v72, v72, s63, v18
  v_fma_f32 v73, v73, s63, v18
  v_mfma_f32_16x16x32_bf16 v[80:83], v[56:59], v[152:155], v[80:83]
  v_fma_f32 v74, v74, s63, v18
  ds_read_b64_tr_b16 v[44:45], v9 offset:49152
  v_mfma_f32_16x16x32_bf16 v[80:83], v[60:63], v[156:159], v[80:83]
  v_exp_f32 v72, v72
  v_mfma_f32_16x16x32_bf16 v[84:87], v[56:59], v[184:187], v[84:87]
  v_fma_f32 v75, v75, s63, v18
  ds_read_b64_tr_b16 v[46:47], v9 offset:51200
  v_mfma_f32_16x16x32_bf16 v[84:87], v[60:63], v[188:191], v[84:87]
  v_exp_f32 v73, v73
  v_mfma_f32_16x16x32_bf16 v[88:91], v[56:59], v[216:219], v[88:91]
  v_add_f32 v14, v14, v72
  ds_read_b64_tr_b16 v[48:49], v6 offset:53248
  v_mfma_f32_16x16x32_bf16 v[88:91], v[60:63], v[220:223], v[88:91]
  v_exp_f32 v74, v74
  v_mfma_f32_16x16x32_bf16 v[92:95], v[56:59], v[248:251], v[92:95]
  v_add_f32 v14, v14, v73
  ds_read_b64_tr_b16 v[50:51], v6 offset:55296
  v_mfma_f32_16x16x32_bf16 v[92:95], v[60:63], v[252:255], v[92:95]
  s_waitcnt lgkmcnt(8)
  v_exp_f32 v75, v75
  v_mfma_f32_16x16x32_bf16 a[0:3], v[32:35], v[112:115], a[0:3]
  v_add_f32 v14, v14, v74
  ds_read_b64_tr_b16 v[52:53], v7 offset:53248
  v_mfma_f32_16x16x32_bf16 a[4:7], v[32:35], v[116:119], a[4:7]
  v_add_f32 v14, v14, v75
  v_cvt_pk_bf16_f32 v104, v72, v73
  v_mfma_f32_16x16x32_bf16 a[8:11], v[32:35], v[120:123], a[8:11]
  v_cvt_pk_bf16_f32 v105, v74, v75
  ds_read_b64_tr_b16 v[54:55], v7 offset:55296
  v_mfma_f32_16x16x32_bf16 a[12:15], v[32:35], v[124:127], a[12:15]
  s_waitcnt lgkmcnt(8)
  v_fma_f32 v76, v76, s63, v19
  v_fma_f32 v77, v77, s63, v19
  v_mfma_f32_16x16x32_bf16 a[16:19], v[36:39], v[112:115], a[16:19]
  s_add_u32 m0, s33, 57088
  v_fma_f32 v78, v78, s63, v19
  ds_read_b64_tr_b16 v[56:57], v8 offset:53248
  v_mfma_f32_16x16x32_bf16 a[20:23], v[36:39], v[116:119], a[20:23]
  buffer_load_dwordx4 v10, s[12:15], s64 offen offset:256 nt lds
  v_mfma_f32_16x16x32_bf16 a[24:27], v[36:39], v[120:123], a[24:27]
  v_fma_f32 v79, v79, s63, v19
  ds_read_b64_tr_b16 v[58:59], v8 offset:55296
  v_mfma_f32_16x16x32_bf16 a[28:31], v[36:39], v[124:127], a[28:31]
  s_waitcnt lgkmcnt(8)
  v_exp_f32 v76, v76
  v_mfma_f32_16x16x32_bf16 a[32:35], v[40:43], v[112:115], a[32:35]
  v_add_f32 v15, v15, v76
  ds_read_b64_tr_b16 v[60:61], v9 offset:53248
  v_mfma_f32_16x16x32_bf16 a[36:39], v[40:43], v[116:119], a[36:39]
  v_exp_f32 v77, v77
  v_mfma_f32_16x16x32_bf16 a[40:43], v[40:43], v[120:123], a[40:43]
  v_add_f32 v15, v15, v77
  ds_read_b64_tr_b16 v[62:63], v9 offset:55296
  v_mfma_f32_16x16x32_bf16 a[44:47], v[40:43], v[124:127], a[44:47]
  s_waitcnt lgkmcnt(8)
  v_exp_f32 v78, v78
  v_mfma_f32_16x16x32_bf16 a[48:51], v[44:47], v[112:115], a[48:51]
  v_add_f32 v15, v15, v78
  ds_read_b64_tr_b16 v[32:33], v6 offset:57344
  v_mfma_f32_16x16x32_bf16 a[52:55], v[44:47], v[116:119], a[52:55]
  v_exp_f32 v79, v79
  v_mfma_f32_16x16x32_bf16 a[56:59], v[44:47], v[120:123], a[56:59]
  v_add_f32 v15, v15, v79
  ds_read_b64_tr_b16 v[34:35], v6 offset:59392
  v_mfma_f32_16x16x32_bf16 a[60:63], v[44:47], v[124:127], a[60:63]
  s_waitcnt lgkmcnt(8)
  v_cvt_pk_bf16_f32 v108, v76, v77
  v_cvt_pk_bf16_f32 v109, v78, v79
  v_mfma_f32_16x16x32_bf16 a[64:67], v[48:51], v[112:115], a[64:67]
  v_fma_f32 v80, v80, s63, v16
  ds_read_b64_tr_b16 v[36:37], v7 offset:57344
  v_mfma_f32_16x16x32_bf16 a[68:71], v[48:51], v[116:119], a[68:71]
  v_exp_f32 v80, v80
  v_mfma_f32_16x16x32_bf16 a[72:75], v[48:51], v[120:123], a[72:75]
  v_fma_f32 v81, v81, s63, v16
  ds_read_b64_tr_b16 v[38:39], v7 offset:59392
  v_mfma_f32_16x16x32_bf16 a[76:79], v[48:51], v[124:127], a[76:79]
  s_waitcnt lgkmcnt(8)
  v_exp_f32 v81, v81
  v_mfma_f32_16x16x32_bf16 a[80:83], v[52:55], v[112:115], a[80:83]
  s_add_u32 m0, s33, 61056
  v_fma_f32 v82, v82, s63, v16
  ds_read_b64_tr_b16 v[40:41], v8 offset:57344
  v_mfma_f32_16x16x32_bf16 a[84:87], v[52:55], v[116:119], a[84:87]
  buffer_load_dwordx4 v10, s[12:15], s64 offen offset:384 nt lds
  v_mfma_f32_16x16x32_bf16 a[88:91], v[52:55], v[120:123], a[88:91]
  s_add_u32 s64, s64, 16384
  v_fma_f32 v83, v83, s63, v16
  ds_read_b64_tr_b16 v[42:43], v8 offset:59392
  v_mfma_f32_16x16x32_bf16 a[92:95], v[52:55], v[124:127], a[92:95]
  s_waitcnt lgkmcnt(8)
  v_exp_f32 v82, v82
  v_mfma_f32_16x16x32_bf16 a[96:99], v[56:59], v[112:115], a[96:99]
  s_and_b32 s64, s64, 0x7ffff
  v_fma_f32 v84, v84, s63, v17
  ds_read_b64_tr_b16 v[44:45], v9 offset:57344
  v_mfma_f32_16x16x32_bf16 a[100:103], v[56:59], v[116:119], a[100:103]
  v_exp_f32 v83, v83
  v_mfma_f32_16x16x32_bf16 a[104:107], v[56:59], v[120:123], a[104:107]
  v_fma_f32 v85, v85, s63, v17
  ds_read_b64_tr_b16 v[46:47], v9 offset:59392
  v_mfma_f32_16x16x32_bf16 a[108:111], v[56:59], v[124:127], a[108:111]
  s_waitcnt lgkmcnt(8)
  v_exp_f32 v84, v84
  v_mfma_f32_16x16x32_bf16 a[112:115], v[60:63], v[112:115], a[112:115]
  v_fma_f32 v86, v86, s63, v17
  ds_read_b64_tr_b16 v[48:49], v6 offset:61440
  v_mfma_f32_16x16x32_bf16 a[116:119], v[60:63], v[116:119], a[116:119]
  v_exp_f32 v85, v85
  v_mfma_f32_16x16x32_bf16 a[120:123], v[60:63], v[120:123], a[120:123]
  v_fma_f32 v87, v87, s63, v17
  ds_read_b64_tr_b16 v[50:51], v6 offset:63488
  v_mfma_f32_16x16x32_bf16 a[124:127], v[60:63], v[124:127], a[124:127]
  s_waitcnt lgkmcnt(8)
  v_exp_f32 v86, v86
  v_mfma_f32_16x16x32_bf16 a[128:131], v[32:35], v[112:115], a[128:131]
  v_add_f32 v12, v12, v80
  ds_read_b64_tr_b16 v[52:53], v7 offset:61440
  v_mfma_f32_16x16x32_bf16 a[132:135], v[32:35], v[116:119], a[132:135]
  v_exp_f32 v87, v87
  v_mfma_f32_16x16x32_bf16 a[136:139], v[32:35], v[120:123], a[136:139]
  s_waitcnt vmcnt(12)
  s_barrier
  ds_read_b64_tr_b16 v[54:55], v7 offset:63488
  v_mfma_f32_16x16x32_bf16 a[140:143], v[32:35], v[124:127], a[140:143]
  s_waitcnt lgkmcnt(8)
  v_add_f32 v12, v12, v81
  v_add_f32 v12, v12, v82
  v_mfma_f32_16x16x32_bf16 a[144:147], v[36:39], v[112:115], a[144:147]
  s_add_u32 m0, s33, 98304
  v_add_f32 v12, v12, v83
  ds_read_b64_tr_b16 v[56:57], v8 offset:61440
  v_mfma_f32_16x16x32_bf16 a[148:151], v[36:39], v[116:119], a[148:151]
  buffer_load_dwordx4 v11, s[16:19], s65 offen nt lds
  v_mfma_f32_16x16x32_bf16 a[152:155], v[36:39], v[120:123], a[152:155]
  v_cvt_pk_bf16_f32 v98, v80, v81
  ds_read_b64_tr_b16 v[58:59], v8 offset:63488
  v_mfma_f32_16x16x32_bf16 a[156:159], v[36:39], v[124:127], a[156:159]
  s_waitcnt lgkmcnt(8)
  v_cvt_pk_bf16_f32 v99, v82, v83
  v_add_f32 v13, v13, v84
  v_mfma_f32_16x16x32_bf16 a[160:163], v[40:43], v[112:115], a[160:163]
  v_add_f32 v13, v13, v85
  ds_read_b64_tr_b16 v[60:61], v9 offset:61440
  v_mfma_f32_16x16x32_bf16 a[164:167], v[40:43], v[116:119], a[164:167]
  v_add_f32 v13, v13, v86
  v_add_f32 v13, v13, v87
  v_mfma_f32_16x16x32_bf16 a[168:171], v[40:43], v[120:123], a[168:171]
  v_cvt_pk_bf16_f32 v102, v84, v85
  ds_read_b64_tr_b16 v[62:63], v9 offset:63488
  v_mfma_f32_16x16x32_bf16 a[172:175], v[40:43], v[124:127], a[172:175]
  s_waitcnt lgkmcnt(8)
  v_cvt_pk_bf16_f32 v103, v86, v87
  v_mfma_f32_16x16x32_bf16 a[176:179], v[44:47], v[112:115], a[176:179]
  ds_read_b128 v[32:35], v4 offset:16384
  v_mfma_f32_16x16x32_bf16 a[180:183], v[44:47], v[116:119], a[180:183]
  v_mfma_f32_16x16x32_bf16 a[184:187], v[44:47], v[120:123], a[184:187]
  ds_read_b128 v[36:39], v5 offset:16384
  v_mfma_f32_16x16x32_bf16 a[188:191], v[44:47], v[124:127], a[188:191]
  s_waitcnt lgkmcnt(8)
  v_mfma_f32_16x16x32_bf16 a[192:195], v[48:51], v[112:115], a[192:195]
  ds_read_b128 v[40:43], v4 offset:20480
  v_mfma_f32_16x16x32_bf16 a[196:199], v[48:51], v[116:119], a[196:199]
  v_mfma_f32_16x16x32_bf16 a[200:203], v[48:51], v[120:123], a[200:203]
  ds_read_b128 v[44:47], v5 offset:20480
  v_mfma_f32_16x16x32_bf16 a[204:207], v[48:51], v[124:127], a[204:207]
  s_waitcnt lgkmcnt(8)
  v_mfma_f32_16x16x32_bf16 a[208:211], v[52:55], v[112:115], a[208:211]
  s_add_u32 m0, s33, 102272
  ds_read_b128 v[48:51], v4 offset:24576
  v_mfma_f32_16x16x32_bf16 a[212:215], v[52:55], v[116:119], a[212:215]
  buffer_load_dwordx4 v11, s[16:19], s65 offen offset:128 nt lds
  v_mfma_f32_16x16x32_bf16 a[216:219], v[52:55], v[120:123], a[216:219]
  v_mfma_f32_16x16x32_bf16 a[220:223], v[52:55], v[124:127], a[220:223]
  s_waitcnt lgkmcnt(7)
  v_mfma_f32_16x16x32_bf16 a[224:227], v[56:59], v[112:115], a[224:227]
  ds_read_b128 v[52:55], v5 offset:24576
  v_mfma_f32_16x16x32_bf16 a[228:231], v[56:59], v[116:119], a[228:231]
  v_mfma_f32_16x16x32_bf16 a[232:235], v[56:59], v[120:123], a[232:235]
  v_mfma_f32_16x16x32_bf16 a[236:239], v[56:59], v[124:127], a[236:239]
  s_waitcnt lgkmcnt(6)
  v_mfma_f32_16x16x32_bf16 a[240:243], v[60:63], v[112:115], a[240:243]
  ds_read_b128 v[56:59], v4 offset:28672
  v_mfma_f32_16x16x32_bf16 a[244:247], v[60:63], v[116:119], a[244:247]
  v_mfma_f32_16x16x32_bf16 a[248:251], v[60:63], v[120:123], a[248:251]
  v_mfma_f32_16x16x32_bf16 a[252:255], v[60:63], v[124:127], a[252:255]
  ds_read_b128 v[60:63], v5 offset:28672
  s_waitcnt lgkmcnt(6)
  v_mfma_f32_16x16x32_bf16 v[64:67], v[32:35], v[128:131], 0
  v_fma_f32 v88, v88, s63, v18
  v_fma_f32 v89, v89, s63, v18
  v_mfma_f32_16x16x32_bf16 v[64:67], v[36:39], v[132:135], v[64:67]
  v_exp_f32 v88, v88
  v_mfma_f32_16x16x32_bf16 v[68:71], v[32:35], v[160:163], 0
  s_cmp_eq_u32 s66, 1
  s_cselect_b32 s14, 0, 524288
  v_fma_f32 v90, v90, s63, v18
  v_mfma_f32_16x16x32_bf16 v[68:71], v[36:39], v[164:167], v[68:71]
  v_exp_f32 v89, v89
  v_mfma_f32_16x16x32_bf16 v[72:75], v[32:35], v[192:195], 0
  s_add_u32 m0, s33, 106240
  v_exp_f32 v90, v90
  v_mfma_f32_16x16x32_bf16 v[72:75], v[36:39], v[196:199], v[72:75]
  buffer_load_dwordx4 v11, s[16:19], s65 offen offset:256 nt lds
  v_mfma_f32_16x16x32_bf16 v[76:79], v[32:35], v[224:227], 0
  v_fma_f32 v91, v91, s63, v18
  v_fma_f32 v92, v92, s63, v19
  v_mfma_f32_16x16x32_bf16 v[76:79], v[36:39], v[228:231], v[76:79]
  s_waitcnt lgkmcnt(4)
  v_exp_f32 v91, v91
  v_mfma_f32_16x16x32_bf16 v[64:67], v[40:43], v[136:139], v[64:67]
  v_exp_f32 v92, v92
  v_mfma_f32_16x16x32_bf16 v[64:67], v[44:47], v[140:143], v[64:67]
  v_fma_f32 v93, v93, s63, v19
  v_fma_f32 v94, v94, s63, v19
  v_mfma_f32_16x16x32_bf16 v[68:71], v[40:43], v[168:171], v[68:71]
  v_fma_f32 v95, v95, s63, v19
  ds_read_b128 v[32:35], v4 offset:18432
  v_mfma_f32_16x16x32_bf16 v[68:71], v[44:47], v[172:175], v[68:71]
  v_exp_f32 v93, v93
  v_mfma_f32_16x16x32_bf16 v[72:75], v[40:43], v[200:203], v[72:75]
  v_exp_f32 v94, v94
  v_mfma_f32_16x16x32_bf16 v[72:75], v[44:47], v[204:207], v[72:75]
  v_exp_f32 v95, v95
  v_mfma_f32_16x16x32_bf16 v[76:79], v[40:43], v[232:235], v[76:79]
  v_add_f32 v14, v14, v88
  ds_read_b128 v[36:39], v5 offset:18432
  v_mfma_f32_16x16x32_bf16 v[76:79], v[44:47], v[236:239], v[76:79]
  s_waitcnt lgkmcnt(4)
  v_add_f32 v14, v14, v89
  v_add_f32 v14, v14, v90
  v_mfma_f32_16x16x32_bf16 v[64:67], v[48:51], v[144:147], v[64:67]
  v_add_f32 v14, v14, v91
  v_cvt_pk_bf16_f32 v106, v88, v89
  v_mfma_f32_16x16x32_bf16 v[64:67], v[52:55], v[148:151], v[64:67]
  v_cvt_pk_bf16_f32 v107, v90, v91
  v_add_f32 v15, v15, v92
  v_mfma_f32_16x16x32_bf16 v[68:71], v[48:51], v[176:179], v[68:71]
  v_add_f32 v15, v15, v93
  ds_read_b128 v[40:43], v4 offset:22528
  v_mfma_f32_16x16x32_bf16 v[68:71], v[52:55], v[180:183], v[68:71]
  v_add_f32 v15, v15, v94
  v_add_f32 v15, v15, v95
  v_mfma_f32_16x16x32_bf16 v[72:75], v[48:51], v[208:211], v[72:75]
  s_add_u32 m0, s33, 110208
  v_cvt_pk_bf16_f32 v110, v92, v93
  v_cvt_pk_bf16_f32 v111, v94, v95
  v_mfma_f32_16x16x32_bf16 v[72:75], v[52:55], v[212:215], v[72:75]
  buffer_load_dwordx4 v11, s[16:19], s65 offen offset:384 nt lds
  v_mfma_f32_16x16x32_bf16 v[76:79], v[48:51], v[240:243], v[76:79]
  s_add_u32 s65, s65, 16384
  ds_read_b128 v[44:47], v5 offset:22528
  v_mfma_f32_16x16x32_bf16 v[76:79], v[52:55], v[244:247], v[76:79]
  s_waitcnt lgkmcnt(4)
  v_mfma_f32_16x16x32_bf16 v[64:67], v[56:59], v[152:155], v[64:67]
  s_and_b32 s65, s65, 0x7ffff
  v_mfma_f32_16x16x32_bf16 v[64:67], v[60:63], v[156:159], v[64:67]
  v_mfma_f32_16x16x32_bf16 v[68:71], v[56:59], v[184:187], v[68:71]
  ds_read_b128 v[48:51], v4 offset:26624
  v_mfma_f32_16x16x32_bf16 v[68:71], v[60:63], v[188:191], v[68:71]
  v_mfma_f32_16x16x32_bf16 v[72:75], v[56:59], v[216:219], v[72:75]
  v_mfma_f32_16x16x32_bf16 v[72:75], v[60:63], v[220:223], v[72:75]
  v_mfma_f32_16x16x32_bf16 v[76:79], v[56:59], v[248:251], v[76:79]
  ds_read_b128 v[52:55], v5 offset:26624
  v_mfma_f32_16x16x32_bf16 v[76:79], v[60:63], v[252:255], v[76:79]
  s_waitcnt lgkmcnt(4)
  v_fma_f32 v64, v64, s63, v16
  v_fma_f32 v65, v65, s63, v16
  v_mfma_f32_16x16x32_bf16 v[80:83], v[32:35], v[128:131], 0
  v_exp_f32 v64, v64
  v_mfma_f32_16x16x32_bf16 v[80:83], v[36:39], v[132:135], v[80:83]
  v_exp_f32 v65, v65
  v_mfma_f32_16x16x32_bf16 v[84:87], v[32:35], v[160:163], 0
  v_fma_f32 v66, v66, s63, v16
  ds_read_b128 v[56:59], v4 offset:30720
  v_mfma_f32_16x16x32_bf16 v[84:87], v[36:39], v[164:167], v[84:87]
  v_exp_f32 v66, v66
  v_mfma_f32_16x16x32_bf16 v[88:91], v[32:35], v[192:195], 0
  s_add_u32 m0, s33, 0
  v_fma_f32 v67, v67, s63, v16
  v_add_f32 v12, v12, v64
  v_mfma_f32_16x16x32_bf16 v[88:91], v[36:39], v[196:199], v[88:91]
  buffer_load_dwordx4 v10, s[12:15], s64 offen nt lds
  v_mfma_f32_16x16x32_bf16 v[92:95], v[32:35], v[224:227], 0
  v_add_f32 v12, v12, v65
  ds_read_b128 v[60:63], v5 offset:30720
  v_mfma_f32_16x16x32_bf16 v[92:95], v[36:39], v[228:231], v[92:95]
  s_waitcnt lgkmcnt(4)
  v_exp_f32 v67, v67
  v_mfma_f32_16x16x32_bf16 v[80:83], v[40:43], v[136:139], v[80:83]
  v_add_f32 v12, v12, v66
  v_add_f32 v12, v12, v67
  v_mfma_f32_16x16x32_bf16 v[80:83], v[44:47], v[140:143], v[80:83]
  v_cvt_pk_bf16_f32 v112, v64, v65
  v_cvt_pk_bf16_f32 v113, v66, v67
  v_mfma_f32_16x16x32_bf16 v[84:87], v[40:43], v[168:171], v[84:87]
  v_fma_f32 v68, v68, s63, v17
  v_fma_f32 v69, v69, s63, v17
  v_mfma_f32_16x16x32_bf16 v[84:87], v[44:47], v[172:175], v[84:87]
  v_exp_f32 v68, v68
  v_mfma_f32_16x16x32_bf16 v[88:91], v[40:43], v[200:203], v[88:91]
  v_fma_f32 v70, v70, s63, v17
  ds_read_b64_tr_b16 v[32:33], v6 offset:0
  v_mfma_f32_16x16x32_bf16 v[88:91], v[44:47], v[204:207], v[88:91]
  v_exp_f32 v69, v69
  v_mfma_f32_16x16x32_bf16 v[92:95], v[40:43], v[232:235], v[92:95]
  v_fma_f32 v71, v71, s63, v17
  ds_read_b64_tr_b16 v[34:35], v6 offset:2048
  v_mfma_f32_16x16x32_bf16 v[92:95], v[44:47], v[236:239], v[92:95]
  s_waitcnt lgkmcnt(4)
  v_exp_f32 v70, v70
  v_mfma_f32_16x16x32_bf16 v[80:83], v[48:51], v[144:147], v[80:83]
  v_add_f32 v13, v13, v68
  ds_read_b64_tr_b16 v[36:37], v7 offset:0
  v_mfma_f32_16x16x32_bf16 v[80:83], v[52:55], v[148:151], v[80:83]
  v_exp_f32 v71, v71
  v_mfma_f32_16x16x32_bf16 v[84:87], v[48:51], v[176:179], v[84:87]
  v_add_f32 v13, v13, v69
  ds_read_b64_tr_b16 v[38:39], v7 offset:2048
  v_mfma_f32_16x16x32_bf16 v[84:87], v[52:55], v[180:183], v[84:87]
  v_add_f32 v13, v13, v70
  v_add_f32 v13, v13, v71
  v_mfma_f32_16x16x32_bf16 v[88:91], v[48:51], v[208:211], v[88:91]
  s_add_u32 m0, s33, 3968
  v_cvt_pk_bf16_f32 v116, v68, v69
  ds_read_b64_tr_b16 v[40:41], v8 offset:0
  v_mfma_f32_16x16x32_bf16 v[88:91], v[52:55], v[212:215], v[88:91]
  buffer_load_dwordx4 v10, s[12:15], s64 offen offset:128 nt lds
  v_mfma_f32_16x16x32_bf16 v[92:95], v[48:51], v[240:243], v[92:95]
  v_cvt_pk_bf16_f32 v117, v70, v71
  ds_read_b64_tr_b16 v[42:43], v8 offset:2048
  v_mfma_f32_16x16x32_bf16 v[92:95], v[52:55], v[244:247], v[92:95]
  s_waitcnt lgkmcnt(6)
  v_fma_f32 v72, v72, s63, v18
  v_fma_f32 v73, v73, s63, v18
  v_mfma_f32_16x16x32_bf16 v[80:83], v[56:59], v[152:155], v[80:83]
  v_fma_f32 v74, v74, s63, v18
  ds_read_b64_tr_b16 v[44:45], v9 offset:0
  v_mfma_f32_16x16x32_bf16 v[80:83], v[60:63], v[156:159], v[80:83]
  v_exp_f32 v72, v72
  v_mfma_f32_16x16x32_bf16 v[84:87], v[56:59], v[184:187], v[84:87]
  v_fma_f32 v75, v75, s63, v18
  ds_read_b64_tr_b16 v[46:47], v9 offset:2048
  v_mfma_f32_16x16x32_bf16 v[84:87], v[60:63], v[188:191], v[84:87]
  v_exp_f32 v73, v73
  v_mfma_f32_16x16x32_bf16 v[88:91], v[56:59], v[216:219], v[88:91]
  v_add_f32 v14, v14, v72
  ds_read_b64_tr_b16 v[48:49], v6 offset:4096
  v_mfma_f32_16x16x32_bf16 v[88:91], v[60:63], v[220:223], v[88:91]
  v_exp_f32 v74, v74
  v_mfma_f32_16x16x32_bf16 v[92:95], v[56:59], v[248:251], v[92:95]
  v_add_f32 v14, v14, v73
  ds_read_b64_tr_b16 v[50:51], v6 offset:6144
  v_mfma_f32_16x16x32_bf16 v[92:95], v[60:63], v[252:255], v[92:95]
  s_waitcnt lgkmcnt(8)
  v_exp_f32 v75, v75
  v_mfma_f32_16x16x32_bf16 a[0:3], v[32:35], v[96:99], a[0:3]
  v_add_f32 v14, v14, v74
  ds_read_b64_tr_b16 v[52:53], v7 offset:4096
  v_mfma_f32_16x16x32_bf16 a[4:7], v[32:35], v[100:103], a[4:7]
  v_add_f32 v14, v14, v75
  v_cvt_pk_bf16_f32 v120, v72, v73
  v_mfma_f32_16x16x32_bf16 a[8:11], v[32:35], v[104:107], a[8:11]
  v_cvt_pk_bf16_f32 v121, v74, v75
  ds_read_b64_tr_b16 v[54:55], v7 offset:6144
  v_mfma_f32_16x16x32_bf16 a[12:15], v[32:35], v[108:111], a[12:15]
  s_waitcnt lgkmcnt(8)
  v_fma_f32 v76, v76, s63, v19
  v_fma_f32 v77, v77, s63, v19
  v_mfma_f32_16x16x32_bf16 a[16:19], v[36:39], v[96:99], a[16:19]
  s_add_u32 m0, s33, 7936
  v_fma_f32 v78, v78, s63, v19
  ds_read_b64_tr_b16 v[56:57], v8 offset:4096
  v_mfma_f32_16x16x32_bf16 a[20:23], v[36:39], v[100:103], a[20:23]
  buffer_load_dwordx4 v10, s[12:15], s64 offen offset:256 nt lds
  v_mfma_f32_16x16x32_bf16 a[24:27], v[36:39], v[104:107], a[24:27]
  v_fma_f32 v79, v79, s63, v19
  ds_read_b64_tr_b16 v[58:59], v8 offset:6144
  v_mfma_f32_16x16x32_bf16 a[28:31], v[36:39], v[108:111], a[28:31]
  s_waitcnt lgkmcnt(8)
  v_exp_f32 v76, v76
  v_mfma_f32_16x16x32_bf16 a[32:35], v[40:43], v[96:99], a[32:35]
  v_add_f32 v15, v15, v76
  ds_read_b64_tr_b16 v[60:61], v9 offset:4096
  v_mfma_f32_16x16x32_bf16 a[36:39], v[40:43], v[100:103], a[36:39]
  v_exp_f32 v77, v77
  v_mfma_f32_16x16x32_bf16 a[40:43], v[40:43], v[104:107], a[40:43]
  v_add_f32 v15, v15, v77
  ds_read_b64_tr_b16 v[62:63], v9 offset:6144
  v_mfma_f32_16x16x32_bf16 a[44:47], v[40:43], v[108:111], a[44:47]
  s_waitcnt lgkmcnt(8)
  v_exp_f32 v78, v78
  v_mfma_f32_16x16x32_bf16 a[48:51], v[44:47], v[96:99], a[48:51]
  v_add_f32 v15, v15, v78
  ds_read_b64_tr_b16 v[32:33], v6 offset:8192
  v_mfma_f32_16x16x32_bf16 a[52:55], v[44:47], v[100:103], a[52:55]
  v_exp_f32 v79, v79
  v_mfma_f32_16x16x32_bf16 a[56:59], v[44:47], v[104:107], a[56:59]
  v_add_f32 v15, v15, v79
  ds_read_b64_tr_b16 v[34:35], v6 offset:10240
  v_mfma_f32_16x16x32_bf16 a[60:63], v[44:47], v[108:111], a[60:63]
  s_waitcnt lgkmcnt(8)
  v_cvt_pk_bf16_f32 v124, v76, v77
  v_cvt_pk_bf16_f32 v125, v78, v79
  v_mfma_f32_16x16x32_bf16 a[64:67], v[48:51], v[96:99], a[64:67]
  v_fma_f32 v80, v80, s63, v16
  ds_read_b64_tr_b16 v[36:37], v7 offset:8192
  v_mfma_f32_16x16x32_bf16 a[68:71], v[48:51], v[100:103], a[68:71]
  v_exp_f32 v80, v80
  v_mfma_f32_16x16x32_bf16 a[72:75], v[48:51], v[104:107], a[72:75]
  v_fma_f32 v81, v81, s63, v16
  ds_read_b64_tr_b16 v[38:39], v7 offset:10240
  v_mfma_f32_16x16x32_bf16 a[76:79], v[48:51], v[108:111], a[76:79]
  s_waitcnt lgkmcnt(8)
  v_exp_f32 v81, v81
  v_mfma_f32_16x16x32_bf16 a[80:83], v[52:55], v[96:99], a[80:83]
  s_add_u32 m0, s33, 11904
  v_fma_f32 v82, v82, s63, v16
  ds_read_b64_tr_b16 v[40:41], v8 offset:8192
  v_mfma_f32_16x16x32_bf16 a[84:87], v[52:55], v[100:103], a[84:87]
  buffer_load_dwordx4 v10, s[12:15], s64 offen offset:384 nt lds
  v_mfma_f32_16x16x32_bf16 a[88:91], v[52:55], v[104:107], a[88:91]
  s_add_u32 s64, s64, 16384
  v_fma_f32 v83, v83, s63, v16
  ds_read_b64_tr_b16 v[42:43], v8 offset:10240
  v_mfma_f32_16x16x32_bf16 a[92:95], v[52:55], v[108:111], a[92:95]
  s_waitcnt lgkmcnt(8)
  v_exp_f32 v82, v82
  v_mfma_f32_16x16x32_bf16 a[96:99], v[56:59], v[96:99], a[96:99]
  s_and_b32 s64, s64, 0x7ffff
  v_fma_f32 v84, v84, s63, v17
  ds_read_b64_tr_b16 v[44:45], v9 offset:8192
  v_mfma_f32_16x16x32_bf16 a[100:103], v[56:59], v[100:103], a[100:103]
  v_exp_f32 v83, v83
  v_mfma_f32_16x16x32_bf16 a[104:107], v[56:59], v[104:107], a[104:107]
  v_fma_f32 v85, v85, s63, v17
  ds_read_b64_tr_b16 v[46:47], v9 offset:10240
  v_mfma_f32_16x16x32_bf16 a[108:111], v[56:59], v[108:111], a[108:111]
  s_waitcnt lgkmcnt(8)
  v_exp_f32 v84, v84
  v_mfma_f32_16x16x32_bf16 a[112:115], v[60:63], v[96:99], a[112:115]
  v_fma_f32 v86, v86, s63, v17
  ds_read_b64_tr_b16 v[48:49], v6 offset:12288
  v_mfma_f32_16x16x32_bf16 a[116:119], v[60:63], v[100:103], a[116:119]
  v_exp_f32 v85, v85
  v_mfma_f32_16x16x32_bf16 a[120:123], v[60:63], v[104:107], a[120:123]
  v_fma_f32 v87, v87, s63, v17
  ds_read_b64_tr_b16 v[50:51], v6 offset:14336
  v_mfma_f32_16x16x32_bf16 a[124:127], v[60:63], v[108:111], a[124:127]
  s_waitcnt lgkmcnt(8)
  v_exp_f32 v86, v86
  v_mfma_f32_16x16x32_bf16 a[128:131], v[32:35], v[96:99], a[128:131]
  v_add_f32 v12, v12, v80
  ds_read_b64_tr_b16 v[52:53], v7 offset:12288
  v_mfma_f32_16x16x32_bf16 a[132:135], v[32:35], v[100:103], a[132:135]
  v_exp_f32 v87, v87
  v_mfma_f32_16x16x32_bf16 a[136:139], v[32:35], v[104:107], a[136:139]
  s_waitcnt vmcnt(12)
  s_barrier
  ds_read_b64_tr_b16 v[54:55], v7 offset:14336
  v_mfma_f32_16x16x32_bf16 a[140:143], v[32:35], v[108:111], a[140:143]
  s_waitcnt lgkmcnt(8)
  v_add_f32 v12, v12, v81
  v_add_f32 v12, v12, v82
  v_mfma_f32_16x16x32_bf16 a[144:147], v[36:39], v[96:99], a[144:147]
  s_add_u32 m0, s33, 114688
  v_add_f32 v12, v12, v83
  ds_read_b64_tr_b16 v[56:57], v8 offset:12288
  v_mfma_f32_16x16x32_bf16 a[148:151], v[36:39], v[100:103], a[148:151]
  buffer_load_dwordx4 v11, s[16:19], s65 offen nt lds
  v_mfma_f32_16x16x32_bf16 a[152:155], v[36:39], v[104:107], a[152:155]
  v_cvt_pk_bf16_f32 v114, v80, v81
  ds_read_b64_tr_b16 v[58:59], v8 offset:14336
  v_mfma_f32_16x16x32_bf16 a[156:159], v[36:39], v[108:111], a[156:159]
  s_waitcnt lgkmcnt(8)
  v_cvt_pk_bf16_f32 v115, v82, v83
  v_add_f32 v13, v13, v84
  v_mfma_f32_16x16x32_bf16 a[160:163], v[40:43], v[96:99], a[160:163]
  v_add_f32 v13, v13, v85
  ds_read_b64_tr_b16 v[60:61], v9 offset:12288
  v_mfma_f32_16x16x32_bf16 a[164:167], v[40:43], v[100:103], a[164:167]
  v_add_f32 v13, v13, v86
  v_add_f32 v13, v13, v87
  v_mfma_f32_16x16x32_bf16 a[168:171], v[40:43], v[104:107], a[168:171]
  v_cvt_pk_bf16_f32 v118, v84, v85
  ds_read_b64_tr_b16 v[62:63], v9 offset:14336
  v_mfma_f32_16x16x32_bf16 a[172:175], v[40:43], v[108:111], a[172:175]
  s_waitcnt lgkmcnt(8)
  v_cvt_pk_bf16_f32 v119, v86, v87
  v_mfma_f32_16x16x32_bf16 a[176:179], v[44:47], v[96:99], a[176:179]
  ds_read_b128 v[32:35], v4 offset:32768
  v_mfma_f32_16x16x32_bf16 a[180:183], v[44:47], v[100:103], a[180:183]
  v_mfma_f32_16x16x32_bf16 a[184:187], v[44:47], v[104:107], a[184:187]
  ds_read_b128 v[36:39], v5 offset:32768
  v_mfma_f32_16x16x32_bf16 a[188:191], v[44:47], v[108:111], a[188:191]
  s_waitcnt lgkmcnt(8)
  v_mfma_f32_16x16x32_bf16 a[192:195], v[48:51], v[96:99], a[192:195]
  ds_read_b128 v[40:43], v4 offset:36864
  v_mfma_f32_16x16x32_bf16 a[196:199], v[48:51], v[100:103], a[196:199]
  v_mfma_f32_16x16x32_bf16 a[200:203], v[48:51], v[104:107], a[200:203]
  ds_read_b128 v[44:47], v5 offset:36864
  v_mfma_f32_16x16x32_bf16 a[204:207], v[48:51], v[108:111], a[204:207]
  s_waitcnt lgkmcnt(8)
  v_mfma_f32_16x16x32_bf16 a[208:211], v[52:55], v[96:99], a[208:211]
  s_add_u32 m0, s33, 118656
  ds_read_b128 v[48:51], v4 offset:40960
  v_mfma_f32_16x16x32_bf16 a[212:215], v[52:55], v[100:103], a[212:215]
  buffer_load_dwordx4 v11, s[16:19], s65 offen offset:128 nt lds
  v_mfma_f32_16x16x32_bf16 a[216:219], v[52:55], v[104:107], a[216:219]
  v_mfma_f32_16x16x32_bf16 a[220:223], v[52:55], v[108:111], a[220:223]
  s_waitcnt lgkmcnt(7)
  v_mfma_f32_16x16x32_bf16 a[224:227], v[56:59], v[96:99], a[224:227]
  s_sub_u32 s66, s66, 1
  ds_read_b128 v[52:55], v5 offset:40960
  v_mfma_f32_16x16x32_bf16 a[228:231], v[56:59], v[100:103], a[228:231]
  s_cmp_lg_u32 s66, 0
  v_mfma_f32_16x16x32_bf16 a[232:235], v[56:59], v[104:107], a[232:235]
  v_mfma_f32_16x16x32_bf16 a[236:239], v[56:59], v[108:111], a[236:239]
  s_waitcnt lgkmcnt(6)
  v_mfma_f32_16x16x32_bf16 a[240:243], v[60:63], v[96:99], a[240:243]
  ds_read_b128 v[56:59], v4 offset:45056
  v_mfma_f32_16x16x32_bf16 a[244:247], v[60:63], v[100:103], a[244:247]
  v_mfma_f32_16x16x32_bf16 a[248:251], v[60:63], v[104:107], a[248:251]
  v_mfma_f32_16x16x32_bf16 a[252:255], v[60:63], v[108:111], a[252:255]
  ds_read_b128 v[60:63], v5 offset:45056
  s_cbranch_scc1 L_attn
  v_lshl_add_u32 v2, s32, 6, v0
  v_mul_u32_u24 v2, 896, v2
  s_waitcnt lgkmcnt(6)
  v_mfma_f32_16x16x32_bf16 v[64:67], v[32:35], v[128:131], 0
  v_fma_f32 v88, v88, s63, v18
  v_fma_f32 v89, v89, s63, v18
  v_mfma_f32_16x16x32_bf16 v[64:67], v[36:39], v[132:135], v[64:67]
  v_exp_f32 v88, v88
  v_mfma_f32_16x16x32_bf16 v[68:71], v[32:35], v[160:163], 0
  v_exp_f32 v89, v89
  v_mfma_f32_16x16x32_bf16 v[68:71], v[36:39], v[164:167], v[68:71]
  v_fma_f32 v90, v90, s63, v18
  v_fma_f32 v91, v91, s63, v18
  v_mfma_f32_16x16x32_bf16 v[72:75], v[32:35], v[192:195], 0
  s_add_u32 m0, s33, 122624
  v_exp_f32 v90, v90
  v_mfma_f32_16x16x32_bf16 v[72:75], v[36:39], v[196:199], v[72:75]
  buffer_load_dwordx4 v11, s[16:19], s65 offen offset:256 nt lds
  v_mfma_f32_16x16x32_bf16 v[76:79], v[32:35], v[224:227], 0
  v_exp_f32 v91, v91
  v_mfma_f32_16x16x32_bf16 v[76:79], v[36:39], v[228:231], v[76:79]
  s_waitcnt lgkmcnt(4)
  v_fma_f32 v92, v92, s63, v19
  v_fma_f32 v93, v93, s63, v19
  v_mfma_f32_16x16x32_bf16 v[64:67], v[40:43], v[136:139], v[64:67]
  v_exp_f32 v92, v92
  v_mfma_f32_16x16x32_bf16 v[64:67], v[44:47], v[140:143], v[64:67]
  v_exp_f32 v93, v93
  v_mfma_f32_16x16x32_bf16 v[68:71], v[40:43], v[168:171], v[68:71]
  v_fma_f32 v94, v94, s63, v19
  ds_read_b128 v[32:35], v4 offset:34816
  v_mfma_f32_16x16x32_bf16 v[68:71], v[44:47], v[172:175], v[68:71]
  v_exp_f32 v94, v94
  v_mfma_f32_16x16x32_bf16 v[72:75], v[40:43], v[200:203], v[72:75]
  v_fma_f32 v95, v95, s63, v19
  v_add_f32 v14, v14, v88
  v_mfma_f32_16x16x32_bf16 v[72:75], v[44:47], v[204:207], v[72:75]
  v_exp_f32 v95, v95
  v_mfma_f32_16x16x32_bf16 v[76:79], v[40:43], v[232:235], v[76:79]
  v_add_f32 v14, v14, v89
  ds_read_b128 v[36:39], v5 offset:34816
  v_mfma_f32_16x16x32_bf16 v[76:79], v[44:47], v[236:239], v[76:79]
  s_waitcnt lgkmcnt(4)
  v_add_f32 v14, v14, v90
  v_add_f32 v14, v14, v91
  v_mfma_f32_16x16x32_bf16 v[64:67], v[48:51], v[144:147], v[64:67]
  v_cvt_pk_bf16_f32 v122, v88, v89
  v_cvt_pk_bf16_f32 v123, v90, v91
  v_mfma_f32_16x16x32_bf16 v[64:67], v[52:55], v[148:151], v[64:67]
  v_add_f32 v15, v15, v92
  v_add_f32 v15, v15, v93
  v_mfma_f32_16x16x32_bf16 v[68:71], v[48:51], v[176:179], v[68:71]
  v_add_f32 v15, v15, v94
  ds_read_b128 v[40:43], v4 offset:38912
  v_mfma_f32_16x16x32_bf16 v[68:71], v[52:55], v[180:183], v[68:71]
  v_add_f32 v15, v15, v95
  v_cvt_pk_bf16_f32 v126, v92, v93
  v_mfma_f32_16x16x32_bf16 v[72:75], v[48:51], v[208:211], v[72:75]
  s_add_u32 m0, s33, 126592
  v_cvt_pk_bf16_f32 v127, v94, v95
  v_mfma_f32_16x16x32_bf16 v[72:75], v[52:55], v[212:215], v[72:75]
  buffer_load_dwordx4 v11, s[16:19], s65 offen offset:384 nt lds
  v_mfma_f32_16x16x32_bf16 v[76:79], v[48:51], v[240:243], v[76:79]
  ds_read_b128 v[44:47], v5 offset:38912
  v_mfma_f32_16x16x32_bf16 v[76:79], v[52:55], v[244:247], v[76:79]
  s_waitcnt lgkmcnt(4)
  v_mfma_f32_16x16x32_bf16 v[64:67], v[56:59], v[152:155], v[64:67]
  v_mfma_f32_16x16x32_bf16 v[64:67], v[60:63], v[156:159], v[64:67]
  v_mfma_f32_16x16x32_bf16 v[68:71], v[56:59], v[184:187], v[68:71]
  ds_read_b128 v[48:51], v4 offset:43008
  v_mfma_f32_16x16x32_bf16 v[68:71], v[60:63], v[188:191], v[68:71]
  v_mfma_f32_16x16x32_bf16 v[72:75], v[56:59], v[216:219], v[72:75]
  v_mfma_f32_16x16x32_bf16 v[72:75], v[60:63], v[220:223], v[72:75]
  v_mfma_f32_16x16x32_bf16 v[76:79], v[56:59], v[248:251], v[76:79]
  ds_read_b128 v[52:55], v5 offset:43008
  v_mfma_f32_16x16x32_bf16 v[76:79], v[60:63], v[252:255], v[76:79]
  s_waitcnt lgkmcnt(4)
  v_fma_f32 v64, v64, s63, v16
  v_fma_f32 v65, v65, s63, v16
  v_mfma_f32_16x16x32_bf16 v[80:83], v[32:35], v[128:131], 0
  v_exp_f32 v64, v64
  v_mfma_f32_16x16x32_bf16 v[80:83], v[36:39], v[132:135], v[80:83]
  v_exp_f32 v65, v65
  v_mfma_f32_16x16x32_bf16 v[84:87], v[32:35], v[160:163], 0
  v_fma_f32 v66, v66, s63, v16
  ds_read_b128 v[56:59], v4 offset:47104
  v_mfma_f32_16x16x32_bf16 v[84:87], v[36:39], v[164:167], v[84:87]
  v_exp_f32 v66, v66
  v_mfma_f32_16x16x32_bf16 v[88:91], v[32:35], v[192:195], 0
  v_fma_f32 v67, v67, s63, v16
  v_add_f32 v12, v12, v64
  v_mfma_f32_16x16x32_bf16 v[88:91], v[36:39], v[196:199], v[88:91]
  v_exp_f32 v67, v67
  v_mfma_f32_16x16x32_bf16 v[92:95], v[32:35], v[224:227], 0
  v_add_f32 v12, v12, v65
  ds_read_b128 v[60:63], v5 offset:47104
  v_mfma_f32_16x16x32_bf16 v[92:95], v[36:39], v[228:231], v[92:95]
  s_waitcnt lgkmcnt(4)
  v_add_f32 v12, v12, v66
  v_add_f32 v12, v12, v67
  v_mfma_f32_16x16x32_bf16 v[80:83], v[40:43], v[136:139], v[80:83]
  buffer_load_dword v24, v26, s[40:43], 0 offen sc1
  v_mfma_f32_16x16x32_bf16 v[80:83], v[44:47], v[140:143], v[80:83]
  v_cvt_pk_bf16_f32 v96, v64, v65
  v_cvt_pk_bf16_f32 v97, v66, v67
  v_mfma_f32_16x16x32_bf16 v[84:87], v[40:43], v[168:171], v[84:87]
  v_fma_f32 v68, v68, s63, v17
  v_fma_f32 v69, v69, s63, v17
  v_mfma_f32_16x16x32_bf16 v[84:87], v[44:47], v[172:175], v[84:87]
  v_exp_f32 v68, v68
  v_mfma_f32_16x16x32_bf16 v[88:91], v[40:43], v[200:203], v[88:91]
  v_fma_f32 v70, v70, s63, v17
  ds_read_b64_tr_b16 v[32:33], v6 offset:16384
  v_mfma_f32_16x16x32_bf16 v[88:91], v[44:47], v[204:207], v[88:91]
  v_exp_f32 v69, v69
  v_mfma_f32_16x16x32_bf16 v[92:95], v[40:43], v[232:235], v[92:95]
  v_fma_f32 v71, v71, s63, v17
  ds_read_b64_tr_b16 v[34:35], v6 offset:18432
  v_mfma_f32_16x16x32_bf16 v[92:95], v[44:47], v[236:239], v[92:95]
  s_waitcnt lgkmcnt(4)
  v_exp_f32 v70, v70
  v_mfma_f32_16x16x32_bf16 v[80:83], v[48:51], v[144:147], v[80:83]
  v_add_f32 v13, v13, v68
  ds_read_b64_tr_b16 v[36:37], v7 offset:16384
  v_mfma_f32_16x16x32_bf16 v[80:83], v[52:55], v[148:151], v[80:83]
  v_exp_f32 v71, v71
  v_mfma_f32_16x16x32_bf16 v[84:87], v[48:51], v[176:179], v[84:87]
  v_add_f32 v13, v13, v69
  ds_read_b64_tr_b16 v[38:39], v7 offset:18432
  v_mfma_f32_16x16x32_bf16 v[84:87], v[52:55], v[180:183], v[84:87]
  buffer_load_dword v1, v2, s[20:23], 0 offen offset:512
  v_mfma_f32_16x16x32_bf16 v[88:91], v[48:51], v[208:211], v[88:91]
  v_add_f32 v13, v13, v70
  ds_read_b64_tr_b16 v[40:41], v8 offset:16384
  v_mfma_f32_16x16x32_bf16 v[88:91], v[52:55], v[212:215], v[88:91]
  v_add_f32 v13, v13, v71
  v_cvt_pk_bf16_f32 v100, v68, v69
  v_mfma_f32_16x16x32_bf16 v[92:95], v[48:51], v[240:243], v[92:95]
  v_cvt_pk_bf16_f32 v101, v70, v71
  ds_read_b64_tr_b16 v[42:43], v8 offset:18432
  v_mfma_f32_16x16x32_bf16 v[92:95], v[52:55], v[244:247], v[92:95]
  s_waitcnt lgkmcnt(6)
  v_fma_f32 v72, v72, s63, v18
  v_fma_f32 v73, v73, s63, v18
  v_mfma_f32_16x16x32_bf16 v[80:83], v[56:59], v[152:155], v[80:83]
  v_fma_f32 v74, v74, s63, v18
  ds_read_b64_tr_b16 v[44:45], v9 offset:16384
  v_mfma_f32_16x16x32_bf16 v[80:83], v[60:63], v[156:159], v[80:83]
  v_exp_f32 v72, v72
  v_mfma_f32_16x16x32_bf16 v[84:87], v[56:59], v[184:187], v[84:87]
  v_fma_f32 v75, v75, s63, v18
  ds_read_b64_tr_b16 v[46:47], v9 offset:18432
  v_mfma_f32_16x16x32_bf16 v[84:87], v[60:63], v[188:191], v[84:87]
  v_exp_f32 v73, v73
  v_mfma_f32_16x16x32_bf16 v[88:91], v[56:59], v[216:219], v[88:91]
  v_add_f32 v14, v14, v72
  ds_read_b64_tr_b16 v[48:49], v6 offset:20480
  v_mfma_f32_16x16x32_bf16 v[88:91], v[60:63], v[220:223], v[88:91]
  v_exp_f32 v74, v74
  v_mfma_f32_16x16x32_bf16 v[92:95], v[56:59], v[248:251], v[92:95]
  v_add_f32 v14, v14, v73
  ds_read_b64_tr_b16 v[50:51], v6 offset:22528
  v_mfma_f32_16x16x32_bf16 v[92:95], v[60:63], v[252:255], v[92:95]
  s_waitcnt lgkmcnt(8)
  buffer_load_dword v1, v2, s[20:23], 0 offen offset:640
  v_mfma_f32_16x16x32_bf16 a[0:3], v[32:35], v[112:115], a[0:3]
  v_add_f32 v14, v14, v74
  ds_read_b64_tr_b16 v[52:53], v7 offset:20480
  v_mfma_f32_16x16x32_bf16 a[4:7], v[32:35], v[116:119], a[4:7]
  v_exp_f32 v75, v75
  v_mfma_f32_16x16x32_bf16 a[8:11], v[32:35], v[120:123], a[8:11]
  v_add_f32 v14, v14, v75
  ds_read_b64_tr_b16 v[54:55], v7 offset:22528
  v_mfma_f32_16x16x32_bf16 a[12:15], v[32:35], v[124:127], a[12:15]
  s_waitcnt lgkmcnt(8)
  v_cvt_pk_bf16_f32 v104, v72, v73
  v_cvt_pk_bf16_f32 v105, v74, v75
  v_mfma_f32_16x16x32_bf16 a[16:19], v[36:39], v[112:115], a[16:19]
  v_fma_f32 v76, v76, s63, v19
  ds_read_b64_tr_b16 v[56:57], v8 offset:20480
  v_mfma_f32_16x16x32_bf16 a[20:23], v[36:39], v[116:119], a[20:23]
  v_exp_f32 v76, v76
  v_mfma_f32_16x16x32_bf16 a[24:27], v[36:39], v[120:123], a[24:27]
  v_fma_f32 v77, v77, s63, v19
  ds_read_b64_tr_b16 v[58:59], v8 offset:22528
  v_mfma_f32_16x16x32_bf16 a[28:31], v[36:39], v[124:127], a[28:31]
  s_waitcnt lgkmcnt(8)
  v_exp_f32 v77, v77
  v_mfma_f32_16x16x32_bf16 a[32:35], v[40:43], v[112:115], a[32:35]
  v_fma_f32 v78, v78, s63, v19
  ds_read_b64_tr_b16 v[60:61], v9 offset:20480
  v_mfma_f32_16x16x32_bf16 a[36:39], v[40:43], v[116:119], a[36:39]
  v_exp_f32 v78, v78
  v_mfma_f32_16x16x32_bf16 a[40:43], v[40:43], v[120:123], a[40:43]
  v_fma_f32 v79, v79, s63, v19
  ds_read_b64_tr_b16 v[62:63], v9 offset:22528
  v_mfma_f32_16x16x32_bf16 a[44:47], v[40:43], v[124:127], a[44:47]
  s_waitcnt lgkmcnt(8)
  buffer_load_dword v1, v2, s[20:23], 0 offen offset:768
  v_mfma_f32_16x16x32_bf16 a[48:51], v[44:47], v[112:115], a[48:51]
  v_add_f32 v15, v15, v76
  ds_read_b64_tr_b16 v[32:33], v6 offset:24576
  v_mfma_f32_16x16x32_bf16 a[52:55], v[44:47], v[116:119], a[52:55]
  v_exp_f32 v79, v79
  v_mfma_f32_16x16x32_bf16 a[56:59], v[44:47], v[120:123], a[56:59]
  v_add_f32 v15, v15, v77
  ds_read_b64_tr_b16 v[34:35], v6 offset:26624
  v_mfma_f32_16x16x32_bf16 a[60:63], v[44:47], v[124:127], a[60:63]
  s_waitcnt lgkmcnt(8)
  v_add_f32 v15, v15, v78
  v_add_f32 v15, v15, v79
  v_mfma_f32_16x16x32_bf16 a[64:67], v[48:51], v[112:115], a[64:67]
  v_cvt_pk_bf16_f32 v108, v76, v77
  ds_read_b64_tr_b16 v[36:37], v7 offset:24576
  v_mfma_f32_16x16x32_bf16 a[68:71], v[48:51], v[116:119], a[68:71]
  v_cvt_pk_bf16_f32 v109, v78, v79
  v_fma_f32 v80, v80, s63, v16
  v_mfma_f32_16x16x32_bf16 a[72:75], v[48:51], v[120:123], a[72:75]
  v_fma_f32 v81, v81, s63, v16
  ds_read_b64_tr_b16 v[38:39], v7 offset:26624
  v_mfma_f32_16x16x32_bf16 a[76:79], v[48:51], v[124:127], a[76:79]
  s_waitcnt lgkmcnt(8)
  v_exp_f32 v80, v80
  v_mfma_f32_16x16x32_bf16 a[80:83], v[52:55], v[112:115], a[80:83]
  v_fma_f32 v82, v82, s63, v16
  ds_read_b64_tr_b16 v[40:41], v8 offset:24576
  v_mfma_f32_16x16x32_bf16 a[84:87], v[52:55], v[116:119], a[84:87]
  v_exp_f32 v81, v81
  v_mfma_f32_16x16x32_bf16 a[88:91], v[52:55], v[120:123], a[88:91]
  v_fma_f32 v83, v83, s63, v16
  ds_read_b64_tr_b16 v[42:43], v8 offset:26624
  v_mfma_f32_16x16x32_bf16 a[92:95], v[52:55], v[124:127], a[92:95]
  s_waitcnt lgkmcnt(8)
  v_exp_f32 v82, v82
  v_mfma_f32_16x16x32_bf16 a[96:99], v[56:59], v[112:115], a[96:99]
  v_fma_f32 v84, v84, s63, v17
  ds_read_b64_tr_b16 v[44:45], v9 offset:24576
  v_mfma_f32_16x16x32_bf16 a[100:103], v[56:59], v[116:119], a[100:103]
  v_exp_f32 v83, v83
  v_mfma_f32_16x16x32_bf16 a[104:107], v[56:59], v[120:123], a[104:107]
  v_fma_f32 v85, v85, s63, v17
  ds_read_b64_tr_b16 v[46:47], v9 offset:26624
  v_mfma_f32_16x16x32_bf16 a[108:111], v[56:59], v[124:127], a[108:111]
  s_waitcnt lgkmcnt(8)
  v_exp_f32 v84, v84
  v_mfma_f32_16x16x32_bf16 a[112:115], v[60:63], v[112:115], a[112:115]
  v_fma_f32 v86, v86, s63, v17
  ds_read_b64_tr_b16 v[48:49], v6 offset:28672
  v_mfma_f32_16x16x32_bf16 a[116:119], v[60:63], v[116:119], a[116:119]
  v_exp_f32 v85, v85
  v_mfma_f32_16x16x32_bf16 a[120:123], v[60:63], v[120:123], a[120:123]
  v_fma_f32 v87, v87, s63, v17
  ds_read_b64_tr_b16 v[50:51], v6 offset:30720
  v_mfma_f32_16x16x32_bf16 a[124:127], v[60:63], v[124:127], a[124:127]
  s_waitcnt lgkmcnt(8)
  v_exp_f32 v86, v86
  v_mfma_f32_16x16x32_bf16 a[128:131], v[32:35], v[112:115], a[128:131]
  v_add_f32 v12, v12, v80
  ds_read_b64_tr_b16 v[52:53], v7 offset:28672
  v_mfma_f32_16x16x32_bf16 a[132:135], v[32:35], v[116:119], a[132:135]
  v_exp_f32 v87, v87
  v_mfma_f32_16x16x32_bf16 a[136:139], v[32:35], v[120:123], a[136:139]
  s_waitcnt vmcnt(8)
  s_barrier
  ds_read_b64_tr_b16 v[54:55], v7 offset:30720
  v_mfma_f32_16x16x32_bf16 a[140:143], v[32:35], v[124:127], a[140:143]
  s_waitcnt lgkmcnt(8)
  v_add_f32 v12, v12, v81
  v_add_f32 v12, v12, v82
  v_mfma_f32_16x16x32_bf16 a[144:147], v[36:39], v[112:115], a[144:147]
  v_add_f32 v12, v12, v83
  ds_read_b64_tr_b16 v[56:57], v8 offset:28672
  v_mfma_f32_16x16x32_bf16 a[148:151], v[36:39], v[116:119], a[148:151]
  v_cvt_pk_bf16_f32 v98, v80, v81
  v_cvt_pk_bf16_f32 v99, v82, v83
  v_mfma_f32_16x16x32_bf16 a[152:155], v[36:39], v[120:123], a[152:155]
  v_add_f32 v13, v13, v84
  ds_read_b64_tr_b16 v[58:59], v8 offset:30720
  v_mfma_f32_16x16x32_bf16 a[156:159], v[36:39], v[124:127], a[156:159]
  s_waitcnt lgkmcnt(8)
  v_add_f32 v13, v13, v85
  v_add_f32 v13, v13, v86
  v_mfma_f32_16x16x32_bf16 a[160:163], v[40:43], v[112:115], a[160:163]
  v_add_f32 v13, v13, v87
  ds_read_b64_tr_b16 v[60:61], v9 offset:28672
  v_mfma_f32_16x16x32_bf16 a[164:167], v[40:43], v[116:119], a[164:167]
  v_cvt_pk_bf16_f32 v102, v84, v85
  v_cvt_pk_bf16_f32 v103, v86, v87
  v_mfma_f32_16x16x32_bf16 a[168:171], v[40:43], v[120:123], a[168:171]
  ds_read_b64_tr_b16 v[62:63], v9 offset:30720
  v_mfma_f32_16x16x32_bf16 a[172:175], v[40:43], v[124:127], a[172:175]
  s_waitcnt lgkmcnt(8)
  v_mfma_f32_16x16x32_bf16 a[176:179], v[44:47], v[112:115], a[176:179]
  ds_read_b128 v[32:35], v4 offset:49152
  v_mfma_f32_16x16x32_bf16 a[180:183], v[44:47], v[116:119], a[180:183]
  v_mfma_f32_16x16x32_bf16 a[184:187], v[44:47], v[120:123], a[184:187]
  ds_read_b128 v[36:39], v5 offset:49152
  v_mfma_f32_16x16x32_bf16 a[188:191], v[44:47], v[124:127], a[188:191]
  s_waitcnt lgkmcnt(8)
  v_mfma_f32_16x16x32_bf16 a[192:195], v[48:51], v[112:115], a[192:195]
  ds_read_b128 v[40:43], v4 offset:53248
  v_mfma_f32_16x16x32_bf16 a[196:199], v[48:51], v[116:119], a[196:199]
  v_mfma_f32_16x16x32_bf16 a[200:203], v[48:51], v[120:123], a[200:203]
  ds_read_b128 v[44:47], v5 offset:53248
  v_mfma_f32_16x16x32_bf16 a[204:207], v[48:51], v[124:127], a[204:207]
  s_waitcnt lgkmcnt(8)
  v_mfma_f32_16x16x32_bf16 a[208:211], v[52:55], v[112:115], a[208:211]
  ds_read_b128 v[48:51], v4 offset:57344
  v_mfma_f32_16x16x32_bf16 a[212:215], v[52:55], v[116:119], a[212:215]
  v_mfma_f32_16x16x32_bf16 a[216:219], v[52:55], v[120:123], a[216:219]
  v_mfma_f32_16x16x32_bf16 a[220:223], v[52:55], v[124:127], a[220:223]
  s_waitcnt lgkmcnt(7)
  v_mfma_f32_16x16x32_bf16 a[224:227], v[56:59], v[112:115], a[224:227]
  ds_read_b128 v[52:55], v5 offset:57344
  v_mfma_f32_16x16x32_bf16 a[228:231], v[56:59], v[116:119], a[228:231]
  v_mfma_f32_16x16x32_bf16 a[232:235], v[56:59], v[120:123], a[232:235]
  v_mfma_f32_16x16x32_bf16 a[236:239], v[56:59], v[124:127], a[236:239]
  s_waitcnt lgkmcnt(6)
  v_mfma_f32_16x16x32_bf16 a[240:243], v[60:63], v[112:115], a[240:243]
  ds_read_b128 v[56:59], v4 offset:61440
  v_mfma_f32_16x16x32_bf16 a[244:247], v[60:63], v[116:119], a[244:247]
  v_mfma_f32_16x16x32_bf16 a[248:251], v[60:63], v[120:123], a[248:251]
  v_mfma_f32_16x16x32_bf16 a[252:255], v[60:63], v[124:127], a[252:255]
  ds_read_b128 v[60:63], v5 offset:61440
  s_waitcnt lgkmcnt(6)
  v_mfma_f32_16x16x32_bf16 v[64:67], v[32:35], v[128:131], 0
  v_fma_f32 v88, v88, s63, v18
  v_fma_f32 v89, v89, s63, v18
  v_mfma_f32_16x16x32_bf16 v[64:67], v[36:39], v[132:135], v[64:67]
  s_mov_b32 s67, 128
  v_exp_f32 v88, v88
  v_mfma_f32_16x16x32_bf16 v[68:71], v[32:35], v[160:163], 0
  s_add_u32 m0, s33, 0
  v_exp_f32 v89, v89
  v_mfma_f32_16x16x32_bf16 v[68:71], v[36:39], v[164:167], v[68:71]
  s_mul_i32 s50, s71, 1048576
  buffer_load_dwordx4 v3, s[20:23], s67 offen nt lds
  v_mfma_f32_16x16x32_bf16 v[72:75], v[32:35], v[192:195], 0
  s_lshl_b32 s51, s32, 16
  v_fma_f32 v90, v90, s63, v18
  v_fma_f32 v91, v91, s63, v18
  v_mfma_f32_16x16x32_bf16 v[72:75], v[36:39], v[196:199], v[72:75]
  s_add_u32 s60, s50, s51
  v_exp_f32 v90, v90
  v_mfma_f32_16x16x32_bf16 v[76:79], v[32:35], v[224:227], 0
  s_lshl_b32 s51, s72, 10
  v_exp_f32 v91, v91
  v_mfma_f32_16x16x32_bf16 v[76:79], v[36:39], v[228:231], v[76:79]
  s_waitcnt lgkmcnt(4)
  v_fma_f32 v92, v92, s63, v19
  v_fma_f32 v93, v93, s63, v19
  v_mfma_f32_16x16x32_bf16 v[64:67], v[40:43], v[136:139], v[64:67]
  s_add_u32 s60, s60, s51
  v_exp_f32 v92, v92
  v_mfma_f32_16x16x32_bf16 v[64:67], v[44:47], v[140:143], v[64:67]
  s_mov_b32 s68, 28800
  v_exp_f32 v93, v93
  v_mfma_f32_16x16x32_bf16 v[68:71], v[40:43], v[168:171], v[68:71]
  s_add_u32 m0, s33, 4096
  v_fma_f32 v94, v94, s63, v19
  ds_read_b128 v[32:35], v4 offset:51200
  v_mfma_f32_16x16x32_bf16 v[68:71], v[44:47], v[172:175], v[68:71]
  s_lshl_b32 s51, s72, 14
  buffer_load_dwordx4 v3, s[20:23], s68 offen nt lds
  v_mfma_f32_16x16x32_bf16 v[72:75], v[40:43], v[200:203], v[72:75]
  s_add_u32 s61, s50, s51
  v_exp_f32 v94, v94
  v_mfma_f32_16x16x32_bf16 v[72:75], v[44:47], v[204:207], v[72:75]
  s_mul_i32 s50, s71, 896
  v_fma_f32 v95, v95, s63, v19
  v_add_f32 v14, v14, v88
  v_mfma_f32_16x16x32_bf16 v[76:79], v[40:43], v[232:235], v[76:79]
  s_lshl_b32 s51, s32, 4
  v_add_f32 v14, v14, v89
  ds_read_b128 v[36:39], v5 offset:51200
  v_mfma_f32_16x16x32_bf16 v[76:79], v[44:47], v[236:239], v[76:79]
  s_waitcnt lgkmcnt(4)
  v_exp_f32 v95, v95
  v_mfma_f32_16x16x32_bf16 v[64:67], v[48:51], v[144:147], v[64:67]
  s_add_u32 s75, s50, s51
  v_add_f32 v14, v14, v90
  v_add_f32 v14, v14, v91
  v_mfma_f32_16x16x32_bf16 v[64:67], v[52:55], v[148:151], v[64:67]
  s_mov_b32 s67, 57472
  v_cvt_pk_bf16_f32 v106, v88, v89
  v_cvt_pk_bf16_f32 v107, v90, v91
  v_mfma_f32_16x16x32_bf16 v[68:71], v[48:51], v[176:179], v[68:71]
  s_add_u32 m0, s33, 8192
  v_add_f32 v15, v15, v92
  ds_read_b128 v[40:43], v4 offset:55296
  v_mfma_f32_16x16x32_bf16 v[68:71], v[52:55], v[180:183], v[68:71]
  s_add_u32 s75, s75, s72
  buffer_load_dwordx4 v3, s[20:23], s67 offen nt lds
  v_mfma_f32_16x16x32_bf16 v[72:75], v[48:51], v[208:211], v[72:75]
  s_add_u32 s76, s50, s51
  v_add_f32 v15, v15, v93
  v_add_f32 v15, v15, v94
  v_mfma_f32_16x16x32_bf16 v[72:75], v[52:55], v[212:215], v[72:75]
  s_add_u32 s76, s76, 16384
  v_add_f32 v15, v15, v95
  v_cvt_pk_bf16_f32 v110, v92, v93
  v_mfma_f32_16x16x32_bf16 v[76:79], v[48:51], v[240:243], v[76:79]
  s_lshr_b32 s51, s72, 2
  v_cvt_pk_bf16_f32 v111, v94, v95
  ds_read_b128 v[44:47], v5 offset:55296
  v_mfma_f32_16x16x32_bf16 v[76:79], v[52:55], v[244:247], v[76:79]
  s_waitcnt lgkmcnt(4)
  v_mfma_f32_16x16x32_bf16 v[64:67], v[56:59], v[152:155], v[64:67]
  s_lshl_b32 s51, s51, 4
  v_mfma_f32_16x16x32_bf16 v[64:67], v[60:63], v[156:159], v[64:67]
  s_mov_b32 s68, 86144
  v_mfma_f32_16x16x32_bf16 v[68:71], v[56:59], v[184:187], v[68:71]
  s_add_u32 m0, s33, 12288
  ds_read_b128 v[48:51], v4 offset:59392
  v_mfma_f32_16x16x32_bf16 v[68:71], v[60:63], v[188:191], v[68:71]
  s_add_u32 s78, s50, s51
  buffer_load_dwordx4 v3, s[20:23], s68 offen nt lds
  v_mfma_f32_16x16x32_bf16 v[72:75], v[56:59], v[216:219], v[72:75]
  s_lshl_b32 s51, s72, 2
  v_mfma_f32_16x16x32_bf16 v[72:75], v[60:63], v[220:223], v[72:75]
  s_add_u32 s79, s50, s51
  v_mfma_f32_16x16x32_bf16 v[76:79], v[56:59], v[248:251], v[76:79]
  s_add_u32 s79, s79, s32
  ds_read_b128 v[52:55], v5 offset:59392
  v_mfma_f32_16x16x32_bf16 v[76:79], v[60:63], v[252:255], v[76:79]
  s_waitcnt lgkmcnt(4)
  v_fma_f32 v64, v64, s63, v16
  v_fma_f32 v65, v65, s63, v16
  v_mfma_f32_16x16x32_bf16 v[80:83], v[32:35], v[128:131], 0
  s_add_u32 s79, s79, 16384
  v_exp_f32 v64, v64
  v_mfma_f32_16x16x32_bf16 v[80:83], v[36:39], v[132:135], v[80:83]
  s_mov_b32 s67, 114816
  v_exp_f32 v65, v65
  v_mfma_f32_16x16x32_bf16 v[84:87], v[32:35], v[160:163], 0
  s_add_u32 m0, s33, 16384
  v_fma_f32 v66, v66, s63, v16
  ds_read_b128 v[56:59], v4 offset:63488
  v_mfma_f32_16x16x32_bf16 v[84:87], v[36:39], v[164:167], v[84:87]
  buffer_load_dwordx4 v3, s[20:23], s67 offen nt lds
  v_mfma_f32_16x16x32_bf16 v[88:91], v[32:35], v[192:195], 0
  v_exp_f32 v66, v66
  v_mfma_f32_16x16x32_bf16 v[88:91], v[36:39], v[196:199], v[88:91]
  v_fma_f32 v67, v67, s63, v16
  v_add_f32 v12, v12, v64
  v_mfma_f32_16x16x32_bf16 v[92:95], v[32:35], v[224:227], 0
  v_add_f32 v12, v12, v65
  ds_read_b128 v[60:63], v5 offset:63488
  v_mfma_f32_16x16x32_bf16 v[92:95], v[36:39], v[228:231], v[92:95]
  s_waitcnt lgkmcnt(4)
  v_exp_f32 v67, v67
  v_mfma_f32_16x16x32_bf16 v[80:83], v[40:43], v[136:139], v[80:83]
  v_add_f32 v12, v12, v66
  v_add_f32 v12, v12, v67
  v_mfma_f32_16x16x32_bf16 v[80:83], v[44:47], v[140:143], v[80:83]
  s_mov_b32 s68, 143488
  v_cvt_pk_bf16_f32 v112, v64, v65
  v_cvt_pk_bf16_f32 v113, v66, v67
  v_mfma_f32_16x16x32_bf16 v[84:87], v[40:43], v[168:171], v[84:87]
  s_add_u32 m0, s33, 20480
  v_fma_f32 v68, v68, s63, v17
  v_fma_f32 v69, v69, s63, v17
  v_mfma_f32_16x16x32_bf16 v[84:87], v[44:47], v[172:175], v[84:87]
  buffer_load_dwordx4 v3, s[20:23], s68 offen nt lds
  v_mfma_f32_16x16x32_bf16 v[88:91], v[40:43], v[200:203], v[88:91]
  v_fma_f32 v70, v70, s63, v17
  ds_read_b64_tr_b16 v[32:33], v6 offset:32768
  v_mfma_f32_16x16x32_bf16 v[88:91], v[44:47], v[204:207], v[88:91]
  v_exp_f32 v68, v68
  v_mfma_f32_16x16x32_bf16 v[92:95], v[40:43], v[232:235], v[92:95]
  v_fma_f32 v71, v71, s63, v17
  ds_read_b64_tr_b16 v[34:35], v6 offset:34816
  v_mfma_f32_16x16x32_bf16 v[92:95], v[44:47], v[236:239], v[92:95]
  s_waitcnt lgkmcnt(4)
  v_exp_f32 v69, v69
  v_mfma_f32_16x16x32_bf16 v[80:83], v[48:51], v[144:147], v[80:83]
  v_add_f32 v13, v13, v68
  ds_read_b64_tr_b16 v[36:37], v7 offset:32768
  v_mfma_f32_16x16x32_bf16 v[80:83], v[52:55], v[148:151], v[80:83]
  s_mov_b32 s67, 172160
  v_exp_f32 v70, v70
  v_mfma_f32_16x16x32_bf16 v[84:87], v[48:51], v[176:179], v[84:87]
  s_add_u32 m0, s33, 24576
  v_add_f32 v13, v13, v69
  ds_read_b64_tr_b16 v[38:39], v7 offset:34816
  v_mfma_f32_16x16x32_bf16 v[84:87], v[52:55], v[180:183], v[84:87]
  buffer_load_dwordx4 v3, s[20:23], s67 offen nt lds
  v_mfma_f32_16x16x32_bf16 v[88:91], v[48:51], v[208:211], v[88:91]
  v_add_f32 v13, v13, v70
  ds_read_b64_tr_b16 v[40:41], v8 offset:32768
  v_mfma_f32_16x16x32_bf16 v[88:91], v[52:55], v[212:215], v[88:91]
  v_exp_f32 v71, v71
  v_mfma_f32_16x16x32_bf16 v[92:95], v[48:51], v[240:243], v[92:95]
  v_add_f32 v13, v13, v71
  ds_read_b64_tr_b16 v[42:43], v8 offset:34816
  v_mfma_f32_16x16x32_bf16 v[92:95], v[52:55], v[244:247], v[92:95]
  s_waitcnt lgkmcnt(6)
  v_cvt_pk_bf16_f32 v116, v68, v69
  v_cvt_pk_bf16_f32 v117, v70, v71
  v_mfma_f32_16x16x32_bf16 v[80:83], v[56:59], v[152:155], v[80:83]
  v_fma_f32 v72, v72, s63, v18
  ds_read_b64_tr_b16 v[44:45], v9 offset:32768
  v_mfma_f32_16x16x32_bf16 v[80:83], v[60:63], v[156:159], v[80:83]
  s_mov_b32 s68, 200832
  v_exp_f32 v72, v72
  v_mfma_f32_16x16x32_bf16 v[84:87], v[56:59], v[184:187], v[84:87]
  s_add_u32 m0, s33, 28672
  v_fma_f32 v73, v73, s63, v18
  ds_read_b64_tr_b16 v[46:47], v9 offset:34816
  v_mfma_f32_16x16x32_bf16 v[84:87], v[60:63], v[188:191], v[84:87]
  buffer_load_dwordx4 v3, s[20:23], s68 offen nt lds
  v_mfma_f32_16x16x32_bf16 v[88:91], v[56:59], v[216:219], v[88:91]
  v_fma_f32 v74, v74, s63, v18
  ds_read_b64_tr_b16 v[48:49], v6 offset:36864
  v_mfma_f32_16x16x32_bf16 v[88:91], v[60:63], v[220:223], v[88:91]
  v_exp_f32 v73, v73
  v_mfma_f32_16x16x32_bf16 v[92:95], v[56:59], v[248:251], v[92:95]
  v_fma_f32 v75, v75, s63, v18
  ds_read_b64_tr_b16 v[50:51], v6 offset:38912
  v_mfma_f32_16x16x32_bf16 v[92:95], v[60:63], v[252:255], v[92:95]
  s_waitcnt lgkmcnt(8)
  v_exp_f32 v74, v74
  v_mfma_f32_16x16x32_bf16 a[0:3], v[32:35], v[96:99], a[0:3]
  v_add_f32 v14, v14, v72
  ds_read_b64_tr_b16 v[52:53], v7 offset:36864
  v_mfma_f32_16x16x32_bf16 a[4:7], v[32:35], v[100:103], a[4:7]
  v_exp_f32 v75, v75
  v_mfma_f32_16x16x32_bf16 a[8:11], v[32:35], v[104:107], a[8:11]
  v_add_f32 v14, v14, v73
  ds_read_b64_tr_b16 v[54:55], v7 offset:38912
  v_mfma_f32_16x16x32_bf16 a[12:15], v[32:35], v[108:111], a[12:15]
  s_waitcnt lgkmcnt(8)
  v_add_f32 v14, v14, v74
  v_add_f32 v14, v14, v75
  v_mfma_f32_16x16x32_bf16 a[16:19], v[36:39], v[96:99], a[16:19]
  v_cvt_pk_bf16_f32 v120, v72, v73
  ds_read_b64_tr_b16 v[56:57], v8 offset:36864
  v_mfma_f32_16x16x32_bf16 a[20:23], v[36:39], v[100:103], a[20:23]
  v_cvt_pk_bf16_f32 v121, v74, v75
  v_fma_f32 v76, v76, s63, v19
  v_mfma_f32_16x16x32_bf16 a[24:27], v[36:39], v[104:107], a[24:27]
  v_fma_f32 v77, v77, s63, v19
  ds_read_b64_tr_b16 v[58:59], v8 offset:38912
  v_mfma_f32_16x16x32_bf16 a[28:31], v[36:39], v[108:111], a[28:31]
  s_waitcnt lgkmcnt(8)
  v_exp_f32 v76, v76
  v_mfma_f32_16x16x32_bf16 a[32:35], v[40:43], v[96:99], a[32:35]
  v_fma_f32 v78, v78, s63, v19
  ds_read_b64_tr_b16 v[60:61], v9 offset:36864
  v_mfma_f32_16x16x32_bf16 a[36:39], v[40:43], v[100:103], a[36:39]
  v_exp_f32 v77, v77
  v_mfma_f32_16x16x32_bf16 a[40:43], v[40:43], v[104:107], a[40:43]
  v_fma_f32 v79, v79, s63, v19
  ds_read_b64_tr_b16 v[62:63], v9 offset:38912
  v_mfma_f32_16x16x32_bf16 a[44:47], v[40:43], v[108:111], a[44:47]
  s_waitcnt lgkmcnt(8)
  v_exp_f32 v78, v78
  v_mfma_f32_16x16x32_bf16 a[48:51], v[44:47], v[96:99], a[48:51]
  v_add_f32 v15, v15, v76
  ds_read_b64_tr_b16 v[32:33], v6 offset:40960
  v_mfma_f32_16x16x32_bf16 a[52:55], v[44:47], v[100:103], a[52:55]
  v_exp_f32 v79, v79
  v_mfma_f32_16x16x32_bf16 a[56:59], v[44:47], v[104:107], a[56:59]
  v_add_f32 v15, v15, v77
  ds_read_b64_tr_b16 v[34:35], v6 offset:43008
  v_mfma_f32_16x16x32_bf16 a[60:63], v[44:47], v[108:111], a[60:63]
  s_waitcnt lgkmcnt(8)
  v_add_f32 v15, v15, v78
  v_add_f32 v15, v15, v79
  v_mfma_f32_16x16x32_bf16 a[64:67], v[48:51], v[96:99], a[64:67]
  v_cvt_pk_bf16_f32 v124, v76, v77
  ds_read_b64_tr_b16 v[36:37], v7 offset:40960
  v_mfma_f32_16x16x32_bf16 a[68:71], v[48:51], v[100:103], a[68:71]
  v_cvt_pk_bf16_f32 v125, v78, v79
  v_fma_f32 v80, v80, s63, v16
  v_mfma_f32_16x16x32_bf16 a[72:75], v[48:51], v[104:107], a[72:75]
  v_fma_f32 v81, v81, s63, v16
  ds_read_b64_tr_b16 v[38:39], v7 offset:43008
  v_mfma_f32_16x16x32_bf16 a[76:79], v[48:51], v[108:111], a[76:79]
  s_waitcnt lgkmcnt(8)
  v_exp_f32 v80, v80
  v_mfma_f32_16x16x32_bf16 a[80:83], v[52:55], v[96:99], a[80:83]
  v_fma_f32 v82, v82, s63, v16
  ds_read_b64_tr_b16 v[40:41], v8 offset:40960
  v_mfma_f32_16x16x32_bf16 a[84:87], v[52:55], v[100:103], a[84:87]
  v_exp_f32 v81, v81
  v_mfma_f32_16x16x32_bf16 a[88:91], v[52:55], v[104:107], a[88:91]
  v_fma_f32 v83, v83, s63, v16
  ds_read_b64_tr_b16 v[42:43], v8 offset:43008
  v_mfma_f32_16x16x32_bf16 a[92:95], v[52:55], v[108:111], a[92:95]
  s_waitcnt lgkmcnt(8)
  v_exp_f32 v82, v82
  v_mfma_f32_16x16x32_bf16 a[96:99], v[56:59], v[96:99], a[96:99]
  v_fma_f32 v84, v84, s63, v17
  ds_read_b64_tr_b16 v[44:45], v9 offset:40960
  v_mfma_f32_16x16x32_bf16 a[100:103], v[56:59], v[100:103], a[100:103]
  v_exp_f32 v83, v83
  v_mfma_f32_16x16x32_bf16 a[104:107], v[56:59], v[104:107], a[104:107]
  v_fma_f32 v85, v85, s63, v17
  ds_read_b64_tr_b16 v[46:47], v9 offset:43008
  v_mfma_f32_16x16x32_bf16 a[108:111], v[56:59], v[108:111], a[108:111]
  s_waitcnt lgkmcnt(8)
  v_exp_f32 v84, v84
  v_mfma_f32_16x16x32_bf16 a[112:115], v[60:63], v[96:99], a[112:115]
  v_fma_f32 v86, v86, s63, v17
  ds_read_b64_tr_b16 v[48:49], v6 offset:45056
  v_mfma_f32_16x16x32_bf16 a[116:119], v[60:63], v[100:103], a[116:119]
  v_exp_f32 v85, v85
  v_mfma_f32_16x16x32_bf16 a[120:123], v[60:63], v[104:107], a[120:123]
  v_fma_f32 v87, v87, s63, v17
  ds_read_b64_tr_b16 v[50:51], v6 offset:47104
  v_mfma_f32_16x16x32_bf16 a[124:127], v[60:63], v[108:111], a[124:127]
  s_waitcnt lgkmcnt(8)
  v_exp_f32 v86, v86
  v_mfma_f32_16x16x32_bf16 a[128:131], v[32:35], v[96:99], a[128:131]
  v_add_f32 v12, v12, v80
  ds_read_b64_tr_b16 v[52:53], v7 offset:45056
  v_mfma_f32_16x16x32_bf16 a[132:135], v[32:35], v[100:103], a[132:135]
  v_exp_f32 v87, v87
  v_mfma_f32_16x16x32_bf16 a[136:139], v[32:35], v[104:107], a[136:139]
  s_waitcnt vmcnt(12)
  s_barrier
  ds_read_b64_tr_b16 v[54:55], v7 offset:47104
  v_mfma_f32_16x16x32_bf16 a[140:143], v[32:35], v[108:111], a[140:143]
  s_waitcnt lgkmcnt(8)
  v_add_f32 v12, v12, v81
  v_add_f32 v12, v12, v82
  v_mfma_f32_16x16x32_bf16 a[144:147], v[36:39], v[96:99], a[144:147]
  v_add_f32 v12, v12, v83
  ds_read_b64_tr_b16 v[56:57], v8 offset:45056
  v_mfma_f32_16x16x32_bf16 a[148:151], v[36:39], v[100:103], a[148:151]
  v_cvt_pk_bf16_f32 v114, v80, v81
  v_cvt_pk_bf16_f32 v115, v82, v83
  v_mfma_f32_16x16x32_bf16 a[152:155], v[36:39], v[104:107], a[152:155]
  v_add_f32 v13, v13, v84
  ds_read_b64_tr_b16 v[58:59], v8 offset:47104
  v_mfma_f32_16x16x32_bf16 a[156:159], v[36:39], v[108:111], a[156:159]
  s_waitcnt lgkmcnt(8)
  v_add_f32 v13, v13, v85
  v_add_f32 v13, v13, v86
  v_mfma_f32_16x16x32_bf16 a[160:163], v[40:43], v[96:99], a[160:163]
  v_add_f32 v13, v13, v87
  ds_read_b64_tr_b16 v[60:61], v9 offset:45056
  v_mfma_f32_16x16x32_bf16 a[164:167], v[40:43], v[100:103], a[164:167]
  v_cvt_pk_bf16_f32 v118, v84, v85
  v_cvt_pk_bf16_f32 v119, v86, v87
  v_mfma_f32_16x16x32_bf16 a[168:171], v[40:43], v[104:107], a[168:171]
  ds_read_b64_tr_b16 v[62:63], v9 offset:47104
  v_mfma_f32_16x16x32_bf16 a[172:175], v[40:43], v[108:111], a[172:175]
  s_waitcnt lgkmcnt(8)
  v_mfma_f32_16x16x32_bf16 a[176:179], v[44:47], v[96:99], a[176:179]
  ds_read_b64_tr_b16 v[32:33], v6 offset:49152
  v_mfma_f32_16x16x32_bf16 a[180:183], v[44:47], v[100:103], a[180:183]
  v_mfma_f32_16x16x32_bf16 a[184:187], v[44:47], v[104:107], a[184:187]
  ds_read_b64_tr_b16 v[34:35], v6 offset:51200
  v_mfma_f32_16x16x32_bf16 a[188:191], v[44:47], v[108:111], a[188:191]
  s_waitcnt lgkmcnt(8)
  v_mfma_f32_16x16x32_bf16 a[192:195], v[48:51], v[96:99], a[192:195]
  ds_read_b64_tr_b16 v[36:37], v7 offset:49152
  v_mfma_f32_16x16x32_bf16 a[196:199], v[48:51], v[100:103], a[196:199]
  v_mfma_f32_16x16x32_bf16 a[200:203], v[48:51], v[104:107], a[200:203]
  ds_read_b64_tr_b16 v[38:39], v7 offset:51200
  v_mfma_f32_16x16x32_bf16 a[204:207], v[48:51], v[108:111], a[204:207]
  s_waitcnt lgkmcnt(8)
  v_mfma_f32_16x16x32_bf16 a[208:211], v[52:55], v[96:99], a[208:211]
  ds_read_b64_tr_b16 v[40:41], v8 offset:49152
  v_mfma_f32_16x16x32_bf16 a[212:215], v[52:55], v[100:103], a[212:215]
  v_mfma_f32_16x16x32_bf16 a[216:219], v[52:55], v[104:107], a[216:219]
  ds_read_b64_tr_b16 v[42:43], v8 offset:51200
  v_mfma_f32_16x16x32_bf16 a[220:223], v[52:55], v[108:111], a[220:223]
  s_waitcnt lgkmcnt(8)
  v_mfma_f32_16x16x32_bf16 a[224:227], v[56:59], v[96:99], a[224:227]
  ds_read_b64_tr_b16 v[44:45], v9 offset:49152
  v_mfma_f32_16x16x32_bf16 a[228:231], v[56:59], v[100:103], a[228:231]
  v_mfma_f32_16x16x32_bf16 a[232:235], v[56:59], v[104:107], a[232:235]
  ds_read_b64_tr_b16 v[46:47], v9 offset:51200
  v_mfma_f32_16x16x32_bf16 a[236:239], v[56:59], v[108:111], a[236:239]
  s_waitcnt lgkmcnt(8)
  v_mfma_f32_16x16x32_bf16 a[240:243], v[60:63], v[96:99], a[240:243]
  ds_read_b64_tr_b16 v[48:49], v6 offset:53248
  v_mfma_f32_16x16x32_bf16 a[244:247], v[60:63], v[100:103], a[244:247]
  v_mfma_f32_16x16x32_bf16 a[248:251], v[60:63], v[104:107], a[248:251]
  ds_read_b64_tr_b16 v[50:51], v6 offset:55296
  v_mfma_f32_16x16x32_bf16 a[252:255], v[60:63], v[108:111], a[252:255]
  v_fma_f32 v88, v88, s63, v18
  v_fma_f32 v89, v89, s63, v18
  v_exp_f32 v88, v88
  v_exp_f32 v89, v89
  s_nop 0
  v_fma_f32 v90, v90, s63, v18
  v_fma_f32 v91, v91, s63, v18
  v_exp_f32 v90, v90
  v_exp_f32 v91, v91
  s_nop 0
  v_add_f32 v14, v14, v88
  v_add_f32 v14, v14, v89
  v_cvt_pk_bf16_f32 v122, v88, v89
  v_add_f32 v14, v14, v90
  v_add_f32 v14, v14, v91
  v_cvt_pk_bf16_f32 v123, v90, v91
  v_fma_f32 v92, v92, s63, v19
  v_fma_f32 v93, v93, s63, v19
  v_exp_f32 v92, v92
  v_exp_f32 v93, v93
  s_nop 0
  v_fma_f32 v94, v94, s63, v19
  v_fma_f32 v95, v95, s63, v19
  v_exp_f32 v94, v94
  v_exp_f32 v95, v95
  s_nop 0
  v_add_f32 v15, v15, v92
  v_add_f32 v15, v15, v93
  v_cvt_pk_bf16_f32 v126, v92, v93
  v_add_f32 v15, v15, v94
  v_add_f32 v15, v15, v95
  v_cvt_pk_bf16_f32 v127, v94, v95
  v_mov_b32 v20, v12
  v_mov_b32 v21, v13
  v_mov_b32 v22, v14
  v_mov_b32 v23, v15
  s_nop 1
  v_permlane32_swap_b32 v12, v20
  v_permlane32_swap_b32 v13, v21
  v_permlane32_swap_b32 v14, v22
  v_permlane32_swap_b32 v15, v23
  s_nop 1
  v_add_f32 v12, v12, v20
  v_add_f32 v13, v13, v21
  v_add_f32 v14, v14, v22
  v_add_f32 v15, v15, v23
  v_mov_b32 v20, v12
  v_mov_b32 v21, v13
  v_mov_b32 v22, v14
  v_mov_b32 v23, v15
  s_nop 1
  v_permlane16_swap_b32 v12, v20
  v_permlane16_swap_b32 v13, v21
  v_permlane16_swap_b32 v14, v22
  v_permlane16_swap_b32 v15, v23
  s_nop 1
  v_add_f32 v12, v12, v20
  v_add_f32 v13, v13, v21
  v_add_f32 v14, v14, v22
  v_add_f32 v15, v15, v23
  s_mov_b32 s67, 0x4e800000
  v_cmp_nge_f32 s[50:51], s67, v12
  v_cmp_nge_f32 s[52:53], s67, v13
  s_nop 0
  s_or_b64 s[50:51], s[50:51], s[52:53]
  s_mov_b64 s[54:55], s[50:51]
  v_cmp_nge_f32 s[50:51], s67, v14
  v_cmp_nge_f32 s[52:53], s67, v15
  s_nop 0
  s_or_b64 s[50:51], s[50:51], s[52:53]
  s_or_b64 s[54:55], s[54:55], s[50:51]
  s_cselect_b32 s50, 1, 0
  s_lshl_b32 s51, s32, 2
  s_add_u32 s51, s51, 98304
  v_mov_b32 v20, s50
  v_mov_b32 v21, s51
  ds_write_b32 v21, v20
  v_rcp_f32 v12, v12
  v_rcp_f32 v13, v13
  v_rcp_f32 v14, v14
  v_rcp_f32 v15, v15
  s_nop 0
  s_waitcnt lgkmcnt(9)
  v_mfma_f32_16x16x32_bf16 a[0:3], v[32:35], v[112:115], a[0:3]
  ds_read_b64_tr_b16 v[52:53], v7 offset:53248
  v_mfma_f32_16x16x32_bf16 a[4:7], v[32:35], v[116:119], a[4:7]
  s_mov_b32 s67, 256
  v_mfma_f32_16x16x32_bf16 a[8:11], v[32:35], v[120:123], a[8:11]
  s_add_u32 m0, s33, 32768
  ds_read_b64_tr_b16 v[54:55], v7 offset:55296
  v_mfma_f32_16x16x32_bf16 a[12:15], v[32:35], v[124:127], a[12:15]
  s_waitcnt lgkmcnt(9)
  buffer_load_dwordx4 v3, s[20:23], s67 offen nt lds
  v_mfma_f32_16x16x32_bf16 a[16:19], v[36:39], v[112:115], a[16:19]
  ds_read_b64_tr_b16 v[56:57], v8 offset:53248
  v_mfma_f32_16x16x32_bf16 a[20:23], v[36:39], v[116:119], a[20:23]
  s_mov_b32 s68, 28928
  v_accvgpr_read_b32 v128, a0
  v_accvgpr_read_b32 v28, a1
  v_mfma_f32_16x16x32_bf16 a[24:27], v[36:39], v[120:123], a[24:27]
  s_add_u32 m0, s33, 36864
  ds_read_b64_tr_b16 v[58:59], v8 offset:55296
  v_accvgpr_read_b32 v129, a2
  v_mfma_f32_16x16x32_bf16 a[28:31], v[36:39], v[124:127], a[28:31]
  s_waitcnt lgkmcnt(9)
  buffer_load_dwordx4 v3, s[20:23], s68 offen nt lds
  v_mfma_f32_16x16x32_bf16 a[32:35], v[40:43], v[112:115], a[32:35]
  ds_read_b64_tr_b16 v[60:61], v9 offset:53248
  v_accvgpr_read_b32 v29, a3
  v_mfma_f32_16x16x32_bf16 a[36:39], v[40:43], v[116:119], a[36:39]
  s_mov_b32 s67, 57600
  v_cvt_pk_bf16_f32 v128, v128, v28
  v_cvt_pk_bf16_f32 v129, v129, v29
  v_mfma_f32_16x16x32_bf16 a[40:43], v[40:43], v[120:123], a[40:43]
  s_add_u32 m0, s33, 40960
  ds_read_b64_tr_b16 v[62:63], v9 offset:55296
  v_accvgpr_read_b32 v160, a4
  v_mfma_f32_16x16x32_bf16 a[44:47], v[40:43], v[124:127], a[44:47]
  s_waitcnt lgkmcnt(9)
  buffer_load_dwordx4 v3, s[20:23], s67 offen nt lds
  v_mfma_f32_16x16x32_bf16 a[48:51], v[44:47], v[112:115], a[48:51]
  ds_read_b64_tr_b16 v[32:33], v6 offset:57344
  v_accvgpr_read_b32 v30, a5
  v_mfma_f32_16x16x32_bf16 a[52:55], v[44:47], v[116:119], a[52:55]
  s_mov_b32 s68, 86272
  v_accvgpr_read_b32 v161, a6
  v_accvgpr_read_b32 v31, a7
  v_mfma_f32_16x16x32_bf16 a[56:59], v[44:47], v[120:123], a[56:59]
  s_add_u32 m0, s33, 45056
  ds_read_b64_tr_b16 v[34:35], v6 offset:59392
  v_cvt_pk_bf16_f32 v160, v160, v30
  v_mfma_f32_16x16x32_bf16 a[60:63], v[44:47], v[124:127], a[60:63]
  s_waitcnt lgkmcnt(9)
  buffer_load_dwordx4 v3, s[20:23], s68 offen nt lds
  v_mfma_f32_16x16x32_bf16 a[64:67], v[48:51], v[112:115], a[64:67]
  ds_read_b64_tr_b16 v[36:37], v7 offset:57344
  v_cvt_pk_bf16_f32 v161, v161, v31
  v_mfma_f32_16x16x32_bf16 a[68:71], v[48:51], v[116:119], a[68:71]
  s_mov_b32 s67, 114944
  v_accvgpr_read_b32 v192, a8
  v_accvgpr_read_b32 v28, a9
  v_mfma_f32_16x16x32_bf16 a[72:75], v[48:51], v[120:123], a[72:75]
  s_add_u32 m0, s33, 49152
  ds_read_b64_tr_b16 v[38:39], v7 offset:59392
  v_accvgpr_read_b32 v193, a10
  v_mfma_f32_16x16x32_bf16 a[76:79], v[48:51], v[124:127], a[76:79]
  s_waitcnt lgkmcnt(8)
  buffer_load_dwordx4 v3, s[20:23], s67 offen nt lds
  v_mfma_f32_16x16x32_bf16 a[80:83], v[52:55], v[112:115], a[80:83]
  ds_read_b64_tr_b16 v[40:41], v8 offset:57344
  v_accvgpr_read_b32 v29, a11
  v_mfma_f32_16x16x32_bf16 a[84:87], v[52:55], v[116:119], a[84:87]
  s_mov_b32 s68, 143616
  v_cvt_pk_bf16_f32 v192, v192, v28
  v_cvt_pk_bf16_f32 v193, v193, v29
  v_mfma_f32_16x16x32_bf16 a[88:91], v[52:55], v[120:123], a[88:91]
  s_add_u32 m0, s33, 53248
  ds_read_b64_tr_b16 v[42:43], v8 offset:59392
  v_accvgpr_read_b32 v224, a12
  v_mfma_f32_16x16x32_bf16 a[92:95], v[52:55], v[124:127], a[92:95]
  s_waitcnt lgkmcnt(8)
  buffer_load_dwordx4 v3, s[20:23], s68 offen nt lds
  v_mfma_f32_16x16x32_bf16 a[96:99], v[56:59], v[112:115], a[96:99]
  ds_read_b64_tr_b16 v[44:45], v9 offset:57344
  v_accvgpr_read_b32 v30, a13
  v_mfma_f32_16x16x32_bf16 a[100:103], v[56:59], v[116:119], a[100:103]
  s_mov_b32 s67, 172288
  v_accvgpr_read_b32 v225, a14
  v_accvgpr_read_b32 v31, a15
  v_mfma_f32_16x16x32_bf16 a[104:107], v[56:59], v[120:123], a[104:107]
  s_add_u32 m0, s33, 57344
  ds_read_b64_tr_b16 v[46:47], v9 offset:59392
  v_cvt_pk_bf16_f32 v224, v224, v30
  v_mfma_f32_16x16x32_bf16 a[108:111], v[56:59], v[124:127], a[108:111]
  s_waitcnt lgkmcnt(8)
  buffer_load_dwordx4 v3, s[20:23], s67 offen nt lds
  v_mfma_f32_16x16x32_bf16 a[112:115], v[60:63], v[112:115], a[112:115]
  ds_read_b64_tr_b16 v[48:49], v6 offset:61440
  v_cvt_pk_bf16_f32 v225, v225, v31
  v_mfma_f32_16x16x32_bf16 a[116:119], v[60:63], v[116:119], a[116:119]
  s_mov_b32 s68, 200960
  v_accvgpr_read_b32 v130, a16
  v_accvgpr_read_b32 v28, a17
  v_mfma_f32_16x16x32_bf16 a[120:123], v[60:63], v[120:123], a[120:123]
  s_add_u32 m0, s33, 61440
  ds_read_b64_tr_b16 v[50:51], v6 offset:63488
  v_accvgpr_read_b32 v131, a18
  v_mfma_f32_16x16x32_bf16 a[124:127], v[60:63], v[124:127], a[124:127]
  s_waitcnt lgkmcnt(8)
  buffer_load_dwordx4 v3, s[20:23], s68 offen nt lds
  v_mfma_f32_16x16x32_bf16 a[128:131], v[32:35], v[112:115], a[128:131]
  ds_read_b64_tr_b16 v[52:53], v7 offset:61440
  v_accvgpr_read_b32 v29, a19
  v_mfma_f32_16x16x32_bf16 a[132:135], v[32:35], v[116:119], a[132:135]
  s_mov_b32 s67, 384
  v_cvt_pk_bf16_f32 v130, v130, v28
  v_cvt_pk_bf16_f32 v131, v131, v29
  v_mfma_f32_16x16x32_bf16 a[136:139], v[32:35], v[120:123], a[136:139]
  s_add_u32 m0, s33, 65536
  ds_read_b64_tr_b16 v[54:55], v7 offset:63488
  v_accvgpr_read_b32 v162, a20
  v_mfma_f32_16x16x32_bf16 a[140:143], v[32:35], v[124:127], a[140:143]
  s_waitcnt lgkmcnt(8)
  buffer_load_dwordx4 v3, s[20:23], s67 offen nt lds
  v_mfma_f32_16x16x32_bf16 a[144:147], v[36:39], v[112:115], a[144:147]
  ds_read_b64_tr_b16 v[56:57], v8 offset:61440
  v_accvgpr_read_b32 v30, a21
  v_mfma_f32_16x16x32_bf16 a[148:151], v[36:39], v[116:119], a[148:151]
  s_mov_b32 s68, 29056
  v_accvgpr_read_b32 v163, a22
  v_accvgpr_read_b32 v31, a23
  v_mfma_f32_16x16x32_bf16 a[152:155], v[36:39], v[120:123], a[152:155]
  s_add_u32 m0, s33, 69632
  ds_read_b64_tr_b16 v[58:59], v8 offset:63488
  v_cvt_pk_bf16_f32 v162, v162, v30
  v_mfma_f32_16x16x32_bf16 a[156:159], v[36:39], v[124:127], a[156:159]
  s_waitcnt lgkmcnt(8)
  buffer_load_dwordx4 v3, s[20:23], s68 offen nt lds
  v_mfma_f32_16x16x32_bf16 a[160:163], v[40:43], v[112:115], a[160:163]
  ds_read_b64_tr_b16 v[60:61], v9 offset:61440
  v_cvt_pk_bf16_f32 v163, v163, v31
  v_mfma_f32_16x16x32_bf16 a[164:167], v[40:43], v[116:119], a[164:167]
  s_mov_b32 s67, 57728
  v_accvgpr_read_b32 v194, a24
  v_accvgpr_read_b32 v28, a25
  v_mfma_f32_16x16x32_bf16 a[168:171], v[40:43], v[120:123], a[168:171]
  s_add_u32 m0, s33, 73728
  ds_read_b64_tr_b16 v[62:63], v9 offset:63488
  v_accvgpr_read_b32 v195, a26
  v_mfma_f32_16x16x32_bf16 a[172:175], v[40:43], v[124:127], a[172:175]
  s_waitcnt lgkmcnt(8)
  buffer_load_dwordx4 v3, s[20:23], s67 offen nt lds
  v_mfma_f32_16x16x32_bf16 a[176:179], v[44:47], v[112:115], a[176:179]
  s_mov_b32 s68, 86400
  v_accvgpr_read_b32 v29, a27
  v_cvt_pk_bf16_f32 v194, v194, v28
  v_mfma_f32_16x16x32_bf16 a[180:183], v[44:47], v[116:119], a[180:183]
  s_add_u32 m0, s33, 77824
  v_cvt_pk_bf16_f32 v195, v195, v29
  v_accvgpr_read_b32 v226, a28
  v_mfma_f32_16x16x32_bf16 a[184:187], v[44:47], v[120:123], a[184:187]
  buffer_load_dwordx4 v3, s[20:23], s68 offen nt lds
  v_mfma_f32_16x16x32_bf16 a[188:191], v[44:47], v[124:127], a[188:191]
  s_waitcnt lgkmcnt(6)
  v_accvgpr_read_b32 v30, a29
  v_accvgpr_read_b32 v227, a30
  v_mfma_f32_16x16x32_bf16 a[192:195], v[48:51], v[112:115], a[192:195]
  s_mov_b32 s67, 115072
  v_accvgpr_read_b32 v31, a31
  v_cvt_pk_bf16_f32 v226, v226, v30
  v_mfma_f32_16x16x32_bf16 a[196:199], v[48:51], v[116:119], a[196:199]
  s_add_u32 m0, s33, 81920
  v_cvt_pk_bf16_f32 v227, v227, v31
  v_accvgpr_read_b32 v132, a32
  v_mfma_f32_16x16x32_bf16 a[200:203], v[48:51], v[120:123], a[200:203]
  buffer_load_dwordx4 v3, s[20:23], s67 offen nt lds
  v_mfma_f32_16x16x32_bf16 a[204:207], v[48:51], v[124:127], a[204:207]
  s_waitcnt lgkmcnt(4)
  v_accvgpr_read_b32 v28, a33
  v_accvgpr_read_b32 v133, a34
  v_mfma_f32_16x16x32_bf16 a[208:211], v[52:55], v[112:115], a[208:211]
  s_mov_b32 s68, 143744
  v_accvgpr_read_b32 v29, a35
  v_cvt_pk_bf16_f32 v132, v132, v28
  v_mfma_f32_16x16x32_bf16 a[212:215], v[52:55], v[116:119], a[212:215]
  s_add_u32 m0, s33, 86016
  v_cvt_pk_bf16_f32 v133, v133, v29
  v_accvgpr_read_b32 v164, a36
  v_mfma_f32_16x16x32_bf16 a[216:219], v[52:55], v[120:123], a[216:219]
  buffer_load_dwordx4 v3, s[20:23], s68 offen nt lds
  v_mfma_f32_16x16x32_bf16 a[220:223], v[52:55], v[124:127], a[220:223]
  s_waitcnt lgkmcnt(2)
  v_accvgpr_read_b32 v30, a37
  v_accvgpr_read_b32 v165, a38
  v_mfma_f32_16x16x32_bf16 a[224:227], v[56:59], v[112:115], a[224:227]
  s_mov_b32 s67, 172416
  v_accvgpr_read_b32 v31, a39
  v_cvt_pk_bf16_f32 v164, v164, v30
  v_mfma_f32_16x16x32_bf16 a[228:231], v[56:59], v[116:119], a[228:231]
  s_add_u32 m0, s33, 90112
  v_cvt_pk_bf16_f32 v165, v165, v31
  v_accvgpr_read_b32 v196, a40
  v_mfma_f32_16x16x32_bf16 a[232:235], v[56:59], v[120:123], a[232:235]
  buffer_load_dwordx4 v3, s[20:23], s67 offen nt lds
  v_mfma_f32_16x16x32_bf16 a[236:239], v[56:59], v[124:127], a[236:239]
  s_waitcnt lgkmcnt(0)
  v_accvgpr_read_b32 v28, a41
  v_accvgpr_read_b32 v197, a42
  v_mfma_f32_16x16x32_bf16 a[240:243], v[60:63], v[112:115], a[240:243]
  s_mov_b32 s68, 201088
  v_accvgpr_read_b32 v29, a43
  v_cvt_pk_bf16_f32 v196, v196, v28
  v_mfma_f32_16x16x32_bf16 a[244:247], v[60:63], v[116:119], a[244:247]
  s_add_u32 m0, s33, 94208
  v_cvt_pk_bf16_f32 v197, v197, v29
  v_accvgpr_read_b32 v228, a44
  v_mfma_f32_16x16x32_bf16 a[248:251], v[60:63], v[120:123], a[248:251]
  buffer_load_dwordx4 v3, s[20:23], s68 offen nt lds
  v_mfma_f32_16x16x32_bf16 a[252:255], v[60:63], v[124:127], a[252:255]
  v_accvgpr_read_b32 v30, a45
  v_accvgpr_read_b32 v229, a46
  s_nop 7
  v_accvgpr_read_b32 v31, a47
  v_cvt_pk_bf16_f32 v228, v228, v30
  v_cvt_pk_bf16_f32 v229, v229, v31
  v_accvgpr_read_b32 v134, a48
  v_accvgpr_read_b32 v28, a49
  v_accvgpr_read_b32 v135, a50
  v_accvgpr_read_b32 v29, a51
  v_cvt_pk_bf16_f32 v134, v134, v28
  v_cvt_pk_bf16_f32 v135, v135, v29
  v_accvgpr_read_b32 v166, a52
  v_accvgpr_read_b32 v30, a53
  v_accvgpr_read_b32 v167, a54
  v_accvgpr_read_b32 v31, a55
  v_cvt_pk_bf16_f32 v166, v166, v30
  v_cvt_pk_bf16_f32 v167, v167, v31
  v_accvgpr_read_b32 v198, a56
  v_accvgpr_read_b32 v28, a57
  v_accvgpr_read_b32 v199, a58
  v_accvgpr_read_b32 v29, a59
  v_cvt_pk_bf16_f32 v198, v198, v28
  v_cvt_pk_bf16_f32 v199, v199, v29
  v_accvgpr_read_b32 v230, a60
  v_accvgpr_read_b32 v30, a61
  v_accvgpr_read_b32 v231, a62
  v_accvgpr_read_b32 v31, a63
  v_cvt_pk_bf16_f32 v230, v230, v30
  v_cvt_pk_bf16_f32 v231, v231, v31
  v_accvgpr_read_b32 v136, a64
  v_accvgpr_read_b32 v28, a65
  v_accvgpr_read_b32 v137, a66
  v_accvgpr_read_b32 v29, a67
  v_cvt_pk_bf16_f32 v136, v136, v28
  v_cvt_pk_bf16_f32 v137, v137, v29
  v_accvgpr_read_b32 v168, a68
  v_accvgpr_read_b32 v30, a69
  v_accvgpr_read_b32 v169, a70
  v_accvgpr_read_b32 v31, a71
  v_cvt_pk_bf16_f32 v168, v168, v30
  v_cvt_pk_bf16_f32 v169, v169, v31
  v_accvgpr_read_b32 v200, a72
  v_accvgpr_read_b32 v28, a73
  v_accvgpr_read_b32 v201, a74
  v_accvgpr_read_b32 v29, a75
  v_cvt_pk_bf16_f32 v200, v200, v28
  v_cvt_pk_bf16_f32 v201, v201, v29
  v_accvgpr_read_b32 v232, a76
  v_accvgpr_read_b32 v30, a77
  v_accvgpr_read_b32 v233, a78
  v_accvgpr_read_b32 v31, a79
  v_cvt_pk_bf16_f32 v232, v232, v30
  v_cvt_pk_bf16_f32 v233, v233, v31
  v_accvgpr_read_b32 v138, a80
  v_accvgpr_read_b32 v28, a81
  v_accvgpr_read_b32 v139, a82
  v_accvgpr_read_b32 v29, a83
  v_cvt_pk_bf16_f32 v138, v138, v28
  v_cvt_pk_bf16_f32 v139, v139, v29
  v_accvgpr_read_b32 v170, a84
  v_accvgpr_read_b32 v30, a85
  v_accvgpr_read_b32 v171, a86
  v_accvgpr_read_b32 v31, a87
  v_cvt_pk_bf16_f32 v170, v170, v30
  v_cvt_pk_bf16_f32 v171, v171, v31
  v_accvgpr_read_b32 v202, a88
  v_accvgpr_read_b32 v28, a89
  v_accvgpr_read_b32 v203, a90
  v_accvgpr_read_b32 v29, a91
  v_cvt_pk_bf16_f32 v202, v202, v28
  v_cvt_pk_bf16_f32 v203, v203, v29
  v_accvgpr_read_b32 v234, a92
  v_accvgpr_read_b32 v30, a93
  v_accvgpr_read_b32 v235, a94
  v_accvgpr_read_b32 v31, a95
  v_cvt_pk_bf16_f32 v234, v234, v30
  v_cvt_pk_bf16_f32 v235, v235, v31
  v_accvgpr_read_b32 v140, a96
  v_accvgpr_read_b32 v28, a97
  v_accvgpr_read_b32 v141, a98
  v_accvgpr_read_b32 v29, a99
  v_cvt_pk_bf16_f32 v140, v140, v28
  v_cvt_pk_bf16_f32 v141, v141, v29
  v_accvgpr_read_b32 v172, a100
  v_accvgpr_read_b32 v30, a101
  v_accvgpr_read_b32 v173, a102
  v_accvgpr_read_b32 v31, a103
  v_cvt_pk_bf16_f32 v172, v172, v30
  v_cvt_pk_bf16_f32 v173, v173, v31
  v_accvgpr_read_b32 v204, a104
  v_accvgpr_read_b32 v28, a105
  v_accvgpr_read_b32 v205, a106
  v_accvgpr_read_b32 v29, a107
  v_cvt_pk_bf16_f32 v204, v204, v28
  v_cvt_pk_bf16_f32 v205, v205, v29
  v_accvgpr_read_b32 v236, a108
  v_accvgpr_read_b32 v30, a109
  v_accvgpr_read_b32 v237, a110
  v_accvgpr_read_b32 v31, a111
  v_cvt_pk_bf16_f32 v236, v236, v30
  v_cvt_pk_bf16_f32 v237, v237, v31
  v_accvgpr_read_b32 v142, a112
  v_accvgpr_read_b32 v28, a113
  v_accvgpr_read_b32 v143, a114
  v_accvgpr_read_b32 v29, a115
  v_cvt_pk_bf16_f32 v142, v142, v28
  v_cvt_pk_bf16_f32 v143, v143, v29
  v_accvgpr_read_b32 v174, a116
  v_accvgpr_read_b32 v30, a117
  v_accvgpr_read_b32 v175, a118
  v_accvgpr_read_b32 v31, a119
  v_cvt_pk_bf16_f32 v174, v174, v30
  v_cvt_pk_bf16_f32 v175, v175, v31
  v_accvgpr_read_b32 v206, a120
  v_accvgpr_read_b32 v28, a121
  v_accvgpr_read_b32 v207, a122
  v_accvgpr_read_b32 v29, a123
  v_cvt_pk_bf16_f32 v206, v206, v28
  v_cvt_pk_bf16_f32 v207, v207, v29
  v_accvgpr_read_b32 v238, a124
  v_accvgpr_read_b32 v30, a125
  v_accvgpr_read_b32 v239, a126
  v_accvgpr_read_b32 v31, a127
  v_cvt_pk_bf16_f32 v238, v238, v30
  v_cvt_pk_bf16_f32 v239, v239, v31
  v_accvgpr_read_b32 v144, a128
  v_accvgpr_read_b32 v28, a129
  v_accvgpr_read_b32 v145, a130
  v_accvgpr_read_b32 v29, a131
  v_cvt_pk_bf16_f32 v144, v144, v28
  v_cvt_pk_bf16_f32 v145, v145, v29
  v_accvgpr_read_b32 v176, a132
  v_accvgpr_read_b32 v30, a133
  v_accvgpr_read_b32 v177, a134
  v_accvgpr_read_b32 v31, a135
  v_cvt_pk_bf16_f32 v176, v176, v30
  v_cvt_pk_bf16_f32 v177, v177, v31
  v_accvgpr_read_b32 v208, a136
  v_accvgpr_read_b32 v28, a137
  v_accvgpr_read_b32 v209, a138
  v_accvgpr_read_b32 v29, a139
  v_cvt_pk_bf16_f32 v208, v208, v28
  v_cvt_pk_bf16_f32 v209, v209, v29
  v_accvgpr_read_b32 v240, a140
  v_accvgpr_read_b32 v30, a141
  v_accvgpr_read_b32 v241, a142
  v_accvgpr_read_b32 v31, a143
  v_cvt_pk_bf16_f32 v240, v240, v30
  v_cvt_pk_bf16_f32 v241, v241, v31
  v_accvgpr_read_b32 v146, a144
  v_accvgpr_read_b32 v28, a145
  v_accvgpr_read_b32 v147, a146
  v_accvgpr_read_b32 v29, a147
  v_cvt_pk_bf16_f32 v146, v146, v28
  v_cvt_pk_bf16_f32 v147, v147, v29
  v_accvgpr_read_b32 v178, a148
  v_accvgpr_read_b32 v30, a149
  v_accvgpr_read_b32 v179, a150
  v_accvgpr_read_b32 v31, a151
  v_cvt_pk_bf16_f32 v178, v178, v30
  v_cvt_pk_bf16_f32 v179, v179, v31
  v_accvgpr_read_b32 v210, a152
  v_accvgpr_read_b32 v28, a153
  v_accvgpr_read_b32 v211, a154
  v_accvgpr_read_b32 v29, a155
  v_cvt_pk_bf16_f32 v210, v210, v28
  v_cvt_pk_bf16_f32 v211, v211, v29
  v_accvgpr_read_b32 v242, a156
  v_accvgpr_read_b32 v30, a157
  v_accvgpr_read_b32 v243, a158
  v_accvgpr_read_b32 v31, a159
  v_cvt_pk_bf16_f32 v242, v242, v30
  v_cvt_pk_bf16_f32 v243, v243, v31
  v_accvgpr_read_b32 v148, a160
  v_accvgpr_read_b32 v28, a161
  v_accvgpr_read_b32 v149, a162
  v_accvgpr_read_b32 v29, a163
  v_cvt_pk_bf16_f32 v148, v148, v28
  v_cvt_pk_bf16_f32 v149, v149, v29
  v_accvgpr_read_b32 v180, a164
  v_accvgpr_read_b32 v30, a165
  v_accvgpr_read_b32 v181, a166
  v_accvgpr_read_b32 v31, a167
  v_cvt_pk_bf16_f32 v180, v180, v30
  v_cvt_pk_bf16_f32 v181, v181, v31
  v_accvgpr_read_b32 v212, a168
  v_accvgpr_read_b32 v28, a169
  v_accvgpr_read_b32 v213, a170
  v_accvgpr_read_b32 v29, a171
  v_cvt_pk_bf16_f32 v212, v212, v28
  v_cvt_pk_bf16_f32 v213, v213, v29
  v_accvgpr_read_b32 v244, a172
  v_accvgpr_read_b32 v30, a173
  v_accvgpr_read_b32 v245, a174
  v_accvgpr_read_b32 v31, a175
  v_cvt_pk_bf16_f32 v244, v244, v30
  v_cvt_pk_bf16_f32 v245, v245, v31
  v_accvgpr_read_b32 v150, a176
  v_accvgpr_read_b32 v28, a177
  v_accvgpr_read_b32 v151, a178
  v_accvgpr_read_b32 v29, a179
  v_cvt_pk_bf16_f32 v150, v150, v28
  v_cvt_pk_bf16_f32 v151, v151, v29
  v_accvgpr_read_b32 v182, a180
  v_accvgpr_read_b32 v30, a181
  v_accvgpr_read_b32 v183, a182
  v_accvgpr_read_b32 v31, a183
  v_cvt_pk_bf16_f32 v182, v182, v30
  v_cvt_pk_bf16_f32 v183, v183, v31
  v_accvgpr_read_b32 v214, a184
  v_accvgpr_read_b32 v28, a185
  v_accvgpr_read_b32 v215, a186
  v_accvgpr_read_b32 v29, a187
  v_cvt_pk_bf16_f32 v214, v214, v28
  v_cvt_pk_bf16_f32 v215, v215, v29
  v_accvgpr_read_b32 v246, a188
  v_accvgpr_read_b32 v30, a189
  v_accvgpr_read_b32 v247, a190
  v_accvgpr_read_b32 v31, a191
  v_cvt_pk_bf16_f32 v246, v246, v30
  v_cvt_pk_bf16_f32 v247, v247, v31
  v_accvgpr_read_b32 v152, a192
  v_accvgpr_read_b32 v28, a193
  v_accvgpr_read_b32 v153, a194
  v_accvgpr_read_b32 v29, a195
  v_cvt_pk_bf16_f32 v152, v152, v28
  v_cvt_pk_bf16_f32 v153, v153, v29
  v_accvgpr_read_b32 v184, a196
  v_accvgpr_read_b32 v30, a197
  v_accvgpr_read_b32 v185, a198
  v_accvgpr_read_b32 v31, a199
  v_cvt_pk_bf16_f32 v184, v184, v30
  v_cvt_pk_bf16_f32 v185, v185, v31
  v_accvgpr_read_b32 v216, a200
  v_accvgpr_read_b32 v28, a201
  v_accvgpr_read_b32 v217, a202
  v_accvgpr_read_b32 v29, a203
  v_cvt_pk_bf16_f32 v216, v216, v28
  v_cvt_pk_bf16_f32 v217, v217, v29
  v_accvgpr_read_b32 v248, a204
  v_accvgpr_read_b32 v30, a205
  v_accvgpr_read_b32 v249, a206
  v_accvgpr_read_b32 v31, a207
  v_cvt_pk_bf16_f32 v248, v248, v30
  v_cvt_pk_bf16_f32 v249, v249, v31
  v_accvgpr_read_b32 v154, a208
  v_accvgpr_read_b32 v28, a209
  v_accvgpr_read_b32 v155, a210
  v_accvgpr_read_b32 v29, a211
  v_cvt_pk_bf16_f32 v154, v154, v28
  v_cvt_pk_bf16_f32 v155, v155, v29
  v_accvgpr_read_b32 v186, a212
  v_accvgpr_read_b32 v30, a213
  v_accvgpr_read_b32 v187, a214
  v_accvgpr_read_b32 v31, a215
  v_cvt_pk_bf16_f32 v186, v186, v30
  v_cvt_pk_bf16_f32 v187, v187, v31
  v_accvgpr_read_b32 v218, a216
  v_accvgpr_read_b32 v28, a217
  v_accvgpr_read_b32 v219, a218
  v_accvgpr_read_b32 v29, a219
  v_cvt_pk_bf16_f32 v218, v218, v28
  v_cvt_pk_bf16_f32 v219, v219, v29
  v_accvgpr_read_b32 v250, a220
  v_accvgpr_read_b32 v30, a221
  v_accvgpr_read_b32 v251, a222
  v_accvgpr_read_b32 v31, a223
  v_cvt_pk_bf16_f32 v250, v250, v30
  v_cvt_pk_bf16_f32 v251, v251, v31
  v_accvgpr_read_b32 v156, a224
  v_accvgpr_read_b32 v28, a225
  v_accvgpr_read_b32 v157, a226
  v_accvgpr_read_b32 v29, a227
  v_cvt_pk_bf16_f32 v156, v156, v28
  v_cvt_pk_bf16_f32 v157, v157, v29
  v_accvgpr_read_b32 v188, a228
  v_accvgpr_read_b32 v30, a229
  v_accvgpr_read_b32 v189, a230
  v_accvgpr_read_b32 v31, a231
  v_cvt_pk_bf16_f32 v188, v188, v30
  v_cvt_pk_bf16_f32 v189, v189, v31
  v_accvgpr_read_b32 v220, a232
  v_accvgpr_read_b32 v28, a233
  v_accvgpr_read_b32 v221, a234
  v_accvgpr_read_b32 v29, a235
  v_cvt_pk_bf16_f32 v220, v220, v28
  v_cvt_pk_bf16_f32 v221, v221, v29
  v_accvgpr_read_b32 v252, a236
  v_accvgpr_read_b32 v30, a237
  v_accvgpr_read_b32 v253, a238
  v_accvgpr_read_b32 v31, a239
  v_cvt_pk_bf16_f32 v252, v252, v30
  v_cvt_pk_bf16_f32 v253, v253, v31
  v_accvgpr_read_b32 v158, a240
  v_accvgpr_read_b32 v28, a241
  v_accvgpr_read_b32 v159, a242
  v_accvgpr_read_b32 v29, a243
  v_cvt_pk_bf16_f32 v158, v158, v28
  v_cvt_pk_bf16_f32 v159, v159, v29
  v_accvgpr_read_b32 v190, a244
  v_accvgpr_read_b32 v30, a245
  v_accvgpr_read_b32 v191, a246
  v_accvgpr_read_b32 v31, a247
  v_cvt_pk_bf16_f32 v190, v190, v30
  v_cvt_pk_bf16_f32 v191, v191, v31
  v_accvgpr_read_b32 v222, a248
  v_accvgpr_read_b32 v28, a249
  v_accvgpr_read_b32 v223, a250
  v_accvgpr_read_b32 v29, a251
  v_cvt_pk_bf16_f32 v222, v222, v28
  v_cvt_pk_bf16_f32 v223, v223, v29
  v_accvgpr_read_b32 v254, a252
  v_accvgpr_read_b32 v30, a253
  v_accvgpr_read_b32 v255, a254
  v_accvgpr_read_b32 v31, a255
  v_cvt_pk_bf16_f32 v254, v254, v30
  v_cvt_pk_bf16_f32 v255, v255, v31
L_p3_entry:
  s_waitcnt vmcnt(24)
  s_waitcnt lgkmcnt(0)
  s_barrier
  v_mov_b32 v1, 98304
  ds_read_b128 v[20:23], v1 offset:0
  s_waitcnt lgkmcnt(0)
  v_or3_b32 v20, v20, v21, v22
  v_or_b32 v20, v20, v23
  s_nop 0
  v_readfirstlane_b32 s50, v20
  s_nop 3
  s_cmp_eq_u32 s3, 0
  s_cselect_b32 s50, s50, 0
  s_cmp_lg_u32 s50, 0
  s_cbranch_scc1 L_restart
  v_lshlrev_b32 v11, 4, v0
  v_mov_b32 v35, 0
  v_mov_b32 v38, v26
  v_and_b32 v50, 3, v0
  v_lshlrev_b32 v50, 2, v50
  v_mov_b32 v51, 1
  v_and_b32 v1, 15, v0
  v_lshrrev_b32 v2, 4, v0
  v_lshlrev_b32 v48, 10, v2
  v_lshl_add_u32 v48, v1, 4, v48
  s_lshl_b32 s68, s32, 8
  v_add_u32 v48, s68, v48
  v_and_b32 v4, 1, v1
  v_lshlrev_b32 v4, 4, v4
  v_mov_b32 v5, 0x3f80
  v_lshlrev_b32 v5, v4, v5
  v_lshrrev_b32 v4, 1, v1
  v_cmp_eq_u32 vcc, 0, v4
  s_nop 1
  v_cndmask_b32 v52, 0, v5, vcc
  v_accvgpr_write_b32 a96, v52
  v_cmp_eq_u32 vcc, 1, v4
  s_nop 1
  v_cndmask_b32 v52, 0, v5, vcc
  v_accvgpr_write_b32 a97, v52
  v_cmp_eq_u32 vcc, 2, v4
  s_nop 1
  v_cndmask_b32 v52, 0, v5, vcc
  v_accvgpr_write_b32 a98, v52
  v_cmp_eq_u32 vcc, 3, v4
  s_nop 1
  v_cndmask_b32 v52, 0, v5, vcc
  v_accvgpr_write_b32 a99, v52
  s_lshl_b32 s67, s73, 8
  s_lshl_b32 s68, s72, 4
  s_add_u32 s67, s67, s68
  v_add_u32 v49, s67, v1
  v_mul_u32_u24 v49, 896, v49
  s_mul_i32 s67, s74, 448
  s_lshl_b32 s68, s32, 2
  s_add_u32 s67, s67, s68
  v_add_u32 v49, s67, v49
  v_lshl_add_u32 v49, v2, 4, v49
  v_lshlrev_b32 v49, 1, v49
  v_cmp_gt_u32 vcc, 2, v2
  s_mov_b32 s67, 0x7ff00000
  v_mov_b32 v4, s67
  v_cndmask_b32 v49, v4, v49, vcc
  v_add_u32 v6, 65536, v6
  v_add_u32 v7, 65536, v7
  v_add_u32 v8, 65536, v8
  v_add_u32 v9, 65536, v9
  s_or_b32 s67, s49, 0x80
  s_mul_i32 s50, s67, 0x01010101
  s_waitcnt vmcnt(24)
  v_and_b32 v24, 0x87878787, v24
  v_cmp_eq_u32 vcc, s50, v24
  s_nop 0
  s_cmp_eq_u64 vcc, -1
  s_cselect_b64 s[44:45], -1, 0
  s_cbranch_scc0 L_grp_far
L_grp_ok:
  ds_read_b64_tr_b16 a[0:1], v6 offset:0
  ds_read_b64_tr_b16 a[2:3], v6 offset:2048
  ds_read_b64_tr_b16 a[4:5], v6 offset:4096
  ds_read_b64_tr_b16 a[6:7], v6 offset:6144
  ds_read_b64_tr_b16 a[8:9], v6 offset:8192
  ds_read_b64_tr_b16 a[10:11], v6 offset:10240
  ds_read_b64_tr_b16 a[12:13], v6 offset:12288
  ds_read_b64_tr_b16 a[14:15], v6 offset:14336
  ds_read_b64_tr_b16 a[16:17], v6 offset:16384
  ds_read_b64_tr_b16 a[18:19], v6 offset:18432
  ds_read_b64_tr_b16 a[20:21], v6 offset:20480
  ds_read_b64_tr_b16 a[22:23], v6 offset:22528
  ds_read_b64_tr_b16 a[24:25], v6 offset:24576
  ds_read_b64_tr_b16 a[26:27], v6 offset:26624
  s_waitcnt lgkmcnt(6)
  ds_read_b64_tr_b16 a[28:29], v6 offset:28672
  ds_read_b64_tr_b16 a[30:31], v6 offset:30720
  s_barrier
  v_lshlrev_b32 v39, 4, v0
  v_add_u32 v39, s33, v39
  s_cmp_eq_u32 s44, 0
  s_cbranch_scc1 L_p3_far
  v_mfma_f32_16x16x32_bf16 v[96:99], a[0:3], v[128:131], 0
  ds_read_b64_tr_b16 a[32:33], v7 offset:0
  v_mfma_f32_16x16x32_bf16 v[96:99], a[4:7], v[132:135], v[96:99]
  s_mov_b32 s67, 512
  v_mfma_f32_16x16x32_bf16 v[96:99], a[8:11], v[136:139], v[96:99]
  s_add_u32 m0, s33, 98304
  ds_read_b64_tr_b16 a[34:35], v7 offset:2048
  v_mfma_f32_16x16x32_bf16 v[96:99], a[12:15], v[140:143], v[96:99]
  s_waitcnt lgkmcnt(6)
  s_mov_b32 s68, 29184
  buffer_load_dwordx4 v3, s[20:23], s67 offen nt lds
  v_mfma_f32_16x16x32_bf16 v[96:99], a[16:19], v[144:147], v[96:99]
  s_add_u32 m0, s33, 102400
  ds_read_b64_tr_b16 a[36:37], v7 offset:4096
  v_mfma_f32_16x16x32_bf16 v[96:99], a[20:23], v[148:151], v[96:99]
  s_waitcnt lgkmcnt(3)
  s_mov_b32 s67, 57856
  buffer_load_dwordx4 v3, s[20:23], s68 offen nt lds
  v_mfma_f32_16x16x32_bf16 v[96:99], a[24:27], v[152:155], v[96:99]
  s_add_u32 m0, s33, 106496
  ds_read_b64_tr_b16 a[38:39], v7 offset:6144
  v_mfma_f32_16x16x32_bf16 v[96:99], a[28:31], v[156:159], v[96:99]
  s_mov_b32 s68, 86528
  buffer_load_dwordx4 v3, s[20:23], s67 offen nt lds
  v_mfma_f32_16x16x32_bf16 v[100:103], a[0:3], v[160:163], 0
  s_add_u32 m0, s33, 110592
  ds_read_b64_tr_b16 a[40:41], v7 offset:8192
  v_mfma_f32_16x16x32_bf16 v[100:103], a[4:7], v[164:167], v[100:103]
  s_mov_b32 s67, 115200
  buffer_load_dwordx4 v3, s[20:23], s68 offen nt lds
  v_mfma_f32_16x16x32_bf16 v[100:103], a[8:11], v[168:171], v[100:103]
  s_add_u32 m0, s33, 114688
  ds_read_b64_tr_b16 a[42:43], v7 offset:10240
  v_mfma_f32_16x16x32_bf16 v[100:103], a[12:15], v[172:175], v[100:103]
  s_mov_b32 s68, 143872
  buffer_load_dwordx4 v3, s[20:23], s67 offen nt lds
  v_mfma_f32_16x16x32_bf16 v[100:103], a[16:19], v[176:179], v[100:103]
  s_add_u32 m0, s33, 118784
  ds_read_b64_tr_b16 a[44:45], v7 offset:12288
  v_mfma_f32_16x16x32_bf16 v[100:103], a[20:23], v[180:183], v[100:103]
  s_mov_b32 s67, 172544
  buffer_load_dwordx4 v3, s[20:23], s68 offen nt lds
  v_mfma_f32_16x16x32_bf16 v[100:103], a[24:27], v[184:187], v[100:103]
  s_add_u32 m0, s33, 122880
  ds_read_b64_tr_b16 a[46:47], v7 offset:14336
  v_mfma_f32_16x16x32_bf16 v[100:103], a[28:31], v[188:191], v[100:103]
  buffer_load_dwordx4 v3, s[20:23], s67 offen nt lds
  v_mfma_f32_16x16x32_bf16 v[104:107], a[0:3], v[192:195], 0
  ds_read_b64_tr_b16 a[48:49], v7 offset:16384
  v_mul_f32 v96, v96, v12
  v_mfma_f32_16x16x32_bf16 v[104:107], a[4:7], v[196:199], v[104:107]
  s_mov_b32 s68, 201216
  v_mul_f32 v97, v97, v12
  v_mul_f32 v98, v98, v12
  v_mfma_f32_16x16x32_bf16 v[104:107], a[8:11], v[200:203], v[104:107]
  s_add_u32 m0, s33, 126976
  ds_read_b64_tr_b16 a[50:51], v7 offset:18432
  v_mul_f32 v99, v99, v12
  v_mfma_f32_16x16x32_bf16 v[104:107], a[12:15], v[204:207], v[104:107]
  buffer_load_dwordx4 v3, s[20:23], s68 offen nt lds
  v_mfma_f32_16x16x32_bf16 v[104:107], a[16:19], v[208:211], v[104:107]
  s_mov_b32 s67, 640
  ds_read_b64_tr_b16 a[52:53], v7 offset:20480
  v_cvt_pk_bf16_f32 v16, v96, v97
  v_mfma_f32_16x16x32_bf16 v[104:107], a[20:23], v[212:215], v[104:107]
  buffer_load_dwordx4 a[100:103], v3, s[20:23], s67 offen nt
  v_mfma_f32_16x16x32_bf16 v[104:107], a[24:27], v[216:219], v[104:107]
  s_mov_b32 s68, 29312
  ds_read_b64_tr_b16 a[54:55], v7 offset:22528
  v_cvt_pk_bf16_f32 v17, v98, v99
  v_mfma_f32_16x16x32_bf16 v[104:107], a[28:31], v[220:223], v[104:107]
  buffer_load_dwordx4 a[104:107], v3, s[20:23], s68 offen nt
  v_mfma_f32_16x16x32_bf16 v[108:111], a[0:3], v[224:227], 0
  ds_read_b64_tr_b16 a[56:57], v7 offset:24576
  v_mul_f32 v100, v100, v13
  v_mfma_f32_16x16x32_bf16 v[108:111], a[4:7], v[228:231], v[108:111]
  v_mul_f32 v101, v101, v13
  v_mul_f32 v102, v102, v13
  v_mfma_f32_16x16x32_bf16 v[108:111], a[8:11], v[232:235], v[108:111]
  s_mov_b32 s67, 57984
  ds_read_b64_tr_b16 a[58:59], v7 offset:26624
  v_mul_f32 v103, v103, v13
  v_mfma_f32_16x16x32_bf16 v[108:111], a[12:15], v[236:239], v[108:111]
  buffer_load_dwordx4 a[108:111], v3, s[20:23], s67 offen nt
  v_mfma_f32_16x16x32_bf16 v[108:111], a[16:19], v[240:243], v[108:111]
  s_waitcnt lgkmcnt(8)
  s_mov_b32 s68, 86656
  ds_read_b64_tr_b16 a[60:61], v7 offset:28672
  v_cvt_pk_bf16_f32 v20, v100, v101
  v_mfma_f32_16x16x32_bf16 v[108:111], a[20:23], v[244:247], v[108:111]
  buffer_load_dwordx4 a[112:115], v3, s[20:23], s68 offen nt
  v_mfma_f32_16x16x32_bf16 v[108:111], a[24:27], v[248:251], v[108:111]
  s_mov_b32 s67, 115328
  ds_read_b64_tr_b16 a[62:63], v7 offset:30720
  v_cvt_pk_bf16_f32 v21, v102, v103
  v_mfma_f32_16x16x32_bf16 v[108:111], a[28:31], v[252:255], v[108:111]
  s_waitcnt lgkmcnt(12)
  buffer_load_dwordx4 a[116:119], v3, s[20:23], s67 offen nt
  v_mfma_f32_16x16x32_bf16 v[112:115], a[32:35], v[128:131], 0
  ds_read_b64_tr_b16 a[0:1], v8 offset:0
  v_mul_f32 v104, v104, v14
  v_mfma_f32_16x16x32_bf16 v[112:115], a[36:39], v[132:135], v[112:115]
  s_waitcnt lgkmcnt(9)
  v_mul_f32 v105, v105, v14
  v_mul_f32 v106, v106, v14
  v_mfma_f32_16x16x32_bf16 v[112:115], a[40:43], v[136:139], v[112:115]
  s_mov_b32 s68, 144000
  ds_read_b64_tr_b16 a[2:3], v8 offset:2048
  v_mul_f32 v107, v107, v14
  v_mfma_f32_16x16x32_bf16 v[112:115], a[44:47], v[140:143], v[112:115]
  s_waitcnt lgkmcnt(6)
  buffer_load_dwordx4 a[120:123], v3, s[20:23], s68 offen nt
  v_mfma_f32_16x16x32_bf16 v[112:115], a[48:51], v[144:147], v[112:115]
  s_mov_b32 s67, 172672
  ds_read_b64_tr_b16 a[4:5], v8 offset:4096
  v_cvt_pk_bf16_f32 v24, v104, v105
  v_mfma_f32_16x16x32_bf16 v[112:115], a[52:55], v[148:151], v[112:115]
  s_waitcnt lgkmcnt(3)
  buffer_load_dwordx4 a[124:127], v3, s[20:23], s67 offen nt
  v_subrev_u32 v7, 131072, v7
  v_mfma_f32_16x16x32_bf16 v[112:115], a[56:59], v[152:155], v[112:115]
  s_mov_b32 s68, 201344
  ds_read_b64_tr_b16 a[6:7], v8 offset:6144
  v_cvt_pk_bf16_f32 v25, v106, v107
  v_mfma_f32_16x16x32_bf16 v[112:115], a[60:63], v[156:159], v[112:115]
  buffer_load_dwordx4 a[128:131], v3, s[20:23], s68 offen nt
  v_mfma_f32_16x16x32_bf16 v[116:119], a[32:35], v[160:163], 0
  ds_read_b64_tr_b16 a[8:9], v8 offset:8192
  v_mul_f32 v108, v108, v15
  v_mfma_f32_16x16x32_bf16 v[116:119], a[36:39], v[164:167], v[116:119]
  v_mul_f32 v109, v109, v15
  v_mul_f32 v110, v110, v15
  v_mfma_f32_16x16x32_bf16 v[116:119], a[40:43], v[168:171], v[116:119]
  s_mov_b32 s67, 768
  ds_read_b64_tr_b16 a[10:11], v8 offset:10240
  v_mul_f32 v111, v111, v15
  v_mfma_f32_16x16x32_bf16 v[116:119], a[44:47], v[172:175], v[116:119]
  buffer_load_dwordx4 a[132:135], v3, s[20:23], s67 offen nt
  v_mfma_f32_16x16x32_bf16 v[116:119], a[48:51], v[176:179], v[116:119]
  s_mov_b32 s68, 29440
  ds_read_b64_tr_b16 a[12:13], v8 offset:12288
  v_cvt_pk_bf16_f32 v28, v108, v109
  v_mfma_f32_16x16x32_bf16 v[116:119], a[52:55], v[180:183], v[116:119]
  buffer_load_dwordx4 a[136:139], v3, s[20:23], s68 offen nt
  v_mfma_f32_16x16x32_bf16 v[116:119], a[56:59], v[184:187], v[116:119]
  s_mov_b32 s67, 58112
  ds_read_b64_tr_b16 a[14:15], v8 offset:14336
  v_cvt_pk_bf16_f32 v29, v110, v111
  v_mfma_f32_16x16x32_bf16 v[116:119], a[60:63], v[188:191], v[116:119]
  buffer_load_dwordx4 a[140:143], v3, s[20:23], s67 offen nt
  v_mfma_f32_16x16x32_bf16 v[120:123], a[32:35], v[192:195], 0
  ds_read_b64_tr_b16 a[16:17], v8 offset:16384
  v_mul_f32 v112, v112, v12
  v_mfma_f32_16x16x32_bf16 v[120:123], a[36:39], v[196:199], v[120:123]
  v_mul_f32 v113, v113, v12
  v_mul_f32 v114, v114, v12
  v_mfma_f32_16x16x32_bf16 v[120:123], a[40:43], v[200:203], v[120:123]
  s_mov_b32 s68, 86784
  ds_read_b64_tr_b16 a[18:19], v8 offset:18432
  v_mul_f32 v115, v115, v12
  v_mfma_f32_16x16x32_bf16 v[120:123], a[44:47], v[204:207], v[120:123]
  buffer_load_dwordx4 a[144:147], v3, s[20:23], s68 offen nt
  v_mfma_f32_16x16x32_bf16 v[120:123], a[48:51], v[208:211], v[120:123]
  s_mov_b32 s67, 115456
  ds_read_b64_tr_b16 a[20:21], v8 offset:20480
  v_cvt_pk_bf16_f32 v18, v112, v113
  v_mfma_f32_16x16x32_bf16 v[120:123], a[52:55], v[212:215], v[120:123]
  buffer_load_dwordx4 a[148:151], v3, s[20:23], s67 offen nt
  v_mfma_f32_16x16x32_bf16 v[120:123], a[56:59], v[216:219], v[120:123]
  s_mov_b32 s68, 144128
  ds_read_b64_tr_b16 a[22:23], v8 offset:22528
  v_cvt_pk_bf16_f32 v19, v114, v115
  v_mfma_f32_16x16x32_bf16 v[120:123], a[60:63], v[220:223], v[120:123]
  buffer_load_dwordx4 a[152:155], v3, s[20:23], s68 offen nt
  v_mfma_f32_16x16x32_bf16 v[124:127], a[32:35], v[224:227], 0
  ds_read_b64_tr_b16 a[24:25], v8 offset:24576
  v_mul_f32 v116, v116, v13
  v_mfma_f32_16x16x32_bf16 v[124:127], a[36:39], v[228:231], v[124:127]
  v_mul_f32 v117, v117, v13
  v_mul_f32 v118, v118, v13
  v_mfma_f32_16x16x32_bf16 v[124:127], a[40:43], v[232:235], v[124:127]
  s_add_u32 s69, s60, 0
  ds_read_b64_tr_b16 a[26:27], v8 offset:26624
  v_mul_f32 v119, v119, v13
  v_mfma_f32_16x16x32_bf16 v[124:127], a[44:47], v[236:239], v[124:127]
  buffer_store_dwordx4 v[16:19], v11, s[56:59], s69 offen
  v_mfma_f32_16x16x32_bf16 v[124:127], a[48:51], v[240:243], v[124:127]
  s_waitcnt lgkmcnt(8)
  s_mov_b32 s67, 172800
  ds_read_b64_tr_b16 a[28:29], v8 offset:28672
  v_cvt_pk_bf16_f32 v22, v116, v117
  v_mfma_f32_16x16x32_bf16 v[124:127], a[52:55], v[244:247], v[124:127]
  buffer_load_dwordx4 a[156:159], v3, s[20:23], s67 offen nt
  v_mfma_f32_16x16x32_bf16 v[124:127], a[56:59], v[248:251], v[124:127]
  s_mov_b32 s68, 201472
  ds_read_b64_tr_b16 a[30:31], v8 offset:30720
  v_cvt_pk_bf16_f32 v23, v118, v119
  v_mfma_f32_16x16x32_bf16 v[124:127], a[60:63], v[252:255], v[124:127]
  s_waitcnt lgkmcnt(12)
  buffer_load_dwordx4 a[160:163], v3, s[20:23], s68 offen nt
  v_mfma_f32_16x16x32_bf16 v[96:99], a[0:3], v[128:131], 0
  ds_read_b64_tr_b16 a[32:33], v9 offset:0
  v_mul_f32 v120, v120, v14
  v_mfma_f32_16x16x32_bf16 v[96:99], a[4:7], v[132:135], v[96:99]
  s_waitcnt lgkmcnt(9)
  v_mul_f32 v121, v121, v14
  v_mul_f32 v122, v122, v14
  v_mfma_f32_16x16x32_bf16 v[96:99], a[8:11], v[136:139], v[96:99]
  ds_read_b64_tr_b16 a[34:35], v9 offset:2048
  v_mul_f32 v123, v123, v14
  v_mfma_f32_16x16x32_bf16 v[96:99], a[12:15], v[140:143], v[96:99]
  s_waitcnt lgkmcnt(6)
  v_mfma_f32_16x16x32_bf16 v[96:99], a[16:19], v[144:147], v[96:99]
  ds_read_b64_tr_b16 a[36:37], v9 offset:4096
  v_cvt_pk_bf16_f32 v26, v120, v121
  v_mfma_f32_16x16x32_bf16 v[96:99], a[20:23], v[148:151], v[96:99]
  s_waitcnt lgkmcnt(3)
  v_subrev_u32 v8, 131072, v8
  v_mfma_f32_16x16x32_bf16 v[96:99], a[24:27], v[152:155], v[96:99]
  ds_read_b64_tr_b16 a[38:39], v9 offset:6144
  v_cvt_pk_bf16_f32 v27, v122, v123
  v_mfma_f32_16x16x32_bf16 v[96:99], a[28:31], v[156:159], v[96:99]
  v_mfma_f32_16x16x32_bf16 v[100:103], a[0:3], v[160:163], 0
  ds_read_b64_tr_b16 a[40:41], v9 offset:8192
  v_mul_f32 v124, v124, v15
  v_mfma_f32_16x16x32_bf16 v[100:103], a[4:7], v[164:167], v[100:103]
  v_mul_f32 v125, v125, v15
  v_mul_f32 v126, v126, v15
  v_mfma_f32_16x16x32_bf16 v[100:103], a[8:11], v[168:171], v[100:103]
  s_add_u32 s70, s60, 16384
  ds_read_b64_tr_b16 a[42:43], v9 offset:10240
  v_mul_f32 v127, v127, v15
  v_mfma_f32_16x16x32_bf16 v[100:103], a[12:15], v[172:175], v[100:103]
  buffer_store_dwordx4 v[20:23], v11, s[56:59], s70 offen
  v_mfma_f32_16x16x32_bf16 v[100:103], a[16:19], v[176:179], v[100:103]
  ds_read_b64_tr_b16 a[44:45], v9 offset:12288
  v_cvt_pk_bf16_f32 v30, v124, v125
  v_mfma_f32_16x16x32_bf16 v[100:103], a[20:23], v[180:183], v[100:103]
  v_mfma_f32_16x16x32_bf16 v[100:103], a[24:27], v[184:187], v[100:103]
  ds_read_b64_tr_b16 a[46:47], v9 offset:14336
  v_cvt_pk_bf16_f32 v31, v126, v127
  v_mfma_f32_16x16x32_bf16 v[100:103], a[28:31], v[188:191], v[100:103]
  v_mfma_f32_16x16x32_bf16 v[104:107], a[0:3], v[192:195], 0
  ds_read_b64_tr_b16 a[48:49], v9 offset:16384
  v_mul_f32 v96, v96, v12
  v_mfma_f32_16x16x32_bf16 v[104:107], a[4:7], v[196:199], v[104:107]
  v_mul_f32 v97, v97, v12
  v_mul_f32 v98, v98, v12
  v_mfma_f32_16x16x32_bf16 v[104:107], a[8:11], v[200:203], v[104:107]
  ds_read_b64_tr_b16 a[50:51], v9 offset:18432
  v_mul_f32 v99, v99, v12
  v_mfma_f32_16x16x32_bf16 v[104:107], a[12:15], v[204:207], v[104:107]
  v_mfma_f32_16x16x32_bf16 v[104:107], a[16:19], v[208:211], v[104:107]
  ds_read_b64_tr_b16 a[52:53], v9 offset:20480
  v_cvt_pk_bf16_f32 v16, v96, v97
  v_mfma_f32_16x16x32_bf16 v[104:107], a[20:23], v[212:215], v[104:107]
  v_subrev_u32 v6, 131072, v6
  v_mfma_f32_16x16x32_bf16 v[104:107], a[24:27], v[216:219], v[104:107]
  ds_read_b64_tr_b16 a[54:55], v9 offset:22528
  v_cvt_pk_bf16_f32 v17, v98, v99
  v_mfma_f32_16x16x32_bf16 v[104:107], a[28:31], v[220:223], v[104:107]
  v_mfma_f32_16x16x32_bf16 v[108:111], a[0:3], v[224:227], 0
  ds_read_b64_tr_b16 a[56:57], v9 offset:24576
  v_mul_f32 v100, v100, v13
  v_mfma_f32_16x16x32_bf16 v[108:111], a[4:7], v[228:231], v[108:111]
  v_mul_f32 v101, v101, v13
  v_mul_f32 v102, v102, v13
  v_mfma_f32_16x16x32_bf16 v[108:111], a[8:11], v[232:235], v[108:111]
  s_add_u32 s69, s60, 32768
  ds_read_b64_tr_b16 a[58:59], v9 offset:26624
  v_mul_f32 v103, v103, v13
  v_mfma_f32_16x16x32_bf16 v[108:111], a[12:15], v[236:239], v[108:111]
  s_waitcnt vmcnt(42)
  s_barrier
  buffer_store_dwordx4 v[24:27], v11, s[56:59], s69 offen
  v_mfma_f32_16x16x32_bf16 v[108:111], a[16:19], v[240:243], v[108:111]
  s_waitcnt lgkmcnt(8)
  ds_read_b64_tr_b16 a[60:61], v9 offset:28672
  v_cvt_pk_bf16_f32 v20, v100, v101
  v_mfma_f32_16x16x32_bf16 v[108:111], a[20:23], v[244:247], v[108:111]
  v_mfma_f32_16x16x32_bf16 v[108:111], a[24:27], v[248:251], v[108:111]
  ds_read_b64_tr_b16 a[62:63], v9 offset:30720
  v_cvt_pk_bf16_f32 v21, v102, v103
  v_mfma_f32_16x16x32_bf16 v[108:111], a[28:31], v[252:255], v[108:111]
  s_waitcnt lgkmcnt(12)
  v_mfma_f32_16x16x32_bf16 v[112:115], a[32:35], v[128:131], 0
  ds_read_b64_tr_b16 a[0:1], v6 offset:0
  v_mul_f32 v104, v104, v14
  v_mfma_f32_16x16x32_bf16 v[112:115], a[36:39], v[132:135], v[112:115]
  s_waitcnt lgkmcnt(9)
  v_mul_f32 v105, v105, v14
  v_mul_f32 v106, v106, v14
  v_mfma_f32_16x16x32_bf16 v[112:115], a[40:43], v[136:139], v[112:115]
  s_add_u32 s70, s60, 49152
  ds_read_b64_tr_b16 a[2:3], v6 offset:2048
  v_mul_f32 v107, v107, v14
  v_mfma_f32_16x16x32_bf16 v[112:115], a[44:47], v[140:143], v[112:115]
  s_waitcnt lgkmcnt(6)
  buffer_store_dwordx4 v[28:31], v11, s[56:59], s70 offen
  v_mfma_f32_16x16x32_bf16 v[112:115], a[48:51], v[144:147], v[112:115]
  ds_read_b64_tr_b16 a[4:5], v6 offset:4096
  v_cvt_pk_bf16_f32 v24, v104, v105
  v_mfma_f32_16x16x32_bf16 v[112:115], a[52:55], v[148:151], v[112:115]
  s_waitcnt lgkmcnt(3)
  v_subrev_u32 v9, 131072, v9
  v_mfma_f32_16x16x32_bf16 v[112:115], a[56:59], v[152:155], v[112:115]
  ds_read_b64_tr_b16 a[6:7], v6 offset:6144
  v_cvt_pk_bf16_f32 v25, v106, v107
  v_mfma_f32_16x16x32_bf16 v[112:115], a[60:63], v[156:159], v[112:115]
  v_mfma_f32_16x16x32_bf16 v[116:119], a[32:35], v[160:163], 0
  ds_read_b64_tr_b16 a[8:9], v6 offset:8192
  v_mul_f32 v108, v108, v15
  v_mfma_f32_16x16x32_bf16 v[116:119], a[36:39], v[164:167], v[116:119]
  v_mul_f32 v109, v109, v15
  v_mul_f32 v110, v110, v15
  v_mfma_f32_16x16x32_bf16 v[116:119], a[40:43], v[168:171], v[116:119]
  ds_read_b64_tr_b16 a[10:11], v6 offset:10240
  v_mul_f32 v111, v111, v15
  v_mfma_f32_16x16x32_bf16 v[116:119], a[44:47], v[172:175], v[116:119]
  v_mfma_f32_16x16x32_bf16 v[116:119], a[48:51], v[176:179], v[116:119]
  ds_read_b64_tr_b16 a[12:13], v6 offset:12288
  v_cvt_pk_bf16_f32 v28, v108, v109
  v_mfma_f32_16x16x32_bf16 v[116:119], a[52:55], v[180:183], v[116:119]
  v_mfma_f32_16x16x32_bf16 v[116:119], a[56:59], v[184:187], v[116:119]
  ds_read_b64_tr_b16 a[14:15], v6 offset:14336
  v_cvt_pk_bf16_f32 v29, v110, v111
  v_mfma_f32_16x16x32_bf16 v[116:119], a[60:63], v[188:191], v[116:119]
  v_mfma_f32_16x16x32_bf16 v[120:123], a[32:35], v[192:195], 0
  ds_read_b64_tr_b16 a[16:17], v6 offset:16384
  v_mul_f32 v112, v112, v12
  v_mfma_f32_16x16x32_bf16 v[120:123], a[36:39], v[196:199], v[120:123]
  v_mul_f32 v113, v113, v12
  v_mul_f32 v114, v114, v12
  v_mfma_f32_16x16x32_bf16 v[120:123], a[40:43], v[200:203], v[120:123]
  ds_read_b64_tr_b16 a[18:19], v6 offset:18432
  v_mul_f32 v115, v115, v12
  v_mfma_f32_16x16x32_bf16 v[120:123], a[44:47], v[204:207], v[120:123]
  v_mfma_f32_16x16x32_bf16 v[120:123], a[48:51], v[208:211], v[120:123]
  ds_read_b64_tr_b16 a[20:21], v6 offset:20480
  v_cvt_pk_bf16_f32 v18, v112, v113
  v_mfma_f32_16x16x32_bf16 v[120:123], a[52:55], v[212:215], v[120:123]
  v_mfma_f32_16x16x32_bf16 v[120:123], a[56:59], v[216:219], v[120:123]
  ds_read_b64_tr_b16 a[22:23], v6 offset:22528
  v_cvt_pk_bf16_f32 v19, v114, v115
  v_mfma_f32_16x16x32_bf16 v[120:123], a[60:63], v[220:223], v[120:123]
  v_mfma_f32_16x16x32_bf16 v[124:127], a[32:35], v[224:227], 0
  ds_read_b64_tr_b16 a[24:25], v6 offset:24576
  v_mul_f32 v116, v116, v13
  v_mfma_f32_16x16x32_bf16 v[124:127], a[36:39], v[228:231], v[124:127]
  v_mul_f32 v117, v117, v13
  v_mul_f32 v118, v118, v13
  v_mfma_f32_16x16x32_bf16 v[124:127], a[40:43], v[232:235], v[124:127]
  s_add_u32 s69, s60, 262144
  ds_read_b64_tr_b16 a[26:27], v6 offset:26624
  v_mul_f32 v119, v119, v13
  v_mfma_f32_16x16x32_bf16 v[124:127], a[44:47], v[236:239], v[124:127]
  buffer_store_dwordx4 v[16:19], v11, s[56:59], s69 offen
  v_mfma_f32_16x16x32_bf16 v[124:127], a[48:51], v[240:243], v[124:127]
  s_waitcnt lgkmcnt(8)
  s_waitcnt vmcnt(1)
  s_add_u32 s55, s75, 0
  ds_read_b64_tr_b16 a[28:29], v6 offset:28672
  v_cvt_pk_bf16_f32 v22, v116, v117
  v_mfma_f32_16x16x32_bf16 v[124:127], a[52:55], v[244:247], v[124:127]
  buffer_store_byte v51, v35, s[36:39], s55 offen
  v_mfma_f32_16x16x32_bf16 v[124:127], a[56:59], v[248:251], v[124:127]
  ds_read_b64_tr_b16 a[30:31], v6 offset:30720
  v_cvt_pk_bf16_f32 v23, v118, v119
  v_mfma_f32_16x16x32_bf16 v[124:127], a[60:63], v[252:255], v[124:127]
  s_waitcnt lgkmcnt(12)
  v_mfma_f32_16x16x32_bf16 v[96:99], a[0:3], v[128:131], 0
  ds_read_b64_tr_b16 a[32:33], v7 offset:0
  v_mul_f32 v120, v120, v14
  v_mfma_f32_16x16x32_bf16 v[96:99], a[4:7], v[132:135], v[96:99]
  s_waitcnt lgkmcnt(9)
  v_mul_f32 v121, v121, v14
  v_mul_f32 v122, v122, v14
  v_mfma_f32_16x16x32_bf16 v[96:99], a[8:11], v[136:139], v[96:99]
  ds_read_b64_tr_b16 a[34:35], v7 offset:2048
  v_mul_f32 v123, v123, v14
  v_mfma_f32_16x16x32_bf16 v[96:99], a[12:15], v[140:143], v[96:99]
  s_waitcnt lgkmcnt(6)
  v_mfma_f32_16x16x32_bf16 v[96:99], a[16:19], v[144:147], v[96:99]
  ds_read_b64_tr_b16 a[36:37], v7 offset:4096
  v_cvt_pk_bf16_f32 v26, v120, v121
  v_mfma_f32_16x16x32_bf16 v[96:99], a[20:23], v[148:151], v[96:99]
  s_waitcnt lgkmcnt(3)
  v_mfma_f32_16x16x32_bf16 v[96:99], a[24:27], v[152:155], v[96:99]
  ds_read_b64_tr_b16 a[38:39], v7 offset:6144
  v_cvt_pk_bf16_f32 v27, v122, v123
  v_mfma_f32_16x16x32_bf16 v[96:99], a[28:31], v[156:159], v[96:99]
  v_mfma_f32_16x16x32_bf16 v[100:103], a[0:3], v[160:163], 0
  ds_read_b64_tr_b16 a[40:41], v7 offset:8192
  v_mul_f32 v124, v124, v15
  v_mfma_f32_16x16x32_bf16 v[100:103], a[4:7], v[164:167], v[100:103]
  v_mul_f32 v125, v125, v15
  v_mul_f32 v126, v126, v15
  v_mfma_f32_16x16x32_bf16 v[100:103], a[8:11], v[168:171], v[100:103]
  s_add_u32 s70, s60, 278528
  ds_read_b64_tr_b16 a[42:43], v7 offset:10240
  v_mul_f32 v127, v127, v15
  v_mfma_f32_16x16x32_bf16 v[100:103], a[12:15], v[172:175], v[100:103]
  buffer_store_dwordx4 v[20:23], v11, s[56:59], s70 offen
  v_mfma_f32_16x16x32_bf16 v[100:103], a[16:19], v[176:179], v[100:103]
  ds_read_b64_tr_b16 a[44:45], v7 offset:12288
  v_cvt_pk_bf16_f32 v30, v124, v125
  v_mfma_f32_16x16x32_bf16 v[100:103], a[20:23], v[180:183], v[100:103]
  v_mfma_f32_16x16x32_bf16 v[100:103], a[24:27], v[184:187], v[100:103]
  ds_read_b64_tr_b16 a[46:47], v7 offset:14336
  v_cvt_pk_bf16_f32 v31, v126, v127
  v_mfma_f32_16x16x32_bf16 v[100:103], a[28:31], v[188:191], v[100:103]
  v_mfma_f32_16x16x32_bf16 v[104:107], a[0:3], v[192:195], 0
  ds_read_b64_tr_b16 a[48:49], v7 offset:16384
  v_mul_f32 v96, v96, v12
  v_mfma_f32_16x16x32_bf16 v[104:107], a[4:7], v[196:199], v[104:107]
  v_mul_f32 v97, v97, v12
  v_mul_f32 v98, v98, v12
  v_mfma_f32_16x16x32_bf16 v[104:107], a[8:11], v[200:203], v[104:107]
  ds_read_b64_tr_b16 a[50:51], v7 offset:18432
  v_mul_f32 v99, v99, v12
  v_mfma_f32_16x16x32_bf16 v[104:107], a[12:15], v[204:207], v[104:107]
  v_mfma_f32_16x16x32_bf16 v[104:107], a[16:19], v[208:211], v[104:107]
  ds_read_b64_tr_b16 a[52:53], v7 offset:20480
  v_cvt_pk_bf16_f32 v16, v96, v97
  v_mfma_f32_16x16x32_bf16 v[104:107], a[20:23], v[212:215], v[104:107]
  v_mfma_f32_16x16x32_bf16 v[104:107], a[24:27], v[216:219], v[104:107]
  ds_read_b64_tr_b16 a[54:55], v7 offset:22528
  v_cvt_pk_bf16_f32 v17, v98, v99
  v_mfma_f32_16x16x32_bf16 v[104:107], a[28:31], v[220:223], v[104:107]
  v_mfma_f32_16x16x32_bf16 v[108:111], a[0:3], v[224:227], 0
  ds_read_b64_tr_b16 a[56:57], v7 offset:24576
  v_mul_f32 v100, v100, v13
  v_mfma_f32_16x16x32_bf16 v[108:111], a[4:7], v[228:231], v[108:111]
  v_mul_f32 v101, v101, v13
  v_mul_f32 v102, v102, v13
  v_mfma_f32_16x16x32_bf16 v[108:111], a[8:11], v[232:235], v[108:111]
  s_add_u32 s69, s60, 294912
  ds_read_b64_tr_b16 a[58:59], v7 offset:26624
  v_mul_f32 v103, v103, v13
  v_mfma_f32_16x16x32_bf16 v[108:111], a[12:15], v[236:239], v[108:111]
  buffer_store_dwordx4 v[24:27], v11, s[56:59], s69 offen
  v_mfma_f32_16x16x32_bf16 v[108:111], a[16:19], v[240:243], v[108:111]
  s_waitcnt lgkmcnt(8)
  ds_read_b64_tr_b16 a[60:61], v7 offset:28672
  v_cvt_pk_bf16_f32 v20, v100, v101
  v_mfma_f32_16x16x32_bf16 v[108:111], a[20:23], v[244:247], v[108:111]
  v_mfma_f32_16x16x32_bf16 v[108:111], a[24:27], v[248:251], v[108:111]
  ds_read_b64_tr_b16 a[62:63], v7 offset:30720
  v_cvt_pk_bf16_f32 v21, v102, v103
  v_mfma_f32_16x16x32_bf16 v[108:111], a[28:31], v[252:255], v[108:111]
  s_waitcnt lgkmcnt(12)
  v_mfma_f32_16x16x32_bf16 v[112:115], a[32:35], v[128:131], 0
  ds_read_b64_tr_b16 a[0:1], v8 offset:0
  v_mul_f32 v104, v104, v14
  v_mfma_f32_16x16x32_bf16 v[112:115], a[36:39], v[132:135], v[112:115]
  s_waitcnt lgkmcnt(9)
  v_mul_f32 v105, v105, v14
  v_mul_f32 v106, v106, v14
  v_mfma_f32_16x16x32_bf16 v[112:115], a[40:43], v[136:139], v[112:115]
  s_add_u32 s70, s60, 311296
  ds_read_b64_tr_b16 a[2:3], v8 offset:2048
  v_mul_f32 v107, v107, v14
  v_mfma_f32_16x16x32_bf16 v[112:115], a[44:47], v[140:143], v[112:115]
  s_waitcnt lgkmcnt(6)
  buffer_store_dwordx4 v[28:31], v11, s[56:59], s70 offen
  v_mfma_f32_16x16x32_bf16 v[112:115], a[48:51], v[144:147], v[112:115]
  ds_read_b64_tr_b16 a[4:5], v8 offset:4096
  v_cvt_pk_bf16_f32 v24, v104, v105
  v_mfma_f32_16x16x32_bf16 v[112:115], a[52:55], v[148:151], v[112:115]
  s_waitcnt lgkmcnt(3)
  v_add_u32 v7, 32768, v7
  v_mfma_f32_16x16x32_bf16 v[112:115], a[56:59], v[152:155], v[112:115]
  s_add_u32 s54, s78, 0
  ds_read_b64_tr_b16 a[6:7], v8 offset:6144
  v_cvt_pk_bf16_f32 v25, v106, v107
  v_mfma_f32_16x16x32_bf16 v[112:115], a[60:63], v[156:159], v[112:115]
  buffer_load_dword v53, v50, s[36:39], s54 offen sc1
  v_mfma_f32_16x16x32_bf16 v[116:119], a[32:35], v[160:163], 0
  ds_read_b64_tr_b16 a[8:9], v8 offset:8192
  v_mul_f32 v108, v108, v15
  v_mfma_f32_16x16x32_bf16 v[116:119], a[36:39], v[164:167], v[116:119]
  v_mul_f32 v109, v109, v15
  v_mul_f32 v110, v110, v15
  v_mfma_f32_16x16x32_bf16 v[116:119], a[40:43], v[168:171], v[116:119]
  ds_read_b64_tr_b16 a[10:11], v8 offset:10240
  v_mul_f32 v111, v111, v15
  v_mfma_f32_16x16x32_bf16 v[116:119], a[44:47], v[172:175], v[116:119]
  v_mfma_f32_16x16x32_bf16 v[116:119], a[48:51], v[176:179], v[116:119]
  ds_read_b64_tr_b16 a[12:13], v8 offset:12288
  v_cvt_pk_bf16_f32 v28, v108, v109
  v_mfma_f32_16x16x32_bf16 v[116:119], a[52:55], v[180:183], v[116:119]
  v_mfma_f32_16x16x32_bf16 v[116:119], a[56:59], v[184:187], v[116:119]
  ds_read_b64_tr_b16 a[14:15], v8 offset:14336
  v_cvt_pk_bf16_f32 v29, v110, v111
  v_mfma_f32_16x16x32_bf16 v[116:119], a[60:63], v[188:191], v[116:119]
  v_mfma_f32_16x16x32_bf16 v[120:123], a[32:35], v[192:195], 0
  ds_read_b64_tr_b16 a[16:17], v8 offset:16384
  v_mul_f32 v112, v112, v12
  v_mfma_f32_16x16x32_bf16 v[120:123], a[36:39], v[196:199], v[120:123]
  v_mul_f32 v113, v113, v12
  v_mul_f32 v114, v114, v12
  v_mfma_f32_16x16x32_bf16 v[120:123], a[40:43], v[200:203], v[120:123]
  ds_read_b64_tr_b16 a[18:19], v8 offset:18432
  v_mul_f32 v115, v115, v12
  v_mfma_f32_16x16x32_bf16 v[120:123], a[44:47], v[204:207], v[120:123]
  v_mfma_f32_16x16x32_bf16 v[120:123], a[48:51], v[208:211], v[120:123]
  ds_read_b64_tr_b16 a[20:21], v8 offset:20480
  v_cvt_pk_bf16_f32 v18, v112, v113
  v_mfma_f32_16x16x32_bf16 v[120:123], a[52:55], v[212:215], v[120:123]
  v_mfma_f32_16x16x32_bf16 v[120:123], a[56:59], v[216:219], v[120:123]
  ds_read_b64_tr_b16 a[22:23], v8 offset:22528
  v_cvt_pk_bf16_f32 v19, v114, v115
  v_mfma_f32_16x16x32_bf16 v[120:123], a[60:63], v[220:223], v[120:123]
  v_mfma_f32_16x16x32_bf16 v[124:127], a[32:35], v[224:227], 0
  ds_read_b64_tr_b16 a[24:25], v8 offset:24576
  v_mul_f32 v116, v116, v13
  v_mfma_f32_16x16x32_bf16 v[124:127], a[36:39], v[228:231], v[124:127]
  v_mul_f32 v117, v117, v13
  v_mul_f32 v118, v118, v13
  v_mfma_f32_16x16x32_bf16 v[124:127], a[40:43], v[232:235], v[124:127]
  s_add_u32 s69, s60, 524288
  ds_read_b64_tr_b16 a[26:27], v8 offset:26624
  v_mul_f32 v119, v119, v13
  v_mfma_f32_16x16x32_bf16 v[124:127], a[44:47], v[236:239], v[124:127]
  buffer_store_dwordx4 v[16:19], v11, s[56:59], s69 offen
  v_mfma_f32_16x16x32_bf16 v[124:127], a[48:51], v[240:243], v[124:127]
  s_waitcnt lgkmcnt(8)
  s_waitcnt vmcnt(2)
  s_add_u32 s55, s75, 64
  ds_read_b64_tr_b16 a[28:29], v8 offset:28672
  v_cvt_pk_bf16_f32 v22, v116, v117
  v_mfma_f32_16x16x32_bf16 v[124:127], a[52:55], v[244:247], v[124:127]
  buffer_store_byte v51, v35, s[36:39], s55 offen
  v_mfma_f32_16x16x32_bf16 v[124:127], a[56:59], v[248:251], v[124:127]
  ds_read_b64_tr_b16 a[30:31], v8 offset:30720
  v_cvt_pk_bf16_f32 v23, v118, v119
  v_mfma_f32_16x16x32_bf16 v[124:127], a[60:63], v[252:255], v[124:127]
  s_waitcnt lgkmcnt(12)
  s_waitcnt vmcnt(2)
  v_cmp_ne_u32 vcc, 0x01010101, v53
  s_nop 0
  s_cbranch_vccnz L_prod0_spin
L_prod0_ok:
  v_mfma_f32_16x16x32_bf16 v[96:99], a[0:3], v[128:131], 0
  ds_read_b64_tr_b16 a[32:33], v9 offset:0
  v_mul_f32 v120, v120, v14
  v_mfma_f32_16x16x32_bf16 v[96:99], a[4:7], v[132:135], v[96:99]
  s_waitcnt lgkmcnt(9)
  v_mul_f32 v121, v121, v14
  v_mul_f32 v122, v122, v14
  v_mfma_f32_16x16x32_bf16 v[96:99], a[8:11], v[136:139], v[96:99]
  s_add_u32 s52, s61, 0
  ds_read_b64_tr_b16 a[34:35], v9 offset:2048
  v_mul_f32 v123, v123, v14
  v_mfma_f32_16x16x32_bf16 v[96:99], a[12:15], v[140:143], v[96:99]
  s_waitcnt lgkmcnt(6)
  buffer_load_dwordx4 a[64:67], v48, s[56:59], s52 offen sc1
  v_mfma_f32_16x16x32_bf16 v[96:99], a[16:19], v[144:147], v[96:99]
  ds_read_b64_tr_b16 a[36:37], v9 offset:4096
  v_cvt_pk_bf16_f32 v26, v120, v121
  v_mfma_f32_16x16x32_bf16 v[96:99], a[20:23], v[148:151], v[96:99]
  s_waitcnt lgkmcnt(3)
  v_add_u32 v8, 32768, v8
  v_mfma_f32_16x16x32_bf16 v[96:99], a[24:27], v[152:155], v[96:99]
  s_add_u32 s53, s61, 4096
  ds_read_b64_tr_b16 a[38:39], v9 offset:6144
  v_cvt_pk_bf16_f32 v27, v122, v123
  v_mfma_f32_16x16x32_bf16 v[96:99], a[28:31], v[156:159], v[96:99]
  buffer_load_dwordx4 a[68:71], v48, s[56:59], s53 offen sc1
  v_mfma_f32_16x16x32_bf16 v[100:103], a[0:3], v[160:163], 0
  ds_read_b64_tr_b16 a[40:41], v9 offset:8192
  v_mul_f32 v124, v124, v15
  v_mfma_f32_16x16x32_bf16 v[100:103], a[4:7], v[164:167], v[100:103]
  v_mul_f32 v125, v125, v15
  v_mul_f32 v126, v126, v15
  v_mfma_f32_16x16x32_bf16 v[100:103], a[8:11], v[168:171], v[100:103]
  s_add_u32 s70, s60, 540672
  ds_read_b64_tr_b16 a[42:43], v9 offset:10240
  v_mul_f32 v127, v127, v15
  v_mfma_f32_16x16x32_bf16 v[100:103], a[12:15], v[172:175], v[100:103]
  buffer_store_dwordx4 v[20:23], v11, s[56:59], s70 offen
  v_mfma_f32_16x16x32_bf16 v[100:103], a[16:19], v[176:179], v[100:103]
  ds_read_b64_tr_b16 a[44:45], v9 offset:12288
  v_cvt_pk_bf16_f32 v30, v124, v125
  v_mfma_f32_16x16x32_bf16 v[100:103], a[20:23], v[180:183], v[100:103]
  v_mfma_f32_16x16x32_bf16 v[100:103], a[24:27], v[184:187], v[100:103]
  ds_read_b64_tr_b16 a[46:47], v9 offset:14336
  v_cvt_pk_bf16_f32 v31, v126, v127
  v_mfma_f32_16x16x32_bf16 v[100:103], a[28:31], v[188:191], v[100:103]
  v_mfma_f32_16x16x32_bf16 v[104:107], a[0:3], v[192:195], 0
  ds_read_b64_tr_b16 a[48:49], v9 offset:16384
  v_mul_f32 v96, v96, v12
  v_mfma_f32_16x16x32_bf16 v[104:107], a[4:7], v[196:199], v[104:107]
  v_mul_f32 v97, v97, v12
  v_mul_f32 v98, v98, v12
  v_mfma_f32_16x16x32_bf16 v[104:107], a[8:11], v[200:203], v[104:107]
  s_add_u32 s52, s61, 8192
  ds_read_b64_tr_b16 a[50:51], v9 offset:18432
  v_mul_f32 v99, v99, v12
  v_mfma_f32_16x16x32_bf16 v[104:107], a[12:15], v[204:207], v[104:107]
  buffer_load_dwordx4 a[72:75], v48, s[56:59], s52 offen sc1
  v_mfma_f32_16x16x32_bf16 v[104:107], a[16:19], v[208:211], v[104:107]
  ds_read_b64_tr_b16 a[52:53], v9 offset:20480
  v_cvt_pk_bf16_f32 v16, v96, v97
  v_mfma_f32_16x16x32_bf16 v[104:107], a[20:23], v[212:215], v[104:107]
  v_add_u32 v6, 32768, v6
  v_mfma_f32_16x16x32_bf16 v[104:107], a[24:27], v[216:219], v[104:107]
  s_add_u32 s53, s61, 12288
  ds_read_b64_tr_b16 a[54:55], v9 offset:22528
  v_cvt_pk_bf16_f32 v17, v98, v99
  v_mfma_f32_16x16x32_bf16 v[104:107], a[28:31], v[220:223], v[104:107]
  buffer_load_dwordx4 a[76:79], v48, s[56:59], s53 offen sc1
  v_mfma_f32_16x16x32_bf16 v[108:111], a[0:3], v[224:227], 0
  ds_read_b64_tr_b16 a[56:57], v9 offset:24576
  v_mul_f32 v100, v100, v13
  v_mfma_f32_16x16x32_bf16 v[108:111], a[4:7], v[228:231], v[108:111]
  v_mul_f32 v101, v101, v13
  v_mul_f32 v102, v102, v13
  v_mfma_f32_16x16x32_bf16 v[108:111], a[8:11], v[232:235], v[108:111]
  s_add_u32 s69, s60, 557056
  ds_read_b64_tr_b16 a[58:59], v9 offset:26624
  v_mul_f32 v103, v103, v13
  v_mfma_f32_16x16x32_bf16 v[108:111], a[12:15], v[236:239], v[108:111]
  s_waitcnt vmcnt(7)
  s_barrier
  buffer_store_dwordx4 v[24:27], v11, s[56:59], s69 offen
  v_mfma_f32_16x16x32_bf16 v[108:111], a[16:19], v[240:243], v[108:111]
  s_waitcnt lgkmcnt(8)
  ds_read_b64_tr_b16 a[60:61], v9 offset:28672
  v_cvt_pk_bf16_f32 v20, v100, v101
  v_mfma_f32_16x16x32_bf16 v[108:111], a[20:23], v[244:247], v[108:111]
  v_mfma_f32_16x16x32_bf16 v[108:111], a[24:27], v[248:251], v[108:111]
  ds_read_b64_tr_b16 a[62:63], v9 offset:30720
  v_cvt_pk_bf16_f32 v21, v102, v103
  v_mfma_f32_16x16x32_bf16 v[108:111], a[28:31], v[252:255], v[108:111]
  s_waitcnt lgkmcnt(12)
  v_mfma_f32_16x16x32_bf16 v[112:115], a[32:35], v[128:131], 0
  ds_read_b64_tr_b16 a[0:1], v6 offset:0
  v_mul_f32 v104, v104, v14
  v_mfma_f32_16x16x32_bf16 v[112:115], a[36:39], v[132:135], v[112:115]
  s_waitcnt lgkmcnt(9)
  v_mul_f32 v105, v105, v14
  v_mul_f32 v106, v106, v14
  v_mfma_f32_16x16x32_bf16 v[112:115], a[40:43], v[136:139], v[112:115]
  s_add_u32 s70, s60, 573440
  ds_read_b64_tr_b16 a[2:3], v6 offset:2048
  v_mul_f32 v107, v107, v14
  v_mfma_f32_16x16x32_bf16 v[112:115], a[44:47], v[140:143], v[112:115]
  s_waitcnt lgkmcnt(6)
  buffer_store_dwordx4 v[28:31], v11, s[56:59], s70 offen
  v_mfma_f32_16x16x32_bf16 v[112:115], a[48:51], v[144:147], v[112:115]
  ds_read_b64_tr_b16 a[4:5], v6 offset:4096
  v_cvt_pk_bf16_f32 v24, v104, v105
  v_mfma_f32_16x16x32_bf16 v[112:115], a[52:55], v[148:151], v[112:115]
  s_waitcnt lgkmcnt(3)
  v_add_u32 v9, 32768, v9
  v_mfma_f32_16x16x32_bf16 v[112:115], a[56:59], v[152:155], v[112:115]
  s_add_u32 s54, s78, 64
  ds_read_b64_tr_b16 a[6:7], v6 offset:6144
  v_cvt_pk_bf16_f32 v25, v106, v107
  v_mfma_f32_16x16x32_bf16 v[112:115], a[60:63], v[156:159], v[112:115]
  s_waitcnt vmcnt(2)
  buffer_load_dword v53, v50, s[36:39], s54 offen sc1
  v_mfma_f32_16x16x32_bf16 v[40:43], a[96:99], a[64:67], 0
  v_mfma_f32_16x16x32_bf16 v[40:43], a[96:99], a[68:71], v[40:43]
  v_mfma_f32_16x16x32_bf16 v[40:43], a[96:99], a[72:75], v[40:43]
  v_mfma_f32_16x16x32_bf16 v[40:43], a[96:99], a[76:79], v[40:43]
  v_mfma_f32_16x16x32_bf16 v[116:119], a[32:35], v[160:163], 0
  ds_read_b64_tr_b16 a[8:9], v6 offset:8192
  v_mul_f32 v108, v108, v15
  v_mfma_f32_16x16x32_bf16 v[116:119], a[36:39], v[164:167], v[116:119]
  v_mul_f32 v109, v109, v15
  v_mul_f32 v110, v110, v15
  v_mfma_f32_16x16x32_bf16 v[116:119], a[40:43], v[168:171], v[116:119]
  s_add_u32 s55, s79, 0
  ds_read_b64_tr_b16 a[10:11], v6 offset:10240
  v_mul_f32 v111, v111, v15
  v_mfma_f32_16x16x32_bf16 v[116:119], a[44:47], v[172:175], v[116:119]
  buffer_store_byte v51, v35, s[36:39], s55 offen
  v_mfma_f32_16x16x32_bf16 v[116:119], a[48:51], v[176:179], v[116:119]
  ds_read_b64_tr_b16 a[12:13], v6 offset:12288
  v_cvt_pk_bf16_f32 v28, v108, v109
  v_mfma_f32_16x16x32_bf16 v[116:119], a[52:55], v[180:183], v[116:119]
  v_mfma_f32_16x16x32_bf16 v[116:119], a[56:59], v[184:187], v[116:119]
  ds_read_b64_tr_b16 a[14:15], v6 offset:14336
  v_cvt_pk_bf16_f32 v29, v110, v111
  v_mfma_f32_16x16x32_bf16 v[116:119], a[60:63], v[188:191], v[116:119]
  v_mfma_f32_16x16x32_bf16 v[120:123], a[32:35], v[192:195], 0
  ds_read_b64_tr_b16 a[16:17], v6 offset:16384
  v_mul_f32 v112, v112, v12
  v_mfma_f32_16x16x32_bf16 v[120:123], a[36:39], v[196:199], v[120:123]
  v_mul_f32 v113, v113, v12
  v_mul_f32 v114, v114, v12
  v_mfma_f32_16x16x32_bf16 v[120:123], a[40:43], v[200:203], v[120:123]
  ds_read_b64_tr_b16 a[18:19], v6 offset:18432
  v_mul_f32 v115, v115, v12
  v_mfma_f32_16x16x32_bf16 v[120:123], a[44:47], v[204:207], v[120:123]
  v_mfma_f32_16x16x32_bf16 v[120:123], a[48:51], v[208:211], v[120:123]
  ds_read_b64_tr_b16 a[20:21], v6 offset:20480
  v_cvt_pk_bf16_f32 v18, v112, v113
  v_mfma_f32_16x16x32_bf16 v[120:123], a[52:55], v[212:215], v[120:123]
  v_mfma_f32_16x16x32_bf16 v[120:123], a[56:59], v[216:219], v[120:123]
  ds_read_b64_tr_b16 a[22:23], v6 offset:22528
  v_cvt_pk_bf16_f32 v19, v114, v115
  v_mfma_f32_16x16x32_bf16 v[120:123], a[60:63], v[220:223], v[120:123]
  v_mfma_f32_16x16x32_bf16 v[124:127], a[32:35], v[224:227], 0
  ds_read_b64_tr_b16 a[24:25], v6 offset:24576
  v_mul_f32 v116, v116, v13
  v_mfma_f32_16x16x32_bf16 v[124:127], a[36:39], v[228:231], v[124:127]
  v_mul_f32 v117, v117, v13
  v_mul_f32 v118, v118, v13
  v_mfma_f32_16x16x32_bf16 v[124:127], a[40:43], v[232:235], v[124:127]
  s_add_u32 s69, s60, 786432
  ds_read_b64_tr_b16 a[26:27], v6 offset:26624
  v_mul_f32 v119, v119, v13
  v_mfma_f32_16x16x32_bf16 v[124:127], a[44:47], v[236:239], v[124:127]
  buffer_store_dwordx4 v[16:19], v11, s[56:59], s69 offen
  v_mfma_f32_16x16x32_bf16 v[124:127], a[48:51], v[240:243], v[124:127]
  s_waitcnt lgkmcnt(8)
  s_waitcnt vmcnt(3)
  s_add_u32 s55, s75, 128
  ds_read_b64_tr_b16 a[28:29], v6 offset:28672
  v_cvt_pk_bf16_f32 v22, v116, v117
  v_mfma_f32_16x16x32_bf16 v[124:127], a[52:55], v[244:247], v[124:127]
  buffer_store_byte v51, v35, s[36:39], s55 offen
  v_mfma_f32_16x16x32_bf16 v[124:127], a[56:59], v[248:251], v[124:127]
  ds_read_b64_tr_b16 a[30:31], v6 offset:30720
  v_cvt_pk_bf16_f32 v23, v118, v119
  v_mfma_f32_16x16x32_bf16 v[124:127], a[60:63], v[252:255], v[124:127]
  s_waitcnt lgkmcnt(12)
  s_waitcnt vmcnt(3)
  v_cmp_ne_u32 vcc, 0x01010101, v53
  s_nop 0
  s_cbranch_vccnz L_prod1_spin
L_prod1_ok:
  v_mfma_f32_16x16x32_bf16 v[96:99], a[0:3], v[128:131], 0
  ds_read_b64_tr_b16 a[32:33], v7 offset:0
  v_mul_f32 v120, v120, v14
  v_mfma_f32_16x16x32_bf16 v[96:99], a[4:7], v[132:135], v[96:99]
  s_waitcnt lgkmcnt(9)
  v_add_u32 v39, 131072, v39
  v_mul_f32 v121, v121, v14
  v_mul_f32 v122, v122, v14
  v_mfma_f32_16x16x32_bf16 v[96:99], a[8:11], v[136:139], v[96:99]
  s_add_u32 s52, s61, 262144
  ds_read_b64_tr_b16 a[34:35], v7 offset:2048
  v_mul_f32 v123, v123, v14
  v_mfma_f32_16x16x32_bf16 v[96:99], a[12:15], v[140:143], v[96:99]
  s_waitcnt lgkmcnt(6)
  buffer_load_dwordx4 a[80:83], v48, s[56:59], s52 offen sc1
  v_mfma_f32_16x16x32_bf16 v[96:99], a[16:19], v[144:147], v[96:99]
  ds_read_b64_tr_b16 a[36:37], v7 offset:4096
  v_cvt_pk_bf16_f32 v26, v120, v121
  v_mfma_f32_16x16x32_bf16 v[96:99], a[20:23], v[148:151], v[96:99]
  s_waitcnt lgkmcnt(3)
  v_mfma_f32_16x16x32_bf16 v[96:99], a[24:27], v[152:155], v[96:99]
  s_add_u32 s53, s61, 266240
  ds_read_b64_tr_b16 a[38:39], v7 offset:6144
  v_cvt_pk_bf16_f32 v27, v122, v123
  v_mfma_f32_16x16x32_bf16 v[96:99], a[28:31], v[156:159], v[96:99]
  buffer_load_dwordx4 a[84:87], v48, s[56:59], s53 offen sc1
  v_mfma_f32_16x16x32_bf16 v[100:103], a[0:3], v[160:163], 0
  ds_read_b64_tr_b16 a[40:41], v7 offset:8192
  v_mul_f32 v124, v124, v15
  v_mfma_f32_16x16x32_bf16 v[100:103], a[4:7], v[164:167], v[100:103]
  v_mul_f32 v125, v125, v15
  v_mul_f32 v126, v126, v15
  v_mfma_f32_16x16x32_bf16 v[100:103], a[8:11], v[168:171], v[100:103]
  s_add_u32 s70, s60, 802816
  ds_read_b64_tr_b16 a[42:43], v7 offset:10240
  v_mul_f32 v127, v127, v15
  v_mfma_f32_16x16x32_bf16 v[100:103], a[12:15], v[172:175], v[100:103]
  buffer_store_dwordx4 v[20:23], v11, s[56:59], s70 offen
  v_mfma_f32_16x16x32_bf16 v[100:103], a[16:19], v[176:179], v[100:103]
  ds_read_b64_tr_b16 a[44:45], v7 offset:12288
  v_cvt_pk_bf16_f32 v30, v124, v125
  v_mfma_f32_16x16x32_bf16 v[100:103], a[20:23], v[180:183], v[100:103]
  v_mfma_f32_16x16x32_bf16 v[100:103], a[24:27], v[184:187], v[100:103]
  s_waitcnt vmcnt(6)
  ds_read_b64_tr_b16 a[46:47], v7 offset:14336
  v_cvt_pk_bf16_f32 v31, v126, v127
  v_mfma_f32_16x16x32_bf16 v[100:103], a[28:31], v[188:191], v[100:103]
  ds_write_b128 v39, a[100:103] offset:0
  v_mfma_f32_16x16x32_bf16 v[104:107], a[0:3], v[192:195], 0
  ds_read_b64_tr_b16 a[48:49], v7 offset:16384
  v_mul_f32 v96, v96, v12
  v_mfma_f32_16x16x32_bf16 v[104:107], a[4:7], v[196:199], v[104:107]
  v_mul_f32 v97, v97, v12
  v_mul_f32 v98, v98, v12
  v_mfma_f32_16x16x32_bf16 v[104:107], a[8:11], v[200:203], v[104:107]
  s_add_u32 s52, s61, 270336
  ds_read_b64_tr_b16 a[50:51], v7 offset:18432
  v_mul_f32 v99, v99, v12
  v_mfma_f32_16x16x32_bf16 v[104:107], a[12:15], v[204:207], v[104:107]
  buffer_load_dwordx4 a[88:91], v48, s[56:59], s52 offen sc1
  v_mfma_f32_16x16x32_bf16 v[104:107], a[16:19], v[208:211], v[104:107]
  ds_read_b64_tr_b16 a[52:53], v7 offset:20480
  v_cvt_pk_bf16_f32 v16, v96, v97
  v_mfma_f32_16x16x32_bf16 v[104:107], a[20:23], v[212:215], v[104:107]
  v_mfma_f32_16x16x32_bf16 v[104:107], a[24:27], v[216:219], v[104:107]
  s_add_u32 s53, s61, 274432
  ds_read_b64_tr_b16 a[54:55], v7 offset:22528
  v_cvt_pk_bf16_f32 v17, v98, v99
  v_mfma_f32_16x16x32_bf16 v[104:107], a[28:31], v[220:223], v[104:107]
  buffer_load_dwordx4 a[92:95], v48, s[56:59], s53 offen sc1
  v_mfma_f32_16x16x32_bf16 v[108:111], a[0:3], v[224:227], 0
  ds_read_b64_tr_b16 a[56:57], v7 offset:24576
  v_mul_f32 v100, v100, v13
  v_mfma_f32_16x16x32_bf16 v[108:111], a[4:7], v[228:231], v[108:111]
  v_mul_f32 v101, v101, v13
  v_mul_f32 v102, v102, v13
  v_mfma_f32_16x16x32_bf16 v[108:111], a[8:11], v[232:235], v[108:111]
  s_waitcnt lgkmcnt(8)
  s_add_u32 s69, s60, 819200
  ds_read_b64_tr_b16 a[58:59], v7 offset:26624
  v_mul_f32 v103, v103, v13
  v_mfma_f32_16x16x32_bf16 v[108:111], a[12:15], v[236:239], v[108:111]
  buffer_store_dwordx4 v[24:27], v11, s[56:59], s69 offen
  v_mfma_f32_16x16x32_bf16 v[108:111], a[16:19], v[240:243], v[108:111]
  ds_read_b64_tr_b16 a[60:61], v7 offset:28672
  v_cvt_pk_bf16_f32 v20, v100, v101
  v_mfma_f32_16x16x32_bf16 v[108:111], a[20:23], v[244:247], v[108:111]
  v_mfma_f32_16x16x32_bf16 v[108:111], a[24:27], v[248:251], v[108:111]
  s_add_u32 s54, s76, 0
  ds_read_b64_tr_b16 a[62:63], v7 offset:30720
  v_cvt_pk_bf16_f32 v21, v102, v103
  v_mfma_f32_16x16x32_bf16 v[108:111], a[28:31], v[252:255], v[108:111]
  s_waitcnt lgkmcnt(13)
  buffer_load_dword v54, v50, s[36:39], s54 offen sc1
  v_mfma_f32_16x16x32_bf16 v[112:115], a[32:35], v[128:131], 0
  ds_read_b64_tr_b16 a[0:1], v8 offset:0
  v_mul_f32 v104, v104, v14
  v_mfma_f32_16x16x32_bf16 v[112:115], a[36:39], v[132:135], v[112:115]
  s_waitcnt lgkmcnt(10)
  v_mul_f32 v105, v105, v14
  v_mul_f32 v106, v106, v14
  v_mfma_f32_16x16x32_bf16 v[112:115], a[40:43], v[136:139], v[112:115]
  s_add_u32 s70, s60, 835584
  ds_read_b64_tr_b16 a[2:3], v8 offset:2048
  v_mul_f32 v107, v107, v14
  v_mfma_f32_16x16x32_bf16 v[112:115], a[44:47], v[140:143], v[112:115]
  s_waitcnt lgkmcnt(6)
  buffer_store_dwordx4 v[28:31], v11, s[56:59], s70 offen
  v_mfma_f32_16x16x32_bf16 v[112:115], a[48:51], v[144:147], v[112:115]
  ds_read_b64_tr_b16 a[4:5], v8 offset:4096
  v_cvt_pk_bf16_f32 v24, v104, v105
  v_mfma_f32_16x16x32_bf16 v[112:115], a[52:55], v[148:151], v[112:115]
  s_waitcnt lgkmcnt(3)
  v_add_u32 v7, 32768, v7
  v_mfma_f32_16x16x32_bf16 v[112:115], a[56:59], v[152:155], v[112:115]
  s_add_u32 s54, s78, 128
  ds_read_b64_tr_b16 a[6:7], v8 offset:6144
  v_cvt_pk_bf16_f32 v25, v106, v107
  v_mfma_f32_16x16x32_bf16 v[112:115], a[60:63], v[156:159], v[112:115]
  s_waitcnt vmcnt(3)
  buffer_load_dword v53, v50, s[36:39], s54 offen sc1
  v_mfma_f32_16x16x32_bf16 v[44:47], a[96:99], a[80:83], 0
  v_cvt_pk_bf16_f32 v40, v40, v41
  v_cvt_pk_bf16_f32 v41, v42, v43
  v_mfma_f32_16x16x32_bf16 v[44:47], a[96:99], a[84:87], v[44:47]
  v_mfma_f32_16x16x32_bf16 v[44:47], a[96:99], a[88:91], v[44:47]
  v_mfma_f32_16x16x32_bf16 v[44:47], a[96:99], a[92:95], v[44:47]
  v_mfma_f32_16x16x32_bf16 v[116:119], a[32:35], v[160:163], 0
  ds_read_b64_tr_b16 a[8:9], v8 offset:8192
  v_mul_f32 v108, v108, v15
  v_mfma_f32_16x16x32_bf16 v[116:119], a[36:39], v[164:167], v[116:119]
  v_mul_f32 v109, v109, v15
  v_mul_f32 v110, v110, v15
  v_mfma_f32_16x16x32_bf16 v[116:119], a[40:43], v[168:171], v[116:119]
  s_add_u32 s55, s79, 64
  ds_read_b64_tr_b16 a[10:11], v8 offset:10240
  v_mul_f32 v111, v111, v15
  v_mfma_f32_16x16x32_bf16 v[116:119], a[44:47], v[172:175], v[116:119]
  buffer_store_byte v51, v35, s[36:39], s55 offen
  v_mfma_f32_16x16x32_bf16 v[116:119], a[48:51], v[176:179], v[116:119]
  ds_read_b64_tr_b16 a[12:13], v8 offset:12288
  v_cvt_pk_bf16_f32 v28, v108, v109
  v_mfma_f32_16x16x32_bf16 v[116:119], a[52:55], v[180:183], v[116:119]
  buffer_store_dwordx2 v[40:41], v49, s[28:31], 0 offen
  v_mfma_f32_16x16x32_bf16 v[116:119], a[56:59], v[184:187], v[116:119]
  ds_read_b64_tr_b16 a[14:15], v8 offset:14336
  v_cvt_pk_bf16_f32 v29, v110, v111
  v_mfma_f32_16x16x32_bf16 v[116:119], a[60:63], v[188:191], v[116:119]
  ds_write_b128 v39, a[104:107] offset:4096
  v_mfma_f32_16x16x32_bf16 v[120:123], a[32:35], v[192:195], 0
  ds_read_b64_tr_b16 a[16:17], v8 offset:16384
  v_mul_f32 v112, v112, v12
  v_mfma_f32_16x16x32_bf16 v[120:123], a[36:39], v[196:199], v[120:123]
  v_mul_f32 v113, v113, v12
  v_mul_f32 v114, v114, v12
  v_mfma_f32_16x16x32_bf16 v[120:123], a[40:43], v[200:203], v[120:123]
  ds_read_b64_tr_b16 a[18:19], v8 offset:18432
  v_mul_f32 v115, v115, v12
  v_mfma_f32_16x16x32_bf16 v[120:123], a[44:47], v[204:207], v[120:123]
  s_waitcnt vmcnt(4)
  v_cmp_ne_u32 vcc, 0x01010101, v54
  s_nop 0
  s_cbranch_vccnz L_cons4_spin
L_cons4_ok:
  v_mfma_f32_16x16x32_bf16 v[120:123], a[48:51], v[208:211], v[120:123]
  ds_read_b64_tr_b16 a[20:21], v8 offset:20480
  v_cvt_pk_bf16_f32 v18, v112, v113
  v_mfma_f32_16x16x32_bf16 v[120:123], a[52:55], v[212:215], v[120:123]
  ds_write_b128 v39, a[108:111] offset:8192
  v_mfma_f32_16x16x32_bf16 v[120:123], a[56:59], v[216:219], v[120:123]
  ds_read_b64_tr_b16 a[22:23], v8 offset:22528
  v_cvt_pk_bf16_f32 v19, v114, v115
  v_mfma_f32_16x16x32_bf16 v[120:123], a[60:63], v[220:223], v[120:123]
  s_waitcnt lgkmcnt(8)
  ds_write_b128 v39, a[112:115] offset:12288
  v_mfma_f32_16x16x32_bf16 v[124:127], a[32:35], v[224:227], 0
  ds_read_b64_tr_b16 a[24:25], v8 offset:24576
  v_mul_f32 v116, v116, v13
  v_mfma_f32_16x16x32_bf16 v[124:127], a[36:39], v[228:231], v[124:127]
  v_mul_f32 v117, v117, v13
  v_mul_f32 v118, v118, v13
  v_mfma_f32_16x16x32_bf16 v[124:127], a[40:43], v[232:235], v[124:127]
  s_add_u32 s69, s60, 0
  ds_read_b64_tr_b16 a[26:27], v8 offset:26624
  v_mul_f32 v119, v119, v13
  v_mfma_f32_16x16x32_bf16 v[124:127], a[44:47], v[236:239], v[124:127]
  buffer_store_dwordx4 v[16:19], v11, s[56:59], s69 offen
  v_mfma_f32_16x16x32_bf16 v[124:127], a[48:51], v[240:243], v[124:127]
  s_waitcnt vmcnt(4)
  s_add_u32 s55, s75, 192
  ds_read_b64_tr_b16 a[28:29], v8 offset:28672
  v_cvt_pk_bf16_f32 v22, v116, v117
  v_mfma_f32_16x16x32_bf16 v[124:127], a[52:55], v[244:247], v[124:127]
  buffer_store_byte v51, v35, s[36:39], s55 offen
  v_mfma_f32_16x16x32_bf16 v[124:127], a[56:59], v[248:251], v[124:127]
  ds_read_b64_tr_b16 a[30:31], v8 offset:30720
  v_cvt_pk_bf16_f32 v23, v118, v119
  v_mfma_f32_16x16x32_bf16 v[124:127], a[60:63], v[252:255], v[124:127]
  s_waitcnt lgkmcnt(15)
  s_waitcnt vmcnt(4)
  v_cmp_ne_u32 vcc, 0x01010101, v53
  s_nop 0
  s_cbranch_vccnz L_prod2_spin
L_prod2_ok:
  v_mfma_f32_16x16x32_bf16 v[96:99], a[0:3], v[128:131], 0
  ds_read_b64_tr_b16 a[32:33], v9 offset:0
  v_mul_f32 v120, v120, v14
  v_mfma_f32_16x16x32_bf16 v[96:99], a[4:7], v[132:135], v[96:99]
  s_waitcnt lgkmcnt(12)
  v_mul_f32 v121, v121, v14
  v_mul_f32 v122, v122, v14
  v_mfma_f32_16x16x32_bf16 v[96:99], a[8:11], v[136:139], v[96:99]
  s_add_u32 s52, s61, 524288
  ds_read_b64_tr_b16 a[34:35], v9 offset:2048
  v_mul_f32 v123, v123, v14
  v_mfma_f32_16x16x32_bf16 v[96:99], a[12:15], v[140:143], v[96:99]
  s_waitcnt lgkmcnt(7)
  buffer_load_dwordx4 a[64:67], v48, s[56:59], s52 offen sc1
  v_mfma_f32_16x16x32_bf16 v[96:99], a[16:19], v[144:147], v[96:99]
  ds_read_b64_tr_b16 a[36:37], v9 offset:4096
  v_cvt_pk_bf16_f32 v26, v120, v121
  v_mfma_f32_16x16x32_bf16 v[96:99], a[20:23], v[148:151], v[96:99]
  s_waitcnt lgkmcnt(3)
  v_add_u32 v8, 32768, v8
  v_mfma_f32_16x16x32_bf16 v[96:99], a[24:27], v[152:155], v[96:99]
  s_add_u32 s53, s61, 528384
  ds_read_b64_tr_b16 a[38:39], v9 offset:6144
  v_cvt_pk_bf16_f32 v27, v122, v123
  v_mfma_f32_16x16x32_bf16 v[96:99], a[28:31], v[156:159], v[96:99]
  buffer_load_dwordx4 a[68:71], v48, s[56:59], s53 offen sc1
  v_mfma_f32_16x16x32_bf16 v[100:103], a[0:3], v[160:163], 0
  ds_read_b64_tr_b16 a[40:41], v9 offset:8192
  v_mul_f32 v124, v124, v15
  v_mfma_f32_16x16x32_bf16 v[100:103], a[4:7], v[164:167], v[100:103]
  v_mul_f32 v125, v125, v15
  v_mul_f32 v126, v126, v15
  v_mfma_f32_16x16x32_bf16 v[100:103], a[8:11], v[168:171], v[100:103]
  s_add_u32 s70, s60, 16384
  ds_read_b64_tr_b16 a[42:43], v9 offset:10240
  v_mul_f32 v127, v127, v15
  v_mfma_f32_16x16x32_bf16 v[100:103], a[12:15], v[172:175], v[100:103]
  buffer_store_dwordx4 v[20:23], v11, s[56:59], s70 offen
  v_mfma_f32_16x16x32_bf16 v[100:103], a[16:19], v[176:179], v[100:103]
  ds_read_b64_tr_b16 a[44:45], v9 offset:12288
  v_cvt_pk_bf16_f32 v30, v124, v125
  v_mfma_f32_16x16x32_bf16 v[100:103], a[20:23], v[180:183], v[100:103]
  v_mfma_f32_16x16x32_bf16 v[100:103], a[24:27], v[184:187], v[100:103]
  ds_read_b64_tr_b16 a[46:47], v9 offset:14336
  v_cvt_pk_bf16_f32 v31, v126, v127
  v_mfma_f32_16x16x32_bf16 v[100:103], a[28:31], v[188:191], v[100:103]
  ds_write_b128 v39, a[116:119] offset:16384
  v_mfma_f32_16x16x32_bf16 v[104:107], a[0:3], v[192:195], 0
  ds_read_b64_tr_b16 a[48:49], v9 offset:16384
  v_mul_f32 v96, v96, v12
  v_mfma_f32_16x16x32_bf16 v[104:107], a[4:7], v[196:199], v[104:107]
  v_mul_f32 v97, v97, v12
  v_mul_f32 v98, v98, v12
  v_mfma_f32_16x16x32_bf16 v[104:107], a[8:11], v[200:203], v[104:107]
  s_add_u32 s52, s61, 532480
  ds_read_b64_tr_b16 a[50:51], v9 offset:18432
  v_mul_f32 v99, v99, v12
  v_mfma_f32_16x16x32_bf16 v[104:107], a[12:15], v[204:207], v[104:107]
  buffer_load_dwordx4 a[72:75], v48, s[56:59], s52 offen sc1
  v_mfma_f32_16x16x32_bf16 v[104:107], a[16:19], v[208:211], v[104:107]
  ds_read_b64_tr_b16 a[52:53], v9 offset:20480
  v_cvt_pk_bf16_f32 v16, v96, v97
  v_mfma_f32_16x16x32_bf16 v[104:107], a[20:23], v[212:215], v[104:107]
  v_add_u32 v6, 32768, v6
  v_mfma_f32_16x16x32_bf16 v[104:107], a[24:27], v[216:219], v[104:107]
  s_add_u32 s53, s61, 536576
  ds_read_b64_tr_b16 a[54:55], v9 offset:22528
  v_cvt_pk_bf16_f32 v17, v98, v99
  v_mfma_f32_16x16x32_bf16 v[104:107], a[28:31], v[220:223], v[104:107]
  buffer_load_dwordx4 a[76:79], v48, s[56:59], s53 offen sc1
  v_mfma_f32_16x16x32_bf16 v[108:111], a[0:3], v[224:227], 0
  ds_read_b64_tr_b16 a[56:57], v9 offset:24576
  v_mul_f32 v100, v100, v13
  v_mfma_f32_16x16x32_bf16 v[108:111], a[4:7], v[228:231], v[108:111]
  v_mul_f32 v101, v101, v13
  v_mul_f32 v102, v102, v13
  v_mfma_f32_16x16x32_bf16 v[108:111], a[8:11], v[232:235], v[108:111]
  s_waitcnt lgkmcnt(8)
  s_add_u32 s69, s60, 32768
  ds_read_b64_tr_b16 a[58:59], v9 offset:26624
  v_mul_f32 v103, v103, v13
  v_mfma_f32_16x16x32_bf16 v[108:111], a[12:15], v[236:239], v[108:111]
  s_waitcnt vmcnt(9)
  s_barrier
  buffer_store_dwordx4 v[24:27], v11, s[56:59], s69 offen
  v_mfma_f32_16x16x32_bf16 v[108:111], a[16:19], v[240:243], v[108:111]
  ds_read_b64_tr_b16 a[60:61], v9 offset:28672
  v_cvt_pk_bf16_f32 v20, v100, v101
  v_mfma_f32_16x16x32_bf16 v[108:111], a[20:23], v[244:247], v[108:111]
  v_mfma_f32_16x16x32_bf16 v[108:111], a[24:27], v[248:251], v[108:111]
  s_add_u32 s54, s76, 64
  ds_read_b64_tr_b16 a[62:63], v9 offset:30720
  v_cvt_pk_bf16_f32 v21, v102, v103
  v_mfma_f32_16x16x32_bf16 v[108:111], a[28:31], v[252:255], v[108:111]
  s_waitcnt lgkmcnt(13)
  buffer_load_dword v54, v50, s[36:39], s54 offen sc1
  v_mfma_f32_16x16x32_bf16 v[112:115], a[32:35], v[128:131], 0
  ds_read_b64_tr_b16 a[0:1], v6 offset:0
  v_mul_f32 v104, v104, v14
  v_mfma_f32_16x16x32_bf16 v[112:115], a[36:39], v[132:135], v[112:115]
  s_waitcnt lgkmcnt(10)
  v_mul_f32 v105, v105, v14
  v_mul_f32 v106, v106, v14
  v_mfma_f32_16x16x32_bf16 v[112:115], a[40:43], v[136:139], v[112:115]
  s_add_u32 s70, s60, 49152
  ds_read_b64_tr_b16 a[2:3], v6 offset:2048
  v_mul_f32 v107, v107, v14
  v_mfma_f32_16x16x32_bf16 v[112:115], a[44:47], v[140:143], v[112:115]
  s_waitcnt lgkmcnt(6)
  buffer_store_dwordx4 v[28:31], v11, s[56:59], s70 offen
  v_mfma_f32_16x16x32_bf16 v[112:115], a[48:51], v[144:147], v[112:115]
  ds_read_b64_tr_b16 a[4:5], v6 offset:4096
  v_cvt_pk_bf16_f32 v24, v104, v105
  v_mfma_f32_16x16x32_bf16 v[112:115], a[52:55], v[148:151], v[112:115]
  s_waitcnt lgkmcnt(3)
  v_add_u32 v9, 32768, v9
  v_mfma_f32_16x16x32_bf16 v[112:115], a[56:59], v[152:155], v[112:115]
  s_add_u32 s54, s78, 192
  ds_read_b64_tr_b16 a[6:7], v6 offset:6144
  v_cvt_pk_bf16_f32 v25, v106, v107
  v_mfma_f32_16x16x32_bf16 v[112:115], a[60:63], v[156:159], v[112:115]
  s_waitcnt vmcnt(3)
  buffer_load_dword v53, v50, s[36:39], s54 offen sc1
  v_mfma_f32_16x16x32_bf16 v[40:43], a[96:99], a[64:67], 0
  v_cvt_pk_bf16_f32 v44, v44, v45
  v_cvt_pk_bf16_f32 v45, v46, v47
  v_mfma_f32_16x16x32_bf16 v[40:43], a[96:99], a[68:71], v[40:43]
  v_mfma_f32_16x16x32_bf16 v[40:43], a[96:99], a[72:75], v[40:43]
  v_mfma_f32_16x16x32_bf16 v[40:43], a[96:99], a[76:79], v[40:43]
  v_mfma_f32_16x16x32_bf16 v[116:119], a[32:35], v[160:163], 0
  ds_read_b64_tr_b16 a[8:9], v6 offset:8192
  v_mul_f32 v108, v108, v15
  v_mfma_f32_16x16x32_bf16 v[116:119], a[36:39], v[164:167], v[116:119]
  v_mul_f32 v109, v109, v15
  v_mul_f32 v110, v110, v15
  v_mfma_f32_16x16x32_bf16 v[116:119], a[40:43], v[168:171], v[116:119]
  s_add_u32 s55, s79, 128
  ds_read_b64_tr_b16 a[10:11], v6 offset:10240
  v_mul_f32 v111, v111, v15
  v_mfma_f32_16x16x32_bf16 v[116:119], a[44:47], v[172:175], v[116:119]
  buffer_store_byte v51, v35, s[36:39], s55 offen
  v_mfma_f32_16x16x32_bf16 v[116:119], a[48:51], v[176:179], v[116:119]
  ds_read_b64_tr_b16 a[12:13], v6 offset:12288
  v_cvt_pk_bf16_f32 v28, v108, v109
  v_mfma_f32_16x16x32_bf16 v[116:119], a[52:55], v[180:183], v[116:119]
  buffer_store_dwordx2 v[44:45], v49, s[28:31], 0 offen offset:64
  v_mfma_f32_16x16x32_bf16 v[116:119], a[56:59], v[184:187], v[116:119]
  ds_read_b64_tr_b16 a[14:15], v6 offset:14336
  v_cvt_pk_bf16_f32 v29, v110, v111
  v_mfma_f32_16x16x32_bf16 v[116:119], a[60:63], v[188:191], v[116:119]
  ds_write_b128 v39, a[120:123] offset:20480
  v_mfma_f32_16x16x32_bf16 v[120:123], a[32:35], v[192:195], 0
  ds_read_b64_tr_b16 a[16:17], v6 offset:16384
  v_mul_f32 v112, v112, v12
  v_mfma_f32_16x16x32_bf16 v[120:123], a[36:39], v[196:199], v[120:123]
  v_mul_f32 v113, v113, v12
  v_mul_f32 v114, v114, v12
  v_mfma_f32_16x16x32_bf16 v[120:123], a[40:43], v[200:203], v[120:123]
  ds_read_b64_tr_b16 a[18:19], v6 offset:18432
  v_mul_f32 v115, v115, v12
  v_mfma_f32_16x16x32_bf16 v[120:123], a[44:47], v[204:207], v[120:123]
  s_waitcnt vmcnt(4)
  v_cmp_ne_u32 vcc, 0x01010101, v54
  s_nop 0
  s_cbranch_vccnz L_cons5_spin
L_cons5_ok:
  v_mfma_f32_16x16x32_bf16 v[120:123], a[48:51], v[208:211], v[120:123]
  ds_read_b64_tr_b16 a[20:21], v6 offset:20480
  v_cvt_pk_bf16_f32 v18, v112, v113
  v_mfma_f32_16x16x32_bf16 v[120:123], a[52:55], v[212:215], v[120:123]
  ds_write_b128 v39, a[124:127] offset:24576
  v_mfma_f32_16x16x32_bf16 v[120:123], a[56:59], v[216:219], v[120:123]
  ds_read_b64_tr_b16 a[22:23], v6 offset:22528
  v_cvt_pk_bf16_f32 v19, v114, v115
  v_mfma_f32_16x16x32_bf16 v[120:123], a[60:63], v[220:223], v[120:123]
  s_waitcnt lgkmcnt(8)
  ds_write_b128 v39, a[128:131] offset:28672
  v_mfma_f32_16x16x32_bf16 v[124:127], a[32:35], v[224:227], 0
  ds_read_b64_tr_b16 a[24:25], v6 offset:24576
  v_mul_f32 v116, v116, v13
  v_mfma_f32_16x16x32_bf16 v[124:127], a[36:39], v[228:231], v[124:127]
  v_mul_f32 v117, v117, v13
  v_mul_f32 v118, v118, v13
  v_mfma_f32_16x16x32_bf16 v[124:127], a[40:43], v[232:235], v[124:127]
  s_add_u32 s69, s60, 262144
  ds_read_b64_tr_b16 a[26:27], v6 offset:26624
  v_mul_f32 v119, v119, v13
  v_mfma_f32_16x16x32_bf16 v[124:127], a[44:47], v[236:239], v[124:127]
  buffer_store_dwordx4 v[16:19], v11, s[56:59], s69 offen
  v_mfma_f32_16x16x32_bf16 v[124:127], a[48:51], v[240:243], v[124:127]
  s_waitcnt vmcnt(4)
  s_add_u32 s55, s75, 256
  ds_read_b64_tr_b16 a[28:29], v6 offset:28672
  v_cvt_pk_bf16_f32 v22, v116, v117
  v_mfma_f32_16x16x32_bf16 v[124:127], a[52:55], v[244:247], v[124:127]
  buffer_store_byte v51, v35, s[36:39], s55 offen
  v_mfma_f32_16x16x32_bf16 v[124:127], a[56:59], v[248:251], v[124:127]
  ds_read_b64_tr_b16 a[30:31], v6 offset:30720
  v_cvt_pk_bf16_f32 v23, v118, v119
  v_mfma_f32_16x16x32_bf16 v[124:127], a[60:63], v[252:255], v[124:127]
  s_waitcnt lgkmcnt(15)
  s_waitcnt vmcnt(4)
  v_cmp_ne_u32 vcc, 0x01010101, v53
  s_nop 0
  s_cbranch_vccnz L_prod3_spin
L_prod3_ok:
  v_mfma_f32_16x16x32_bf16 v[96:99], a[0:3], v[128:131], 0
  ds_read_b64_tr_b16 a[32:33], v7 offset:0
  v_mul_f32 v120, v120, v14
  v_mfma_f32_16x16x32_bf16 v[96:99], a[4:7], v[132:135], v[96:99]
  s_waitcnt lgkmcnt(12)
  v_add_u32 v39, 4294836224, v39
  v_mul_f32 v121, v121, v14
  v_mul_f32 v122, v122, v14
  v_mfma_f32_16x16x32_bf16 v[96:99], a[8:11], v[136:139], v[96:99]
  s_add_u32 s52, s61, 786432
  ds_read_b64_tr_b16 a[34:35], v7 offset:2048
  v_mul_f32 v123, v123, v14
  v_mfma_f32_16x16x32_bf16 v[96:99], a[12:15], v[140:143], v[96:99]
  s_waitcnt lgkmcnt(7)
  buffer_load_dwordx4 a[80:83], v48, s[56:59], s52 offen sc1
  v_mfma_f32_16x16x32_bf16 v[96:99], a[16:19], v[144:147], v[96:99]
  ds_read_b64_tr_b16 a[36:37], v7 offset:4096
  v_cvt_pk_bf16_f32 v26, v120, v121
  v_mfma_f32_16x16x32_bf16 v[96:99], a[20:23], v[148:151], v[96:99]
  s_waitcnt lgkmcnt(3)
  v_mfma_f32_16x16x32_bf16 v[96:99], a[24:27], v[152:155], v[96:99]
  s_add_u32 s53, s61, 790528
  ds_read_b64_tr_b16 a[38:39], v7 offset:6144
  v_cvt_pk_bf16_f32 v27, v122, v123
  v_mfma_f32_16x16x32_bf16 v[96:99], a[28:31], v[156:159], v[96:99]
  buffer_load_dwordx4 a[84:87], v48, s[56:59], s53 offen sc1
  v_mfma_f32_16x16x32_bf16 v[100:103], a[0:3], v[160:163], 0
  ds_read_b64_tr_b16 a[40:41], v7 offset:8192
  v_mul_f32 v124, v124, v15
  v_mfma_f32_16x16x32_bf16 v[100:103], a[4:7], v[164:167], v[100:103]
  v_mul_f32 v125, v125, v15
  v_mul_f32 v126, v126, v15
  v_mfma_f32_16x16x32_bf16 v[100:103], a[8:11], v[168:171], v[100:103]
  s_add_u32 s70, s60, 278528
  ds_read_b64_tr_b16 a[42:43], v7 offset:10240
  v_mul_f32 v127, v127, v15
  v_mfma_f32_16x16x32_bf16 v[100:103], a[12:15], v[172:175], v[100:103]
  buffer_store_dwordx4 v[20:23], v11, s[56:59], s70 offen
  v_mfma_f32_16x16x32_bf16 v[100:103], a[16:19], v[176:179], v[100:103]
  ds_read_b64_tr_b16 a[44:45], v7 offset:12288
  v_cvt_pk_bf16_f32 v30, v124, v125
  v_mfma_f32_16x16x32_bf16 v[100:103], a[20:23], v[180:183], v[100:103]
  v_mfma_f32_16x16x32_bf16 v[100:103], a[24:27], v[184:187], v[100:103]
  s_waitcnt vmcnt(7)
  ds_read_b64_tr_b16 a[46:47], v7 offset:14336
  v_cvt_pk_bf16_f32 v31, v126, v127
  v_mfma_f32_16x16x32_bf16 v[100:103], a[28:31], v[188:191], v[100:103]
  ds_write_b128 v39, a[132:135] offset:0
  v_mfma_f32_16x16x32_bf16 v[104:107], a[0:3], v[192:195], 0
  ds_read_b64_tr_b16 a[48:49], v7 offset:16384
  v_mul_f32 v96, v96, v12
  v_mfma_f32_16x16x32_bf16 v[104:107], a[4:7], v[196:199], v[104:107]
  v_mul_f32 v97, v97, v12
  v_mul_f32 v98, v98, v12
  v_mfma_f32_16x16x32_bf16 v[104:107], a[8:11], v[200:203], v[104:107]
  s_add_u32 s52, s61, 794624
  ds_read_b64_tr_b16 a[50:51], v7 offset:18432
  v_mul_f32 v99, v99, v12
  v_mfma_f32_16x16x32_bf16 v[104:107], a[12:15], v[204:207], v[104:107]
  buffer_load_dwordx4 a[88:91], v48, s[56:59], s52 offen sc1
  v_mfma_f32_16x16x32_bf16 v[104:107], a[16:19], v[208:211], v[104:107]
  ds_read_b64_tr_b16 a[52:53], v7 offset:20480
  v_cvt_pk_bf16_f32 v16, v96, v97
  v_mfma_f32_16x16x32_bf16 v[104:107], a[20:23], v[212:215], v[104:107]
  v_mfma_f32_16x16x32_bf16 v[104:107], a[24:27], v[216:219], v[104:107]
  s_add_u32 s53, s61, 798720
  ds_read_b64_tr_b16 a[54:55], v7 offset:22528
  v_cvt_pk_bf16_f32 v17, v98, v99
  v_mfma_f32_16x16x32_bf16 v[104:107], a[28:31], v[220:223], v[104:107]
  buffer_load_dwordx4 a[92:95], v48, s[56:59], s53 offen sc1
  v_mfma_f32_16x16x32_bf16 v[108:111], a[0:3], v[224:227], 0
  ds_read_b64_tr_b16 a[56:57], v7 offset:24576
  v_mul_f32 v100, v100, v13
  v_mfma_f32_16x16x32_bf16 v[108:111], a[4:7], v[228:231], v[108:111]
  v_mul_f32 v101, v101, v13
  v_mul_f32 v102, v102, v13
  v_mfma_f32_16x16x32_bf16 v[108:111], a[8:11], v[232:235], v[108:111]
  s_waitcnt lgkmcnt(8)
  s_add_u32 s69, s60, 294912
  ds_read_b64_tr_b16 a[58:59], v7 offset:26624
  v_mul_f32 v103, v103, v13
  v_mfma_f32_16x16x32_bf16 v[108:111], a[12:15], v[236:239], v[108:111]
  buffer_store_dwordx4 v[24:27], v11, s[56:59], s69 offen
  v_mfma_f32_16x16x32_bf16 v[108:111], a[16:19], v[240:243], v[108:111]
  ds_read_b64_tr_b16 a[60:61], v7 offset:28672
  v_cvt_pk_bf16_f32 v20, v100, v101
  v_mfma_f32_16x16x32_bf16 v[108:111], a[20:23], v[244:247], v[108:111]
  v_mfma_f32_16x16x32_bf16 v[108:111], a[24:27], v[248:251], v[108:111]
  s_add_u32 s54, s76, 128
  ds_read_b64_tr_b16 a[62:63], v7 offset:30720
  v_cvt_pk_bf16_f32 v21, v102, v103
  v_mfma_f32_16x16x32_bf16 v[108:111], a[28:31], v[252:255], v[108:111]
  s_waitcnt lgkmcnt(13)
  buffer_load_dword v54, v50, s[36:39], s54 offen sc1
  v_mfma_f32_16x16x32_bf16 v[112:115], a[32:35], v[128:131], 0
  ds_read_b64_tr_b16 a[0:1], v8 offset:0
  v_mul_f32 v104, v104, v14
  v_mfma_f32_16x16x32_bf16 v[112:115], a[36:39], v[132:135], v[112:115]
  s_waitcnt lgkmcnt(10)
  v_mul_f32 v105, v105, v14
  v_mul_f32 v106, v106, v14
  v_mfma_f32_16x16x32_bf16 v[112:115], a[40:43], v[136:139], v[112:115]
  s_add_u32 s70, s60, 311296
  ds_read_b64_tr_b16 a[2:3], v8 offset:2048
  v_mul_f32 v107, v107, v14
  v_mfma_f32_16x16x32_bf16 v[112:115], a[44:47], v[140:143], v[112:115]
  s_waitcnt lgkmcnt(6)
  buffer_store_dwordx4 v[28:31], v11, s[56:59], s70 offen
  v_mfma_f32_16x16x32_bf16 v[112:115], a[48:51], v[144:147], v[112:115]
  ds_read_b64_tr_b16 a[4:5], v8 offset:4096
  v_cvt_pk_bf16_f32 v24, v104, v105
  v_mfma_f32_16x16x32_bf16 v[112:115], a[52:55], v[148:151], v[112:115]
  s_waitcnt lgkmcnt(3)
  v_add_u32 v7, 32768, v7
  v_mfma_f32_16x16x32_bf16 v[112:115], a[56:59], v[152:155], v[112:115]
  s_add_u32 s54, s78, 256
  ds_read_b64_tr_b16 a[6:7], v8 offset:6144
  v_cvt_pk_bf16_f32 v25, v106, v107
  v_mfma_f32_16x16x32_bf16 v[112:115], a[60:63], v[156:159], v[112:115]
  s_waitcnt vmcnt(3)
  buffer_load_dword v53, v50, s[36:39], s54 offen sc1
  v_mfma_f32_16x16x32_bf16 v[44:47], a[96:99], a[80:83], 0
  v_cvt_pk_bf16_f32 v40, v40, v41
  v_cvt_pk_bf16_f32 v41, v42, v43
  v_mfma_f32_16x16x32_bf16 v[44:47], a[96:99], a[84:87], v[44:47]
  v_mfma_f32_16x16x32_bf16 v[44:47], a[96:99], a[88:91], v[44:47]
  v_mfma_f32_16x16x32_bf16 v[44:47], a[96:99], a[92:95], v[44:47]
  v_mfma_f32_16x16x32_bf16 v[116:119], a[32:35], v[160:163], 0
  ds_read_b64_tr_b16 a[8:9], v8 offset:8192
  v_mul_f32 v108, v108, v15
  v_mfma_f32_16x16x32_bf16 v[116:119], a[36:39], v[164:167], v[116:119]
  v_mul_f32 v109, v109, v15
  v_mul_f32 v110, v110, v15
  v_mfma_f32_16x16x32_bf16 v[116:119], a[40:43], v[168:171], v[116:119]
  s_add_u32 s55, s79, 192
  ds_read_b64_tr_b16 a[10:11], v8 offset:10240
  v_mul_f32 v111, v111, v15
  v_mfma_f32_16x16x32_bf16 v[116:119], a[44:47], v[172:175], v[116:119]
  buffer_store_byte v51, v35, s[36:39], s55 offen
  v_mfma_f32_16x16x32_bf16 v[116:119], a[48:51], v[176:179], v[116:119]
  ds_read_b64_tr_b16 a[12:13], v8 offset:12288
  v_cvt_pk_bf16_f32 v28, v108, v109
  v_mfma_f32_16x16x32_bf16 v[116:119], a[52:55], v[180:183], v[116:119]
  buffer_store_dwordx2 v[40:41], v49, s[28:31], 0 offen offset:128
  v_mfma_f32_16x16x32_bf16 v[116:119], a[56:59], v[184:187], v[116:119]
  ds_read_b64_tr_b16 a[14:15], v8 offset:14336
  v_cvt_pk_bf16_f32 v29, v110, v111
  v_mfma_f32_16x16x32_bf16 v[116:119], a[60:63], v[188:191], v[116:119]
  ds_write_b128 v39, a[136:139] offset:4096
  v_mfma_f32_16x16x32_bf16 v[120:123], a[32:35], v[192:195], 0
  ds_read_b64_tr_b16 a[16:17], v8 offset:16384
  v_mul_f32 v112, v112, v12
  v_mfma_f32_16x16x32_bf16 v[120:123], a[36:39], v[196:199], v[120:123]
  v_mul_f32 v113, v113, v12
  v_mul_f32 v114, v114, v12
  v_mfma_f32_16x16x32_bf16 v[120:123], a[40:43], v[200:203], v[120:123]
  ds_read_b64_tr_b16 a[18:19], v8 offset:18432
  v_mul_f32 v115, v115, v12
  v_mfma_f32_16x16x32_bf16 v[120:123], a[44:47], v[204:207], v[120:123]
  s_waitcnt vmcnt(4)
  v_cmp_ne_u32 vcc, 0x01010101, v54
  s_nop 0
  s_cbranch_vccnz L_cons6_spin
L_cons6_ok:
  v_mfma_f32_16x16x32_bf16 v[120:123], a[48:51], v[208:211], v[120:123]
  ds_read_b64_tr_b16 a[20:21], v8 offset:20480
  v_cvt_pk_bf16_f32 v18, v112, v113
  v_mfma_f32_16x16x32_bf16 v[120:123], a[52:55], v[212:215], v[120:123]
  ds_write_b128 v39, a[140:143] offset:8192
  v_mfma_f32_16x16x32_bf16 v[120:123], a[56:59], v[216:219], v[120:123]
  ds_read_b64_tr_b16 a[22:23], v8 offset:22528
  v_cvt_pk_bf16_f32 v19, v114, v115
  v_mfma_f32_16x16x32_bf16 v[120:123], a[60:63], v[220:223], v[120:123]
  s_waitcnt lgkmcnt(8)
  ds_write_b128 v39, a[144:147] offset:12288
  v_mfma_f32_16x16x32_bf16 v[124:127], a[32:35], v[224:227], 0
  ds_read_b64_tr_b16 a[24:25], v8 offset:24576
  v_mul_f32 v116, v116, v13
  v_mfma_f32_16x16x32_bf16 v[124:127], a[36:39], v[228:231], v[124:127]
  v_mul_f32 v117, v117, v13
  v_mul_f32 v118, v118, v13
  v_mfma_f32_16x16x32_bf16 v[124:127], a[40:43], v[232:235], v[124:127]
  s_add_u32 s69, s60, 524288
  ds_read_b64_tr_b16 a[26:27], v8 offset:26624
  v_mul_f32 v119, v119, v13
  v_mfma_f32_16x16x32_bf16 v[124:127], a[44:47], v[236:239], v[124:127]
  buffer_store_dwordx4 v[16:19], v11, s[56:59], s69 offen
  v_mfma_f32_16x16x32_bf16 v[124:127], a[48:51], v[240:243], v[124:127]
  s_waitcnt vmcnt(4)
  s_add_u32 s55, s75, 320
  ds_read_b64_tr_b16 a[28:29], v8 offset:28672
  v_cvt_pk_bf16_f32 v22, v116, v117
  v_mfma_f32_16x16x32_bf16 v[124:127], a[52:55], v[244:247], v[124:127]
  buffer_store_byte v51, v35, s[36:39], s55 offen
  v_mfma_f32_16x16x32_bf16 v[124:127], a[56:59], v[248:251], v[124:127]
  ds_read_b64_tr_b16 a[30:31], v8 offset:30720
  v_cvt_pk_bf16_f32 v23, v118, v119
  v_mfma_f32_16x16x32_bf16 v[124:127], a[60:63], v[252:255], v[124:127]
  s_waitcnt lgkmcnt(15)
  s_waitcnt vmcnt(4)
  v_cmp_ne_u32 vcc, 0x01010101, v53
  s_nop 0
  s_cbranch_vccnz L_prod4_spin
L_prod4_ok:
  v_mfma_f32_16x16x32_bf16 v[96:99], a[0:3], v[128:131], 0
  ds_read_b64_tr_b16 a[32:33], v9 offset:0
  v_mul_f32 v120, v120, v14
  v_mfma_f32_16x16x32_bf16 v[96:99], a[4:7], v[132:135], v[96:99]
  s_waitcnt lgkmcnt(12)
  v_mul_f32 v121, v121, v14
  v_mul_f32 v122, v122, v14
  v_mfma_f32_16x16x32_bf16 v[96:99], a[8:11], v[136:139], v[96:99]
  s_add_u32 s52, s61, 0
  ds_read_b64_tr_b16 a[34:35], v9 offset:2048
  v_mul_f32 v123, v123, v14
  v_mfma_f32_16x16x32_bf16 v[96:99], a[12:15], v[140:143], v[96:99]
  s_waitcnt lgkmcnt(7)
  buffer_load_dwordx4 a[64:67], v48, s[56:59], s52 offen sc1
  v_mfma_f32_16x16x32_bf16 v[96:99], a[16:19], v[144:147], v[96:99]
  ds_read_b64_tr_b16 a[36:37], v9 offset:4096
  v_cvt_pk_bf16_f32 v26, v120, v121
  v_mfma_f32_16x16x32_bf16 v[96:99], a[20:23], v[148:151], v[96:99]
  s_waitcnt lgkmcnt(3)
  v_add_u32 v8, 32768, v8
  v_mfma_f32_16x16x32_bf16 v[96:99], a[24:27], v[152:155], v[96:99]
  s_add_u32 s53, s61, 4096
  ds_read_b64_tr_b16 a[38:39], v9 offset:6144
  v_cvt_pk_bf16_f32 v27, v122, v123
  v_mfma_f32_16x16x32_bf16 v[96:99], a[28:31], v[156:159], v[96:99]
  buffer_load_dwordx4 a[68:71], v48, s[56:59], s53 offen sc1
  v_mfma_f32_16x16x32_bf16 v[100:103], a[0:3], v[160:163], 0
  ds_read_b64_tr_b16 a[40:41], v9 offset:8192
  v_mul_f32 v124, v124, v15
  v_mfma_f32_16x16x32_bf16 v[100:103], a[4:7], v[164:167], v[100:103]
  v_mul_f32 v125, v125, v15
  v_mul_f32 v126, v126, v15
  v_mfma_f32_16x16x32_bf16 v[100:103], a[8:11], v[168:171], v[100:103]
  s_add_u32 s70, s60, 540672
  ds_read_b64_tr_b16 a[42:43], v9 offset:10240
  v_mul_f32 v127, v127, v15
  v_mfma_f32_16x16x32_bf16 v[100:103], a[12:15], v[172:175], v[100:103]
  buffer_store_dwordx4 v[20:23], v11, s[56:59], s70 offen
  v_mfma_f32_16x16x32_bf16 v[100:103], a[16:19], v[176:179], v[100:103]
  ds_read_b64_tr_b16 a[44:45], v9 offset:12288
  v_cvt_pk_bf16_f32 v30, v124, v125
  v_mfma_f32_16x16x32_bf16 v[100:103], a[20:23], v[180:183], v[100:103]
  v_mfma_f32_16x16x32_bf16 v[100:103], a[24:27], v[184:187], v[100:103]
  ds_read_b64_tr_b16 a[46:47], v9 offset:14336
  v_cvt_pk_bf16_f32 v31, v126, v127
  v_mfma_f32_16x16x32_bf16 v[100:103], a[28:31], v[188:191], v[100:103]
  ds_write_b128 v39, a[148:151] offset:16384
  v_mfma_f32_16x16x32_bf16 v[104:107], a[0:3], v[192:195], 0
  ds_read_b64_tr_b16 a[48:49], v9 offset:16384
  v_mul_f32 v96, v96, v12
  v_mfma_f32_16x16x32_bf16 v[104:107], a[4:7], v[196:199], v[104:107]
  v_mul_f32 v97, v97, v12
  v_mul_f32 v98, v98, v12
  v_mfma_f32_16x16x32_bf16 v[104:107], a[8:11], v[200:203], v[104:107]
  s_add_u32 s52, s61, 8192
  ds_read_b64_tr_b16 a[50:51], v9 offset:18432
  v_mul_f32 v99, v99, v12
  v_mfma_f32_16x16x32_bf16 v[104:107], a[12:15], v[204:207], v[104:107]
  buffer_load_dwordx4 a[72:75], v48, s[56:59], s52 offen sc1
  v_mfma_f32_16x16x32_bf16 v[104:107], a[16:19], v[208:211], v[104:107]
  ds_read_b64_tr_b16 a[52:53], v9 offset:20480
  v_cvt_pk_bf16_f32 v16, v96, v97
  v_mfma_f32_16x16x32_bf16 v[104:107], a[20:23], v[212:215], v[104:107]
  v_add_u32 v6, 32768, v6
  v_mfma_f32_16x16x32_bf16 v[104:107], a[24:27], v[216:219], v[104:107]
  s_add_u32 s53, s61, 12288
  ds_read_b64_tr_b16 a[54:55], v9 offset:22528
  v_cvt_pk_bf16_f32 v17, v98, v99
  v_mfma_f32_16x16x32_bf16 v[104:107], a[28:31], v[220:223], v[104:107]
  buffer_load_dwordx4 a[76:79], v48, s[56:59], s53 offen sc1
  v_mfma_f32_16x16x32_bf16 v[108:111], a[0:3], v[224:227], 0
  ds_read_b64_tr_b16 a[56:57], v9 offset:24576
  v_mul_f32 v100, v100, v13
  v_mfma_f32_16x16x32_bf16 v[108:111], a[4:7], v[228:231], v[108:111]
  v_mul_f32 v101, v101, v13
  v_mul_f32 v102, v102, v13
  v_mfma_f32_16x16x32_bf16 v[108:111], a[8:11], v[232:235], v[108:111]
  s_waitcnt lgkmcnt(8)
  s_add_u32 s69, s60, 557056
  ds_read_b64_tr_b16 a[58:59], v9 offset:26624
  v_mul_f32 v103, v103, v13
  v_mfma_f32_16x16x32_bf16 v[108:111], a[12:15], v[236:239], v[108:111]
  s_waitcnt vmcnt(9)
  s_barrier
  buffer_store_dwordx4 v[24:27], v11, s[56:59], s69 offen
  v_mfma_f32_16x16x32_bf16 v[108:111], a[16:19], v[240:243], v[108:111]
  ds_read_b64_tr_b16 a[60:61], v9 offset:28672
  v_cvt_pk_bf16_f32 v20, v100, v101
  v_mfma_f32_16x16x32_bf16 v[108:111], a[20:23], v[244:247], v[108:111]
  v_mfma_f32_16x16x32_bf16 v[108:111], a[24:27], v[248:251], v[108:111]
  s_add_u32 s54, s76, 192
  ds_read_b64_tr_b16 a[62:63], v9 offset:30720
  v_cvt_pk_bf16_f32 v21, v102, v103
  v_mfma_f32_16x16x32_bf16 v[108:111], a[28:31], v[252:255], v[108:111]
  s_waitcnt lgkmcnt(13)
  buffer_load_dword v54, v50, s[36:39], s54 offen sc1
  v_mfma_f32_16x16x32_bf16 v[112:115], a[32:35], v[128:131], 0
  ds_read_b64_tr_b16 a[0:1], v6 offset:0
  v_mul_f32 v104, v104, v14
  v_mfma_f32_16x16x32_bf16 v[112:115], a[36:39], v[132:135], v[112:115]
  s_waitcnt lgkmcnt(10)
  v_mul_f32 v105, v105, v14
  v_mul_f32 v106, v106, v14
  v_mfma_f32_16x16x32_bf16 v[112:115], a[40:43], v[136:139], v[112:115]
  s_add_u32 s70, s60, 573440
  ds_read_b64_tr_b16 a[2:3], v6 offset:2048
  v_mul_f32 v107, v107, v14
  v_mfma_f32_16x16x32_bf16 v[112:115], a[44:47], v[140:143], v[112:115]
  s_waitcnt lgkmcnt(6)
  buffer_store_dwordx4 v[28:31], v11, s[56:59], s70 offen
  v_mfma_f32_16x16x32_bf16 v[112:115], a[48:51], v[144:147], v[112:115]
  ds_read_b64_tr_b16 a[4:5], v6 offset:4096
  v_cvt_pk_bf16_f32 v24, v104, v105
  v_mfma_f32_16x16x32_bf16 v[112:115], a[52:55], v[148:151], v[112:115]
  s_waitcnt lgkmcnt(3)
  v_add_u32 v9, 32768, v9
  v_mfma_f32_16x16x32_bf16 v[112:115], a[56:59], v[152:155], v[112:115]
  s_add_u32 s54, s78, 320
  ds_read_b64_tr_b16 a[6:7], v6 offset:6144
  v_cvt_pk_bf16_f32 v25, v106, v107
  v_mfma_f32_16x16x32_bf16 v[112:115], a[60:63], v[156:159], v[112:115]
  s_waitcnt vmcnt(3)
  buffer_load_dword v53, v50, s[36:39], s54 offen sc1
  v_mfma_f32_16x16x32_bf16 v[40:43], a[96:99], a[64:67], 0
  v_cvt_pk_bf16_f32 v44, v44, v45
  v_cvt_pk_bf16_f32 v45, v46, v47
  v_mfma_f32_16x16x32_bf16 v[40:43], a[96:99], a[68:71], v[40:43]
  v_mfma_f32_16x16x32_bf16 v[40:43], a[96:99], a[72:75], v[40:43]
  v_mfma_f32_16x16x32_bf16 v[40:43], a[96:99], a[76:79], v[40:43]
  v_mfma_f32_16x16x32_bf16 v[116:119], a[32:35], v[160:163], 0
  ds_read_b64_tr_b16 a[8:9], v6 offset:8192
  v_mul_f32 v108, v108, v15
  v_mfma_f32_16x16x32_bf16 v[116:119], a[36:39], v[164:167], v[116:119]
  v_mul_f32 v109, v109, v15
  v_mul_f32 v110, v110, v15
  v_mfma_f32_16x16x32_bf16 v[116:119], a[40:43], v[168:171], v[116:119]
  s_add_u32 s55, s79, 256
  ds_read_b64_tr_b16 a[10:11], v6 offset:10240
  v_mul_f32 v111, v111, v15
  v_mfma_f32_16x16x32_bf16 v[116:119], a[44:47], v[172:175], v[116:119]
  buffer_store_byte v51, v35, s[36:39], s55 offen
  v_mfma_f32_16x16x32_bf16 v[116:119], a[48:51], v[176:179], v[116:119]
  ds_read_b64_tr_b16 a[12:13], v6 offset:12288
  v_cvt_pk_bf16_f32 v28, v108, v109
  v_mfma_f32_16x16x32_bf16 v[116:119], a[52:55], v[180:183], v[116:119]
  buffer_store_dwordx2 v[44:45], v49, s[28:31], 0 offen offset:192
  v_mfma_f32_16x16x32_bf16 v[116:119], a[56:59], v[184:187], v[116:119]
  ds_read_b64_tr_b16 a[14:15], v6 offset:14336
  v_cvt_pk_bf16_f32 v29, v110, v111
  v_mfma_f32_16x16x32_bf16 v[116:119], a[60:63], v[188:191], v[116:119]
  ds_write_b128 v39, a[152:155] offset:20480
  v_mfma_f32_16x16x32_bf16 v[120:123], a[32:35], v[192:195], 0
  ds_read_b64_tr_b16 a[16:17], v6 offset:16384
  v_mul_f32 v112, v112, v12
  v_mfma_f32_16x16x32_bf16 v[120:123], a[36:39], v[196:199], v[120:123]
  v_mul_f32 v113, v113, v12
  v_mul_f32 v114, v114, v12
  v_mfma_f32_16x16x32_bf16 v[120:123], a[40:43], v[200:203], v[120:123]
  ds_read_b64_tr_b16 a[18:19], v6 offset:18432
  v_mul_f32 v115, v115, v12
  v_mfma_f32_16x16x32_bf16 v[120:123], a[44:47], v[204:207], v[120:123]
  s_waitcnt vmcnt(4)
  v_cmp_ne_u32 vcc, 0x01010101, v54
  s_nop 0
  s_cbranch_vccnz L_cons7_spin
L_cons7_ok:
  v_mfma_f32_16x16x32_bf16 v[120:123], a[48:51], v[208:211], v[120:123]
  ds_read_b64_tr_b16 a[20:21], v6 offset:20480
  v_cvt_pk_bf16_f32 v18, v112, v113
  v_mfma_f32_16x16x32_bf16 v[120:123], a[52:55], v[212:215], v[120:123]
  ds_write_b128 v39, a[156:159] offset:24576
  v_mfma_f32_16x16x32_bf16 v[120:123], a[56:59], v[216:219], v[120:123]
  ds_read_b64_tr_b16 a[22:23], v6 offset:22528
  v_cvt_pk_bf16_f32 v19, v114, v115
  v_mfma_f32_16x16x32_bf16 v[120:123], a[60:63], v[220:223], v[120:123]
  s_waitcnt lgkmcnt(8)
  ds_write_b128 v39, a[160:163] offset:28672
  v_mfma_f32_16x16x32_bf16 v[124:127], a[32:35], v[224:227], 0
  ds_read_b64_tr_b16 a[24:25], v6 offset:24576
  v_mul_f32 v116, v116, v13
  v_mfma_f32_16x16x32_bf16 v[124:127], a[36:39], v[228:231], v[124:127]
  v_mul_f32 v117, v117, v13
  v_mul_f32 v118, v118, v13
  v_mfma_f32_16x16x32_bf16 v[124:127], a[40:43], v[232:235], v[124:127]
  s_add_u32 s69, s60, 786432
  ds_read_b64_tr_b16 a[26:27], v6 offset:26624
  v_mul_f32 v119, v119, v13
  v_mfma_f32_16x16x32_bf16 v[124:127], a[44:47], v[236:239], v[124:127]
  buffer_store_dwordx4 v[16:19], v11, s[56:59], s69 offen
  v_mfma_f32_16x16x32_bf16 v[124:127], a[48:51], v[240:243], v[124:127]
  s_waitcnt vmcnt(4)
  s_add_u32 s55, s75, 384
  ds_read_b64_tr_b16 a[28:29], v6 offset:28672
  v_cvt_pk_bf16_f32 v22, v116, v117
  v_mfma_f32_16x16x32_bf16 v[124:127], a[52:55], v[244:247], v[124:127]
  buffer_store_byte v51, v35, s[36:39], s55 offen
  v_mfma_f32_16x16x32_bf16 v[124:127], a[56:59], v[248:251], v[124:127]
  ds_read_b64_tr_b16 a[30:31], v6 offset:30720
  v_cvt_pk_bf16_f32 v23, v118, v119
  v_mfma_f32_16x16x32_bf16 v[124:127], a[60:63], v[252:255], v[124:127]
  s_waitcnt lgkmcnt(15)
  s_waitcnt vmcnt(4)
  v_cmp_ne_u32 vcc, 0x01010101, v53
  s_nop 0
  s_cbranch_vccnz L_prod5_spin
L_prod5_ok:
  v_mfma_f32_16x16x32_bf16 v[96:99], a[0:3], v[128:131], 0
  ds_read_b64_tr_b16 a[32:33], v7 offset:0
  v_mul_f32 v120, v120, v14
  v_mfma_f32_16x16x32_bf16 v[96:99], a[4:7], v[132:135], v[96:99]
  s_waitcnt lgkmcnt(12)
  v_mul_f32 v121, v121, v14
  v_mul_f32 v122, v122, v14
  v_mfma_f32_16x16x32_bf16 v[96:99], a[8:11], v[136:139], v[96:99]
  s_add_u32 s52, s61, 262144
  ds_read_b64_tr_b16 a[34:35], v7 offset:2048
  v_mul_f32 v123, v123, v14
  v_mfma_f32_16x16x32_bf16 v[96:99], a[12:15], v[140:143], v[96:99]
  s_waitcnt lgkmcnt(7)
  buffer_load_dwordx4 a[80:83], v48, s[56:59], s52 offen sc1
  v_mfma_f32_16x16x32_bf16 v[96:99], a[16:19], v[144:147], v[96:99]
  ds_read_b64_tr_b16 a[36:37], v7 offset:4096
  v_cvt_pk_bf16_f32 v26, v120, v121
  v_mfma_f32_16x16x32_bf16 v[96:99], a[20:23], v[148:151], v[96:99]
  s_waitcnt lgkmcnt(3)
  v_mfma_f32_16x16x32_bf16 v[96:99], a[24:27], v[152:155], v[96:99]
  s_add_u32 s53, s61, 266240
  ds_read_b64_tr_b16 a[38:39], v7 offset:6144
  v_cvt_pk_bf16_f32 v27, v122, v123
  v_mfma_f32_16x16x32_bf16 v[96:99], a[28:31], v[156:159], v[96:99]
  buffer_load_dwordx4 a[84:87], v48, s[56:59], s53 offen sc1
  v_mfma_f32_16x16x32_bf16 v[100:103], a[0:3], v[160:163], 0
  ds_read_b64_tr_b16 a[40:41], v7 offset:8192
  v_mul_f32 v124, v124, v15
  v_mfma_f32_16x16x32_bf16 v[100:103], a[4:7], v[164:167], v[100:103]
  v_mul_f32 v125, v125, v15
  v_mul_f32 v126, v126, v15
  v_mfma_f32_16x16x32_bf16 v[100:103], a[8:11], v[168:171], v[100:103]
  s_add_u32 s70, s60, 802816
  ds_read_b64_tr_b16 a[42:43], v7 offset:10240
  v_mul_f32 v127, v127, v15
  v_mfma_f32_16x16x32_bf16 v[100:103], a[12:15], v[172:175], v[100:103]
  buffer_store_dwordx4 v[20:23], v11, s[56:59], s70 offen
  v_mfma_f32_16x16x32_bf16 v[100:103], a[16:19], v[176:179], v[100:103]
  ds_read_b64_tr_b16 a[44:45], v7 offset:12288
  v_cvt_pk_bf16_f32 v30, v124, v125
  v_mfma_f32_16x16x32_bf16 v[100:103], a[20:23], v[180:183], v[100:103]
  v_mfma_f32_16x16x32_bf16 v[100:103], a[24:27], v[184:187], v[100:103]
  ds_read_b64_tr_b16 a[46:47], v7 offset:14336
  v_cvt_pk_bf16_f32 v31, v126, v127
  v_mfma_f32_16x16x32_bf16 v[100:103], a[28:31], v[188:191], v[100:103]
  v_mfma_f32_16x16x32_bf16 v[104:107], a[0:3], v[192:195], 0
  ds_read_b64_tr_b16 a[48:49], v7 offset:16384
  v_mul_f32 v96, v96, v12
  v_mfma_f32_16x16x32_bf16 v[104:107], a[4:7], v[196:199], v[104:107]
  v_mul_f32 v97, v97, v12
  v_mul_f32 v98, v98, v12
  v_mfma_f32_16x16x32_bf16 v[104:107], a[8:11], v[200:203], v[104:107]
  s_add_u32 s52, s61, 270336
  ds_read_b64_tr_b16 a[50:51], v7 offset:18432
  v_mul_f32 v99, v99, v12
  v_mfma_f32_16x16x32_bf16 v[104:107], a[12:15], v[204:207], v[104:107]
  buffer_load_dwordx4 a[88:91], v48, s[56:59], s52 offen sc1
  v_mfma_f32_16x16x32_bf16 v[104:107], a[16:19], v[208:211], v[104:107]
  ds_read_b64_tr_b16 a[52:53], v7 offset:20480
  v_cvt_pk_bf16_f32 v16, v96, v97
  v_mfma_f32_16x16x32_bf16 v[104:107], a[20:23], v[212:215], v[104:107]
  v_mfma_f32_16x16x32_bf16 v[104:107], a[24:27], v[216:219], v[104:107]
  s_add_u32 s53, s61, 274432
  ds_read_b64_tr_b16 a[54:55], v7 offset:22528
  v_cvt_pk_bf16_f32 v17, v98, v99
  v_mfma_f32_16x16x32_bf16 v[104:107], a[28:31], v[220:223], v[104:107]
  buffer_load_dwordx4 a[92:95], v48, s[56:59], s53 offen sc1
  v_mfma_f32_16x16x32_bf16 v[108:111], a[0:3], v[224:227], 0
  ds_read_b64_tr_b16 a[56:57], v7 offset:24576
  v_mul_f32 v100, v100, v13
  v_mfma_f32_16x16x32_bf16 v[108:111], a[4:7], v[228:231], v[108:111]
  v_mul_f32 v101, v101, v13
  v_mul_f32 v102, v102, v13
  v_mfma_f32_16x16x32_bf16 v[108:111], a[8:11], v[232:235], v[108:111]
  s_add_u32 s69, s60, 819200
  ds_read_b64_tr_b16 a[58:59], v7 offset:26624
  v_mul_f32 v103, v103, v13
  v_mfma_f32_16x16x32_bf16 v[108:111], a[12:15], v[236:239], v[108:111]
  buffer_store_dwordx4 v[24:27], v11, s[56:59], s69 offen
  v_mfma_f32_16x16x32_bf16 v[108:111], a[16:19], v[240:243], v[108:111]
  s_waitcnt lgkmcnt(8)
  ds_read_b64_tr_b16 a[60:61], v7 offset:28672
  v_cvt_pk_bf16_f32 v20, v100, v101
  v_mfma_f32_16x16x32_bf16 v[108:111], a[20:23], v[244:247], v[108:111]
  v_mfma_f32_16x16x32_bf16 v[108:111], a[24:27], v[248:251], v[108:111]
  s_add_u32 s54, s76, 256
  ds_read_b64_tr_b16 a[62:63], v7 offset:30720
  v_cvt_pk_bf16_f32 v21, v102, v103
  v_mfma_f32_16x16x32_bf16 v[108:111], a[28:31], v[252:255], v[108:111]
  s_waitcnt lgkmcnt(12)
  buffer_load_dword v54, v50, s[36:39], s54 offen sc1
  v_mfma_f32_16x16x32_bf16 v[112:115], a[32:35], v[128:131], 0
  ds_read_b64_tr_b16 a[0:1], v8 offset:0
  v_mul_f32 v104, v104, v14
  v_mfma_f32_16x16x32_bf16 v[112:115], a[36:39], v[132:135], v[112:115]
  s_waitcnt lgkmcnt(9)
  v_mul_f32 v105, v105, v14
  v_mul_f32 v106, v106, v14
  v_mfma_f32_16x16x32_bf16 v[112:115], a[40:43], v[136:139], v[112:115]
  s_add_u32 s70, s60, 835584
  ds_read_b64_tr_b16 a[2:3], v8 offset:2048
  v_mul_f32 v107, v107, v14
  v_mfma_f32_16x16x32_bf16 v[112:115], a[44:47], v[140:143], v[112:115]
  s_waitcnt lgkmcnt(6)
  buffer_store_dwordx4 v[28:31], v11, s[56:59], s70 offen
  v_mfma_f32_16x16x32_bf16 v[112:115], a[48:51], v[144:147], v[112:115]
  ds_read_b64_tr_b16 a[4:5], v8 offset:4096
  v_cvt_pk_bf16_f32 v24, v104, v105
  v_mfma_f32_16x16x32_bf16 v[112:115], a[52:55], v[148:151], v[112:115]
  s_waitcnt lgkmcnt(3)
  v_add_u32 v7, 32768, v7
  v_mfma_f32_16x16x32_bf16 v[112:115], a[56:59], v[152:155], v[112:115]
  s_add_u32 s54, s78, 384
  ds_read_b64_tr_b16 a[6:7], v8 offset:6144
  v_cvt_pk_bf16_f32 v25, v106, v107
  v_mfma_f32_16x16x32_bf16 v[112:115], a[60:63], v[156:159], v[112:115]
  s_waitcnt vmcnt(3)
  buffer_load_dword v53, v50, s[36:39], s54 offen sc1
  v_mfma_f32_16x16x32_bf16 v[44:47], a[96:99], a[80:83], 0
  v_cvt_pk_bf16_f32 v40, v40, v41
  v_cvt_pk_bf16_f32 v41, v42, v43
  v_mfma_f32_16x16x32_bf16 v[44:47], a[96:99], a[84:87], v[44:47]
  v_mfma_f32_16x16x32_bf16 v[44:47], a[96:99], a[88:91], v[44:47]
  v_mfma_f32_16x16x32_bf16 v[44:47], a[96:99], a[92:95], v[44:47]
  v_mfma_f32_16x16x32_bf16 v[116:119], a[32:35], v[160:163], 0
  ds_read_b64_tr_b16 a[8:9], v8 offset:8192
  v_mul_f32 v108, v108, v15
  v_mfma_f32_16x16x32_bf16 v[116:119], a[36:39], v[164:167], v[116:119]
  v_mul_f32 v109, v109, v15
  v_mul_f32 v110, v110, v15
  v_mfma_f32_16x16x32_bf16 v[116:119], a[40:43], v[168:171], v[116:119]
  s_add_u32 s55, s79, 320
  ds_read_b64_tr_b16 a[10:11], v8 offset:10240
  v_mul_f32 v111, v111, v15
  v_mfma_f32_16x16x32_bf16 v[116:119], a[44:47], v[172:175], v[116:119]
  buffer_store_byte v51, v35, s[36:39], s55 offen
  v_mfma_f32_16x16x32_bf16 v[116:119], a[48:51], v[176:179], v[116:119]
  ds_read_b64_tr_b16 a[12:13], v8 offset:12288
  v_cvt_pk_bf16_f32 v28, v108, v109
  v_mfma_f32_16x16x32_bf16 v[116:119], a[52:55], v[180:183], v[116:119]
  buffer_store_dwordx2 v[40:41], v49, s[28:31], 0 offen offset:256
  v_mfma_f32_16x16x32_bf16 v[116:119], a[56:59], v[184:187], v[116:119]
  ds_read_b64_tr_b16 a[14:15], v8 offset:14336
  v_cvt_pk_bf16_f32 v29, v110, v111
  v_mfma_f32_16x16x32_bf16 v[116:119], a[60:63], v[188:191], v[116:119]
  v_mfma_f32_16x16x32_bf16 v[120:123], a[32:35], v[192:195], 0
  ds_read_b64_tr_b16 a[16:17], v8 offset:16384
  v_mul_f32 v112, v112, v12
  v_mfma_f32_16x16x32_bf16 v[120:123], a[36:39], v[196:199], v[120:123]
  v_mul_f32 v113, v113, v12
  v_mul_f32 v114, v114, v12
  v_mfma_f32_16x16x32_bf16 v[120:123], a[40:43], v[200:203], v[120:123]
  ds_read_b64_tr_b16 a[18:19], v8 offset:18432
  v_mul_f32 v115, v115, v12
  v_mfma_f32_16x16x32_bf16 v[120:123], a[44:47], v[204:207], v[120:123]
  s_waitcnt vmcnt(4)
  v_cmp_ne_u32 vcc, 0x01010101, v54
  s_nop 0
  s_cbranch_vccnz L_cons8_spin
L_cons8_ok:
  v_mfma_f32_16x16x32_bf16 v[120:123], a[48:51], v[208:211], v[120:123]
  ds_read_b64_tr_b16 a[20:21], v8 offset:20480
  v_cvt_pk_bf16_f32 v18, v112, v113
  v_mfma_f32_16x16x32_bf16 v[120:123], a[52:55], v[212:215], v[120:123]
  v_mfma_f32_16x16x32_bf16 v[120:123], a[56:59], v[216:219], v[120:123]
  ds_read_b64_tr_b16 a[22:23], v8 offset:22528
  v_cvt_pk_bf16_f32 v19, v114, v115
  v_mfma_f32_16x16x32_bf16 v[120:123], a[60:63], v[220:223], v[120:123]
  v_mfma_f32_16x16x32_bf16 v[124:127], a[32:35], v[224:227], 0
  ds_read_b64_tr_b16 a[24:25], v8 offset:24576
  v_mul_f32 v116, v116, v13
  v_mfma_f32_16x16x32_bf16 v[124:127], a[36:39], v[228:231], v[124:127]
  v_mul_f32 v117, v117, v13
  v_mul_f32 v118, v118, v13
  v_mfma_f32_16x16x32_bf16 v[124:127], a[40:43], v[232:235], v[124:127]
  s_add_u32 s69, s60, 0
  ds_read_b64_tr_b16 a[26:27], v8 offset:26624
  v_mul_f32 v119, v119, v13
  v_mfma_f32_16x16x32_bf16 v[124:127], a[44:47], v[236:239], v[124:127]
  buffer_store_dwordx4 v[16:19], v11, s[56:59], s69 offen
  v_mfma_f32_16x16x32_bf16 v[124:127], a[48:51], v[240:243], v[124:127]
  s_waitcnt lgkmcnt(8)
  s_waitcnt vmcnt(4)
  s_add_u32 s55, s75, 448
  ds_read_b64_tr_b16 a[28:29], v8 offset:28672
  v_cvt_pk_bf16_f32 v22, v116, v117
  v_mfma_f32_16x16x32_bf16 v[124:127], a[52:55], v[244:247], v[124:127]
  buffer_store_byte v51, v35, s[36:39], s55 offen
  v_mfma_f32_16x16x32_bf16 v[124:127], a[56:59], v[248:251], v[124:127]
  ds_read_b64_tr_b16 a[30:31], v8 offset:30720
  v_cvt_pk_bf16_f32 v23, v118, v119
  v_mfma_f32_16x16x32_bf16 v[124:127], a[60:63], v[252:255], v[124:127]
  s_waitcnt lgkmcnt(12)
  s_waitcnt vmcnt(4)
  v_cmp_ne_u32 vcc, 0x01010101, v53
  s_nop 0
  s_cbranch_vccnz L_prod6_spin
L_prod6_ok:
  v_mfma_f32_16x16x32_bf16 v[96:99], a[0:3], v[128:131], 0
  ds_read_b64_tr_b16 a[32:33], v9 offset:0
  v_mul_f32 v120, v120, v14
  v_mfma_f32_16x16x32_bf16 v[96:99], a[4:7], v[132:135], v[96:99]
  s_waitcnt lgkmcnt(9)
  v_mul_f32 v121, v121, v14
  v_mul_f32 v122, v122, v14
  v_mfma_f32_16x16x32_bf16 v[96:99], a[8:11], v[136:139], v[96:99]
  s_add_u32 s52, s61, 524288
  ds_read_b64_tr_b16 a[34:35], v9 offset:2048
  v_mul_f32 v123, v123, v14
  v_mfma_f32_16x16x32_bf16 v[96:99], a[12:15], v[140:143], v[96:99]
  s_waitcnt lgkmcnt(6)
  buffer_load_dwordx4 a[64:67], v48, s[56:59], s52 offen sc1
  v_mfma_f32_16x16x32_bf16 v[96:99], a[16:19], v[144:147], v[96:99]
  ds_read_b64_tr_b16 a[36:37], v9 offset:4096
  v_cvt_pk_bf16_f32 v26, v120, v121
  v_mfma_f32_16x16x32_bf16 v[96:99], a[20:23], v[148:151], v[96:99]
  s_waitcnt lgkmcnt(3)
  v_add_u32 v8, 32768, v8
  v_mfma_f32_16x16x32_bf16 v[96:99], a[24:27], v[152:155], v[96:99]
  s_add_u32 s53, s61, 528384
  ds_read_b64_tr_b16 a[38:39], v9 offset:6144
  v_cvt_pk_bf16_f32 v27, v122, v123
  v_mfma_f32_16x16x32_bf16 v[96:99], a[28:31], v[156:159], v[96:99]
  buffer_load_dwordx4 a[68:71], v48, s[56:59], s53 offen sc1
  v_mfma_f32_16x16x32_bf16 v[100:103], a[0:3], v[160:163], 0
  ds_read_b64_tr_b16 a[40:41], v9 offset:8192
  v_mul_f32 v124, v124, v15
  v_mfma_f32_16x16x32_bf16 v[100:103], a[4:7], v[164:167], v[100:103]
  v_mul_f32 v125, v125, v15
  v_mul_f32 v126, v126, v15
  v_mfma_f32_16x16x32_bf16 v[100:103], a[8:11], v[168:171], v[100:103]
  s_add_u32 s70, s60, 16384
  ds_read_b64_tr_b16 a[42:43], v9 offset:10240
  v_mul_f32 v127, v127, v15
  v_mfma_f32_16x16x32_bf16 v[100:103], a[12:15], v[172:175], v[100:103]
  buffer_store_dwordx4 v[20:23], v11, s[56:59], s70 offen
  v_mfma_f32_16x16x32_bf16 v[100:103], a[16:19], v[176:179], v[100:103]
  ds_read_b64_tr_b16 a[44:45], v9 offset:12288
  v_cvt_pk_bf16_f32 v30, v124, v125
  v_mfma_f32_16x16x32_bf16 v[100:103], a[20:23], v[180:183], v[100:103]
  v_mfma_f32_16x16x32_bf16 v[100:103], a[24:27], v[184:187], v[100:103]
  ds_read_b64_tr_b16 a[46:47], v9 offset:14336
  v_cvt_pk_bf16_f32 v31, v126, v127
  v_mfma_f32_16x16x32_bf16 v[100:103], a[28:31], v[188:191], v[100:103]
  v_mfma_f32_16x16x32_bf16 v[104:107], a[0:3], v[192:195], 0
  ds_read_b64_tr_b16 a[48:49], v9 offset:16384
  v_mul_f32 v96, v96, v12
  v_mfma_f32_16x16x32_bf16 v[104:107], a[4:7], v[196:199], v[104:107]
  v_mul_f32 v97, v97, v12
  v_mul_f32 v98, v98, v12
  v_mfma_f32_16x16x32_bf16 v[104:107], a[8:11], v[200:203], v[104:107]
  s_add_u32 s52, s61, 532480
  ds_read_b64_tr_b16 a[50:51], v9 offset:18432
  v_mul_f32 v99, v99, v12
  v_mfma_f32_16x16x32_bf16 v[104:107], a[12:15], v[204:207], v[104:107]
  buffer_load_dwordx4 a[72:75], v48, s[56:59], s52 offen sc1
  v_mfma_f32_16x16x32_bf16 v[104:107], a[16:19], v[208:211], v[104:107]
  ds_read_b64_tr_b16 a[52:53], v9 offset:20480
  v_cvt_pk_bf16_f32 v16, v96, v97
  v_mfma_f32_16x16x32_bf16 v[104:107], a[20:23], v[212:215], v[104:107]
  v_add_u32 v6, 32768, v6
  v_mfma_f32_16x16x32_bf16 v[104:107], a[24:27], v[216:219], v[104:107]
  s_add_u32 s53, s61, 536576
  ds_read_b64_tr_b16 a[54:55], v9 offset:22528
  v_cvt_pk_bf16_f32 v17, v98, v99
  v_mfma_f32_16x16x32_bf16 v[104:107], a[28:31], v[220:223], v[104:107]
  buffer_load_dwordx4 a[76:79], v48, s[56:59], s53 offen sc1
  v_mfma_f32_16x16x32_bf16 v[108:111], a[0:3], v[224:227], 0
  ds_read_b64_tr_b16 a[56:57], v9 offset:24576
  v_mul_f32 v100, v100, v13
  v_mfma_f32_16x16x32_bf16 v[108:111], a[4:7], v[228:231], v[108:111]
  v_mul_f32 v101, v101, v13
  v_mul_f32 v102, v102, v13
  v_mfma_f32_16x16x32_bf16 v[108:111], a[8:11], v[232:235], v[108:111]
  s_add_u32 s69, s60, 32768
  ds_read_b64_tr_b16 a[58:59], v9 offset:26624
  v_mul_f32 v103, v103, v13
  v_mfma_f32_16x16x32_bf16 v[108:111], a[12:15], v[236:239], v[108:111]
  s_barrier
  buffer_store_dwordx4 v[24:27], v11, s[56:59], s69 offen
  v_mfma_f32_16x16x32_bf16 v[108:111], a[16:19], v[240:243], v[108:111]
  s_waitcnt lgkmcnt(8)
  ds_read_b64_tr_b16 a[60:61], v9 offset:28672
  v_cvt_pk_bf16_f32 v20, v100, v101
  v_mfma_f32_16x16x32_bf16 v[108:111], a[20:23], v[244:247], v[108:111]
  v_mfma_f32_16x16x32_bf16 v[108:111], a[24:27], v[248:251], v[108:111]
  s_add_u32 s54, s76, 320
  ds_read_b64_tr_b16 a[62:63], v9 offset:30720
  v_cvt_pk_bf16_f32 v21, v102, v103
  v_mfma_f32_16x16x32_bf16 v[108:111], a[28:31], v[252:255], v[108:111]
  s_waitcnt lgkmcnt(12)
  buffer_load_dword v54, v50, s[36:39], s54 offen sc1
  v_mfma_f32_16x16x32_bf16 v[112:115], a[32:35], v[128:131], 0
  ds_read_b64_tr_b16 a[0:1], v6 offset:0
  v_mul_f32 v104, v104, v14
  v_mfma_f32_16x16x32_bf16 v[112:115], a[36:39], v[132:135], v[112:115]
  s_waitcnt lgkmcnt(9)
  v_mul_f32 v105, v105, v14
  v_mul_f32 v106, v106, v14
  v_mfma_f32_16x16x32_bf16 v[112:115], a[40:43], v[136:139], v[112:115]
  s_add_u32 s70, s60, 49152
  ds_read_b64_tr_b16 a[2:3], v6 offset:2048
  v_mul_f32 v107, v107, v14
  v_mfma_f32_16x16x32_bf16 v[112:115], a[44:47], v[140:143], v[112:115]
  s_waitcnt lgkmcnt(6)
  buffer_store_dwordx4 v[28:31], v11, s[56:59], s70 offen
  v_mfma_f32_16x16x32_bf16 v[112:115], a[48:51], v[144:147], v[112:115]
  ds_read_b64_tr_b16 a[4:5], v6 offset:4096
  v_cvt_pk_bf16_f32 v24, v104, v105
  v_mfma_f32_16x16x32_bf16 v[112:115], a[52:55], v[148:151], v[112:115]
  s_waitcnt lgkmcnt(3)
  v_add_u32 v9, 32768, v9
  v_mfma_f32_16x16x32_bf16 v[112:115], a[56:59], v[152:155], v[112:115]
  s_add_u32 s54, s78, 448
  ds_read_b64_tr_b16 a[6:7], v6 offset:6144
  v_cvt_pk_bf16_f32 v25, v106, v107
  v_mfma_f32_16x16x32_bf16 v[112:115], a[60:63], v[156:159], v[112:115]
  s_waitcnt vmcnt(3)
  buffer_load_dword v53, v50, s[36:39], s54 offen sc1
  v_mfma_f32_16x16x32_bf16 v[40:43], a[96:99], a[64:67], 0
  v_cvt_pk_bf16_f32 v44, v44, v45
  v_cvt_pk_bf16_f32 v45, v46, v47
  v_mfma_f32_16x16x32_bf16 v[40:43], a[96:99], a[68:71], v[40:43]
  v_mfma_f32_16x16x32_bf16 v[40:43], a[96:99], a[72:75], v[40:43]
  v_mfma_f32_16x16x32_bf16 v[40:43], a[96:99], a[76:79], v[40:43]
  v_mfma_f32_16x16x32_bf16 v[116:119], a[32:35], v[160:163], 0
  ds_read_b64_tr_b16 a[8:9], v6 offset:8192
  v_mul_f32 v108, v108, v15
  v_mfma_f32_16x16x32_bf16 v[116:119], a[36:39], v[164:167], v[116:119]
  v_mul_f32 v109, v109, v15
  v_mul_f32 v110, v110, v15
  v_mfma_f32_16x16x32_bf16 v[116:119], a[40:43], v[168:171], v[116:119]
  s_add_u32 s55, s79, 384
  ds_read_b64_tr_b16 a[10:11], v6 offset:10240
  v_mul_f32 v111, v111, v15
  v_mfma_f32_16x16x32_bf16 v[116:119], a[44:47], v[172:175], v[116:119]
  buffer_store_byte v51, v35, s[36:39], s55 offen
  v_mfma_f32_16x16x32_bf16 v[116:119], a[48:51], v[176:179], v[116:119]
  ds_read_b64_tr_b16 a[12:13], v6 offset:12288
  v_cvt_pk_bf16_f32 v28, v108, v109
  v_mfma_f32_16x16x32_bf16 v[116:119], a[52:55], v[180:183], v[116:119]
  buffer_store_dwordx2 v[44:45], v49, s[28:31], 0 offen offset:320
  v_mfma_f32_16x16x32_bf16 v[116:119], a[56:59], v[184:187], v[116:119]
  ds_read_b64_tr_b16 a[14:15], v6 offset:14336
  v_cvt_pk_bf16_f32 v29, v110, v111
  v_mfma_f32_16x16x32_bf16 v[116:119], a[60:63], v[188:191], v[116:119]
  v_mfma_f32_16x16x32_bf16 v[120:123], a[32:35], v[192:195], 0
  ds_read_b64_tr_b16 a[16:17], v6 offset:16384
  v_mul_f32 v112, v112, v12
  v_mfma_f32_16x16x32_bf16 v[120:123], a[36:39], v[196:199], v[120:123]
  v_mul_f32 v113, v113, v12
  v_mul_f32 v114, v114, v12
  v_mfma_f32_16x16x32_bf16 v[120:123], a[40:43], v[200:203], v[120:123]
  ds_read_b64_tr_b16 a[18:19], v6 offset:18432
  v_mul_f32 v115, v115, v12
  v_mfma_f32_16x16x32_bf16 v[120:123], a[44:47], v[204:207], v[120:123]
  s_waitcnt vmcnt(4)
  v_cmp_ne_u32 vcc, 0x01010101, v54
  s_nop 0
  s_cbranch_vccnz L_cons9_spin
L_cons9_ok:
  v_mfma_f32_16x16x32_bf16 v[120:123], a[48:51], v[208:211], v[120:123]
  ds_read_b64_tr_b16 a[20:21], v6 offset:20480
  v_cvt_pk_bf16_f32 v18, v112, v113
  v_mfma_f32_16x16x32_bf16 v[120:123], a[52:55], v[212:215], v[120:123]
  v_mfma_f32_16x16x32_bf16 v[120:123], a[56:59], v[216:219], v[120:123]
  ds_read_b64_tr_b16 a[22:23], v6 offset:22528
  v_cvt_pk_bf16_f32 v19, v114, v115
  v_mfma_f32_16x16x32_bf16 v[120:123], a[60:63], v[220:223], v[120:123]
  v_mfma_f32_16x16x32_bf16 v[124:127], a[32:35], v[224:227], 0
  ds_read_b64_tr_b16 a[24:25], v6 offset:24576
  v_mul_f32 v116, v116, v13
  v_mfma_f32_16x16x32_bf16 v[124:127], a[36:39], v[228:231], v[124:127]
  v_mul_f32 v117, v117, v13
  v_mul_f32 v118, v118, v13
  v_mfma_f32_16x16x32_bf16 v[124:127], a[40:43], v[232:235], v[124:127]
  s_add_u32 s69, s60, 262144
  ds_read_b64_tr_b16 a[26:27], v6 offset:26624
  v_mul_f32 v119, v119, v13
  v_mfma_f32_16x16x32_bf16 v[124:127], a[44:47], v[236:239], v[124:127]
  buffer_store_dwordx4 v[16:19], v11, s[56:59], s69 offen
  v_mfma_f32_16x16x32_bf16 v[124:127], a[48:51], v[240:243], v[124:127]
  s_waitcnt lgkmcnt(8)
  s_waitcnt vmcnt(4)
  s_add_u32 s55, s75, 512
  ds_read_b64_tr_b16 a[28:29], v6 offset:28672
  v_cvt_pk_bf16_f32 v22, v116, v117
  v_mfma_f32_16x16x32_bf16 v[124:127], a[52:55], v[244:247], v[124:127]
  buffer_store_byte v51, v35, s[36:39], s55 offen
  v_mfma_f32_16x16x32_bf16 v[124:127], a[56:59], v[248:251], v[124:127]
  ds_read_b64_tr_b16 a[30:31], v6 offset:30720
  v_cvt_pk_bf16_f32 v23, v118, v119
  v_mfma_f32_16x16x32_bf16 v[124:127], a[60:63], v[252:255], v[124:127]
  s_waitcnt lgkmcnt(12)
  s_waitcnt vmcnt(4)
  v_cmp_ne_u32 vcc, 0x01010101, v53
  s_nop 0
  s_cbranch_vccnz L_prod7_spin
L_prod7_ok:
  v_mfma_f32_16x16x32_bf16 v[96:99], a[0:3], v[128:131], 0
  ds_read_b64_tr_b16 a[32:33], v7 offset:0
  v_mul_f32 v120, v120, v14
  v_mfma_f32_16x16x32_bf16 v[96:99], a[4:7], v[132:135], v[96:99]
  s_waitcnt lgkmcnt(9)
  v_mul_f32 v121, v121, v14
  v_mul_f32 v122, v122, v14
  v_mfma_f32_16x16x32_bf16 v[96:99], a[8:11], v[136:139], v[96:99]
  s_add_u32 s52, s61, 786432
  ds_read_b64_tr_b16 a[34:35], v7 offset:2048
  v_mul_f32 v123, v123, v14
  v_mfma_f32_16x16x32_bf16 v[96:99], a[12:15], v[140:143], v[96:99]
  s_waitcnt lgkmcnt(6)
  buffer_load_dwordx4 a[80:83], v48, s[56:59], s52 offen sc1
  v_mfma_f32_16x16x32_bf16 v[96:99], a[16:19], v[144:147], v[96:99]
  ds_read_b64_tr_b16 a[36:37], v7 offset:4096
  v_cvt_pk_bf16_f32 v26, v120, v121
  v_mfma_f32_16x16x32_bf16 v[96:99], a[20:23], v[148:151], v[96:99]
  s_waitcnt lgkmcnt(3)
  v_mfma_f32_16x16x32_bf16 v[96:99], a[24:27], v[152:155], v[96:99]
  s_add_u32 s53, s61, 790528
  ds_read_b64_tr_b16 a[38:39], v7 offset:6144
  v_cvt_pk_bf16_f32 v27, v122, v123
  v_mfma_f32_16x16x32_bf16 v[96:99], a[28:31], v[156:159], v[96:99]
  buffer_load_dwordx4 a[84:87], v48, s[56:59], s53 offen sc1
  v_mfma_f32_16x16x32_bf16 v[100:103], a[0:3], v[160:163], 0
  ds_read_b64_tr_b16 a[40:41], v7 offset:8192
  v_mul_f32 v124, v124, v15
  v_mfma_f32_16x16x32_bf16 v[100:103], a[4:7], v[164:167], v[100:103]
  v_mul_f32 v125, v125, v15
  v_mul_f32 v126, v126, v15
  v_mfma_f32_16x16x32_bf16 v[100:103], a[8:11], v[168:171], v[100:103]
  s_add_u32 s70, s60, 278528
  ds_read_b64_tr_b16 a[42:43], v7 offset:10240
  v_mul_f32 v127, v127, v15
  v_mfma_f32_16x16x32_bf16 v[100:103], a[12:15], v[172:175], v[100:103]
  buffer_store_dwordx4 v[20:23], v11, s[56:59], s70 offen
  v_mfma_f32_16x16x32_bf16 v[100:103], a[16:19], v[176:179], v[100:103]
  ds_read_b64_tr_b16 a[44:45], v7 offset:12288
  v_cvt_pk_bf16_f32 v30, v124, v125
  v_mfma_f32_16x16x32_bf16 v[100:103], a[20:23], v[180:183], v[100:103]
  v_mfma_f32_16x16x32_bf16 v[100:103], a[24:27], v[184:187], v[100:103]
  ds_read_b64_tr_b16 a[46:47], v7 offset:14336
  v_cvt_pk_bf16_f32 v31, v126, v127
  v_mfma_f32_16x16x32_bf16 v[100:103], a[28:31], v[188:191], v[100:103]
  v_mfma_f32_16x16x32_bf16 v[104:107], a[0:3], v[192:195], 0
  ds_read_b64_tr_b16 a[48:49], v7 offset:16384
  v_mul_f32 v96, v96, v12
  v_mfma_f32_16x16x32_bf16 v[104:107], a[4:7], v[196:199], v[104:107]
  v_mul_f32 v97, v97, v12
  v_mul_f32 v98, v98, v12
  v_mfma_f32_16x16x32_bf16 v[104:107], a[8:11], v[200:203], v[104:107]
  s_add_u32 s52, s61, 794624
  ds_read_b64_tr_b16 a[50:51], v7 offset:18432
  v_mul_f32 v99, v99, v12
  v_mfma_f32_16x16x32_bf16 v[104:107], a[12:15], v[204:207], v[104:107]
  buffer_load_dwordx4 a[88:91], v48, s[56:59], s52 offen sc1
  v_mfma_f32_16x16x32_bf16 v[104:107], a[16:19], v[208:211], v[104:107]
  ds_read_b64_tr_b16 a[52:53], v7 offset:20480
  v_cvt_pk_bf16_f32 v16, v96, v97
  v_mfma_f32_16x16x32_bf16 v[104:107], a[20:23], v[212:215], v[104:107]
  v_mfma_f32_16x16x32_bf16 v[104:107], a[24:27], v[216:219], v[104:107]
  s_add_u32 s53, s61, 798720
  ds_read_b64_tr_b16 a[54:55], v7 offset:22528
  v_cvt_pk_bf16_f32 v17, v98, v99
  v_mfma_f32_16x16x32_bf16 v[104:107], a[28:31], v[220:223], v[104:107]
  buffer_load_dwordx4 a[92:95], v48, s[56:59], s53 offen sc1
  v_mfma_f32_16x16x32_bf16 v[108:111], a[0:3], v[224:227], 0
  ds_read_b64_tr_b16 a[56:57], v7 offset:24576
  v_mul_f32 v100, v100, v13
  v_mfma_f32_16x16x32_bf16 v[108:111], a[4:7], v[228:231], v[108:111]
  v_mul_f32 v101, v101, v13
  v_mul_f32 v102, v102, v13
  v_mfma_f32_16x16x32_bf16 v[108:111], a[8:11], v[232:235], v[108:111]
  s_add_u32 s69, s60, 294912
  ds_read_b64_tr_b16 a[58:59], v7 offset:26624
  v_mul_f32 v103, v103, v13
  v_mfma_f32_16x16x32_bf16 v[108:111], a[12:15], v[236:239], v[108:111]
  buffer_store_dwordx4 v[24:27], v11, s[56:59], s69 offen
  v_mfma_f32_16x16x32_bf16 v[108:111], a[16:19], v[240:243], v[108:111]
  s_waitcnt lgkmcnt(8)
  ds_read_b64_tr_b16 a[60:61], v7 offset:28672
  v_cvt_pk_bf16_f32 v20, v100, v101
  v_mfma_f32_16x16x32_bf16 v[108:111], a[20:23], v[244:247], v[108:111]
  v_mfma_f32_16x16x32_bf16 v[108:111], a[24:27], v[248:251], v[108:111]
  s_add_u32 s54, s76, 384
  ds_read_b64_tr_b16 a[62:63], v7 offset:30720
  v_cvt_pk_bf16_f32 v21, v102, v103
  v_mfma_f32_16x16x32_bf16 v[108:111], a[28:31], v[252:255], v[108:111]
  s_waitcnt lgkmcnt(12)
  buffer_load_dword v54, v50, s[36:39], s54 offen sc1
  v_mfma_f32_16x16x32_bf16 v[112:115], a[32:35], v[128:131], 0
  ds_read_b64_tr_b16 a[0:1], v8 offset:0
  v_mul_f32 v104, v104, v14
  v_mfma_f32_16x16x32_bf16 v[112:115], a[36:39], v[132:135], v[112:115]
  s_waitcnt lgkmcnt(9)
  v_mul_f32 v105, v105, v14
  v_mul_f32 v106, v106, v14
  v_mfma_f32_16x16x32_bf16 v[112:115], a[40:43], v[136:139], v[112:115]
  s_add_u32 s70, s60, 311296
  ds_read_b64_tr_b16 a[2:3], v8 offset:2048
  v_mul_f32 v107, v107, v14
  v_mfma_f32_16x16x32_bf16 v[112:115], a[44:47], v[140:143], v[112:115]
  s_waitcnt lgkmcnt(6)
  buffer_store_dwordx4 v[28:31], v11, s[56:59], s70 offen
  v_mfma_f32_16x16x32_bf16 v[112:115], a[48:51], v[144:147], v[112:115]
  ds_read_b64_tr_b16 a[4:5], v8 offset:4096
  v_cvt_pk_bf16_f32 v24, v104, v105
  v_mfma_f32_16x16x32_bf16 v[112:115], a[52:55], v[148:151], v[112:115]
  s_waitcnt lgkmcnt(3)
  v_subrev_u32 v7, 131072, v7
  v_mfma_f32_16x16x32_bf16 v[112:115], a[56:59], v[152:155], v[112:115]
  s_add_u32 s54, s78, 512
  ds_read_b64_tr_b16 a[6:7], v8 offset:6144
  v_cvt_pk_bf16_f32 v25, v106, v107
  v_mfma_f32_16x16x32_bf16 v[112:115], a[60:63], v[156:159], v[112:115]
  s_waitcnt vmcnt(3)
  buffer_load_dword v53, v50, s[36:39], s54 offen sc1
  v_mfma_f32_16x16x32_bf16 v[44:47], a[96:99], a[80:83], 0
  v_cvt_pk_bf16_f32 v40, v40, v41
  v_cvt_pk_bf16_f32 v41, v42, v43
  v_mfma_f32_16x16x32_bf16 v[44:47], a[96:99], a[84:87], v[44:47]
  v_mfma_f32_16x16x32_bf16 v[44:47], a[96:99], a[88:91], v[44:47]
  v_mfma_f32_16x16x32_bf16 v[44:47], a[96:99], a[92:95], v[44:47]
  v_mfma_f32_16x16x32_bf16 v[116:119], a[32:35], v[160:163], 0
  ds_read_b64_tr_b16 a[8:9], v8 offset:8192
  v_mul_f32 v108, v108, v15
  v_mfma_f32_16x16x32_bf16 v[116:119], a[36:39], v[164:167], v[116:119]
  v_mul_f32 v109, v109, v15
  v_mul_f32 v110, v110, v15
  v_mfma_f32_16x16x32_bf16 v[116:119], a[40:43], v[168:171], v[116:119]
  s_add_u32 s55, s79, 448
  ds_read_b64_tr_b16 a[10:11], v8 offset:10240
  v_mul_f32 v111, v111, v15
  v_mfma_f32_16x16x32_bf16 v[116:119], a[44:47], v[172:175], v[116:119]
  buffer_store_byte v51, v35, s[36:39], s55 offen
  v_mfma_f32_16x16x32_bf16 v[116:119], a[48:51], v[176:179], v[116:119]
  ds_read_b64_tr_b16 a[12:13], v8 offset:12288
  v_cvt_pk_bf16_f32 v28, v108, v109
  v_mfma_f32_16x16x32_bf16 v[116:119], a[52:55], v[180:183], v[116:119]
  buffer_store_dwordx2 v[40:41], v49, s[28:31], 0 offen offset:384
  v_mfma_f32_16x16x32_bf16 v[116:119], a[56:59], v[184:187], v[116:119]
  ds_read_b64_tr_b16 a[14:15], v8 offset:14336
  v_cvt_pk_bf16_f32 v29, v110, v111
  v_mfma_f32_16x16x32_bf16 v[116:119], a[60:63], v[188:191], v[116:119]
  v_mfma_f32_16x16x32_bf16 v[120:123], a[32:35], v[192:195], 0
  ds_read_b64_tr_b16 a[16:17], v8 offset:16384
  v_mul_f32 v112, v112, v12
  v_mfma_f32_16x16x32_bf16 v[120:123], a[36:39], v[196:199], v[120:123]
  v_mul_f32 v113, v113, v12
  v_mul_f32 v114, v114, v12
  v_mfma_f32_16x16x32_bf16 v[120:123], a[40:43], v[200:203], v[120:123]
  ds_read_b64_tr_b16 a[18:19], v8 offset:18432
  v_mul_f32 v115, v115, v12
  v_mfma_f32_16x16x32_bf16 v[120:123], a[44:47], v[204:207], v[120:123]
  s_waitcnt vmcnt(4)
  v_cmp_ne_u32 vcc, 0x01010101, v54
  s_nop 0
  s_cbranch_vccnz L_cons10_spin
L_cons10_ok:
  v_mfma_f32_16x16x32_bf16 v[120:123], a[48:51], v[208:211], v[120:123]
  ds_read_b64_tr_b16 a[20:21], v8 offset:20480
  v_cvt_pk_bf16_f32 v18, v112, v113
  v_mfma_f32_16x16x32_bf16 v[120:123], a[52:55], v[212:215], v[120:123]
  v_mfma_f32_16x16x32_bf16 v[120:123], a[56:59], v[216:219], v[120:123]
  ds_read_b64_tr_b16 a[22:23], v8 offset:22528
  v_cvt_pk_bf16_f32 v19, v114, v115
  v_mfma_f32_16x16x32_bf16 v[120:123], a[60:63], v[220:223], v[120:123]
  v_mfma_f32_16x16x32_bf16 v[124:127], a[32:35], v[224:227], 0
  ds_read_b64_tr_b16 a[24:25], v8 offset:24576
  v_mul_f32 v116, v116, v13
  v_mfma_f32_16x16x32_bf16 v[124:127], a[36:39], v[228:231], v[124:127]
  v_mul_f32 v117, v117, v13
  v_mul_f32 v118, v118, v13
  v_mfma_f32_16x16x32_bf16 v[124:127], a[40:43], v[232:235], v[124:127]
  s_add_u32 s69, s60, 524288
  ds_read_b64_tr_b16 a[26:27], v8 offset:26624
  v_mul_f32 v119, v119, v13
  v_mfma_f32_16x16x32_bf16 v[124:127], a[44:47], v[236:239], v[124:127]
  buffer_store_dwordx4 v[16:19], v11, s[56:59], s69 offen nt
  v_mfma_f32_16x16x32_bf16 v[124:127], a[48:51], v[240:243], v[124:127]
  s_waitcnt lgkmcnt(8)
  s_waitcnt vmcnt(4)
  s_add_u32 s55, s75, 576
  ds_read_b64_tr_b16 a[28:29], v8 offset:28672
  v_cvt_pk_bf16_f32 v22, v116, v117
  v_mfma_f32_16x16x32_bf16 v[124:127], a[52:55], v[244:247], v[124:127]
  buffer_store_byte v51, v35, s[36:39], s55 offen
  v_mfma_f32_16x16x32_bf16 v[124:127], a[56:59], v[248:251], v[124:127]
  ds_read_b64_tr_b16 a[30:31], v8 offset:30720
  v_cvt_pk_bf16_f32 v23, v118, v119
  v_mfma_f32_16x16x32_bf16 v[124:127], a[60:63], v[252:255], v[124:127]
  s_waitcnt lgkmcnt(12)
  s_waitcnt vmcnt(4)
  v_cmp_ne_u32 vcc, 0x01010101, v53
  s_nop 0
  s_cbranch_vccnz L_prod8_spin
L_prod8_ok:
  v_mfma_f32_16x16x32_bf16 v[96:99], a[0:3], v[128:131], 0
  ds_read_b64_tr_b16 a[32:33], v9 offset:0
  v_mul_f32 v120, v120, v14
  v_mfma_f32_16x16x32_bf16 v[96:99], a[4:7], v[132:135], v[96:99]
  s_waitcnt lgkmcnt(9)
  v_mul_f32 v121, v121, v14
  v_mul_f32 v122, v122, v14
  v_mfma_f32_16x16x32_bf16 v[96:99], a[8:11], v[136:139], v[96:99]
  s_add_u32 s52, s61, 0
  ds_read_b64_tr_b16 a[34:35], v9 offset:2048
  v_mul_f32 v123, v123, v14
  v_mfma_f32_16x16x32_bf16 v[96:99], a[12:15], v[140:143], v[96:99]
  s_waitcnt lgkmcnt(6)
  buffer_load_dwordx4 a[64:67], v48, s[56:59], s52 offen sc1
  v_mfma_f32_16x16x32_bf16 v[96:99], a[16:19], v[144:147], v[96:99]
  ds_read_b64_tr_b16 a[36:37], v9 offset:4096
  v_cvt_pk_bf16_f32 v26, v120, v121
  v_mfma_f32_16x16x32_bf16 v[96:99], a[20:23], v[148:151], v[96:99]
  s_waitcnt lgkmcnt(3)
  v_subrev_u32 v8, 131072, v8
  v_mfma_f32_16x16x32_bf16 v[96:99], a[24:27], v[152:155], v[96:99]
  s_add_u32 s53, s61, 4096
  ds_read_b64_tr_b16 a[38:39], v9 offset:6144
  v_cvt_pk_bf16_f32 v27, v122, v123
  v_mfma_f32_16x16x32_bf16 v[96:99], a[28:31], v[156:159], v[96:99]
  buffer_load_dwordx4 a[68:71], v48, s[56:59], s53 offen sc1
  v_mfma_f32_16x16x32_bf16 v[100:103], a[0:3], v[160:163], 0
  ds_read_b64_tr_b16 a[40:41], v9 offset:8192
  v_mul_f32 v124, v124, v15
  v_mfma_f32_16x16x32_bf16 v[100:103], a[4:7], v[164:167], v[100:103]
  v_mul_f32 v125, v125, v15
  v_mul_f32 v126, v126, v15
  v_mfma_f32_16x16x32_bf16 v[100:103], a[8:11], v[168:171], v[100:103]
  s_add_u32 s70, s60, 540672
  ds_read_b64_tr_b16 a[42:43], v9 offset:10240
  v_mul_f32 v127, v127, v15
  v_mfma_f32_16x16x32_bf16 v[100:103], a[12:15], v[172:175], v[100:103]
  buffer_store_dwordx4 v[20:23], v11, s[56:59], s70 offen nt
  v_mfma_f32_16x16x32_bf16 v[100:103], a[16:19], v[176:179], v[100:103]
  ds_read_b64_tr_b16 a[44:45], v9 offset:12288
  v_cvt_pk_bf16_f32 v30, v124, v125
  v_mfma_f32_16x16x32_bf16 v[100:103], a[20:23], v[180:183], v[100:103]
  v_mfma_f32_16x16x32_bf16 v[100:103], a[24:27], v[184:187], v[100:103]
  ds_read_b64_tr_b16 a[46:47], v9 offset:14336
  v_cvt_pk_bf16_f32 v31, v126, v127
  v_mfma_f32_16x16x32_bf16 v[100:103], a[28:31], v[188:191], v[100:103]
  v_mfma_f32_16x16x32_bf16 v[104:107], a[0:3], v[192:195], 0
  ds_read_b64_tr_b16 a[48:49], v9 offset:16384
  v_mul_f32 v96, v96, v12
  v_mfma_f32_16x16x32_bf16 v[104:107], a[4:7], v[196:199], v[104:107]
  v_mul_f32 v97, v97, v12
  v_mul_f32 v98, v98, v12
  v_mfma_f32_16x16x32_bf16 v[104:107], a[8:11], v[200:203], v[104:107]
  s_add_u32 s52, s61, 8192
  ds_read_b64_tr_b16 a[50:51], v9 offset:18432
  v_mul_f32 v99, v99, v12
  v_mfma_f32_16x16x32_bf16 v[104:107], a[12:15], v[204:207], v[104:107]
  buffer_load_dwordx4 a[72:75], v48, s[56:59], s52 offen sc1
  v_mfma_f32_16x16x32_bf16 v[104:107], a[16:19], v[208:211], v[104:107]
  ds_read_b64_tr_b16 a[52:53], v9 offset:20480
  v_cvt_pk_bf16_f32 v16, v96, v97
  v_mfma_f32_16x16x32_bf16 v[104:107], a[20:23], v[212:215], v[104:107]
  v_subrev_u32 v6, 131072, v6
  v_mfma_f32_16x16x32_bf16 v[104:107], a[24:27], v[216:219], v[104:107]
  s_add_u32 s53, s61, 12288
  ds_read_b64_tr_b16 a[54:55], v9 offset:22528
  v_cvt_pk_bf16_f32 v17, v98, v99
  v_mfma_f32_16x16x32_bf16 v[104:107], a[28:31], v[220:223], v[104:107]
  buffer_load_dwordx4 a[76:79], v48, s[56:59], s53 offen sc1
  v_mfma_f32_16x16x32_bf16 v[108:111], a[0:3], v[224:227], 0
  ds_read_b64_tr_b16 a[56:57], v9 offset:24576
  v_mul_f32 v100, v100, v13
  v_mfma_f32_16x16x32_bf16 v[108:111], a[4:7], v[228:231], v[108:111]
  v_mul_f32 v101, v101, v13
  v_mul_f32 v102, v102, v13
  v_mfma_f32_16x16x32_bf16 v[108:111], a[8:11], v[232:235], v[108:111]
  s_add_u32 s69, s60, 557056
  ds_read_b64_tr_b16 a[58:59], v9 offset:26624
  v_mul_f32 v103, v103, v13
  v_mfma_f32_16x16x32_bf16 v[108:111], a[12:15], v[236:239], v[108:111]
  s_barrier
  buffer_store_dwordx4 v[24:27], v11, s[56:59], s69 offen nt
  v_mfma_f32_16x16x32_bf16 v[108:111], a[16:19], v[240:243], v[108:111]
  s_waitcnt lgkmcnt(8)
  ds_read_b64_tr_b16 a[60:61], v9 offset:28672
  v_cvt_pk_bf16_f32 v20, v100, v101
  v_mfma_f32_16x16x32_bf16 v[108:111], a[20:23], v[244:247], v[108:111]
  v_mfma_f32_16x16x32_bf16 v[108:111], a[24:27], v[248:251], v[108:111]
  s_add_u32 s54, s76, 448
  ds_read_b64_tr_b16 a[62:63], v9 offset:30720
  v_cvt_pk_bf16_f32 v21, v102, v103
  v_mfma_f32_16x16x32_bf16 v[108:111], a[28:31], v[252:255], v[108:111]
  s_waitcnt lgkmcnt(12)
  buffer_load_dword v54, v50, s[36:39], s54 offen sc1
  v_mfma_f32_16x16x32_bf16 v[112:115], a[32:35], v[128:131], 0
  ds_read_b64_tr_b16 a[0:1], v6 offset:0
  v_mul_f32 v104, v104, v14
  v_mfma_f32_16x16x32_bf16 v[112:115], a[36:39], v[132:135], v[112:115]
  s_waitcnt lgkmcnt(9)
  v_mul_f32 v105, v105, v14
  v_mul_f32 v106, v106, v14
  v_mfma_f32_16x16x32_bf16 v[112:115], a[40:43], v[136:139], v[112:115]
  s_add_u32 s70, s60, 573440
  ds_read_b64_tr_b16 a[2:3], v6 offset:2048
  v_mul_f32 v107, v107, v14
  v_mfma_f32_16x16x32_bf16 v[112:115], a[44:47], v[140:143], v[112:115]
  s_waitcnt lgkmcnt(6)
  buffer_store_dwordx4 v[28:31], v11, s[56:59], s70 offen nt
  v_mfma_f32_16x16x32_bf16 v[112:115], a[48:51], v[144:147], v[112:115]
  ds_read_b64_tr_b16 a[4:5], v6 offset:4096
  v_cvt_pk_bf16_f32 v24, v104, v105
  v_mfma_f32_16x16x32_bf16 v[112:115], a[52:55], v[148:151], v[112:115]
  s_waitcnt lgkmcnt(3)
  v_subrev_u32 v9, 131072, v9
  v_mfma_f32_16x16x32_bf16 v[112:115], a[56:59], v[152:155], v[112:115]
  s_add_u32 s54, s78, 576
  ds_read_b64_tr_b16 a[6:7], v6 offset:6144
  v_cvt_pk_bf16_f32 v25, v106, v107
  v_mfma_f32_16x16x32_bf16 v[112:115], a[60:63], v[156:159], v[112:115]
  s_waitcnt vmcnt(3)
  buffer_load_dword v53, v50, s[36:39], s54 offen sc1
  v_mfma_f32_16x16x32_bf16 v[40:43], a[96:99], a[64:67], 0
  v_cvt_pk_bf16_f32 v44, v44, v45
  v_cvt_pk_bf16_f32 v45, v46, v47
  v_mfma_f32_16x16x32_bf16 v[40:43], a[96:99], a[68:71], v[40:43]
  v_mfma_f32_16x16x32_bf16 v[40:43], a[96:99], a[72:75], v[40:43]
  v_mfma_f32_16x16x32_bf16 v[40:43], a[96:99], a[76:79], v[40:43]
  v_mfma_f32_16x16x32_bf16 v[116:119], a[32:35], v[160:163], 0
  ds_read_b64_tr_b16 a[8:9], v6 offset:8192
  v_mul_f32 v108, v108, v15
  v_mfma_f32_16x16x32_bf16 v[116:119], a[36:39], v[164:167], v[116:119]
  v_mul_f32 v109, v109, v15
  v_mul_f32 v110, v110, v15
  v_mfma_f32_16x16x32_bf16 v[116:119], a[40:43], v[168:171], v[116:119]
  s_add_u32 s55, s79, 512
  ds_read_b64_tr_b16 a[10:11], v6 offset:10240
  v_mul_f32 v111, v111, v15
  v_mfma_f32_16x16x32_bf16 v[116:119], a[44:47], v[172:175], v[116:119]
  buffer_store_byte v51, v35, s[36:39], s55 offen
  v_mfma_f32_16x16x32_bf16 v[116:119], a[48:51], v[176:179], v[116:119]
  ds_read_b64_tr_b16 a[12:13], v6 offset:12288
  v_cvt_pk_bf16_f32 v28, v108, v109
  v_mfma_f32_16x16x32_bf16 v[116:119], a[52:55], v[180:183], v[116:119]
  buffer_store_dwordx2 v[44:45], v49, s[28:31], 0 offen offset:448
  v_mfma_f32_16x16x32_bf16 v[116:119], a[56:59], v[184:187], v[116:119]
  ds_read_b64_tr_b16 a[14:15], v6 offset:14336
  v_cvt_pk_bf16_f32 v29, v110, v111
  v_mfma_f32_16x16x32_bf16 v[116:119], a[60:63], v[188:191], v[116:119]
  v_mfma_f32_16x16x32_bf16 v[120:123], a[32:35], v[192:195], 0
  ds_read_b64_tr_b16 a[16:17], v6 offset:16384
  v_mul_f32 v112, v112, v12
  v_mfma_f32_16x16x32_bf16 v[120:123], a[36:39], v[196:199], v[120:123]
  v_mul_f32 v113, v113, v12
  v_mul_f32 v114, v114, v12
  v_mfma_f32_16x16x32_bf16 v[120:123], a[40:43], v[200:203], v[120:123]
  ds_read_b64_tr_b16 a[18:19], v6 offset:18432
  v_mul_f32 v115, v115, v12
  v_mfma_f32_16x16x32_bf16 v[120:123], a[44:47], v[204:207], v[120:123]
  s_waitcnt vmcnt(4)
  v_cmp_ne_u32 vcc, 0x01010101, v54
  s_nop 0
  s_cbranch_vccnz L_cons11_spin
L_cons11_ok:
  v_mfma_f32_16x16x32_bf16 v[120:123], a[48:51], v[208:211], v[120:123]
  ds_read_b64_tr_b16 a[20:21], v6 offset:20480
  v_cvt_pk_bf16_f32 v18, v112, v113
  v_mfma_f32_16x16x32_bf16 v[120:123], a[52:55], v[212:215], v[120:123]
  v_mfma_f32_16x16x32_bf16 v[120:123], a[56:59], v[216:219], v[120:123]
  ds_read_b64_tr_b16 a[22:23], v6 offset:22528
  v_cvt_pk_bf16_f32 v19, v114, v115
  v_mfma_f32_16x16x32_bf16 v[120:123], a[60:63], v[220:223], v[120:123]
  v_mfma_f32_16x16x32_bf16 v[124:127], a[32:35], v[224:227], 0
  ds_read_b64_tr_b16 a[24:25], v6 offset:24576
  v_mul_f32 v116, v116, v13
  v_mfma_f32_16x16x32_bf16 v[124:127], a[36:39], v[228:231], v[124:127]
  v_mul_f32 v117, v117, v13
  v_mul_f32 v118, v118, v13
  v_mfma_f32_16x16x32_bf16 v[124:127], a[40:43], v[232:235], v[124:127]
  s_add_u32 s69, s60, 786432
  ds_read_b64_tr_b16 a[26:27], v6 offset:26624
  v_mul_f32 v119, v119, v13
  v_mfma_f32_16x16x32_bf16 v[124:127], a[44:47], v[236:239], v[124:127]
  buffer_store_dwordx4 v[16:19], v11, s[56:59], s69 offen nt
  v_mfma_f32_16x16x32_bf16 v[124:127], a[48:51], v[240:243], v[124:127]
  s_waitcnt lgkmcnt(8)
  s_waitcnt vmcnt(4)
  s_add_u32 s55, s75, 640
  ds_read_b64_tr_b16 a[28:29], v6 offset:28672
  v_cvt_pk_bf16_f32 v22, v116, v117
  v_mfma_f32_16x16x32_bf16 v[124:127], a[52:55], v[244:247], v[124:127]
  buffer_store_byte v51, v35, s[36:39], s55 offen
  v_mfma_f32_16x16x32_bf16 v[124:127], a[56:59], v[248:251], v[124:127]
  ds_read_b64_tr_b16 a[30:31], v6 offset:30720
  v_cvt_pk_bf16_f32 v23, v118, v119
  v_mfma_f32_16x16x32_bf16 v[124:127], a[60:63], v[252:255], v[124:127]
  s_waitcnt lgkmcnt(12)
  s_waitcnt vmcnt(4)
  v_cmp_ne_u32 vcc, 0x01010101, v53
  s_nop 0
  s_cbranch_vccnz L_prod9_spin
L_prod9_ok:
  v_mfma_f32_16x16x32_bf16 v[96:99], a[0:3], v[128:131], 0
  ds_read_b64_tr_b16 a[32:33], v7 offset:0
  v_mul_f32 v120, v120, v14
  v_mfma_f32_16x16x32_bf16 v[96:99], a[4:7], v[132:135], v[96:99]
  s_waitcnt lgkmcnt(9)
  v_mul_f32 v121, v121, v14
  v_mul_f32 v122, v122, v14
  v_mfma_f32_16x16x32_bf16 v[96:99], a[8:11], v[136:139], v[96:99]
  s_add_u32 s52, s61, 262144
  ds_read_b64_tr_b16 a[34:35], v7 offset:2048
  v_mul_f32 v123, v123, v14
  v_mfma_f32_16x16x32_bf16 v[96:99], a[12:15], v[140:143], v[96:99]
  s_waitcnt lgkmcnt(6)
  buffer_load_dwordx4 a[80:83], v48, s[56:59], s52 offen sc1
  v_mfma_f32_16x16x32_bf16 v[96:99], a[16:19], v[144:147], v[96:99]
  ds_read_b64_tr_b16 a[36:37], v7 offset:4096
  v_cvt_pk_bf16_f32 v26, v120, v121
  v_mfma_f32_16x16x32_bf16 v[96:99], a[20:23], v[148:151], v[96:99]
  s_waitcnt lgkmcnt(3)
  v_mfma_f32_16x16x32_bf16 v[96:99], a[24:27], v[152:155], v[96:99]
  s_add_u32 s53, s61, 266240
  ds_read_b64_tr_b16 a[38:39], v7 offset:6144
  v_cvt_pk_bf16_f32 v27, v122, v123
  v_mfma_f32_16x16x32_bf16 v[96:99], a[28:31], v[156:159], v[96:99]
  buffer_load_dwordx4 a[84:87], v48, s[56:59], s53 offen sc1
  v_mfma_f32_16x16x32_bf16 v[100:103], a[0:3], v[160:163], 0
  ds_read_b64_tr_b16 a[40:41], v7 offset:8192
  v_mul_f32 v124, v124, v15
  v_mfma_f32_16x16x32_bf16 v[100:103], a[4:7], v[164:167], v[100:103]
  v_mul_f32 v125, v125, v15
  v_mul_f32 v126, v126, v15
  v_mfma_f32_16x16x32_bf16 v[100:103], a[8:11], v[168:171], v[100:103]
  s_add_u32 s70, s60, 802816
  ds_read_b64_tr_b16 a[42:43], v7 offset:10240
  v_mul_f32 v127, v127, v15
  v_mfma_f32_16x16x32_bf16 v[100:103], a[12:15], v[172:175], v[100:103]
  buffer_store_dwordx4 v[20:23], v11, s[56:59], s70 offen nt
  v_mfma_f32_16x16x32_bf16 v[100:103], a[16:19], v[176:179], v[100:103]
  ds_read_b64_tr_b16 a[44:45], v7 offset:12288
  v_cvt_pk_bf16_f32 v30, v124, v125
  v_mfma_f32_16x16x32_bf16 v[100:103], a[20:23], v[180:183], v[100:103]
  v_mfma_f32_16x16x32_bf16 v[100:103], a[24:27], v[184:187], v[100:103]
  ds_read_b64_tr_b16 a[46:47], v7 offset:14336
  v_cvt_pk_bf16_f32 v31, v126, v127
  v_mfma_f32_16x16x32_bf16 v[100:103], a[28:31], v[188:191], v[100:103]
  v_mfma_f32_16x16x32_bf16 v[104:107], a[0:3], v[192:195], 0
  ds_read_b64_tr_b16 a[48:49], v7 offset:16384
  v_mul_f32 v96, v96, v12
  v_mfma_f32_16x16x32_bf16 v[104:107], a[4:7], v[196:199], v[104:107]
  v_mul_f32 v97, v97, v12
  v_mul_f32 v98, v98, v12
  v_mfma_f32_16x16x32_bf16 v[104:107], a[8:11], v[200:203], v[104:107]
  s_add_u32 s52, s61, 270336
  ds_read_b64_tr_b16 a[50:51], v7 offset:18432
  v_mul_f32 v99, v99, v12
  v_mfma_f32_16x16x32_bf16 v[104:107], a[12:15], v[204:207], v[104:107]
  buffer_load_dwordx4 a[88:91], v48, s[56:59], s52 offen sc1
  v_mfma_f32_16x16x32_bf16 v[104:107], a[16:19], v[208:211], v[104:107]
  ds_read_b64_tr_b16 a[52:53], v7 offset:20480
  v_cvt_pk_bf16_f32 v16, v96, v97
  v_mfma_f32_16x16x32_bf16 v[104:107], a[20:23], v[212:215], v[104:107]
  v_mfma_f32_16x16x32_bf16 v[104:107], a[24:27], v[216:219], v[104:107]
  s_add_u32 s53, s61, 274432
  ds_read_b64_tr_b16 a[54:55], v7 offset:22528
  v_cvt_pk_bf16_f32 v17, v98, v99
  v_mfma_f32_16x16x32_bf16 v[104:107], a[28:31], v[220:223], v[104:107]
  buffer_load_dwordx4 a[92:95], v48, s[56:59], s53 offen sc1
  v_mfma_f32_16x16x32_bf16 v[108:111], a[0:3], v[224:227], 0
  ds_read_b64_tr_b16 a[56:57], v7 offset:24576
  v_mul_f32 v100, v100, v13
  v_mfma_f32_16x16x32_bf16 v[108:111], a[4:7], v[228:231], v[108:111]
  v_mul_f32 v101, v101, v13
  v_mul_f32 v102, v102, v13
  v_mfma_f32_16x16x32_bf16 v[108:111], a[8:11], v[232:235], v[108:111]
  s_add_u32 s69, s60, 819200
  ds_read_b64_tr_b16 a[58:59], v7 offset:26624
  v_mul_f32 v103, v103, v13
  v_mfma_f32_16x16x32_bf16 v[108:111], a[12:15], v[236:239], v[108:111]
  buffer_store_dwordx4 v[24:27], v11, s[56:59], s69 offen nt
  v_mfma_f32_16x16x32_bf16 v[108:111], a[16:19], v[240:243], v[108:111]
  s_waitcnt lgkmcnt(8)
  ds_read_b64_tr_b16 a[60:61], v7 offset:28672
  v_cvt_pk_bf16_f32 v20, v100, v101
  v_mfma_f32_16x16x32_bf16 v[108:111], a[20:23], v[244:247], v[108:111]
  v_mfma_f32_16x16x32_bf16 v[108:111], a[24:27], v[248:251], v[108:111]
  s_add_u32 s54, s76, 512
  ds_read_b64_tr_b16 a[62:63], v7 offset:30720
  v_cvt_pk_bf16_f32 v21, v102, v103
  v_mfma_f32_16x16x32_bf16 v[108:111], a[28:31], v[252:255], v[108:111]
  s_waitcnt lgkmcnt(12)
  buffer_load_dword v54, v50, s[36:39], s54 offen sc1
  v_mfma_f32_16x16x32_bf16 v[112:115], a[32:35], v[128:131], 0
  ds_read_b64_tr_b16 a[0:1], v8 offset:0
  v_mul_f32 v104, v104, v14
  v_mfma_f32_16x16x32_bf16 v[112:115], a[36:39], v[132:135], v[112:115]
  s_waitcnt lgkmcnt(9)
  v_mul_f32 v105, v105, v14
  v_mul_f32 v106, v106, v14
  v_mfma_f32_16x16x32_bf16 v[112:115], a[40:43], v[136:139], v[112:115]
  s_add_u32 s70, s60, 835584
  ds_read_b64_tr_b16 a[2:3], v8 offset:2048
  v_mul_f32 v107, v107, v14
  v_mfma_f32_16x16x32_bf16 v[112:115], a[44:47], v[140:143], v[112:115]
  s_waitcnt lgkmcnt(6)
  buffer_store_dwordx4 v[28:31], v11, s[56:59], s70 offen nt
  v_mfma_f32_16x16x32_bf16 v[112:115], a[48:51], v[144:147], v[112:115]
  ds_read_b64_tr_b16 a[4:5], v8 offset:4096
  v_cvt_pk_bf16_f32 v24, v104, v105
  v_mfma_f32_16x16x32_bf16 v[112:115], a[52:55], v[148:151], v[112:115]
  s_waitcnt lgkmcnt(3)
  v_mfma_f32_16x16x32_bf16 v[112:115], a[56:59], v[152:155], v[112:115]
  s_add_u32 s54, s78, 640
  ds_read_b64_tr_b16 a[6:7], v8 offset:6144
  v_cvt_pk_bf16_f32 v25, v106, v107
  v_mfma_f32_16x16x32_bf16 v[112:115], a[60:63], v[156:159], v[112:115]
  s_waitcnt vmcnt(3)
  buffer_load_dword v53, v50, s[36:39], s54 offen sc1
  v_mfma_f32_16x16x32_bf16 v[44:47], a[96:99], a[80:83], 0
  v_cvt_pk_bf16_f32 v40, v40, v41
  v_cvt_pk_bf16_f32 v41, v42, v43
  v_mfma_f32_16x16x32_bf16 v[44:47], a[96:99], a[84:87], v[44:47]
  v_mfma_f32_16x16x32_bf16 v[44:47], a[96:99], a[88:91], v[44:47]
  v_mfma_f32_16x16x32_bf16 v[44:47], a[96:99], a[92:95], v[44:47]
  v_mfma_f32_16x16x32_bf16 v[116:119], a[32:35], v[160:163], 0
  ds_read_b64_tr_b16 a[8:9], v8 offset:8192
  v_mul_f32 v108, v108, v15
  v_mfma_f32_16x16x32_bf16 v[116:119], a[36:39], v[164:167], v[116:119]
  v_mul_f32 v109, v109, v15
  v_mul_f32 v110, v110, v15
  v_mfma_f32_16x16x32_bf16 v[116:119], a[40:43], v[168:171], v[116:119]
  s_add_u32 s55, s79, 576
  ds_read_b64_tr_b16 a[10:11], v8 offset:10240
  v_mul_f32 v111, v111, v15
  v_mfma_f32_16x16x32_bf16 v[116:119], a[44:47], v[172:175], v[116:119]
  buffer_store_byte v51, v35, s[36:39], s55 offen
  v_mfma_f32_16x16x32_bf16 v[116:119], a[48:51], v[176:179], v[116:119]
  ds_read_b64_tr_b16 a[12:13], v8 offset:12288
  v_cvt_pk_bf16_f32 v28, v108, v109
  v_mfma_f32_16x16x32_bf16 v[116:119], a[52:55], v[180:183], v[116:119]
  buffer_store_dwordx2 v[40:41], v49, s[28:31], 0 offen offset:512
  v_mfma_f32_16x16x32_bf16 v[116:119], a[56:59], v[184:187], v[116:119]
  ds_read_b64_tr_b16 a[14:15], v8 offset:14336
  v_cvt_pk_bf16_f32 v29, v110, v111
  v_mfma_f32_16x16x32_bf16 v[116:119], a[60:63], v[188:191], v[116:119]
  v_mfma_f32_16x16x32_bf16 v[120:123], a[32:35], v[192:195], 0
  ds_read_b64_tr_b16 a[16:17], v8 offset:16384
  v_mul_f32 v112, v112, v12
  v_mfma_f32_16x16x32_bf16 v[120:123], a[36:39], v[196:199], v[120:123]
  v_mul_f32 v113, v113, v12
  v_mul_f32 v114, v114, v12
  v_mfma_f32_16x16x32_bf16 v[120:123], a[40:43], v[200:203], v[120:123]
  ds_read_b64_tr_b16 a[18:19], v8 offset:18432
  v_mul_f32 v115, v115, v12
  v_mfma_f32_16x16x32_bf16 v[120:123], a[44:47], v[204:207], v[120:123]
  s_waitcnt vmcnt(4)
  v_cmp_ne_u32 vcc, 0x01010101, v54
  s_nop 0
  s_cbranch_vccnz L_cons12_spin
L_cons12_ok:
  v_mfma_f32_16x16x32_bf16 v[120:123], a[48:51], v[208:211], v[120:123]
  ds_read_b64_tr_b16 a[20:21], v8 offset:20480
  v_cvt_pk_bf16_f32 v18, v112, v113
  v_mfma_f32_16x16x32_bf16 v[120:123], a[52:55], v[212:215], v[120:123]
  v_mfma_f32_16x16x32_bf16 v[120:123], a[56:59], v[216:219], v[120:123]
  ds_read_b64_tr_b16 a[22:23], v8 offset:22528
  v_cvt_pk_bf16_f32 v19, v114, v115
  v_mfma_f32_16x16x32_bf16 v[120:123], a[60:63], v[220:223], v[120:123]
  v_mfma_f32_16x16x32_bf16 v[124:127], a[32:35], v[224:227], 0
  ds_read_b64_tr_b16 a[24:25], v8 offset:24576
  v_mul_f32 v116, v116, v13
  v_mfma_f32_16x16x32_bf16 v[124:127], a[36:39], v[228:231], v[124:127]
  v_mul_f32 v117, v117, v13
  v_mul_f32 v118, v118, v13
  v_mfma_f32_16x16x32_bf16 v[124:127], a[40:43], v[232:235], v[124:127]
  s_add_u32 s69, s60, 0
  ds_read_b64_tr_b16 a[26:27], v8 offset:26624
  v_mul_f32 v119, v119, v13
  v_mfma_f32_16x16x32_bf16 v[124:127], a[44:47], v[236:239], v[124:127]
  buffer_store_dwordx4 v[16:19], v11, s[56:59], s69 offen nt
  v_mfma_f32_16x16x32_bf16 v[124:127], a[48:51], v[240:243], v[124:127]
  s_waitcnt lgkmcnt(8)
  s_waitcnt vmcnt(4)
  s_add_u32 s55, s75, 704
  ds_read_b64_tr_b16 a[28:29], v8 offset:28672
  v_cvt_pk_bf16_f32 v22, v116, v117
  v_mfma_f32_16x16x32_bf16 v[124:127], a[52:55], v[244:247], v[124:127]
  buffer_store_byte v51, v35, s[36:39], s55 offen
  v_mfma_f32_16x16x32_bf16 v[124:127], a[56:59], v[248:251], v[124:127]
  ds_read_b64_tr_b16 a[30:31], v8 offset:30720
  v_cvt_pk_bf16_f32 v23, v118, v119
  v_mfma_f32_16x16x32_bf16 v[124:127], a[60:63], v[252:255], v[124:127]
  s_waitcnt lgkmcnt(12)
  s_waitcnt vmcnt(4)
  v_cmp_ne_u32 vcc, 0x01010101, v53
  s_nop 0
  s_cbranch_vccnz L_prod10_spin
L_prod10_ok:
  v_mfma_f32_16x16x32_bf16 v[96:99], a[0:3], v[128:131], 0
  ds_read_b64_tr_b16 a[32:33], v9 offset:0
  v_mul_f32 v120, v120, v14
  v_mfma_f32_16x16x32_bf16 v[96:99], a[4:7], v[132:135], v[96:99]
  s_waitcnt lgkmcnt(9)
  v_mul_f32 v121, v121, v14
  v_mul_f32 v122, v122, v14
  v_mfma_f32_16x16x32_bf16 v[96:99], a[8:11], v[136:139], v[96:99]
  s_add_u32 s52, s61, 524288
  ds_read_b64_tr_b16 a[34:35], v9 offset:2048
  v_mul_f32 v123, v123, v14
  v_mfma_f32_16x16x32_bf16 v[96:99], a[12:15], v[140:143], v[96:99]
  s_waitcnt lgkmcnt(6)
  buffer_load_dwordx4 a[64:67], v48, s[56:59], s52 offen sc1
  v_mfma_f32_16x16x32_bf16 v[96:99], a[16:19], v[144:147], v[96:99]
  ds_read_b64_tr_b16 a[36:37], v9 offset:4096
  v_cvt_pk_bf16_f32 v26, v120, v121
  v_mfma_f32_16x16x32_bf16 v[96:99], a[20:23], v[148:151], v[96:99]
  s_waitcnt lgkmcnt(3)
  v_mfma_f32_16x16x32_bf16 v[96:99], a[24:27], v[152:155], v[96:99]
  s_add_u32 s53, s61, 528384
  ds_read_b64_tr_b16 a[38:39], v9 offset:6144
  v_cvt_pk_bf16_f32 v27, v122, v123
  v_mfma_f32_16x16x32_bf16 v[96:99], a[28:31], v[156:159], v[96:99]
  buffer_load_dwordx4 a[68:71], v48, s[56:59], s53 offen sc1
  v_mfma_f32_16x16x32_bf16 v[100:103], a[0:3], v[160:163], 0
  ds_read_b64_tr_b16 a[40:41], v9 offset:8192
  v_mul_f32 v124, v124, v15
  v_mfma_f32_16x16x32_bf16 v[100:103], a[4:7], v[164:167], v[100:103]
  v_mul_f32 v125, v125, v15
  v_mul_f32 v126, v126, v15
  v_mfma_f32_16x16x32_bf16 v[100:103], a[8:11], v[168:171], v[100:103]
  s_add_u32 s70, s60, 16384
  ds_read_b64_tr_b16 a[42:43], v9 offset:10240
  v_mul_f32 v127, v127, v15
  v_mfma_f32_16x16x32_bf16 v[100:103], a[12:15], v[172:175], v[100:103]
  buffer_store_dwordx4 v[20:23], v11, s[56:59], s70 offen nt
  v_mfma_f32_16x16x32_bf16 v[100:103], a[16:19], v[176:179], v[100:103]
  ds_read_b64_tr_b16 a[44:45], v9 offset:12288
  v_cvt_pk_bf16_f32 v30, v124, v125
  v_mfma_f32_16x16x32_bf16 v[100:103], a[20:23], v[180:183], v[100:103]
  v_mfma_f32_16x16x32_bf16 v[100:103], a[24:27], v[184:187], v[100:103]
  ds_read_b64_tr_b16 a[46:47], v9 offset:14336
  v_cvt_pk_bf16_f32 v31, v126, v127
  v_mfma_f32_16x16x32_bf16 v[100:103], a[28:31], v[188:191], v[100:103]
  v_mfma_f32_16x16x32_bf16 v[104:107], a[0:3], v[192:195], 0
  ds_read_b64_tr_b16 a[48:49], v9 offset:16384
  v_mul_f32 v96, v96, v12
  v_mfma_f32_16x16x32_bf16 v[104:107], a[4:7], v[196:199], v[104:107]
  v_mul_f32 v97, v97, v12
  v_mul_f32 v98, v98, v12
  v_mfma_f32_16x16x32_bf16 v[104:107], a[8:11], v[200:203], v[104:107]
  s_add_u32 s52, s61, 532480
  ds_read_b64_tr_b16 a[50:51], v9 offset:18432
  v_mul_f32 v99, v99, v12
  v_mfma_f32_16x16x32_bf16 v[104:107], a[12:15], v[204:207], v[104:107]
  buffer_load_dwordx4 a[72:75], v48, s[56:59], s52 offen sc1
  v_mfma_f32_16x16x32_bf16 v[104:107], a[16:19], v[208:211], v[104:107]
  ds_read_b64_tr_b16 a[52:53], v9 offset:20480
  v_cvt_pk_bf16_f32 v16, v96, v97
  v_mfma_f32_16x16x32_bf16 v[104:107], a[20:23], v[212:215], v[104:107]
  v_mfma_f32_16x16x32_bf16 v[104:107], a[24:27], v[216:219], v[104:107]
  s_add_u32 s53, s61, 536576
  ds_read_b64_tr_b16 a[54:55], v9 offset:22528
  v_cvt_pk_bf16_f32 v17, v98, v99
  v_mfma_f32_16x16x32_bf16 v[104:107], a[28:31], v[220:223], v[104:107]
  buffer_load_dwordx4 a[76:79], v48, s[56:59], s53 offen sc1
  v_mfma_f32_16x16x32_bf16 v[108:111], a[0:3], v[224:227], 0
  ds_read_b64_tr_b16 a[56:57], v9 offset:24576
  v_mul_f32 v100, v100, v13
  v_mfma_f32_16x16x32_bf16 v[108:111], a[4:7], v[228:231], v[108:111]
  v_mul_f32 v101, v101, v13
  v_mul_f32 v102, v102, v13
  v_mfma_f32_16x16x32_bf16 v[108:111], a[8:11], v[232:235], v[108:111]
  s_add_u32 s69, s60, 32768
  ds_read_b64_tr_b16 a[58:59], v9 offset:26624
  v_mul_f32 v103, v103, v13
  v_mfma_f32_16x16x32_bf16 v[108:111], a[12:15], v[236:239], v[108:111]
  buffer_store_dwordx4 v[24:27], v11, s[56:59], s69 offen nt
  v_mfma_f32_16x16x32_bf16 v[108:111], a[16:19], v[240:243], v[108:111]
  s_waitcnt lgkmcnt(8)
  ds_read_b64_tr_b16 a[60:61], v9 offset:28672
  v_cvt_pk_bf16_f32 v20, v100, v101
  v_mfma_f32_16x16x32_bf16 v[108:111], a[20:23], v[244:247], v[108:111]
  v_mfma_f32_16x16x32_bf16 v[108:111], a[24:27], v[248:251], v[108:111]
  s_add_u32 s54, s76, 576
  ds_read_b64_tr_b16 a[62:63], v9 offset:30720
  v_cvt_pk_bf16_f32 v21, v102, v103
  v_mfma_f32_16x16x32_bf16 v[108:111], a[28:31], v[252:255], v[108:111]
  s_waitcnt lgkmcnt(12)
  buffer_load_dword v54, v50, s[36:39], s54 offen sc1
  v_mfma_f32_16x16x32_bf16 v[112:115], a[32:35], v[128:131], 0
  v_mul_f32 v104, v104, v14
  v_mfma_f32_16x16x32_bf16 v[112:115], a[36:39], v[132:135], v[112:115]
  s_waitcnt lgkmcnt(8)
  v_mul_f32 v105, v105, v14
  v_mul_f32 v106, v106, v14
  v_mfma_f32_16x16x32_bf16 v[112:115], a[40:43], v[136:139], v[112:115]
  s_add_u32 s70, s60, 49152
  v_mul_f32 v107, v107, v14
  v_mfma_f32_16x16x32_bf16 v[112:115], a[44:47], v[140:143], v[112:115]
  s_waitcnt lgkmcnt(4)
  buffer_store_dwordx4 v[28:31], v11, s[56:59], s70 offen nt
  v_mfma_f32_16x16x32_bf16 v[112:115], a[48:51], v[144:147], v[112:115]
  v_cvt_pk_bf16_f32 v24, v104, v105
  v_mfma_f32_16x16x32_bf16 v[112:115], a[52:55], v[148:151], v[112:115]
  s_waitcnt lgkmcnt(0)
  v_mfma_f32_16x16x32_bf16 v[112:115], a[56:59], v[152:155], v[112:115]
  s_add_u32 s54, s78, 704
  v_cvt_pk_bf16_f32 v25, v106, v107
  v_mfma_f32_16x16x32_bf16 v[112:115], a[60:63], v[156:159], v[112:115]
  s_waitcnt vmcnt(3)
  buffer_load_dword v53, v50, s[36:39], s54 offen sc1
  v_mfma_f32_16x16x32_bf16 v[40:43], a[96:99], a[64:67], 0
  v_cvt_pk_bf16_f32 v44, v44, v45
  v_cvt_pk_bf16_f32 v45, v46, v47
  v_mfma_f32_16x16x32_bf16 v[40:43], a[96:99], a[68:71], v[40:43]
  v_mfma_f32_16x16x32_bf16 v[40:43], a[96:99], a[72:75], v[40:43]
  v_mfma_f32_16x16x32_bf16 v[40:43], a[96:99], a[76:79], v[40:43]
  v_mfma_f32_16x16x32_bf16 v[116:119], a[32:35], v[160:163], 0
  v_mul_f32 v108, v108, v15
  v_mfma_f32_16x16x32_bf16 v[116:119], a[36:39], v[164:167], v[116:119]
  v_mul_f32 v109, v109, v15
  v_mul_f32 v110, v110, v15
  v_mfma_f32_16x16x32_bf16 v[116:119], a[40:43], v[168:171], v[116:119]
  v_mul_f32 v111, v111, v15
  v_mfma_f32_16x16x32_bf16 v[116:119], a[44:47], v[172:175], v[116:119]
  v_mfma_f32_16x16x32_bf16 v[116:119], a[48:51], v[176:179], v[116:119]
  v_cvt_pk_bf16_f32 v28, v108, v109
  v_mfma_f32_16x16x32_bf16 v[116:119], a[52:55], v[180:183], v[116:119]
  buffer_store_dwordx2 v[44:45], v49, s[28:31], 0 offen offset:576
  v_mfma_f32_16x16x32_bf16 v[116:119], a[56:59], v[184:187], v[116:119]
  v_cvt_pk_bf16_f32 v29, v110, v111
  v_mfma_f32_16x16x32_bf16 v[116:119], a[60:63], v[188:191], v[116:119]
  v_mfma_f32_16x16x32_bf16 v[120:123], a[32:35], v[192:195], 0
  v_mul_f32 v112, v112, v12
  v_mfma_f32_16x16x32_bf16 v[120:123], a[36:39], v[196:199], v[120:123]
  v_mul_f32 v113, v113, v12
  v_mul_f32 v114, v114, v12
  v_mfma_f32_16x16x32_bf16 v[120:123], a[40:43], v[200:203], v[120:123]
  v_mul_f32 v115, v115, v12
  v_mfma_f32_16x16x32_bf16 v[120:123], a[44:47], v[204:207], v[120:123]
  s_waitcnt vmcnt(3)
  v_cmp_ne_u32 vcc, 0x01010101, v54
  s_nop 0
  s_cbranch_vccnz L_cons13_spin
L_cons13_ok:
  v_mfma_f32_16x16x32_bf16 v[120:123], a[48:51], v[208:211], v[120:123]
  v_cvt_pk_bf16_f32 v18, v112, v113
  v_mfma_f32_16x16x32_bf16 v[120:123], a[52:55], v[212:215], v[120:123]
  v_mfma_f32_16x16x32_bf16 v[120:123], a[56:59], v[216:219], v[120:123]
  v_cvt_pk_bf16_f32 v19, v114, v115
  v_mfma_f32_16x16x32_bf16 v[120:123], a[60:63], v[220:223], v[120:123]
  v_mfma_f32_16x16x32_bf16 v[124:127], a[32:35], v[224:227], 0
  v_mul_f32 v116, v116, v13
  v_mfma_f32_16x16x32_bf16 v[124:127], a[36:39], v[228:231], v[124:127]
  v_mul_f32 v117, v117, v13
  v_mul_f32 v118, v118, v13
  v_mfma_f32_16x16x32_bf16 v[124:127], a[40:43], v[232:235], v[124:127]
  s_add_u32 s69, s60, 262144
  v_mul_f32 v119, v119, v13
  v_mfma_f32_16x16x32_bf16 v[124:127], a[44:47], v[236:239], v[124:127]
  buffer_store_dwordx4 v[16:19], v11, s[56:59], s69 offen nt
  v_mfma_f32_16x16x32_bf16 v[124:127], a[48:51], v[240:243], v[124:127]
  s_waitcnt vmcnt(3)
  s_add_u32 s55, s75, 768
  v_cvt_pk_bf16_f32 v22, v116, v117
  v_mfma_f32_16x16x32_bf16 v[124:127], a[52:55], v[244:247], v[124:127]
  buffer_store_byte v51, v35, s[36:39], s55 offen
  v_mfma_f32_16x16x32_bf16 v[124:127], a[56:59], v[248:251], v[124:127]
  v_cvt_pk_bf16_f32 v23, v118, v119
  v_mfma_f32_16x16x32_bf16 v[124:127], a[60:63], v[252:255], v[124:127]
  s_waitcnt vmcnt(3)
  v_cmp_ne_u32 vcc, 0x01010101, v53
  s_nop 0
  s_cbranch_vccnz L_prod11_spin
L_prod11_ok:
  s_nop 7
  s_add_u32 s70, s60, 278528
  s_nop 1
  buffer_store_dwordx4 v[20:23], v11, s[56:59], s70 offen nt
  v_mul_f32 v120, v120, v14
  v_mul_f32 v121, v121, v14
  v_mul_f32 v122, v122, v14
  v_mul_f32 v123, v123, v14
  v_cvt_pk_bf16_f32 v26, v120, v121
  v_cvt_pk_bf16_f32 v27, v122, v123
  s_add_u32 s69, s60, 294912
  s_nop 1
  buffer_store_dwordx4 v[24:27], v11, s[56:59], s69 offen nt
  v_mul_f32 v124, v124, v15
  v_mul_f32 v125, v125, v15
  v_mul_f32 v126, v126, v15
  v_mul_f32 v127, v127, v15
  v_cvt_pk_bf16_f32 v30, v124, v125
  v_cvt_pk_bf16_f32 v31, v126, v127
  s_add_u32 s70, s60, 311296
  s_nop 1
  buffer_store_dwordx4 v[28:31], v11, s[56:59], s70 offen nt
  s_add_u32 s52, s61, 786432
  buffer_load_dwordx4 a[80:83], v48, s[56:59], s52 offen sc1
  s_add_u32 s53, s61, 790528
  buffer_load_dwordx4 a[84:87], v48, s[56:59], s53 offen sc1
  s_add_u32 s52, s61, 794624
  buffer_load_dwordx4 a[88:91], v48, s[56:59], s52 offen sc1
  s_add_u32 s53, s61, 798720
  buffer_load_dwordx4 a[92:95], v48, s[56:59], s53 offen sc1
  s_add_u32 s54, s78, 768
  buffer_load_dword v53, v50, s[36:39], s54 offen sc1
  s_waitcnt vmcnt(5)
  s_add_u32 s55, s75, 832
  buffer_store_byte v51, v35, s[36:39], s55 offen
  v_cvt_pk_bf16_f32 v40, v40, v41
  v_cvt_pk_bf16_f32 v41, v42, v43
  buffer_store_dwordx2 v[40:41], v49, s[28:31], 0 offen offset:640
  s_waitcnt vmcnt(2)
  v_cmp_ne_u32 vcc, 0x01010101, v53
  s_nop 0
  s_cbranch_vccnz L_prod12_spin
L_prod12_ok:
  s_add_u32 s52, s61, 0
  buffer_load_dwordx4 a[64:67], v48, s[56:59], s52 offen sc1
  s_add_u32 s53, s61, 4096
  buffer_load_dwordx4 a[68:71], v48, s[56:59], s53 offen sc1
  s_add_u32 s52, s61, 8192
  buffer_load_dwordx4 a[72:75], v48, s[56:59], s52 offen sc1
  s_add_u32 s53, s61, 12288
  buffer_load_dwordx4 a[76:79], v48, s[56:59], s53 offen sc1
  s_waitcnt vmcnt(6)
  v_mfma_f32_16x16x32_bf16 v[44:47], a[96:99], a[80:83], 0
  v_mfma_f32_16x16x32_bf16 v[44:47], a[96:99], a[84:87], v[44:47]
  v_mfma_f32_16x16x32_bf16 v[44:47], a[96:99], a[88:91], v[44:47]
  v_mfma_f32_16x16x32_bf16 v[44:47], a[96:99], a[92:95], v[44:47]
  s_add_u32 s54, s78, 832
  buffer_load_dword v53, v50, s[36:39], s54 offen sc1
  s_waitcnt vmcnt(0)
  v_cmp_ne_u32 vcc, 0x01010101, v53
  s_nop 0
  s_cbranch_vccnz L_prod13_spin
L_prod13_ok:
  s_add_u32 s52, s61, 262144
  buffer_load_dwordx4 a[80:83], v48, s[56:59], s52 offen sc1
  s_add_u32 s53, s61, 266240
  buffer_load_dwordx4 a[84:87], v48, s[56:59], s53 offen sc1
  s_add_u32 s52, s61, 270336
  buffer_load_dwordx4 a[88:91], v48, s[56:59], s52 offen sc1
  s_add_u32 s53, s61, 274432
  buffer_load_dwordx4 a[92:95], v48, s[56:59], s53 offen sc1
  s_waitcnt vmcnt(4)
  v_mfma_f32_16x16x32_bf16 v[40:43], a[96:99], a[64:67], 0
  v_mfma_f32_16x16x32_bf16 v[40:43], a[96:99], a[68:71], v[40:43]
  v_mfma_f32_16x16x32_bf16 v[40:43], a[96:99], a[72:75], v[40:43]
  v_mfma_f32_16x16x32_bf16 v[40:43], a[96:99], a[76:79], v[40:43]
  s_nop 3
  v_cvt_pk_bf16_f32 v44, v44, v45
  v_cvt_pk_bf16_f32 v45, v46, v47
  buffer_store_dwordx2 v[44:45], v49, s[28:31], 0 offen offset:704
  s_waitcnt vmcnt(1)
  v_mfma_f32_16x16x32_bf16 v[44:47], a[96:99], a[80:83], 0
  v_mfma_f32_16x16x32_bf16 v[44:47], a[96:99], a[84:87], v[44:47]
  v_mfma_f32_16x16x32_bf16 v[44:47], a[96:99], a[88:91], v[44:47]
  v_mfma_f32_16x16x32_bf16 v[44:47], a[96:99], a[92:95], v[44:47]
  s_nop 3
  v_cvt_pk_bf16_f32 v40, v40, v41
  v_cvt_pk_bf16_f32 v41, v42, v43
  buffer_store_dwordx2 v[40:41], v49, s[28:31], 0 offen offset:768
  s_nop 7
  v_cvt_pk_bf16_f32 v44, v44, v45
  v_cvt_pk_bf16_f32 v45, v46, v47
  buffer_store_dwordx2 v[44:45], v49, s[28:31], 0 offen offset:832
  s_waitcnt vmcnt(0)
L_end:
  s_endpgm
L_restart:
  s_waitcnt vmcnt(0)
  s_waitcnt lgkmcnt(0)
  s_barrier
  s_mov_b32 s3, 1
  s_branch L_again
L_grp_far:
  s_or_b32 s67, s49, 0x80
  v_mov_b32 v25, s67
  v_mov_b32 v27, 0
  buffer_store_byte v25, v27, s[40:43], s47 offen sc1
  s_waitcnt vmcnt(0)
  s_mov_b32 s62, 524288
L_grp_again:
  s_sub_u32 s62, s62, 1
  s_cmp_eq_u32 s62, 0
  s_cbranch_scc1 L_grp_ok
  buffer_load_dword v24, v26, s[40:43], 0 offen sc1
  s_waitcnt vmcnt(0)
  v_and_b32 v24, 0x87878787, v24
  v_cmp_eq_u32 vcc, s50, v24
  s_nop 0
  s_cmp_eq_u64 vcc, -1
  s_cselect_b64 s[44:45], -1, 0
  s_cbranch_scc1 L_grp_ok
  v_mov_b32 v24, 0
  v_cmp_gt_u32 vcc, 4, v0
  s_and_saveexec_b64 s[54:55], vcc
  buffer_atomic_add v24, v26, s[40:43], 0 offen sc0 sc1
  s_waitcnt vmcnt(0)
  s_mov_b64 exec, s[54:55]
  v_and_b32 v25, 0x80808080, v24
  v_cmp_eq_u32 vcc, 0x80808080, v25
  s_nop 0
  s_and_b64 s[52:53], vcc, 15
  s_cmp_eq_u64 s[52:53], 15
  s_cbranch_scc0 L_grp_again
  v_and_b32 v24, 0x87878787, v24
  v_cmp_eq_u32 vcc, s50, v24
  s_nop 0
  s_and_b64 s[52:53], vcc, 15
  s_cmp_eq_u64 s[52:53], 15
  s_cselect_b64 s[44:45], -1, 0
  s_branch L_grp_ok
L_prod0_spin:
  s_add_u32 s54, s78, 0
  s_mov_b32 s62, 524288
L_prod0_again:
  s_sub_u32 s62, s62, 1
  s_cmp_eq_u32 s62, 0
  s_cbranch_scc1 L_prod0_ok
  buffer_load_dword v53, v50, s[36:39], s54 offen sc1
  s_waitcnt vmcnt(0)
  v_cmp_ne_u32 vcc, 0x01010101, v53
  s_nop 0
  s_cbranch_vccnz L_prod0_again
  s_branch L_prod0_ok
L_prod1_spin:
  s_add_u32 s54, s78, 64
  s_mov_b32 s62, 524288
L_prod1_again:
  s_sub_u32 s62, s62, 1
  s_cmp_eq_u32 s62, 0
  s_cbranch_scc1 L_prod1_ok
  buffer_load_dword v53, v50, s[36:39], s54 offen sc1
  s_waitcnt vmcnt(0)
  v_cmp_ne_u32 vcc, 0x01010101, v53
  s_nop 0
  s_cbranch_vccnz L_prod1_again
  s_branch L_prod1_ok
L_prod2_spin:
  s_add_u32 s54, s78, 128
  s_mov_b32 s62, 524288
L_prod2_again:
  s_sub_u32 s62, s62, 1
  s_cmp_eq_u32 s62, 0
  s_cbranch_scc1 L_prod2_ok
  buffer_load_dword v53, v50, s[36:39], s54 offen sc1
  s_waitcnt vmcnt(0)
  v_cmp_ne_u32 vcc, 0x01010101, v53
  s_nop 0
  s_cbranch_vccnz L_prod2_again
  s_branch L_prod2_ok
L_prod3_spin:
  s_add_u32 s54, s78, 192
  s_mov_b32 s62, 524288
L_prod3_again:
  s_sub_u32 s62, s62, 1
  s_cmp_eq_u32 s62, 0
  s_cbranch_scc1 L_prod3_ok
  buffer_load_dword v53, v50, s[36:39], s54 offen sc1
  s_waitcnt vmcnt(0)
  v_cmp_ne_u32 vcc, 0x01010101, v53
  s_nop 0
  s_cbranch_vccnz L_prod3_again
  s_branch L_prod3_ok
L_cons4_spin:
  s_add_u32 s54, s76, 0
  s_mov_b32 s62, 524288
L_cons4_again:
  s_sub_u32 s62, s62, 1
  s_cmp_eq_u32 s62, 0
  s_cbranch_scc1 L_cons4_ok
  buffer_load_dword v54, v50, s[36:39], s54 offen sc1
  s_waitcnt vmcnt(0)
  v_cmp_ne_u32 vcc, 0x01010101, v54
  s_nop 0
  s_cbranch_vccnz L_cons4_again
  s_branch L_cons4_ok
L_prod4_spin:
  s_add_u32 s54, s78, 256
  s_mov_b32 s62, 524288
L_prod4_again:
  s_sub_u32 s62, s62, 1
  s_cmp_eq_u32 s62, 0
  s_cbranch_scc1 L_prod4_ok
  buffer_load_dword v53, v50, s[36:39], s54 offen sc1
  s_waitcnt vmcnt(0)
  v_cmp_ne_u32 vcc, 0x01010101, v53
  s_nop 0
  s_cbranch_vccnz L_prod4_again
  s_branch L_prod4_ok
L_cons5_spin:
  s_add_u32 s54, s76, 64
  s_mov_b32 s62, 524288
L_cons5_again:
  s_sub_u32 s62, s62, 1
  s_cmp_eq_u32 s62, 0
  s_cbranch_scc1 L_cons5_ok
  buffer_load_dword v54, v50, s[36:39], s54 offen sc1
  s_waitcnt vmcnt(0)
  v_cmp_ne_u32 vcc, 0x01010101, v54
  s_nop 0
  s_cbranch_vccnz L_cons5_again
  s_branch L_cons5_ok
L_prod5_spin:
  s_add_u32 s54, s78, 320
  s_mov_b32 s62, 524288
L_prod5_again:
  s_sub_u32 s62, s62, 1
  s_cmp_eq_u32 s62, 0
  s_cbranch_scc1 L_prod5_ok
  buffer_load_dword v53, v50, s[36:39], s54 offen sc1
  s_waitcnt vmcnt(0)
  v_cmp_ne_u32 vcc, 0x01010101, v53
  s_nop 0
  s_cbranch_vccnz L_prod5_again
  s_branch L_prod5_ok
L_cons6_spin:
  s_add_u32 s54, s76, 128
  s_mov_b32 s62, 524288
L_cons6_again:
  s_sub_u32 s62, s62, 1
  s_cmp_eq_u32 s62, 0
  s_cbranch_scc1 L_cons6_ok
  buffer_load_dword v54, v50, s[36:39], s54 offen sc1
  s_waitcnt vmcnt(0)
  v_cmp_ne_u32 vcc, 0x01010101, v54
  s_nop 0
  s_cbranch_vccnz L_cons6_again
  s_branch L_cons6_ok
L_prod6_spin:
  s_add_u32 s54, s78, 384
  s_mov_b32 s62, 524288
L_prod6_again:
  s_sub_u32 s62, s62, 1
  s_cmp_eq_u32 s62, 0
  s_cbranch_scc1 L_prod6_ok
  buffer_load_dword v53, v50, s[36:39], s54 offen sc1
  s_waitcnt vmcnt(0)
  v_cmp_ne_u32 vcc, 0x01010101, v53
  s_nop 0
  s_cbranch_vccnz L_prod6_again
  s_branch L_prod6_ok
L_cons7_spin:
  s_add_u32 s54, s76, 192
  s_mov_b32 s62, 524288
L_cons7_again:
  s_sub_u32 s62, s62, 1
  s_cmp_eq_u32 s62, 0
  s_cbranch_scc1 L_cons7_ok
  buffer_load_dword v54, v50, s[36:39], s54 offen sc1
  s_waitcnt vmcnt(0)
  v_cmp_ne_u32 vcc, 0x01010101, v54
  s_nop 0
  s_cbranch_vccnz L_cons7_again
  s_branch L_cons7_ok
L_prod7_spin:
  s_add_u32 s54, s78, 448
  s_mov_b32 s62, 524288
L_prod7_again:
  s_sub_u32 s62, s62, 1
  s_cmp_eq_u32 s62, 0
  s_cbranch_scc1 L_prod7_ok
  buffer_load_dword v53, v50, s[36:39], s54 offen sc1
  s_waitcnt vmcnt(0)
  v_cmp_ne_u32 vcc, 0x01010101, v53
  s_nop 0
  s_cbranch_vccnz L_prod7_again
  s_branch L_prod7_ok
L_cons8_spin:
  s_add_u32 s54, s76, 256
  s_mov_b32 s62, 524288
L_cons8_again:
  s_sub_u32 s62, s62, 1
  s_cmp_eq_u32 s62, 0
  s_cbranch_scc1 L_cons8_ok
  buffer_load_dword v54, v50, s[36:39], s54 offen sc1
  s_waitcnt vmcnt(0)
  v_cmp_ne_u32 vcc, 0x01010101, v54
  s_nop 0
  s_cbranch_vccnz L_cons8_again
  s_branch L_cons8_ok
L_prod8_spin:
  s_add_u32 s54, s78, 512
  s_mov_b32 s62, 524288
L_prod8_again:
  s_sub_u32 s62, s62, 1
  s_cmp_eq_u32 s62, 0
  s_cbranch_scc1 L_prod8_ok
  buffer_load_dword v53, v50, s[36:39], s54 offen sc1
  s_waitcnt vmcnt(0)
  v_cmp_ne_u32 vcc, 0x01010101, v53
  s_nop 0
  s_cbranch_vccnz L_prod8_again
  s_branch L_prod8_ok
L_cons9_spin:
  s_add_u32 s54, s76, 320
  s_mov_b32 s62, 524288
L_cons9_again:
  s_sub_u32 s62, s62, 1
  s_cmp_eq_u32 s62, 0
  s_cbranch_scc1 L_cons9_ok
  buffer_load_dword v54, v50, s[36:39], s54 offen sc1
  s_waitcnt vmcnt(0)
  v_cmp_ne_u32 vcc, 0x01010101, v54
  s_nop 0
  s_cbranch_vccnz L_cons9_again
  s_branch L_cons9_ok
L_prod9_spin:
  s_add_u32 s54, s78, 576
  s_mov_b32 s62, 524288
L_prod9_again:
  s_sub_u32 s62, s62, 1
  s_cmp_eq_u32 s62, 0
  s_cbranch_scc1 L_prod9_ok
  buffer_load_dword v53, v50, s[36:39], s54 offen sc1
  s_waitcnt vmcnt(0)
  v_cmp_ne_u32 vcc, 0x01010101, v53
  s_nop 0
  s_cbranch_vccnz L_prod9_again
  s_branch L_prod9_ok
L_cons10_spin:
  s_add_u32 s54, s76, 384
  s_mov_b32 s62, 524288
L_cons10_again:
  s_sub_u32 s62, s62, 1
  s_cmp_eq_u32 s62, 0
  s_cbranch_scc1 L_cons10_ok
  buffer_load_dword v54, v50, s[36:39], s54 offen sc1
  s_waitcnt vmcnt(0)
  v_cmp_ne_u32 vcc, 0x01010101, v54
  s_nop 0
  s_cbranch_vccnz L_cons10_again
  s_branch L_cons10_ok
L_prod10_spin:
  s_add_u32 s54, s78, 640
  s_mov_b32 s62, 524288
L_prod10_again:
  s_sub_u32 s62, s62, 1
  s_cmp_eq_u32 s62, 0
  s_cbranch_scc1 L_prod10_ok
  buffer_load_dword v53, v50, s[36:39], s54 offen sc1
  s_waitcnt vmcnt(0)
  v_cmp_ne_u32 vcc, 0x01010101, v53
  s_nop 0
  s_cbranch_vccnz L_prod10_again
  s_branch L_prod10_ok
L_cons11_spin:
  s_add_u32 s54, s76, 448
  s_mov_b32 s62, 524288
L_cons11_again:
  s_sub_u32 s62, s62, 1
  s_cmp_eq_u32 s62, 0
  s_cbranch_scc1 L_cons11_ok
  buffer_load_dword v54, v50, s[36:39], s54 offen sc1
  s_waitcnt vmcnt(0)
  v_cmp_ne_u32 vcc, 0x01010101, v54
  s_nop 0
  s_cbranch_vccnz L_cons11_again
  s_branch L_cons11_ok
L_prod11_spin:
  s_add_u32 s54, s78, 704
  s_mov_b32 s62, 524288
L_prod11_again:
  s_sub_u32 s62, s62, 1
  s_cmp_eq_u32 s62, 0
  s_cbranch_scc1 L_prod11_ok
  buffer_load_dword v53, v50, s[36:39], s54 offen sc1
  s_waitcnt vmcnt(0)
  v_cmp_ne_u32 vcc, 0x01010101, v53
  s_nop 0
  s_cbranch_vccnz L_prod11_again
  s_branch L_prod11_ok
L_cons12_spin:
  s_add_u32 s54, s76, 512
  s_mov_b32 s62, 524288
L_cons12_again:
  s_sub_u32 s62, s62, 1
  s_cmp_eq_u32 s62, 0
  s_cbranch_scc1 L_cons12_ok
  buffer_load_dword v54, v50, s[36:39], s54 offen sc1
  s_waitcnt vmcnt(0)
  v_cmp_ne_u32 vcc, 0x01010101, v54
  s_nop 0
  s_cbranch_vccnz L_cons12_again
  s_branch L_cons12_ok
L_cons13_spin:
  s_add_u32 s54, s76, 576
  s_mov_b32 s62, 524288
L_cons13_again:
  s_sub_u32 s62, s62, 1
  s_cmp_eq_u32 s62, 0
  s_cbranch_scc1 L_cons13_ok
  buffer_load_dword v54, v50, s[36:39], s54 offen sc1
  s_waitcnt vmcnt(0)
  v_cmp_ne_u32 vcc, 0x01010101, v54
  s_nop 0
  s_cbranch_vccnz L_cons13_again
  s_branch L_cons13_ok
L_prod12_spin:
  s_add_u32 s54, s78, 768
  s_mov_b32 s62, 524288
L_prod12_again:
  s_sub_u32 s62, s62, 1
  s_cmp_eq_u32 s62, 0
  s_cbranch_scc1 L_prod12_ok
  buffer_load_dword v53, v50, s[36:39], s54 offen sc1
  s_waitcnt vmcnt(0)
  v_cmp_ne_u32 vcc, 0x01010101, v53
  s_nop 0
  s_cbranch_vccnz L_prod12_again
  s_branch L_prod12_ok
L_prod13_spin:
  s_add_u32 s54, s78, 832
  s_mov_b32 s62, 524288
L_prod13_again:
  s_sub_u32 s62, s62, 1
  s_cmp_eq_u32 s62, 0
  s_cbranch_scc1 L_prod13_ok
  buffer_load_dword v53, v50, s[36:39], s54 offen sc1
  s_waitcnt vmcnt(0)
  v_cmp_ne_u32 vcc, 0x01010101, v53
  s_nop 0
  s_cbranch_vccnz L_prod13_again
  s_branch L_prod13_ok
L_p3_far:
  s_mul_i32 s77, s71, 3670016
  s_lshl_b32 s69, s72, 15
  s_add_u32 s46, s77, s69
  s_lshl_b32 s69, s32, 17
  s_add_u32 s77, s77, s69
  s_lshl_b32 s69, s72, 11
  s_add_u32 s77, s77, s69
  s_or_b32 s69, s49, 0xf0
  v_mov_b32 v34, s69
  v_lshrrev_b32 v1, 5, v0
  v_lshlrev_b32 v1, 11, v1
  v_and_b32 v2, 31, v0
  v_lshl_add_u32 v36, v2, 4, v1
  s_lshl_b32 s69, s32, 9
  v_add_u32 v36, s69, v36
  v_and_b32 v1, 15, v0
  v_lshrrev_b32 v2, 4, v0
  v_lshrrev_b32 v4, 3, v1
  v_and_b32 v5, 1, v2
  v_and_b32 v48, 1, v1
  v_lshlrev_b32 v48, 4, v48
  v_mov_b32 v49, 0x3f80
  v_lshlrev_b32 v49, v48, v49
  v_cmp_eq_u32 vcc, v4, v5
  s_nop 1
  v_cndmask_b32 v49, 0, v49, vcc
  v_bfe_u32 v50, v1, 1, 2
  v_cmp_eq_u32 vcc, 0, v50
  s_nop 1
  v_cndmask_b32 v51, 0, v49, vcc
  v_accvgpr_write_b32 a224, v51
  v_cmp_eq_u32 vcc, 1, v50
  s_nop 1
  v_cndmask_b32 v51, 0, v49, vcc
  v_accvgpr_write_b32 a225, v51
  v_cmp_eq_u32 vcc, 2, v50
  s_nop 1
  v_cndmask_b32 v51, 0, v49, vcc
  v_accvgpr_write_b32 a226, v51
  v_cmp_eq_u32 vcc, 3, v50
  s_nop 1
  v_cndmask_b32 v51, 0, v49, vcc
  v_accvgpr_write_b32 a227, v51
  s_lshl_b32 s69, s73, 8
  s_lshl_b32 s70, s72, 4
  s_add_u32 s69, s69, s70
  v_add_u32 v37, s69, v1
  v_mul_u32_u24 v37, 896, v37
  s_mul_i32 s69, s74, 448
  s_lshr_b32 s70, s32, 1
  s_lshl_b32 s70, s70, 5
  s_add_u32 s69, s69, s70
  s_and_b32 s70, s32, 1
  s_lshl_b32 s70, s70, 3
  s_add_u32 s69, s69, s70
  v_add_u32 v37, s69, v37
  v_lshl_add_u32 v37, v5, 4, v37
  v_lshrrev_b32 v4, 1, v2
  v_lshl_add_u32 v37, v4, 2, v37
  v_lshlrev_b32 v37, 1, v37
  v_mfma_f32_16x16x32_bf16 v[96:99], a[0:3], v[128:131], 0
  ds_read_b64_tr_b16 a[32:33], v7 offset:0
  v_mfma_f32_16x16x32_bf16 v[96:99], a[4:7], v[132:135], v[96:99]
  s_mov_b32 s67, 512
  v_mfma_f32_16x16x32_bf16 v[96:99], a[8:11], v[136:139], v[96:99]
  s_add_u32 m0, s33, 98304
  ds_read_b64_tr_b16 a[34:35], v7 offset:2048
  v_mfma_f32_16x16x32_bf16 v[96:99], a[12:15], v[140:143], v[96:99]
  s_waitcnt lgkmcnt(6)
  s_mov_b32 s68, 29184
  buffer_load_dwordx4 v3, s[20:23], s67 offen nt lds
  v_mfma_f32_16x16x32_bf16 v[96:99], a[16:19], v[144:147], v[96:99]
  s_add_u32 m0, s33, 102400
  ds_read_b64_tr_b16 a[36:37], v7 offset:4096
  v_mfma_f32_16x16x32_bf16 v[96:99], a[20:23], v[148:151], v[96:99]
  s_waitcnt lgkmcnt(3)
  s_mov_b32 s67, 57856
  buffer_load_dwordx4 v3, s[20:23], s68 offen nt lds
  v_mfma_f32_16x16x32_bf16 v[96:99], a[24:27], v[152:155], v[96:99]
  s_add_u32 m0, s33, 106496
  ds_read_b64_tr_b16 a[38:39], v7 offset:6144
  v_mfma_f32_16x16x32_bf16 v[96:99], a[28:31], v[156:159], v[96:99]
  s_mov_b32 s68, 86528
  buffer_load_dwordx4 v3, s[20:23], s67 offen nt lds
  v_mfma_f32_16x16x32_bf16 v[100:103], a[0:3], v[160:163], 0
  s_add_u32 m0, s33, 110592
  ds_read_b64_tr_b16 a[40:41], v7 offset:8192
  v_mfma_f32_16x16x32_bf16 v[100:103], a[4:7], v[164:167], v[100:103]
  s_mov_b32 s67, 115200
  buffer_load_dwordx4 v3, s[20:23], s68 offen nt lds
  v_mfma_f32_16x16x32_bf16 v[100:103], a[8:11], v[168:171], v[100:103]
  s_add_u32 m0, s33, 114688
  ds_read_b64_tr_b16 a[42:43], v7 offset:10240
  v_mfma_f32_16x16x32_bf16 v[100:103], a[12:15], v[172:175], v[100:103]
  s_mov_b32 s68, 143872
  buffer_load_dwordx4 v3, s[20:23], s67 offen nt lds
  v_mfma_f32_16x16x32_bf16 v[100:103], a[16:19], v[176:179], v[100:103]
  s_add_u32 m0, s33, 118784
  ds_read_b64_tr_b16 a[44:45], v7 offset:12288
  v_mfma_f32_16x16x32_bf16 v[100:103], a[20:23], v[180:183], v[100:103]
  s_mov_b32 s67, 172544
  buffer_load_dwordx4 v3, s[20:23], s68 offen nt lds
  v_mfma_f32_16x16x32_bf16 v[100:103], a[24:27], v[184:187], v[100:103]
  s_add_u32 m0, s33, 122880
  ds_read_b64_tr_b16 a[46:47], v7 offset:14336
  v_mfma_f32_16x16x32_bf16 v[100:103], a[28:31], v[188:191], v[100:103]
  buffer_load_dwordx4 v3, s[20:23], s67 offen nt lds
  v_mfma_f32_16x16x32_bf16 v[104:107], a[0:3], v[192:195], 0
  ds_read_b64_tr_b16 a[48:49], v7 offset:16384
  v_mul_f32 v96, v96, v12
  v_mfma_f32_16x16x32_bf16 v[104:107], a[4:7], v[196:199], v[104:107]
  s_mov_b32 s68, 201216
  v_mul_f32 v97, v97, v12
  v_mul_f32 v98, v98, v12
  v_mfma_f32_16x16x32_bf16 v[104:107], a[8:11], v[200:203], v[104:107]
  s_add_u32 m0, s33, 126976
  ds_read_b64_tr_b16 a[50:51], v7 offset:18432
  v_mul_f32 v99, v99, v12
  v_mfma_f32_16x16x32_bf16 v[104:107], a[12:15], v[204:207], v[104:107]
  buffer_load_dwordx4 v3, s[20:23], s68 offen nt lds
  v_mfma_f32_16x16x32_bf16 v[104:107], a[16:19], v[208:211], v[104:107]
  s_mov_b32 s67, 640
  ds_read_b64_tr_b16 a[52:53], v7 offset:20480
  v_cvt_pk_bf16_f32 v16, v96, v97
  v_mfma_f32_16x16x32_bf16 v[104:107], a[20:23], v[212:215], v[104:107]
  buffer_load_dwordx4 a[100:103], v3, s[20:23], s67 offen nt
  v_mfma_f32_16x16x32_bf16 v[104:107], a[24:27], v[216:219], v[104:107]
  s_mov_b32 s68, 29312
  ds_read_b64_tr_b16 a[54:55], v7 offset:22528
  v_cvt_pk_bf16_f32 v17, v98, v99
  v_mfma_f32_16x16x32_bf16 v[104:107], a[28:31], v[220:223], v[104:107]
  buffer_load_dwordx4 a[104:107], v3, s[20:23], s68 offen nt
  v_mfma_f32_16x16x32_bf16 v[108:111], a[0:3], v[224:227], 0
  ds_read_b64_tr_b16 a[56:57], v7 offset:24576
  v_mul_f32 v100, v100, v13
  v_mfma_f32_16x16x32_bf16 v[108:111], a[4:7], v[228:231], v[108:111]
  v_mul_f32 v101, v101, v13
  v_mul_f32 v102, v102, v13
  v_mfma_f32_16x16x32_bf16 v[108:111], a[8:11], v[232:235], v[108:111]
  s_mov_b32 s67, 57984
  ds_read_b64_tr_b16 a[58:59], v7 offset:26624
  v_mul_f32 v103, v103, v13
  v_mfma_f32_16x16x32_bf16 v[108:111], a[12:15], v[236:239], v[108:111]
  buffer_load_dwordx4 a[108:111], v3, s[20:23], s67 offen nt
  v_mfma_f32_16x16x32_bf16 v[108:111], a[16:19], v[240:243], v[108:111]
  s_waitcnt lgkmcnt(8)
  s_mov_b32 s68, 86656
  ds_read_b64_tr_b16 a[60:61], v7 offset:28672
  v_cvt_pk_bf16_f32 v20, v100, v101
  v_mfma_f32_16x16x32_bf16 v[108:111], a[20:23], v[244:247], v[108:111]
  buffer_load_dwordx4 a[112:115], v3, s[20:23], s68 offen nt
  v_mfma_f32_16x16x32_bf16 v[108:111], a[24:27], v[248:251], v[108:111]
  s_mov_b32 s67, 115328
  ds_read_b64_tr_b16 a[62:63], v7 offset:30720
  v_cvt_pk_bf16_f32 v21, v102, v103
  v_mfma_f32_16x16x32_bf16 v[108:111], a[28:31], v[252:255], v[108:111]
  s_waitcnt lgkmcnt(12)
  buffer_load_dwordx4 a[116:119], v3, s[20:23], s67 offen nt
  v_mfma_f32_16x16x32_bf16 v[112:115], a[32:35], v[128:131], 0
  ds_read_b64_tr_b16 a[0:1], v8 offset:0
  v_mul_f32 v104, v104, v14
  v_mfma_f32_16x16x32_bf16 v[112:115], a[36:39], v[132:135], v[112:115]
  s_waitcnt lgkmcnt(9)
  v_mul_f32 v105, v105, v14
  v_mul_f32 v106, v106, v14
  v_mfma_f32_16x16x32_bf16 v[112:115], a[40:43], v[136:139], v[112:115]
  s_mov_b32 s68, 144000
  ds_read_b64_tr_b16 a[2:3], v8 offset:2048
  v_mul_f32 v107, v107, v14
  v_mfma_f32_16x16x32_bf16 v[112:115], a[44:47], v[140:143], v[112:115]
  s_waitcnt lgkmcnt(6)
  buffer_load_dwordx4 a[120:123], v3, s[20:23], s68 offen nt
  v_mfma_f32_16x16x32_bf16 v[112:115], a[48:51], v[144:147], v[112:115]
  s_mov_b32 s67, 172672
  ds_read_b64_tr_b16 a[4:5], v8 offset:4096
  v_cvt_pk_bf16_f32 v24, v104, v105
  v_mfma_f32_16x16x32_bf16 v[112:115], a[52:55], v[148:151], v[112:115]
  s_waitcnt lgkmcnt(3)
  buffer_load_dwordx4 a[124:127], v3, s[20:23], s67 offen nt
  v_subrev_u32 v7, 131072, v7
  v_mfma_f32_16x16x32_bf16 v[112:115], a[56:59], v[152:155], v[112:115]
  s_mov_b32 s68, 201344
  ds_read_b64_tr_b16 a[6:7], v8 offset:6144
  v_cvt_pk_bf16_f32 v25, v106, v107
  v_mfma_f32_16x16x32_bf16 v[112:115], a[60:63], v[156:159], v[112:115]
  buffer_load_dwordx4 a[128:131], v3, s[20:23], s68 offen nt
  v_mfma_f32_16x16x32_bf16 v[116:119], a[32:35], v[160:163], 0
  ds_read_b64_tr_b16 a[8:9], v8 offset:8192
  v_mul_f32 v108, v108, v15
  v_mfma_f32_16x16x32_bf16 v[116:119], a[36:39], v[164:167], v[116:119]
  v_mul_f32 v109, v109, v15
  v_mul_f32 v110, v110, v15
  v_mfma_f32_16x16x32_bf16 v[116:119], a[40:43], v[168:171], v[116:119]
  s_mov_b32 s67, 768
  ds_read_b64_tr_b16 a[10:11], v8 offset:10240
  v_mul_f32 v111, v111, v15
  v_mfma_f32_16x16x32_bf16 v[116:119], a[44:47], v[172:175], v[116:119]
  buffer_load_dwordx4 a[132:135], v3, s[20:23], s67 offen nt
  v_mfma_f32_16x16x32_bf16 v[116:119], a[48:51], v[176:179], v[116:119]
  s_mov_b32 s68, 29440
  ds_read_b64_tr_b16 a[12:13], v8 offset:12288
  v_cvt_pk_bf16_f32 v28, v108, v109
  v_mfma_f32_16x16x32_bf16 v[116:119], a[52:55], v[180:183], v[116:119]
  buffer_load_dwordx4 a[136:139], v3, s[20:23], s68 offen nt
  v_mfma_f32_16x16x32_bf16 v[116:119], a[56:59], v[184:187], v[116:119]
  s_mov_b32 s67, 58112
  ds_read_b64_tr_b16 a[14:15], v8 offset:14336
  v_cvt_pk_bf16_f32 v29, v110, v111
  v_mfma_f32_16x16x32_bf16 v[116:119], a[60:63], v[188:191], v[116:119]
  buffer_load_dwordx4 a[140:143], v3, s[20:23], s67 offen nt
  v_mfma_f32_16x16x32_bf16 v[120:123], a[32:35], v[192:195], 0
  ds_read_b64_tr_b16 a[16:17], v8 offset:16384
  v_mul_f32 v112, v112, v12
  v_mfma_f32_16x16x32_bf16 v[120:123], a[36:39], v[196:199], v[120:123]
  v_mul_f32 v113, v113, v12
  v_mul_f32 v114, v114, v12
  v_mfma_f32_16x16x32_bf16 v[120:123], a[40:43], v[200:203], v[120:123]
  s_mov_b32 s68, 86784
  ds_read_b64_tr_b16 a[18:19], v8 offset:18432
  v_mul_f32 v115, v115, v12
  v_mfma_f32_16x16x32_bf16 v[120:123], a[44:47], v[204:207], v[120:123]
  buffer_load_dwordx4 a[144:147], v3, s[20:23], s68 offen nt
  v_mfma_f32_16x16x32_bf16 v[120:123], a[48:51], v[208:211], v[120:123]
  s_mov_b32 s67, 115456
  ds_read_b64_tr_b16 a[20:21], v8 offset:20480
  v_cvt_pk_bf16_f32 v18, v112, v113
  v_mfma_f32_16x16x32_bf16 v[120:123], a[52:55], v[212:215], v[120:123]
  buffer_load_dwordx4 a[148:151], v3, s[20:23], s67 offen nt
  v_mfma_f32_16x16x32_bf16 v[120:123], a[56:59], v[216:219], v[120:123]
  s_mov_b32 s68, 144128
  ds_read_b64_tr_b16 a[22:23], v8 offset:22528
  v_cvt_pk_bf16_f32 v19, v114, v115
  v_mfma_f32_16x16x32_bf16 v[120:123], a[60:63], v[220:223], v[120:123]
  buffer_load_dwordx4 a[152:155], v3, s[20:23], s68 offen nt
  v_mfma_f32_16x16x32_bf16 v[124:127], a[32:35], v[224:227], 0
  ds_read_b64_tr_b16 a[24:25], v8 offset:24576
  v_mul_f32 v116, v116, v13
  v_mfma_f32_16x16x32_bf16 v[124:127], a[36:39], v[228:231], v[124:127]
  v_mul_f32 v117, v117, v13
  v_mul_f32 v118, v118, v13
  v_mfma_f32_16x16x32_bf16 v[124:127], a[40:43], v[232:235], v[124:127]
  s_add_u32 s69, s77, 0
  ds_read_b64_tr_b16 a[26:27], v8 offset:26624
  v_mul_f32 v119, v119, v13
  v_mfma_f32_16x16x32_bf16 v[124:127], a[44:47], v[236:239], v[124:127]
  buffer_store_dwordx4 v[16:19], v11, s[24:27], s69 offen
  v_mfma_f32_16x16x32_bf16 v[124:127], a[48:51], v[240:243], v[124:127]
  s_waitcnt lgkmcnt(8)
  s_mov_b32 s67, 172800
  ds_read_b64_tr_b16 a[28:29], v8 offset:28672
  v_cvt_pk_bf16_f32 v22, v116, v117
  v_mfma_f32_16x16x32_bf16 v[124:127], a[52:55], v[244:247], v[124:127]
  buffer_load_dwordx4 a[156:159], v3, s[20:23], s67 offen nt
  v_mfma_f32_16x16x32_bf16 v[124:127], a[56:59], v[248:251], v[124:127]
  s_mov_b32 s68, 201472
  ds_read_b64_tr_b16 a[30:31], v8 offset:30720
  v_cvt_pk_bf16_f32 v23, v118, v119
  v_mfma_f32_16x16x32_bf16 v[124:127], a[60:63], v[252:255], v[124:127]
  s_waitcnt lgkmcnt(12)
  buffer_load_dwordx4 a[160:163], v3, s[20:23], s68 offen nt
  v_mfma_f32_16x16x32_bf16 v[96:99], a[0:3], v[128:131], 0
  ds_read_b64_tr_b16 a[32:33], v9 offset:0
  v_mul_f32 v120, v120, v14
  v_mfma_f32_16x16x32_bf16 v[96:99], a[4:7], v[132:135], v[96:99]
  s_waitcnt lgkmcnt(9)
  v_mul_f32 v121, v121, v14
  v_mul_f32 v122, v122, v14
  v_mfma_f32_16x16x32_bf16 v[96:99], a[8:11], v[136:139], v[96:99]
  ds_read_b64_tr_b16 a[34:35], v9 offset:2048
  v_mul_f32 v123, v123, v14
  v_mfma_f32_16x16x32_bf16 v[96:99], a[12:15], v[140:143], v[96:99]
  s_waitcnt lgkmcnt(6)
  v_mfma_f32_16x16x32_bf16 v[96:99], a[16:19], v[144:147], v[96:99]
  ds_read_b64_tr_b16 a[36:37], v9 offset:4096
  v_cvt_pk_bf16_f32 v26, v120, v121
  v_mfma_f32_16x16x32_bf16 v[96:99], a[20:23], v[148:151], v[96:99]
  s_waitcnt lgkmcnt(3)
  v_subrev_u32 v8, 131072, v8
  v_mfma_f32_16x16x32_bf16 v[96:99], a[24:27], v[152:155], v[96:99]
  ds_read_b64_tr_b16 a[38:39], v9 offset:6144
  v_cvt_pk_bf16_f32 v27, v122, v123
  v_mfma_f32_16x16x32_bf16 v[96:99], a[28:31], v[156:159], v[96:99]
  v_mfma_f32_16x16x32_bf16 v[100:103], a[0:3], v[160:163], 0
  ds_read_b64_tr_b16 a[40:41], v9 offset:8192
  v_mul_f32 v124, v124, v15
  v_mfma_f32_16x16x32_bf16 v[100:103], a[4:7], v[164:167], v[100:103]
  v_mul_f32 v125, v125, v15
  v_mul_f32 v126, v126, v15
  v_mfma_f32_16x16x32_bf16 v[100:103], a[8:11], v[168:171], v[100:103]
  s_add_u32 s70, s77, 32768
  ds_read_b64_tr_b16 a[42:43], v9 offset:10240
  v_mul_f32 v127, v127, v15
  v_mfma_f32_16x16x32_bf16 v[100:103], a[12:15], v[172:175], v[100:103]
  buffer_store_dwordx4 v[20:23], v11, s[24:27], s70 offen
  v_mfma_f32_16x16x32_bf16 v[100:103], a[16:19], v[176:179], v[100:103]
  ds_read_b64_tr_b16 a[44:45], v9 offset:12288
  v_cvt_pk_bf16_f32 v30, v124, v125
  v_mfma_f32_16x16x32_bf16 v[100:103], a[20:23], v[180:183], v[100:103]
  v_mfma_f32_16x16x32_bf16 v[100:103], a[24:27], v[184:187], v[100:103]
  ds_read_b64_tr_b16 a[46:47], v9 offset:14336
  v_cvt_pk_bf16_f32 v31, v126, v127
  v_mfma_f32_16x16x32_bf16 v[100:103], a[28:31], v[188:191], v[100:103]
  v_mfma_f32_16x16x32_bf16 v[104:107], a[0:3], v[192:195], 0
  ds_read_b64_tr_b16 a[48:49], v9 offset:16384
  v_mul_f32 v96, v96, v12
  v_mfma_f32_16x16x32_bf16 v[104:107], a[4:7], v[196:199], v[104:107]
  v_mul_f32 v97, v97, v12
  v_mul_f32 v98, v98, v12
  v_mfma_f32_16x16x32_bf16 v[104:107], a[8:11], v[200:203], v[104:107]
  ds_read_b64_tr_b16 a[50:51], v9 offset:18432
  v_mul_f32 v99, v99, v12
  v_mfma_f32_16x16x32_bf16 v[104:107], a[12:15], v[204:207], v[104:107]
  v_mfma_f32_16x16x32_bf16 v[104:107], a[16:19], v[208:211], v[104:107]
  ds_read_b64_tr_b16 a[52:53], v9 offset:20480
  v_cvt_pk_bf16_f32 v16, v96, v97
  v_mfma_f32_16x16x32_bf16 v[104:107], a[20:23], v[212:215], v[104:107]
  v_subrev_u32 v6, 131072, v6
  v_mfma_f32_16x16x32_bf16 v[104:107], a[24:27], v[216:219], v[104:107]
  ds_read_b64_tr_b16 a[54:55], v9 offset:22528
  v_cvt_pk_bf16_f32 v17, v98, v99
  v_mfma_f32_16x16x32_bf16 v[104:107], a[28:31], v[220:223], v[104:107]
  v_mfma_f32_16x16x32_bf16 v[108:111], a[0:3], v[224:227], 0
  ds_read_b64_tr_b16 a[56:57], v9 offset:24576
  v_mul_f32 v100, v100, v13
  v_mfma_f32_16x16x32_bf16 v[108:111], a[4:7], v[228:231], v[108:111]
  v_mul_f32 v101, v101, v13
  v_mul_f32 v102, v102, v13
  v_mfma_f32_16x16x32_bf16 v[108:111], a[8:11], v[232:235], v[108:111]
  s_add_u32 s69, s77, 65536
  ds_read_b64_tr_b16 a[58:59], v9 offset:26624
  v_mul_f32 v103, v103, v13
  v_mfma_f32_16x16x32_bf16 v[108:111], a[12:15], v[236:239], v[108:111]
  s_waitcnt vmcnt(42)
  s_barrier
  buffer_store_dwordx4 v[24:27], v11, s[24:27], s69 offen
  v_mfma_f32_16x16x32_bf16 v[108:111], a[16:19], v[240:243], v[108:111]
  s_waitcnt lgkmcnt(8)
  ds_read_b64_tr_b16 a[60:61], v9 offset:28672
  v_cvt_pk_bf16_f32 v20, v100, v101
  v_mfma_f32_16x16x32_bf16 v[108:111], a[20:23], v[244:247], v[108:111]
  v_mfma_f32_16x16x32_bf16 v[108:111], a[24:27], v[248:251], v[108:111]
  ds_read_b64_tr_b16 a[62:63], v9 offset:30720
  v_cvt_pk_bf16_f32 v21, v102, v103
  v_mfma_f32_16x16x32_bf16 v[108:111], a[28:31], v[252:255], v[108:111]
  s_waitcnt lgkmcnt(12)
  v_mfma_f32_16x16x32_bf16 v[112:115], a[32:35], v[128:131], 0
  ds_read_b64_tr_b16 a[0:1], v6 offset:0
  v_mul_f32 v104, v104, v14
  v_mfma_f32_16x16x32_bf16 v[112:115], a[36:39], v[132:135], v[112:115]
  s_waitcnt lgkmcnt(9)
  v_mul_f32 v105, v105, v14
  v_mul_f32 v106, v106, v14
  v_mfma_f32_16x16x32_bf16 v[112:115], a[40:43], v[136:139], v[112:115]
  s_add_u32 s70, s77, 98304
  ds_read_b64_tr_b16 a[2:3], v6 offset:2048
  v_mul_f32 v107, v107, v14
  v_mfma_f32_16x16x32_bf16 v[112:115], a[44:47], v[140:143], v[112:115]
  s_waitcnt lgkmcnt(6)
  buffer_store_dwordx4 v[28:31], v11, s[24:27], s70 offen
  v_mfma_f32_16x16x32_bf16 v[112:115], a[48:51], v[144:147], v[112:115]
  ds_read_b64_tr_b16 a[4:5], v6 offset:4096
  v_cvt_pk_bf16_f32 v24, v104, v105
  v_mfma_f32_16x16x32_bf16 v[112:115], a[52:55], v[148:151], v[112:115]
  s_waitcnt lgkmcnt(3)
  v_subrev_u32 v9, 131072, v9
  v_mfma_f32_16x16x32_bf16 v[112:115], a[56:59], v[152:155], v[112:115]
  ds_read_b64_tr_b16 a[6:7], v6 offset:6144
  v_cvt_pk_bf16_f32 v25, v106, v107
  v_mfma_f32_16x16x32_bf16 v[112:115], a[60:63], v[156:159], v[112:115]
  v_mfma_f32_16x16x32_bf16 v[116:119], a[32:35], v[160:163], 0
  ds_read_b64_tr_b16 a[8:9], v6 offset:8192
  v_mul_f32 v108, v108, v15
  v_mfma_f32_16x16x32_bf16 v[116:119], a[36:39], v[164:167], v[116:119]
  v_mul_f32 v109, v109, v15
  v_mul_f32 v110, v110, v15
  v_mfma_f32_16x16x32_bf16 v[116:119], a[40:43], v[168:171], v[116:119]
  ds_read_b64_tr_b16 a[10:11], v6 offset:10240
  v_mul_f32 v111, v111, v15
  v_mfma_f32_16x16x32_bf16 v[116:119], a[44:47], v[172:175], v[116:119]
  v_mfma_f32_16x16x32_bf16 v[116:119], a[48:51], v[176:179], v[116:119]
  ds_read_b64_tr_b16 a[12:13], v6 offset:12288
  v_cvt_pk_bf16_f32 v28, v108, v109
  v_mfma_f32_16x16x32_bf16 v[116:119], a[52:55], v[180:183], v[116:119]
  v_mfma_f32_16x16x32_bf16 v[116:119], a[56:59], v[184:187], v[116:119]
  ds_read_b64_tr_b16 a[14:15], v6 offset:14336
  v_cvt_pk_bf16_f32 v29, v110, v111
  v_mfma_f32_16x16x32_bf16 v[116:119], a[60:63], v[188:191], v[116:119]
  v_mfma_f32_16x16x32_bf16 v[120:123], a[32:35], v[192:195], 0
  ds_read_b64_tr_b16 a[16:17], v6 offset:16384
  v_mul_f32 v112, v112, v12
  v_mfma_f32_16x16x32_bf16 v[120:123], a[36:39], v[196:199], v[120:123]
  v_mul_f32 v113, v113, v12
  v_mul_f32 v114, v114, v12
  v_mfma_f32_16x16x32_bf16 v[120:123], a[40:43], v[200:203], v[120:123]
  ds_read_b64_tr_b16 a[18:19], v6 offset:18432
  v_mul_f32 v115, v115, v12
  v_mfma_f32_16x16x32_bf16 v[120:123], a[44:47], v[204:207], v[120:123]
  v_mfma_f32_16x16x32_bf16 v[120:123], a[48:51], v[208:211], v[120:123]
  ds_read_b64_tr_b16 a[20:21], v6 offset:20480
  v_cvt_pk_bf16_f32 v18, v112, v113
  v_mfma_f32_16x16x32_bf16 v[120:123], a[52:55], v[212:215], v[120:123]
  v_mfma_f32_16x16x32_bf16 v[120:123], a[56:59], v[216:219], v[120:123]
  ds_read_b64_tr_b16 a[22:23], v6 offset:22528
  v_cvt_pk_bf16_f32 v19, v114, v115
  v_mfma_f32_16x16x32_bf16 v[120:123], a[60:63], v[220:223], v[120:123]
  v_mfma_f32_16x16x32_bf16 v[124:127], a[32:35], v[224:227], 0
  ds_read_b64_tr_b16 a[24:25], v6 offset:24576
  v_mul_f32 v116, v116, v13
  v_mfma_f32_16x16x32_bf16 v[124:127], a[36:39], v[228:231], v[124:127]
  v_mul_f32 v117, v117, v13
  v_mul_f32 v118, v118, v13
  v_mfma_f32_16x16x32_bf16 v[124:127], a[40:43], v[232:235], v[124:127]
  s_add_u32 s69, s77, 1024
  ds_read_b64_tr_b16 a[26:27], v6 offset:26624
  v_mul_f32 v119, v119, v13
  v_mfma_f32_16x16x32_bf16 v[124:127], a[44:47], v[236:239], v[124:127]
  buffer_store_dwordx4 v[16:19], v11, s[24:27], s69 offen
  v_mfma_f32_16x16x32_bf16 v[124:127], a[48:51], v[240:243], v[124:127]
  s_waitcnt lgkmcnt(8)
  ds_read_b64_tr_b16 a[28:29], v6 offset:28672
  v_cvt_pk_bf16_f32 v22, v116, v117
  v_mfma_f32_16x16x32_bf16 v[124:127], a[52:55], v[244:247], v[124:127]
  v_mfma_f32_16x16x32_bf16 v[124:127], a[56:59], v[248:251], v[124:127]
  ds_read_b64_tr_b16 a[30:31], v6 offset:30720
  v_cvt_pk_bf16_f32 v23, v118, v119
  v_mfma_f32_16x16x32_bf16 v[124:127], a[60:63], v[252:255], v[124:127]
  s_waitcnt lgkmcnt(12)
  v_mfma_f32_16x16x32_bf16 v[96:99], a[0:3], v[128:131], 0
  ds_read_b64_tr_b16 a[32:33], v7 offset:0
  v_mul_f32 v120, v120, v14
  v_mfma_f32_16x16x32_bf16 v[96:99], a[4:7], v[132:135], v[96:99]
  s_waitcnt lgkmcnt(9)
  v_mul_f32 v121, v121, v14
  v_mul_f32 v122, v122, v14
  v_mfma_f32_16x16x32_bf16 v[96:99], a[8:11], v[136:139], v[96:99]
  ds_read_b64_tr_b16 a[34:35], v7 offset:2048
  v_mul_f32 v123, v123, v14
  v_mfma_f32_16x16x32_bf16 v[96:99], a[12:15], v[140:143], v[96:99]
  s_waitcnt lgkmcnt(6)
  v_mfma_f32_16x16x32_bf16 v[96:99], a[16:19], v[144:147], v[96:99]
  ds_read_b64_tr_b16 a[36:37], v7 offset:4096
  v_cvt_pk_bf16_f32 v26, v120, v121
  v_mfma_f32_16x16x32_bf16 v[96:99], a[20:23], v[148:151], v[96:99]
  s_waitcnt lgkmcnt(3)
  v_mfma_f32_16x16x32_bf16 v[96:99], a[24:27], v[152:155], v[96:99]
  ds_read_b64_tr_b16 a[38:39], v7 offset:6144
  v_cvt_pk_bf16_f32 v27, v122, v123
  v_mfma_f32_16x16x32_bf16 v[96:99], a[28:31], v[156:159], v[96:99]
  v_mfma_f32_16x16x32_bf16 v[100:103], a[0:3], v[160:163], 0
  ds_read_b64_tr_b16 a[40:41], v7 offset:8192
  v_mul_f32 v124, v124, v15
  v_mfma_f32_16x16x32_bf16 v[100:103], a[4:7], v[164:167], v[100:103]
  v_mul_f32 v125, v125, v15
  v_mul_f32 v126, v126, v15
  v_mfma_f32_16x16x32_bf16 v[100:103], a[8:11], v[168:171], v[100:103]
  s_add_u32 s70, s77, 33792
  ds_read_b64_tr_b16 a[42:43], v7 offset:10240
  v_mul_f32 v127, v127, v15
  v_mfma_f32_16x16x32_bf16 v[100:103], a[12:15], v[172:175], v[100:103]
  buffer_store_dwordx4 v[20:23], v11, s[24:27], s70 offen
  v_mfma_f32_16x16x32_bf16 v[100:103], a[16:19], v[176:179], v[100:103]
  ds_read_b64_tr_b16 a[44:45], v7 offset:12288
  v_cvt_pk_bf16_f32 v30, v124, v125
  v_mfma_f32_16x16x32_bf16 v[100:103], a[20:23], v[180:183], v[100:103]
  v_mfma_f32_16x16x32_bf16 v[100:103], a[24:27], v[184:187], v[100:103]
  ds_read_b64_tr_b16 a[46:47], v7 offset:14336
  v_cvt_pk_bf16_f32 v31, v126, v127
  v_mfma_f32_16x16x32_bf16 v[100:103], a[28:31], v[188:191], v[100:103]
  v_mfma_f32_16x16x32_bf16 v[104:107], a[0:3], v[192:195], 0
  ds_read_b64_tr_b16 a[48:49], v7 offset:16384
  v_mul_f32 v96, v96, v12
  v_mfma_f32_16x16x32_bf16 v[104:107], a[4:7], v[196:199], v[104:107]
  v_mul_f32 v97, v97, v12
  v_mul_f32 v98, v98, v12
  v_mfma_f32_16x16x32_bf16 v[104:107], a[8:11], v[200:203], v[104:107]
  ds_read_b64_tr_b16 a[50:51], v7 offset:18432
  v_mul_f32 v99, v99, v12
  v_mfma_f32_16x16x32_bf16 v[104:107], a[12:15], v[204:207], v[104:107]
  v_mfma_f32_16x16x32_bf16 v[104:107], a[16:19], v[208:211], v[104:107]
  ds_read_b64_tr_b16 a[52:53], v7 offset:20480
  v_cvt_pk_bf16_f32 v16, v96, v97
  v_mfma_f32_16x16x32_bf16 v[104:107], a[20:23], v[212:215], v[104:107]
  v_mfma_f32_16x16x32_bf16 v[104:107], a[24:27], v[216:219], v[104:107]
  ds_read_b64_tr_b16 a[54:55], v7 offset:22528
  v_cvt_pk_bf16_f32 v17, v98, v99
  v_mfma_f32_16x16x32_bf16 v[104:107], a[28:31], v[220:223], v[104:107]
  v_mfma_f32_16x16x32_bf16 v[108:111], a[0:3], v[224:227], 0
  ds_read_b64_tr_b16 a[56:57], v7 offset:24576
  v_mul_f32 v100, v100, v13
  v_mfma_f32_16x16x32_bf16 v[108:111], a[4:7], v[228:231], v[108:111]
  v_mul_f32 v101, v101, v13
  v_mul_f32 v102, v102, v13
  v_mfma_f32_16x16x32_bf16 v[108:111], a[8:11], v[232:235], v[108:111]
  s_add_u32 s69, s77, 66560
  ds_read_b64_tr_b16 a[58:59], v7 offset:26624
  v_mul_f32 v103, v103, v13
  v_mfma_f32_16x16x32_bf16 v[108:111], a[12:15], v[236:239], v[108:111]
  buffer_store_dwordx4 v[24:27], v11, s[24:27], s69 offen
  v_mfma_f32_16x16x32_bf16 v[108:111], a[16:19], v[240:243], v[108:111]
  s_waitcnt lgkmcnt(8)
  ds_read_b64_tr_b16 a[60:61], v7 offset:28672
  v_cvt_pk_bf16_f32 v20, v100, v101
  v_mfma_f32_16x16x32_bf16 v[108:111], a[20:23], v[244:247], v[108:111]
  v_mfma_f32_16x16x32_bf16 v[108:111], a[24:27], v[248:251], v[108:111]
  ds_read_b64_tr_b16 a[62:63], v7 offset:30720
  v_cvt_pk_bf16_f32 v21, v102, v103
  v_mfma_f32_16x16x32_bf16 v[108:111], a[28:31], v[252:255], v[108:111]
  s_waitcnt lgkmcnt(12)
  v_mfma_f32_16x16x32_bf16 v[112:115], a[32:35], v[128:131], 0
  ds_read_b64_tr_b16 a[0:1], v8 offset:0
  v_mul_f32 v104, v104, v14
  v_mfma_f32_16x16x32_bf16 v[112:115], a[36:39], v[132:135], v[112:115]
  s_waitcnt lgkmcnt(9)
  v_mul_f32 v105, v105, v14
  v_mul_f32 v106, v106, v14
  v_mfma_f32_16x16x32_bf16 v[112:115], a[40:43], v[136:139], v[112:115]
  s_add_u32 s70, s77, 99328
  ds_read_b64_tr_b16 a[2:3], v8 offset:2048
  v_mul_f32 v107, v107, v14
  v_mfma_f32_16x16x32_bf16 v[112:115], a[44:47], v[140:143], v[112:115]
  s_waitcnt lgkmcnt(6)
  buffer_store_dwordx4 v[28:31], v11, s[24:27], s70 offen
  v_mfma_f32_16x16x32_bf16 v[112:115], a[48:51], v[144:147], v[112:115]
  ds_read_b64_tr_b16 a[4:5], v8 offset:4096
  v_cvt_pk_bf16_f32 v24, v104, v105
  v_mfma_f32_16x16x32_bf16 v[112:115], a[52:55], v[148:151], v[112:115]
  s_waitcnt lgkmcnt(3)
  v_add_u32 v7, 32768, v7
  v_mfma_f32_16x16x32_bf16 v[112:115], a[56:59], v[152:155], v[112:115]
  ds_read_b64_tr_b16 a[6:7], v8 offset:6144
  v_cvt_pk_bf16_f32 v25, v106, v107
  v_mfma_f32_16x16x32_bf16 v[112:115], a[60:63], v[156:159], v[112:115]
  v_mfma_f32_16x16x32_bf16 v[116:119], a[32:35], v[160:163], 0
  ds_read_b64_tr_b16 a[8:9], v8 offset:8192
  v_mul_f32 v108, v108, v15
  v_mfma_f32_16x16x32_bf16 v[116:119], a[36:39], v[164:167], v[116:119]
  v_mul_f32 v109, v109, v15
  v_mul_f32 v110, v110, v15
  v_mfma_f32_16x16x32_bf16 v[116:119], a[40:43], v[168:171], v[116:119]
  ds_read_b64_tr_b16 a[10:11], v8 offset:10240
  v_mul_f32 v111, v111, v15
  v_mfma_f32_16x16x32_bf16 v[116:119], a[44:47], v[172:175], v[116:119]
  v_mfma_f32_16x16x32_bf16 v[116:119], a[48:51], v[176:179], v[116:119]
  ds_read_b64_tr_b16 a[12:13], v8 offset:12288
  v_cvt_pk_bf16_f32 v28, v108, v109
  v_mfma_f32_16x16x32_bf16 v[116:119], a[52:55], v[180:183], v[116:119]
  v_mfma_f32_16x16x32_bf16 v[116:119], a[56:59], v[184:187], v[116:119]
  ds_read_b64_tr_b16 a[14:15], v8 offset:14336
  v_cvt_pk_bf16_f32 v29, v110, v111
  v_mfma_f32_16x16x32_bf16 v[116:119], a[60:63], v[188:191], v[116:119]
  v_mfma_f32_16x16x32_bf16 v[120:123], a[32:35], v[192:195], 0
  ds_read_b64_tr_b16 a[16:17], v8 offset:16384
  v_mul_f32 v112, v112, v12
  v_mfma_f32_16x16x32_bf16 v[120:123], a[36:39], v[196:199], v[120:123]
  v_mul_f32 v113, v113, v12
  v_mul_f32 v114, v114, v12
  v_mfma_f32_16x16x32_bf16 v[120:123], a[40:43], v[200:203], v[120:123]
  ds_read_b64_tr_b16 a[18:19], v8 offset:18432
  v_mul_f32 v115, v115, v12
  v_mfma_f32_16x16x32_bf16 v[120:123], a[44:47], v[204:207], v[120:123]
  v_mfma_f32_16x16x32_bf16 v[120:123], a[48:51], v[208:211], v[120:123]
  ds_read_b64_tr_b16 a[20:21], v8 offset:20480
  v_cvt_pk_bf16_f32 v18, v112, v113
  v_mfma_f32_16x16x32_bf16 v[120:123], a[52:55], v[212:215], v[120:123]
  v_mfma_f32_16x16x32_bf16 v[120:123], a[56:59], v[216:219], v[120:123]
  ds_read_b64_tr_b16 a[22:23], v8 offset:22528
  v_cvt_pk_bf16_f32 v19, v114, v115
  v_mfma_f32_16x16x32_bf16 v[120:123], a[60:63], v[220:223], v[120:123]
  v_mfma_f32_16x16x32_bf16 v[124:127], a[32:35], v[224:227], 0
  ds_read_b64_tr_b16 a[24:25], v8 offset:24576
  v_mul_f32 v116, v116, v13
  v_mfma_f32_16x16x32_bf16 v[124:127], a[36:39], v[228:231], v[124:127]
  v_mul_f32 v117, v117, v13
  v_mul_f32 v118, v118, v13
  v_mfma_f32_16x16x32_bf16 v[124:127], a[40:43], v[232:235], v[124:127]
  s_add_u32 s69, s77, 524288
  ds_read_b64_tr_b16 a[26:27], v8 offset:26624
  v_mul_f32 v119, v119, v13
  v_mfma_f32_16x16x32_bf16 v[124:127], a[44:47], v[236:239], v[124:127]
  buffer_store_dwordx4 v[16:19], v11, s[24:27], s69 offen
  v_mfma_f32_16x16x32_bf16 v[124:127], a[48:51], v[240:243], v[124:127]
  s_waitcnt lgkmcnt(8)
  ds_read_b64_tr_b16 a[28:29], v8 offset:28672
  v_cvt_pk_bf16_f32 v22, v116, v117
  v_mfma_f32_16x16x32_bf16 v[124:127], a[52:55], v[244:247], v[124:127]
  v_mfma_f32_16x16x32_bf16 v[124:127], a[56:59], v[248:251], v[124:127]
  ds_read_b64_tr_b16 a[30:31], v8 offset:30720
  v_cvt_pk_bf16_f32 v23, v118, v119
  v_mfma_f32_16x16x32_bf16 v[124:127], a[60:63], v[252:255], v[124:127]
  s_waitcnt lgkmcnt(12)
  v_mfma_f32_16x16x32_bf16 v[96:99], a[0:3], v[128:131], 0
  ds_read_b64_tr_b16 a[32:33], v9 offset:0
  v_mul_f32 v120, v120, v14
  v_mfma_f32_16x16x32_bf16 v[96:99], a[4:7], v[132:135], v[96:99]
  s_waitcnt lgkmcnt(9)
  v_mul_f32 v121, v121, v14
  v_mul_f32 v122, v122, v14
  v_mfma_f32_16x16x32_bf16 v[96:99], a[8:11], v[136:139], v[96:99]
  ds_read_b64_tr_b16 a[34:35], v9 offset:2048
  v_mul_f32 v123, v123, v14
  v_mfma_f32_16x16x32_bf16 v[96:99], a[12:15], v[140:143], v[96:99]
  s_waitcnt lgkmcnt(6)
  v_mfma_f32_16x16x32_bf16 v[96:99], a[16:19], v[144:147], v[96:99]
  ds_read_b64_tr_b16 a[36:37], v9 offset:4096
  v_cvt_pk_bf16_f32 v26, v120, v121
  v_mfma_f32_16x16x32_bf16 v[96:99], a[20:23], v[148:151], v[96:99]
  s_waitcnt lgkmcnt(3)
  v_add_u32 v8, 32768, v8
  v_mfma_f32_16x16x32_bf16 v[96:99], a[24:27], v[152:155], v[96:99]
  ds_read_b64_tr_b16 a[38:39], v9 offset:6144
  v_cvt_pk_bf16_f32 v27, v122, v123
  v_mfma_f32_16x16x32_bf16 v[96:99], a[28:31], v[156:159], v[96:99]
  v_mfma_f32_16x16x32_bf16 v[100:103], a[0:3], v[160:163], 0
  ds_read_b64_tr_b16 a[40:41], v9 offset:8192
  v_mul_f32 v124, v124, v15
  v_mfma_f32_16x16x32_bf16 v[100:103], a[4:7], v[164:167], v[100:103]
  v_mul_f32 v125, v125, v15
  v_mul_f32 v126, v126, v15
  v_mfma_f32_16x16x32_bf16 v[100:103], a[8:11], v[168:171], v[100:103]
  s_add_u32 s70, s77, 557056
  ds_read_b64_tr_b16 a[42:43], v9 offset:10240
  v_mul_f32 v127, v127, v15
  v_mfma_f32_16x16x32_bf16 v[100:103], a[12:15], v[172:175], v[100:103]
  buffer_store_dwordx4 v[20:23], v11, s[24:27], s70 offen
  v_mfma_f32_16x16x32_bf16 v[100:103], a[16:19], v[176:179], v[100:103]
  ds_read_b64_tr_b16 a[44:45], v9 offset:12288
  v_cvt_pk_bf16_f32 v30, v124, v125
  v_mfma_f32_16x16x32_bf16 v[100:103], a[20:23], v[180:183], v[100:103]
  v_mfma_f32_16x16x32_bf16 v[100:103], a[24:27], v[184:187], v[100:103]
  ds_read_b64_tr_b16 a[46:47], v9 offset:14336
  v_cvt_pk_bf16_f32 v31, v126, v127
  v_mfma_f32_16x16x32_bf16 v[100:103], a[28:31], v[188:191], v[100:103]
  v_mfma_f32_16x16x32_bf16 v[104:107], a[0:3], v[192:195], 0
  ds_read_b64_tr_b16 a[48:49], v9 offset:16384
  v_mul_f32 v96, v96, v12
  v_mfma_f32_16x16x32_bf16 v[104:107], a[4:7], v[196:199], v[104:107]
  v_mul_f32 v97, v97, v12
  v_mul_f32 v98, v98, v12
  v_mfma_f32_16x16x32_bf16 v[104:107], a[8:11], v[200:203], v[104:107]
  ds_read_b64_tr_b16 a[50:51], v9 offset:18432
  v_mul_f32 v99, v99, v12
  v_mfma_f32_16x16x32_bf16 v[104:107], a[12:15], v[204:207], v[104:107]
  v_mfma_f32_16x16x32_bf16 v[104:107], a[16:19], v[208:211], v[104:107]
  ds_read_b64_tr_b16 a[52:53], v9 offset:20480
  v_cvt_pk_bf16_f32 v16, v96, v97
  v_mfma_f32_16x16x32_bf16 v[104:107], a[20:23], v[212:215], v[104:107]
  v_add_u32 v6, 32768, v6
  v_mfma_f32_16x16x32_bf16 v[104:107], a[24:27], v[216:219], v[104:107]
  ds_read_b64_tr_b16 a[54:55], v9 offset:22528
  v_cvt_pk_bf16_f32 v17, v98, v99
  v_mfma_f32_16x16x32_bf16 v[104:107], a[28:31], v[220:223], v[104:107]
  v_mfma_f32_16x16x32_bf16 v[108:111], a[0:3], v[224:227], 0
  ds_read_b64_tr_b16 a[56:57], v9 offset:24576
  v_mul_f32 v100, v100, v13
  v_mfma_f32_16x16x32_bf16 v[108:111], a[4:7], v[228:231], v[108:111]
  v_mul_f32 v101, v101, v13
  v_mul_f32 v102, v102, v13
  v_mfma_f32_16x16x32_bf16 v[108:111], a[8:11], v[232:235], v[108:111]
  s_add_u32 s69, s77, 589824
  ds_read_b64_tr_b16 a[58:59], v9 offset:26624
  v_mul_f32 v103, v103, v13
  v_mfma_f32_16x16x32_bf16 v[108:111], a[12:15], v[236:239], v[108:111]
  s_waitcnt vmcnt(42)
  s_barrier
  buffer_store_dwordx4 v[24:27], v11, s[24:27], s69 offen
  v_mfma_f32_16x16x32_bf16 v[108:111], a[16:19], v[240:243], v[108:111]
  s_waitcnt lgkmcnt(8)
  ds_read_b64_tr_b16 a[60:61], v9 offset:28672
  v_cvt_pk_bf16_f32 v20, v100, v101
  v_mfma_f32_16x16x32_bf16 v[108:111], a[20:23], v[244:247], v[108:111]
  v_mfma_f32_16x16x32_bf16 v[108:111], a[24:27], v[248:251], v[108:111]
  ds_read_b64_tr_b16 a[62:63], v9 offset:30720
  v_cvt_pk_bf16_f32 v21, v102, v103
  v_mfma_f32_16x16x32_bf16 v[108:111], a[28:31], v[252:255], v[108:111]
  s_waitcnt lgkmcnt(12)
  v_mfma_f32_16x16x32_bf16 v[112:115], a[32:35], v[128:131], 0
  ds_read_b64_tr_b16 a[0:1], v6 offset:0
  v_mul_f32 v104, v104, v14
  v_mfma_f32_16x16x32_bf16 v[112:115], a[36:39], v[132:135], v[112:115]
  s_waitcnt lgkmcnt(9)
  v_mul_f32 v105, v105, v14
  v_mul_f32 v106, v106, v14
  v_mfma_f32_16x16x32_bf16 v[112:115], a[40:43], v[136:139], v[112:115]
  s_add_u32 s70, s77, 622592
  ds_read_b64_tr_b16 a[2:3], v6 offset:2048
  v_mul_f32 v107, v107, v14
  v_mfma_f32_16x16x32_bf16 v[112:115], a[44:47], v[140:143], v[112:115]
  s_waitcnt lgkmcnt(6)
  buffer_store_dwordx4 v[28:31], v11, s[24:27], s70 offen
  v_mfma_f32_16x16x32_bf16 v[112:115], a[48:51], v[144:147], v[112:115]
  ds_read_b64_tr_b16 a[4:5], v6 offset:4096
  v_cvt_pk_bf16_f32 v24, v104, v105
  v_mfma_f32_16x16x32_bf16 v[112:115], a[52:55], v[148:151], v[112:115]
  s_waitcnt lgkmcnt(3)
  v_add_u32 v9, 32768, v9
  v_mfma_f32_16x16x32_bf16 v[112:115], a[56:59], v[152:155], v[112:115]
  ds_read_b64_tr_b16 a[6:7], v6 offset:6144
  v_cvt_pk_bf16_f32 v25, v106, v107
  v_mfma_f32_16x16x32_bf16 v[112:115], a[60:63], v[156:159], v[112:115]
  v_mfma_f32_16x16x32_bf16 v[116:119], a[32:35], v[160:163], 0
  ds_read_b64_tr_b16 a[8:9], v6 offset:8192
  v_mul_f32 v108, v108, v15
  v_mfma_f32_16x16x32_bf16 v[116:119], a[36:39], v[164:167], v[116:119]
  v_mul_f32 v109, v109, v15
  v_mul_f32 v110, v110, v15
  v_mfma_f32_16x16x32_bf16 v[116:119], a[40:43], v[168:171], v[116:119]
  ds_read_b64_tr_b16 a[10:11], v6 offset:10240
  v_mul_f32 v111, v111, v15
  v_mfma_f32_16x16x32_bf16 v[116:119], a[44:47], v[172:175], v[116:119]
  v_mfma_f32_16x16x32_bf16 v[116:119], a[48:51], v[176:179], v[116:119]
  ds_read_b64_tr_b16 a[12:13], v6 offset:12288
  v_cvt_pk_bf16_f32 v28, v108, v109
  v_mfma_f32_16x16x32_bf16 v[116:119], a[52:55], v[180:183], v[116:119]
  v_mfma_f32_16x16x32_bf16 v[116:119], a[56:59], v[184:187], v[116:119]
  ds_read_b64_tr_b16 a[14:15], v6 offset:14336
  v_cvt_pk_bf16_f32 v29, v110, v111
  v_mfma_f32_16x16x32_bf16 v[116:119], a[60:63], v[188:191], v[116:119]
  v_mfma_f32_16x16x32_bf16 v[120:123], a[32:35], v[192:195], 0
  ds_read_b64_tr_b16 a[16:17], v6 offset:16384
  v_mul_f32 v112, v112, v12
  v_mfma_f32_16x16x32_bf16 v[120:123], a[36:39], v[196:199], v[120:123]
  v_mul_f32 v113, v113, v12
  v_mul_f32 v114, v114, v12
  v_mfma_f32_16x16x32_bf16 v[120:123], a[40:43], v[200:203], v[120:123]
  ds_read_b64_tr_b16 a[18:19], v6 offset:18432
  v_mul_f32 v115, v115, v12
  v_mfma_f32_16x16x32_bf16 v[120:123], a[44:47], v[204:207], v[120:123]
  v_mfma_f32_16x16x32_bf16 v[120:123], a[48:51], v[208:211], v[120:123]
  ds_read_b64_tr_b16 a[20:21], v6 offset:20480
  v_cvt_pk_bf16_f32 v18, v112, v113
  v_mfma_f32_16x16x32_bf16 v[120:123], a[52:55], v[212:215], v[120:123]
  v_mfma_f32_16x16x32_bf16 v[120:123], a[56:59], v[216:219], v[120:123]
  ds_read_b64_tr_b16 a[22:23], v6 offset:22528
  v_cvt_pk_bf16_f32 v19, v114, v115
  v_mfma_f32_16x16x32_bf16 v[120:123], a[60:63], v[220:223], v[120:123]
  v_mfma_f32_16x16x32_bf16 v[124:127], a[32:35], v[224:227], 0
  ds_read_b64_tr_b16 a[24:25], v6 offset:24576
  v_mul_f32 v116, v116, v13
  v_mfma_f32_16x16x32_bf16 v[124:127], a[36:39], v[228:231], v[124:127]
  v_mul_f32 v117, v117, v13
  v_mul_f32 v118, v118, v13
  v_mfma_f32_16x16x32_bf16 v[124:127], a[40:43], v[232:235], v[124:127]
  s_add_u32 s69, s77, 525312
  ds_read_b64_tr_b16 a[26:27], v6 offset:26624
  v_mul_f32 v119, v119, v13
  v_mfma_f32_16x16x32_bf16 v[124:127], a[44:47], v[236:239], v[124:127]
  buffer_store_dwordx4 v[16:19], v11, s[24:27], s69 offen
  v_mfma_f32_16x16x32_bf16 v[124:127], a[48:51], v[240:243], v[124:127]
  s_waitcnt lgkmcnt(8)
  ds_read_b64_tr_b16 a[28:29], v6 offset:28672
  v_cvt_pk_bf16_f32 v22, v116, v117
  v_mfma_f32_16x16x32_bf16 v[124:127], a[52:55], v[244:247], v[124:127]
  v_mfma_f32_16x16x32_bf16 v[124:127], a[56:59], v[248:251], v[124:127]
  ds_read_b64_tr_b16 a[30:31], v6 offset:30720
  v_cvt_pk_bf16_f32 v23, v118, v119
  v_mfma_f32_16x16x32_bf16 v[124:127], a[60:63], v[252:255], v[124:127]
  s_waitcnt lgkmcnt(12)
  v_mfma_f32_16x16x32_bf16 v[96:99], a[0:3], v[128:131], 0
  ds_read_b64_tr_b16 a[32:33], v7 offset:0
  v_mul_f32 v120, v120, v14
  v_mfma_f32_16x16x32_bf16 v[96:99], a[4:7], v[132:135], v[96:99]
  s_waitcnt lgkmcnt(9)
  v_add_u32 v39, 131072, v39
  v_mul_f32 v121, v121, v14
  v_mul_f32 v122, v122, v14
  v_mfma_f32_16x16x32_bf16 v[96:99], a[8:11], v[136:139], v[96:99]
  ds_read_b64_tr_b16 a[34:35], v7 offset:2048
  v_mul_f32 v123, v123, v14
  v_mfma_f32_16x16x32_bf16 v[96:99], a[12:15], v[140:143], v[96:99]
  s_waitcnt lgkmcnt(6)
  v_mfma_f32_16x16x32_bf16 v[96:99], a[16:19], v[144:147], v[96:99]
  ds_read_b64_tr_b16 a[36:37], v7 offset:4096
  v_cvt_pk_bf16_f32 v26, v120, v121
  v_mfma_f32_16x16x32_bf16 v[96:99], a[20:23], v[148:151], v[96:99]
  s_waitcnt lgkmcnt(3)
  v_mfma_f32_16x16x32_bf16 v[96:99], a[24:27], v[152:155], v[96:99]
  ds_read_b64_tr_b16 a[38:39], v7 offset:6144
  v_cvt_pk_bf16_f32 v27, v122, v123
  v_mfma_f32_16x16x32_bf16 v[96:99], a[28:31], v[156:159], v[96:99]
  v_mfma_f32_16x16x32_bf16 v[100:103], a[0:3], v[160:163], 0
  ds_read_b64_tr_b16 a[40:41], v7 offset:8192
  v_mul_f32 v124, v124, v15
  v_mfma_f32_16x16x32_bf16 v[100:103], a[4:7], v[164:167], v[100:103]
  v_mul_f32 v125, v125, v15
  v_mul_f32 v126, v126, v15
  v_mfma_f32_16x16x32_bf16 v[100:103], a[8:11], v[168:171], v[100:103]
  s_add_u32 s70, s77, 558080
  ds_read_b64_tr_b16 a[42:43], v7 offset:10240
  v_mul_f32 v127, v127, v15
  v_mfma_f32_16x16x32_bf16 v[100:103], a[12:15], v[172:175], v[100:103]
  buffer_store_dwordx4 v[20:23], v11, s[24:27], s70 offen
  v_mfma_f32_16x16x32_bf16 v[100:103], a[16:19], v[176:179], v[100:103]
  ds_read_b64_tr_b16 a[44:45], v7 offset:12288
  v_cvt_pk_bf16_f32 v30, v124, v125
  v_mfma_f32_16x16x32_bf16 v[100:103], a[20:23], v[180:183], v[100:103]
  v_mfma_f32_16x16x32_bf16 v[100:103], a[24:27], v[184:187], v[100:103]
  s_waitcnt vmcnt(22)
  ds_read_b64_tr_b16 a[46:47], v7 offset:14336
  v_cvt_pk_bf16_f32 v31, v126, v127
  v_mfma_f32_16x16x32_bf16 v[100:103], a[28:31], v[188:191], v[100:103]
  ds_write_b128 v39, a[100:103] offset:0
  v_mfma_f32_16x16x32_bf16 v[104:107], a[0:3], v[192:195], 0
  ds_read_b64_tr_b16 a[48:49], v7 offset:16384
  v_mul_f32 v96, v96, v12
  v_mfma_f32_16x16x32_bf16 v[104:107], a[4:7], v[196:199], v[104:107]
  v_mul_f32 v97, v97, v12
  v_mul_f32 v98, v98, v12
  v_mfma_f32_16x16x32_bf16 v[104:107], a[8:11], v[200:203], v[104:107]
  ds_read_b64_tr_b16 a[50:51], v7 offset:18432
  v_mul_f32 v99, v99, v12
  v_mfma_f32_16x16x32_bf16 v[104:107], a[12:15], v[204:207], v[104:107]
  v_mfma_f32_16x16x32_bf16 v[104:107], a[16:19], v[208:211], v[104:107]
  ds_read_b64_tr_b16 a[52:53], v7 offset:20480
  v_cvt_pk_bf16_f32 v16, v96, v97
  v_mfma_f32_16x16x32_bf16 v[104:107], a[20:23], v[212:215], v[104:107]
  v_mfma_f32_16x16x32_bf16 v[104:107], a[24:27], v[216:219], v[104:107]
  ds_read_b64_tr_b16 a[54:55], v7 offset:22528
  v_cvt_pk_bf16_f32 v17, v98, v99
  v_mfma_f32_16x16x32_bf16 v[104:107], a[28:31], v[220:223], v[104:107]
  v_mfma_f32_16x16x32_bf16 v[108:111], a[0:3], v[224:227], 0
  ds_read_b64_tr_b16 a[56:57], v7 offset:24576
  v_mul_f32 v100, v100, v13
  v_mfma_f32_16x16x32_bf16 v[108:111], a[4:7], v[228:231], v[108:111]
  v_mul_f32 v101, v101, v13
  v_mul_f32 v102, v102, v13
  v_mfma_f32_16x16x32_bf16 v[108:111], a[8:11], v[232:235], v[108:111]
  s_waitcnt lgkmcnt(8)
  s_add_u32 s69, s77, 590848
  ds_read_b64_tr_b16 a[58:59], v7 offset:26624
  v_mul_f32 v103, v103, v13
  v_mfma_f32_16x16x32_bf16 v[108:111], a[12:15], v[236:239], v[108:111]
  buffer_store_dwordx4 v[24:27], v11, s[24:27], s69 offen
  v_mfma_f32_16x16x32_bf16 v[108:111], a[16:19], v[240:243], v[108:111]
  ds_read_b64_tr_b16 a[60:61], v7 offset:28672
  v_cvt_pk_bf16_f32 v20, v100, v101
  v_mfma_f32_16x16x32_bf16 v[108:111], a[20:23], v[244:247], v[108:111]
  v_mfma_f32_16x16x32_bf16 v[108:111], a[24:27], v[248:251], v[108:111]
  ds_read_b64_tr_b16 a[62:63], v7 offset:30720
  v_cvt_pk_bf16_f32 v21, v102, v103
  v_mfma_f32_16x16x32_bf16 v[108:111], a[28:31], v[252:255], v[108:111]
  s_waitcnt lgkmcnt(13)
  v_mfma_f32_16x16x32_bf16 v[112:115], a[32:35], v[128:131], 0
  ds_read_b64_tr_b16 a[0:1], v8 offset:0
  v_mul_f32 v104, v104, v14
  v_mfma_f32_16x16x32_bf16 v[112:115], a[36:39], v[132:135], v[112:115]
  s_waitcnt lgkmcnt(10)
  v_mul_f32 v105, v105, v14
  v_mul_f32 v106, v106, v14
  v_mfma_f32_16x16x32_bf16 v[112:115], a[40:43], v[136:139], v[112:115]
  s_add_u32 s70, s77, 623616
  ds_read_b64_tr_b16 a[2:3], v8 offset:2048
  v_mul_f32 v107, v107, v14
  v_mfma_f32_16x16x32_bf16 v[112:115], a[44:47], v[140:143], v[112:115]
  s_waitcnt lgkmcnt(6)
  buffer_store_dwordx4 v[28:31], v11, s[24:27], s70 offen
  v_mfma_f32_16x16x32_bf16 v[112:115], a[48:51], v[144:147], v[112:115]
  ds_read_b64_tr_b16 a[4:5], v8 offset:4096
  v_cvt_pk_bf16_f32 v24, v104, v105
  v_mfma_f32_16x16x32_bf16 v[112:115], a[52:55], v[148:151], v[112:115]
  s_waitcnt lgkmcnt(3)
  v_add_u32 v7, 32768, v7
  v_mfma_f32_16x16x32_bf16 v[112:115], a[56:59], v[152:155], v[112:115]
  ds_read_b64_tr_b16 a[6:7], v8 offset:6144
  v_cvt_pk_bf16_f32 v25, v106, v107
  v_mfma_f32_16x16x32_bf16 v[112:115], a[60:63], v[156:159], v[112:115]
  v_mfma_f32_16x16x32_bf16 v[116:119], a[32:35], v[160:163], 0
  ds_read_b64_tr_b16 a[8:9], v8 offset:8192
  v_mul_f32 v108, v108, v15
  v_mfma_f32_16x16x32_bf16 v[116:119], a[36:39], v[164:167], v[116:119]
  v_mul_f32 v109, v109, v15
  v_mul_f32 v110, v110, v15
  v_mfma_f32_16x16x32_bf16 v[116:119], a[40:43], v[168:171], v[116:119]
  ds_read_b64_tr_b16 a[10:11], v8 offset:10240
  v_mul_f32 v111, v111, v15
  v_mfma_f32_16x16x32_bf16 v[116:119], a[44:47], v[172:175], v[116:119]
  v_mfma_f32_16x16x32_bf16 v[116:119], a[48:51], v[176:179], v[116:119]
  ds_read_b64_tr_b16 a[12:13], v8 offset:12288
  v_cvt_pk_bf16_f32 v28, v108, v109
  v_mfma_f32_16x16x32_bf16 v[116:119], a[52:55], v[180:183], v[116:119]
  v_mfma_f32_16x16x32_bf16 v[116:119], a[56:59], v[184:187], v[116:119]
  ds_read_b64_tr_b16 a[14:15], v8 offset:14336
  v_cvt_pk_bf16_f32 v29, v110, v111
  v_mfma_f32_16x16x32_bf16 v[116:119], a[60:63], v[188:191], v[116:119]
  ds_write_b128 v39, a[104:107] offset:4096
  v_mfma_f32_16x16x32_bf16 v[120:123], a[32:35], v[192:195], 0
  ds_read_b64_tr_b16 a[16:17], v8 offset:16384
  v_mul_f32 v112, v112, v12
  v_mfma_f32_16x16x32_bf16 v[120:123], a[36:39], v[196:199], v[120:123]
  v_mul_f32 v113, v113, v12
  v_mul_f32 v114, v114, v12
  v_mfma_f32_16x16x32_bf16 v[120:123], a[40:43], v[200:203], v[120:123]
  ds_read_b64_tr_b16 a[18:19], v8 offset:18432
  v_mul_f32 v115, v115, v12
  v_mfma_f32_16x16x32_bf16 v[120:123], a[44:47], v[204:207], v[120:123]
  v_mfma_f32_16x16x32_bf16 v[120:123], a[48:51], v[208:211], v[120:123]
  ds_read_b64_tr_b16 a[20:21], v8 offset:20480
  v_cvt_pk_bf16_f32 v18, v112, v113
  v_mfma_f32_16x16x32_bf16 v[120:123], a[52:55], v[212:215], v[120:123]
  ds_write_b128 v39, a[108:111] offset:8192
  v_mfma_f32_16x16x32_bf16 v[120:123], a[56:59], v[216:219], v[120:123]
  ds_read_b64_tr_b16 a[22:23], v8 offset:22528
  v_cvt_pk_bf16_f32 v19, v114, v115
  v_mfma_f32_16x16x32_bf16 v[120:123], a[60:63], v[220:223], v[120:123]
  s_waitcnt lgkmcnt(8)
  ds_write_b128 v39, a[112:115] offset:12288
  v_mfma_f32_16x16x32_bf16 v[124:127], a[32:35], v[224:227], 0
  ds_read_b64_tr_b16 a[24:25], v8 offset:24576
  v_mul_f32 v116, v116, v13
  v_mfma_f32_16x16x32_bf16 v[124:127], a[36:39], v[228:231], v[124:127]
  v_mul_f32 v117, v117, v13
  v_mul_f32 v118, v118, v13
  v_mfma_f32_16x16x32_bf16 v[124:127], a[40:43], v[232:235], v[124:127]
  s_add_u32 s69, s77, 1048576
  ds_read_b64_tr_b16 a[26:27], v8 offset:26624
  v_mul_f32 v119, v119, v13
  v_mfma_f32_16x16x32_bf16 v[124:127], a[44:47], v[236:239], v[124:127]
  buffer_store_dwordx4 v[16:19], v11, s[24:27], s69 offen
  v_mfma_f32_16x16x32_bf16 v[124:127], a[48:51], v[240:243], v[124:127]
  ds_read_b64_tr_b16 a[28:29], v8 offset:28672
  v_cvt_pk_bf16_f32 v22, v116, v117
  v_mfma_f32_16x16x32_bf16 v[124:127], a[52:55], v[244:247], v[124:127]
  v_mfma_f32_16x16x32_bf16 v[124:127], a[56:59], v[248:251], v[124:127]
  ds_read_b64_tr_b16 a[30:31], v8 offset:30720
  v_cvt_pk_bf16_f32 v23, v118, v119
  v_mfma_f32_16x16x32_bf16 v[124:127], a[60:63], v[252:255], v[124:127]
  s_waitcnt lgkmcnt(15)
  v_mfma_f32_16x16x32_bf16 v[96:99], a[0:3], v[128:131], 0
  ds_read_b64_tr_b16 a[32:33], v9 offset:0
  v_mul_f32 v120, v120, v14
  v_mfma_f32_16x16x32_bf16 v[96:99], a[4:7], v[132:135], v[96:99]
  s_waitcnt lgkmcnt(12)
  v_mul_f32 v121, v121, v14
  v_mul_f32 v122, v122, v14
  v_mfma_f32_16x16x32_bf16 v[96:99], a[8:11], v[136:139], v[96:99]
  ds_read_b64_tr_b16 a[34:35], v9 offset:2048
  v_mul_f32 v123, v123, v14
  v_mfma_f32_16x16x32_bf16 v[96:99], a[12:15], v[140:143], v[96:99]
  s_waitcnt lgkmcnt(7)
  v_mfma_f32_16x16x32_bf16 v[96:99], a[16:19], v[144:147], v[96:99]
  ds_read_b64_tr_b16 a[36:37], v9 offset:4096
  v_cvt_pk_bf16_f32 v26, v120, v121
  v_mfma_f32_16x16x32_bf16 v[96:99], a[20:23], v[148:151], v[96:99]
  s_waitcnt lgkmcnt(3)
  v_add_u32 v8, 32768, v8
  v_mfma_f32_16x16x32_bf16 v[96:99], a[24:27], v[152:155], v[96:99]
  ds_read_b64_tr_b16 a[38:39], v9 offset:6144
  v_cvt_pk_bf16_f32 v27, v122, v123
  v_mfma_f32_16x16x32_bf16 v[96:99], a[28:31], v[156:159], v[96:99]
  v_mfma_f32_16x16x32_bf16 v[100:103], a[0:3], v[160:163], 0
  ds_read_b64_tr_b16 a[40:41], v9 offset:8192
  v_mul_f32 v124, v124, v15
  v_mfma_f32_16x16x32_bf16 v[100:103], a[4:7], v[164:167], v[100:103]
  v_mul_f32 v125, v125, v15
  v_mul_f32 v126, v126, v15
  v_mfma_f32_16x16x32_bf16 v[100:103], a[8:11], v[168:171], v[100:103]
  s_add_u32 s70, s77, 1081344
  ds_read_b64_tr_b16 a[42:43], v9 offset:10240
  v_mul_f32 v127, v127, v15
  v_mfma_f32_16x16x32_bf16 v[100:103], a[12:15], v[172:175], v[100:103]
  buffer_store_dwordx4 v[20:23], v11, s[24:27], s70 offen
  v_mfma_f32_16x16x32_bf16 v[100:103], a[16:19], v[176:179], v[100:103]
  ds_read_b64_tr_b16 a[44:45], v9 offset:12288
  v_cvt_pk_bf16_f32 v30, v124, v125
  v_mfma_f32_16x16x32_bf16 v[100:103], a[20:23], v[180:183], v[100:103]
  v_mfma_f32_16x16x32_bf16 v[100:103], a[24:27], v[184:187], v[100:103]
  ds_read_b64_tr_b16 a[46:47], v9 offset:14336
  v_cvt_pk_bf16_f32 v31, v126, v127
  v_mfma_f32_16x16x32_bf16 v[100:103], a[28:31], v[188:191], v[100:103]
  ds_write_b128 v39, a[116:119] offset:16384
  v_mfma_f32_16x16x32_bf16 v[104:107], a[0:3], v[192:195], 0
  ds_read_b64_tr_b16 a[48:49], v9 offset:16384
  v_mul_f32 v96, v96, v12
  v_mfma_f32_16x16x32_bf16 v[104:107], a[4:7], v[196:199], v[104:107]
  v_mul_f32 v97, v97, v12
  v_mul_f32 v98, v98, v12
  v_mfma_f32_16x16x32_bf16 v[104:107], a[8:11], v[200:203], v[104:107]
  ds_read_b64_tr_b16 a[50:51], v9 offset:18432
  v_mul_f32 v99, v99, v12
  v_mfma_f32_16x16x32_bf16 v[104:107], a[12:15], v[204:207], v[104:107]
  v_mfma_f32_16x16x32_bf16 v[104:107], a[16:19], v[208:211], v[104:107]
  ds_read_b64_tr_b16 a[52:53], v9 offset:20480
  v_cvt_pk_bf16_f32 v16, v96, v97
  v_mfma_f32_16x16x32_bf16 v[104:107], a[20:23], v[212:215], v[104:107]
  v_add_u32 v6, 32768, v6
  v_mfma_f32_16x16x32_bf16 v[104:107], a[24:27], v[216:219], v[104:107]
  ds_read_b64_tr_b16 a[54:55], v9 offset:22528
  v_cvt_pk_bf16_f32 v17, v98, v99
  v_mfma_f32_16x16x32_bf16 v[104:107], a[28:31], v[220:223], v[104:107]
  v_mfma_f32_16x16x32_bf16 v[108:111], a[0:3], v[224:227], 0
  ds_read_b64_tr_b16 a[56:57], v9 offset:24576
  v_mul_f32 v100, v100, v13
  v_mfma_f32_16x16x32_bf16 v[108:111], a[4:7], v[228:231], v[108:111]
  v_mul_f32 v101, v101, v13
  v_mul_f32 v102, v102, v13
  v_mfma_f32_16x16x32_bf16 v[108:111], a[8:11], v[232:235], v[108:111]
  s_waitcnt lgkmcnt(8)
  s_add_u32 s69, s77, 1114112
  ds_read_b64_tr_b16 a[58:59], v9 offset:26624
  v_mul_f32 v103, v103, v13
  v_mfma_f32_16x16x32_bf16 v[108:111], a[12:15], v[236:239], v[108:111]
  s_waitcnt vmcnt(26)
  s_barrier
  buffer_store_dwordx4 v[24:27], v11, s[24:27], s69 offen
  v_mfma_f32_16x16x32_bf16 v[108:111], a[16:19], v[240:243], v[108:111]
  ds_read_b64_tr_b16 a[60:61], v9 offset:28672
  v_cvt_pk_bf16_f32 v20, v100, v101
  v_mfma_f32_16x16x32_bf16 v[108:111], a[20:23], v[244:247], v[108:111]
  v_mfma_f32_16x16x32_bf16 v[108:111], a[24:27], v[248:251], v[108:111]
  ds_read_b64_tr_b16 a[62:63], v9 offset:30720
  v_cvt_pk_bf16_f32 v21, v102, v103
  v_mfma_f32_16x16x32_bf16 v[108:111], a[28:31], v[252:255], v[108:111]
  s_waitcnt lgkmcnt(13)
  v_mfma_f32_16x16x32_bf16 v[112:115], a[32:35], v[128:131], 0
  ds_read_b64_tr_b16 a[0:1], v6 offset:0
  v_mul_f32 v104, v104, v14
  v_mfma_f32_16x16x32_bf16 v[112:115], a[36:39], v[132:135], v[112:115]
  s_waitcnt lgkmcnt(10)
  v_mul_f32 v105, v105, v14
  v_mul_f32 v106, v106, v14
  v_mfma_f32_16x16x32_bf16 v[112:115], a[40:43], v[136:139], v[112:115]
  s_add_u32 s70, s77, 1146880
  ds_read_b64_tr_b16 a[2:3], v6 offset:2048
  v_mul_f32 v107, v107, v14
  v_mfma_f32_16x16x32_bf16 v[112:115], a[44:47], v[140:143], v[112:115]
  s_waitcnt lgkmcnt(6)
  buffer_store_dwordx4 v[28:31], v11, s[24:27], s70 offen
  v_mfma_f32_16x16x32_bf16 v[112:115], a[48:51], v[144:147], v[112:115]
  ds_read_b64_tr_b16 a[4:5], v6 offset:4096
  v_cvt_pk_bf16_f32 v24, v104, v105
  v_mfma_f32_16x16x32_bf16 v[112:115], a[52:55], v[148:151], v[112:115]
  s_waitcnt lgkmcnt(3)
  v_add_u32 v9, 32768, v9
  v_mfma_f32_16x16x32_bf16 v[112:115], a[56:59], v[152:155], v[112:115]
  ds_read_b64_tr_b16 a[6:7], v6 offset:6144
  v_cvt_pk_bf16_f32 v25, v106, v107
  v_mfma_f32_16x16x32_bf16 v[112:115], a[60:63], v[156:159], v[112:115]
  v_mfma_f32_16x16x32_bf16 v[116:119], a[32:35], v[160:163], 0
  ds_read_b64_tr_b16 a[8:9], v6 offset:8192
  v_mul_f32 v108, v108, v15
  v_mfma_f32_16x16x32_bf16 v[116:119], a[36:39], v[164:167], v[116:119]
  v_mul_f32 v109, v109, v15
  v_mul_f32 v110, v110, v15
  v_mfma_f32_16x16x32_bf16 v[116:119], a[40:43], v[168:171], v[116:119]
  ds_read_b64_tr_b16 a[10:11], v6 offset:10240
  v_mul_f32 v111, v111, v15
  v_mfma_f32_16x16x32_bf16 v[116:119], a[44:47], v[172:175], v[116:119]
  v_mfma_f32_16x16x32_bf16 v[116:119], a[48:51], v[176:179], v[116:119]
  ds_read_b64_tr_b16 a[12:13], v6 offset:12288
  v_cvt_pk_bf16_f32 v28, v108, v109
  v_mfma_f32_16x16x32_bf16 v[116:119], a[52:55], v[180:183], v[116:119]
  v_mfma_f32_16x16x32_bf16 v[116:119], a[56:59], v[184:187], v[116:119]
  ds_read_b64_tr_b16 a[14:15], v6 offset:14336
  v_cvt_pk_bf16_f32 v29, v110, v111
  v_mfma_f32_16x16x32_bf16 v[116:119], a[60:63], v[188:191], v[116:119]
  ds_write_b128 v39, a[120:123] offset:20480
  v_mfma_f32_16x16x32_bf16 v[120:123], a[32:35], v[192:195], 0
  ds_read_b64_tr_b16 a[16:17], v6 offset:16384
  v_mul_f32 v112, v112, v12
  v_mfma_f32_16x16x32_bf16 v[120:123], a[36:39], v[196:199], v[120:123]
  v_mul_f32 v113, v113, v12
  v_mul_f32 v114, v114, v12
  v_mfma_f32_16x16x32_bf16 v[120:123], a[40:43], v[200:203], v[120:123]
  ds_read_b64_tr_b16 a[18:19], v6 offset:18432
  v_mul_f32 v115, v115, v12
  v_mfma_f32_16x16x32_bf16 v[120:123], a[44:47], v[204:207], v[120:123]
  v_mfma_f32_16x16x32_bf16 v[120:123], a[48:51], v[208:211], v[120:123]
  ds_read_b64_tr_b16 a[20:21], v6 offset:20480
  v_cvt_pk_bf16_f32 v18, v112, v113
  v_mfma_f32_16x16x32_bf16 v[120:123], a[52:55], v[212:215], v[120:123]
  ds_write_b128 v39, a[124:127] offset:24576
  v_mfma_f32_16x16x32_bf16 v[120:123], a[56:59], v[216:219], v[120:123]
  ds_read_b64_tr_b16 a[22:23], v6 offset:22528
  v_cvt_pk_bf16_f32 v19, v114, v115
  v_mfma_f32_16x16x32_bf16 v[120:123], a[60:63], v[220:223], v[120:123]
  s_waitcnt lgkmcnt(8)
  ds_write_b128 v39, a[128:131] offset:28672
  v_mfma_f32_16x16x32_bf16 v[124:127], a[32:35], v[224:227], 0
  ds_read_b64_tr_b16 a[24:25], v6 offset:24576
  v_mul_f32 v116, v116, v13
  v_mfma_f32_16x16x32_bf16 v[124:127], a[36:39], v[228:231], v[124:127]
  v_mul_f32 v117, v117, v13
  v_mul_f32 v118, v118, v13
  v_mfma_f32_16x16x32_bf16 v[124:127], a[40:43], v[232:235], v[124:127]
  s_add_u32 s69, s77, 1049600
  ds_read_b64_tr_b16 a[26:27], v6 offset:26624
  v_mul_f32 v119, v119, v13
  v_mfma_f32_16x16x32_bf16 v[124:127], a[44:47], v[236:239], v[124:127]
  buffer_store_dwordx4 v[16:19], v11, s[24:27], s69 offen
  v_mfma_f32_16x16x32_bf16 v[124:127], a[48:51], v[240:243], v[124:127]
  ds_read_b64_tr_b16 a[28:29], v6 offset:28672
  v_cvt_pk_bf16_f32 v22, v116, v117
  v_mfma_f32_16x16x32_bf16 v[124:127], a[52:55], v[244:247], v[124:127]
  v_mfma_f32_16x16x32_bf16 v[124:127], a[56:59], v[248:251], v[124:127]
  ds_read_b64_tr_b16 a[30:31], v6 offset:30720
  v_cvt_pk_bf16_f32 v23, v118, v119
  v_mfma_f32_16x16x32_bf16 v[124:127], a[60:63], v[252:255], v[124:127]
  s_waitcnt lgkmcnt(15)
  v_mfma_f32_16x16x32_bf16 v[96:99], a[0:3], v[128:131], 0
  ds_read_b64_tr_b16 a[32:33], v7 offset:0
  v_mul_f32 v120, v120, v14
  v_mfma_f32_16x16x32_bf16 v[96:99], a[4:7], v[132:135], v[96:99]
  s_waitcnt lgkmcnt(12)
  v_add_u32 v39, 4294836224, v39
  v_mul_f32 v121, v121, v14
  v_mul_f32 v122, v122, v14
  v_mfma_f32_16x16x32_bf16 v[96:99], a[8:11], v[136:139], v[96:99]
  ds_read_b64_tr_b16 a[34:35], v7 offset:2048
  v_mul_f32 v123, v123, v14
  v_mfma_f32_16x16x32_bf16 v[96:99], a[12:15], v[140:143], v[96:99]
  s_waitcnt lgkmcnt(7)
  v_mfma_f32_16x16x32_bf16 v[96:99], a[16:19], v[144:147], v[96:99]
  ds_read_b64_tr_b16 a[36:37], v7 offset:4096
  v_cvt_pk_bf16_f32 v26, v120, v121
  v_mfma_f32_16x16x32_bf16 v[96:99], a[20:23], v[148:151], v[96:99]
  s_waitcnt lgkmcnt(3)
  v_mfma_f32_16x16x32_bf16 v[96:99], a[24:27], v[152:155], v[96:99]
  ds_read_b64_tr_b16 a[38:39], v7 offset:6144
  v_cvt_pk_bf16_f32 v27, v122, v123
  v_mfma_f32_16x16x32_bf16 v[96:99], a[28:31], v[156:159], v[96:99]
  v_mfma_f32_16x16x32_bf16 v[100:103], a[0:3], v[160:163], 0
  ds_read_b64_tr_b16 a[40:41], v7 offset:8192
  v_mul_f32 v124, v124, v15
  v_mfma_f32_16x16x32_bf16 v[100:103], a[4:7], v[164:167], v[100:103]
  v_mul_f32 v125, v125, v15
  v_mul_f32 v126, v126, v15
  v_mfma_f32_16x16x32_bf16 v[100:103], a[8:11], v[168:171], v[100:103]
  s_add_u32 s70, s77, 1082368
  ds_read_b64_tr_b16 a[42:43], v7 offset:10240
  v_mul_f32 v127, v127, v15
  v_mfma_f32_16x16x32_bf16 v[100:103], a[12:15], v[172:175], v[100:103]
  buffer_store_dwordx4 v[20:23], v11, s[24:27], s70 offen
  v_mfma_f32_16x16x32_bf16 v[100:103], a[16:19], v[176:179], v[100:103]
  ds_read_b64_tr_b16 a[44:45], v7 offset:12288
  v_cvt_pk_bf16_f32 v30, v124, v125
  v_mfma_f32_16x16x32_bf16 v[100:103], a[20:23], v[180:183], v[100:103]
  v_mfma_f32_16x16x32_bf16 v[100:103], a[24:27], v[184:187], v[100:103]
  s_waitcnt vmcnt(21)
  ds_read_b64_tr_b16 a[46:47], v7 offset:14336
  v_cvt_pk_bf16_f32 v31, v126, v127
  v_mfma_f32_16x16x32_bf16 v[100:103], a[28:31], v[188:191], v[100:103]
  ds_write_b128 v39, a[132:135] offset:0
  v_mfma_f32_16x16x32_bf16 v[104:107], a[0:3], v[192:195], 0
  ds_read_b64_tr_b16 a[48:49], v7 offset:16384
  v_mul_f32 v96, v96, v12
  v_mfma_f32_16x16x32_bf16 v[104:107], a[4:7], v[196:199], v[104:107]
  v_mul_f32 v97, v97, v12
  v_mul_f32 v98, v98, v12
  v_mfma_f32_16x16x32_bf16 v[104:107], a[8:11], v[200:203], v[104:107]
  ds_read_b64_tr_b16 a[50:51], v7 offset:18432
  v_mul_f32 v99, v99, v12
  v_mfma_f32_16x16x32_bf16 v[104:107], a[12:15], v[204:207], v[104:107]
  v_mfma_f32_16x16x32_bf16 v[104:107], a[16:19], v[208:211], v[104:107]
  ds_read_b64_tr_b16 a[52:53], v7 offset:20480
  v_cvt_pk_bf16_f32 v16, v96, v97
  v_mfma_f32_16x16x32_bf16 v[104:107], a[20:23], v[212:215], v[104:107]
  v_mfma_f32_16x16x32_bf16 v[104:107], a[24:27], v[216:219], v[104:107]
  ds_read_b64_tr_b16 a[54:55], v7 offset:22528
  v_cvt_pk_bf16_f32 v17, v98, v99
  v_mfma_f32_16x16x32_bf16 v[104:107], a[28:31], v[220:223], v[104:107]
  v_mfma_f32_16x16x32_bf16 v[108:111], a[0:3], v[224:227], 0
  ds_read_b64_tr_b16 a[56:57], v7 offset:24576
  v_mul_f32 v100, v100, v13
  v_mfma_f32_16x16x32_bf16 v[108:111], a[4:7], v[228:231], v[108:111]
  v_mul_f32 v101, v101, v13
  v_mul_f32 v102, v102, v13
  v_mfma_f32_16x16x32_bf16 v[108:111], a[8:11], v[232:235], v[108:111]
  s_waitcnt lgkmcnt(8)
  s_add_u32 s69, s77, 1115136
  ds_read_b64_tr_b16 a[58:59], v7 offset:26624
  v_mul_f32 v103, v103, v13
  v_mfma_f32_16x16x32_bf16 v[108:111], a[12:15], v[236:239], v[108:111]
  buffer_store_dwordx4 v[24:27], v11, s[24:27], s69 offen
  v_mfma_f32_16x16x32_bf16 v[108:111], a[16:19], v[240:243], v[108:111]
  ds_read_b64_tr_b16 a[60:61], v7 offset:28672
  v_cvt_pk_bf16_f32 v20, v100, v101
  v_mfma_f32_16x16x32_bf16 v[108:111], a[20:23], v[244:247], v[108:111]
  v_mfma_f32_16x16x32_bf16 v[108:111], a[24:27], v[248:251], v[108:111]
  ds_read_b64_tr_b16 a[62:63], v7 offset:30720
  v_cvt_pk_bf16_f32 v21, v102, v103
  v_mfma_f32_16x16x32_bf16 v[108:111], a[28:31], v[252:255], v[108:111]
  s_waitcnt lgkmcnt(13)
  v_mfma_f32_16x16x32_bf16 v[112:115], a[32:35], v[128:131], 0
  ds_read_b64_tr_b16 a[0:1], v8 offset:0
  v_mul_f32 v104, v104, v14
  v_mfma_f32_16x16x32_bf16 v[112:115], a[36:39], v[132:135], v[112:115]
  s_waitcnt lgkmcnt(10)
  v_mul_f32 v105, v105, v14
  v_mul_f32 v106, v106, v14
  v_mfma_f32_16x16x32_bf16 v[112:115], a[40:43], v[136:139], v[112:115]
  s_add_u32 s70, s77, 1147904
  ds_read_b64_tr_b16 a[2:3], v8 offset:2048
  v_mul_f32 v107, v107, v14
  v_mfma_f32_16x16x32_bf16 v[112:115], a[44:47], v[140:143], v[112:115]
  s_waitcnt lgkmcnt(6)
  buffer_store_dwordx4 v[28:31], v11, s[24:27], s70 offen
  v_mfma_f32_16x16x32_bf16 v[112:115], a[48:51], v[144:147], v[112:115]
  ds_read_b64_tr_b16 a[4:5], v8 offset:4096
  v_cvt_pk_bf16_f32 v24, v104, v105
  v_mfma_f32_16x16x32_bf16 v[112:115], a[52:55], v[148:151], v[112:115]
  s_waitcnt lgkmcnt(3)
  v_add_u32 v7, 32768, v7
  v_mfma_f32_16x16x32_bf16 v[112:115], a[56:59], v[152:155], v[112:115]
  ds_read_b64_tr_b16 a[6:7], v8 offset:6144
  v_cvt_pk_bf16_f32 v25, v106, v107
  v_mfma_f32_16x16x32_bf16 v[112:115], a[60:63], v[156:159], v[112:115]
  v_mfma_f32_16x16x32_bf16 v[116:119], a[32:35], v[160:163], 0
  ds_read_b64_tr_b16 a[8:9], v8 offset:8192
  v_mul_f32 v108, v108, v15
  v_mfma_f32_16x16x32_bf16 v[116:119], a[36:39], v[164:167], v[116:119]
  v_mul_f32 v109, v109, v15
  v_mul_f32 v110, v110, v15
  v_mfma_f32_16x16x32_bf16 v[116:119], a[40:43], v[168:171], v[116:119]
  ds_read_b64_tr_b16 a[10:11], v8 offset:10240
  v_mul_f32 v111, v111, v15
  v_mfma_f32_16x16x32_bf16 v[116:119], a[44:47], v[172:175], v[116:119]
  v_mfma_f32_16x16x32_bf16 v[116:119], a[48:51], v[176:179], v[116:119]
  ds_read_b64_tr_b16 a[12:13], v8 offset:12288
  v_cvt_pk_bf16_f32 v28, v108, v109
  v_mfma_f32_16x16x32_bf16 v[116:119], a[52:55], v[180:183], v[116:119]
  v_mfma_f32_16x16x32_bf16 v[116:119], a[56:59], v[184:187], v[116:119]
  ds_read_b64_tr_b16 a[14:15], v8 offset:14336
  v_cvt_pk_bf16_f32 v29, v110, v111
  v_mfma_f32_16x16x32_bf16 v[116:119], a[60:63], v[188:191], v[116:119]
  ds_write_b128 v39, a[136:139] offset:4096
  v_mfma_f32_16x16x32_bf16 v[120:123], a[32:35], v[192:195], 0
  ds_read_b64_tr_b16 a[16:17], v8 offset:16384
  v_mul_f32 v112, v112, v12
  v_mfma_f32_16x16x32_bf16 v[120:123], a[36:39], v[196:199], v[120:123]
  v_mul_f32 v113, v113, v12
  v_mul_f32 v114, v114, v12
  v_mfma_f32_16x16x32_bf16 v[120:123], a[40:43], v[200:203], v[120:123]
  ds_read_b64_tr_b16 a[18:19], v8 offset:18432
  v_mul_f32 v115, v115, v12
  v_mfma_f32_16x16x32_bf16 v[120:123], a[44:47], v[204:207], v[120:123]
  v_mfma_f32_16x16x32_bf16 v[120:123], a[48:51], v[208:211], v[120:123]
  ds_read_b64_tr_b16 a[20:21], v8 offset:20480
  v_cvt_pk_bf16_f32 v18, v112, v113
  v_mfma_f32_16x16x32_bf16 v[120:123], a[52:55], v[212:215], v[120:123]
  ds_write_b128 v39, a[140:143] offset:8192
  v_mfma_f32_16x16x32_bf16 v[120:123], a[56:59], v[216:219], v[120:123]
  ds_read_b64_tr_b16 a[22:23], v8 offset:22528
  v_cvt_pk_bf16_f32 v19, v114, v115
  v_mfma_f32_16x16x32_bf16 v[120:123], a[60:63], v[220:223], v[120:123]
  s_waitcnt lgkmcnt(8)
  ds_write_b128 v39, a[144:147] offset:12288
  v_mfma_f32_16x16x32_bf16 v[124:127], a[32:35], v[224:227], 0
  ds_read_b64_tr_b16 a[24:25], v8 offset:24576
  v_mul_f32 v116, v116, v13
  v_mfma_f32_16x16x32_bf16 v[124:127], a[36:39], v[228:231], v[124:127]
  v_mul_f32 v117, v117, v13
  v_mul_f32 v118, v118, v13
  v_mfma_f32_16x16x32_bf16 v[124:127], a[40:43], v[232:235], v[124:127]
  s_add_u32 s69, s77, 1572864
  ds_read_b64_tr_b16 a[26:27], v8 offset:26624
  v_mul_f32 v119, v119, v13
  v_mfma_f32_16x16x32_bf16 v[124:127], a[44:47], v[236:239], v[124:127]
  buffer_store_dwordx4 v[16:19], v11, s[24:27], s69 offen
  v_mfma_f32_16x16x32_bf16 v[124:127], a[48:51], v[240:243], v[124:127]
  ds_read_b64_tr_b16 a[28:29], v8 offset:28672
  v_cvt_pk_bf16_f32 v22, v116, v117
  v_mfma_f32_16x16x32_bf16 v[124:127], a[52:55], v[244:247], v[124:127]
  v_mfma_f32_16x16x32_bf16 v[124:127], a[56:59], v[248:251], v[124:127]
  ds_read_b64_tr_b16 a[30:31], v8 offset:30720
  v_cvt_pk_bf16_f32 v23, v118, v119
  v_mfma_f32_16x16x32_bf16 v[124:127], a[60:63], v[252:255], v[124:127]
  s_waitcnt lgkmcnt(15)
  v_mfma_f32_16x16x32_bf16 v[96:99], a[0:3], v[128:131], 0
  ds_read_b64_tr_b16 a[32:33], v9 offset:0
  v_mul_f32 v120, v120, v14
  v_mfma_f32_16x16x32_bf16 v[96:99], a[4:7], v[132:135], v[96:99]
  s_waitcnt lgkmcnt(12)
  v_mul_f32 v121, v121, v14
  v_mul_f32 v122, v122, v14
  v_mfma_f32_16x16x32_bf16 v[96:99], a[8:11], v[136:139], v[96:99]
  ds_read_b64_tr_b16 a[34:35], v9 offset:2048
  v_mul_f32 v123, v123, v14
  v_mfma_f32_16x16x32_bf16 v[96:99], a[12:15], v[140:143], v[96:99]
  s_waitcnt lgkmcnt(7)
  v_mfma_f32_16x16x32_bf16 v[96:99], a[16:19], v[144:147], v[96:99]
  ds_read_b64_tr_b16 a[36:37], v9 offset:4096
  v_cvt_pk_bf16_f32 v26, v120, v121
  v_mfma_f32_16x16x32_bf16 v[96:99], a[20:23], v[148:151], v[96:99]
  s_waitcnt lgkmcnt(3)
  v_add_u32 v8, 32768, v8
  v_mfma_f32_16x16x32_bf16 v[96:99], a[24:27], v[152:155], v[96:99]
  ds_read_b64_tr_b16 a[38:39], v9 offset:6144
  v_cvt_pk_bf16_f32 v27, v122, v123
  v_mfma_f32_16x16x32_bf16 v[96:99], a[28:31], v[156:159], v[96:99]
  v_mfma_f32_16x16x32_bf16 v[100:103], a[0:3], v[160:163], 0
  ds_read_b64_tr_b16 a[40:41], v9 offset:8192
  v_mul_f32 v124, v124, v15
  v_mfma_f32_16x16x32_bf16 v[100:103], a[4:7], v[164:167], v[100:103]
  v_mul_f32 v125, v125, v15
  v_mul_f32 v126, v126, v15
  v_mfma_f32_16x16x32_bf16 v[100:103], a[8:11], v[168:171], v[100:103]
  s_add_u32 s70, s77, 1605632
  ds_read_b64_tr_b16 a[42:43], v9 offset:10240
  v_mul_f32 v127, v127, v15
  v_mfma_f32_16x16x32_bf16 v[100:103], a[12:15], v[172:175], v[100:103]
  buffer_store_dwordx4 v[20:23], v11, s[24:27], s70 offen
  v_mfma_f32_16x16x32_bf16 v[100:103], a[16:19], v[176:179], v[100:103]
  ds_read_b64_tr_b16 a[44:45], v9 offset:12288
  v_cvt_pk_bf16_f32 v30, v124, v125
  v_mfma_f32_16x16x32_bf16 v[100:103], a[20:23], v[180:183], v[100:103]
  v_mfma_f32_16x16x32_bf16 v[100:103], a[24:27], v[184:187], v[100:103]
  ds_read_b64_tr_b16 a[46:47], v9 offset:14336
  v_cvt_pk_bf16_f32 v31, v126, v127
  v_mfma_f32_16x16x32_bf16 v[100:103], a[28:31], v[188:191], v[100:103]
  ds_write_b128 v39, a[148:151] offset:16384
  v_mfma_f32_16x16x32_bf16 v[104:107], a[0:3], v[192:195], 0
  ds_read_b64_tr_b16 a[48:49], v9 offset:16384
  v_mul_f32 v96, v96, v12
  v_mfma_f32_16x16x32_bf16 v[104:107], a[4:7], v[196:199], v[104:107]
  v_mul_f32 v97, v97, v12
  v_mul_f32 v98, v98, v12
  v_mfma_f32_16x16x32_bf16 v[104:107], a[8:11], v[200:203], v[104:107]
  ds_read_b64_tr_b16 a[50:51], v9 offset:18432
  v_mul_f32 v99, v99, v12
  v_mfma_f32_16x16x32_bf16 v[104:107], a[12:15], v[204:207], v[104:107]
  v_mfma_f32_16x16x32_bf16 v[104:107], a[16:19], v[208:211], v[104:107]
  ds_read_b64_tr_b16 a[52:53], v9 offset:20480
  v_cvt_pk_bf16_f32 v16, v96, v97
  v_mfma_f32_16x16x32_bf16 v[104:107], a[20:23], v[212:215], v[104:107]
  v_add_u32 v6, 32768, v6
  v_mfma_f32_16x16x32_bf16 v[104:107], a[24:27], v[216:219], v[104:107]
  ds_read_b64_tr_b16 a[54:55], v9 offset:22528
  v_cvt_pk_bf16_f32 v17, v98, v99
  v_mfma_f32_16x16x32_bf16 v[104:107], a[28:31], v[220:223], v[104:107]
  v_mfma_f32_16x16x32_bf16 v[108:111], a[0:3], v[224:227], 0
  ds_read_b64_tr_b16 a[56:57], v9 offset:24576
  v_mul_f32 v100, v100, v13
  v_mfma_f32_16x16x32_bf16 v[108:111], a[4:7], v[228:231], v[108:111]
  v_mul_f32 v101, v101, v13
  v_mul_f32 v102, v102, v13
  v_mfma_f32_16x16x32_bf16 v[108:111], a[8:11], v[232:235], v[108:111]
  s_waitcnt lgkmcnt(8)
  s_add_u32 s69, s77, 1638400
  ds_read_b64_tr_b16 a[58:59], v9 offset:26624
  v_mul_f32 v103, v103, v13
  v_mfma_f32_16x16x32_bf16 v[108:111], a[12:15], v[236:239], v[108:111]
  s_waitcnt vmcnt(25)
  s_barrier
  buffer_store_dwordx4 v[24:27], v11, s[24:27], s69 offen
  v_mfma_f32_16x16x32_bf16 v[108:111], a[16:19], v[240:243], v[108:111]
  ds_read_b64_tr_b16 a[60:61], v9 offset:28672
  v_cvt_pk_bf16_f32 v20, v100, v101
  v_mfma_f32_16x16x32_bf16 v[108:111], a[20:23], v[244:247], v[108:111]
  v_mfma_f32_16x16x32_bf16 v[108:111], a[24:27], v[248:251], v[108:111]
  ds_read_b64_tr_b16 a[62:63], v9 offset:30720
  v_cvt_pk_bf16_f32 v21, v102, v103
  v_mfma_f32_16x16x32_bf16 v[108:111], a[28:31], v[252:255], v[108:111]
  s_waitcnt lgkmcnt(13)
  v_mfma_f32_16x16x32_bf16 v[112:115], a[32:35], v[128:131], 0
  ds_read_b64_tr_b16 a[0:1], v6 offset:0
  v_mul_f32 v104, v104, v14
  v_mfma_f32_16x16x32_bf16 v[112:115], a[36:39], v[132:135], v[112:115]
  s_waitcnt lgkmcnt(10)
  v_mul_f32 v105, v105, v14
  v_mul_f32 v106, v106, v14
  v_mfma_f32_16x16x32_bf16 v[112:115], a[40:43], v[136:139], v[112:115]
  s_add_u32 s70, s77, 1671168
  ds_read_b64_tr_b16 a[2:3], v6 offset:2048
  v_mul_f32 v107, v107, v14
  v_mfma_f32_16x16x32_bf16 v[112:115], a[44:47], v[140:143], v[112:115]
  s_waitcnt lgkmcnt(6)
  buffer_store_dwordx4 v[28:31], v11, s[24:27], s70 offen
  v_mfma_f32_16x16x32_bf16 v[112:115], a[48:51], v[144:147], v[112:115]
  ds_read_b64_tr_b16 a[4:5], v6 offset:4096
  v_cvt_pk_bf16_f32 v24, v104, v105
  v_mfma_f32_16x16x32_bf16 v[112:115], a[52:55], v[148:151], v[112:115]
  s_waitcnt lgkmcnt(3)
  v_add_u32 v9, 32768, v9
  v_mfma_f32_16x16x32_bf16 v[112:115], a[56:59], v[152:155], v[112:115]
  ds_read_b64_tr_b16 a[6:7], v6 offset:6144
  v_cvt_pk_bf16_f32 v25, v106, v107
  v_mfma_f32_16x16x32_bf16 v[112:115], a[60:63], v[156:159], v[112:115]
  v_mfma_f32_16x16x32_bf16 v[116:119], a[32:35], v[160:163], 0
  ds_read_b64_tr_b16 a[8:9], v6 offset:8192
  v_mul_f32 v108, v108, v15
  v_mfma_f32_16x16x32_bf16 v[116:119], a[36:39], v[164:167], v[116:119]
  v_mul_f32 v109, v109, v15
  v_mul_f32 v110, v110, v15
  v_mfma_f32_16x16x32_bf16 v[116:119], a[40:43], v[168:171], v[116:119]
  ds_read_b64_tr_b16 a[10:11], v6 offset:10240
  v_mul_f32 v111, v111, v15
  v_mfma_f32_16x16x32_bf16 v[116:119], a[44:47], v[172:175], v[116:119]
  v_mfma_f32_16x16x32_bf16 v[116:119], a[48:51], v[176:179], v[116:119]
  ds_read_b64_tr_b16 a[12:13], v6 offset:12288
  v_cvt_pk_bf16_f32 v28, v108, v109
  v_mfma_f32_16x16x32_bf16 v[116:119], a[52:55], v[180:183], v[116:119]
  v_mfma_f32_16x16x32_bf16 v[116:119], a[56:59], v[184:187], v[116:119]
  ds_read_b64_tr_b16 a[14:15], v6 offset:14336
  v_cvt_pk_bf16_f32 v29, v110, v111
  v_mfma_f32_16x16x32_bf16 v[116:119], a[60:63], v[188:191], v[116:119]
  ds_write_b128 v39, a[152:155] offset:20480
  v_mfma_f32_16x16x32_bf16 v[120:123], a[32:35], v[192:195], 0
  ds_read_b64_tr_b16 a[16:17], v6 offset:16384
  v_mul_f32 v112, v112, v12
  v_mfma_f32_16x16x32_bf16 v[120:123], a[36:39], v[196:199], v[120:123]
  v_mul_f32 v113, v113, v12
  v_mul_f32 v114, v114, v12
  v_mfma_f32_16x16x32_bf16 v[120:123], a[40:43], v[200:203], v[120:123]
  ds_read_b64_tr_b16 a[18:19], v6 offset:18432
  v_mul_f32 v115, v115, v12
  v_mfma_f32_16x16x32_bf16 v[120:123], a[44:47], v[204:207], v[120:123]
  v_mfma_f32_16x16x32_bf16 v[120:123], a[48:51], v[208:211], v[120:123]
  ds_read_b64_tr_b16 a[20:21], v6 offset:20480
  v_cvt_pk_bf16_f32 v18, v112, v113
  v_mfma_f32_16x16x32_bf16 v[120:123], a[52:55], v[212:215], v[120:123]
  ds_write_b128 v39, a[156:159] offset:24576
  v_mfma_f32_16x16x32_bf16 v[120:123], a[56:59], v[216:219], v[120:123]
  ds_read_b64_tr_b16 a[22:23], v6 offset:22528
  v_cvt_pk_bf16_f32 v19, v114, v115
  v_mfma_f32_16x16x32_bf16 v[120:123], a[60:63], v[220:223], v[120:123]
  s_waitcnt lgkmcnt(8)
  ds_write_b128 v39, a[160:163] offset:28672
  v_mfma_f32_16x16x32_bf16 v[124:127], a[32:35], v[224:227], 0
  ds_read_b64_tr_b16 a[24:25], v6 offset:24576
  v_mul_f32 v116, v116, v13
  v_mfma_f32_16x16x32_bf16 v[124:127], a[36:39], v[228:231], v[124:127]
  v_mul_f32 v117, v117, v13
  v_mul_f32 v118, v118, v13
  v_mfma_f32_16x16x32_bf16 v[124:127], a[40:43], v[232:235], v[124:127]
  s_add_u32 s69, s77, 1573888
  ds_read_b64_tr_b16 a[26:27], v6 offset:26624
  v_mul_f32 v119, v119, v13
  v_mfma_f32_16x16x32_bf16 v[124:127], a[44:47], v[236:239], v[124:127]
  buffer_store_dwordx4 v[16:19], v11, s[24:27], s69 offen
  v_mfma_f32_16x16x32_bf16 v[124:127], a[48:51], v[240:243], v[124:127]
  ds_read_b64_tr_b16 a[28:29], v6 offset:28672
  v_cvt_pk_bf16_f32 v22, v116, v117
  v_mfma_f32_16x16x32_bf16 v[124:127], a[52:55], v[244:247], v[124:127]
  v_mfma_f32_16x16x32_bf16 v[124:127], a[56:59], v[248:251], v[124:127]
  ds_read_b64_tr_b16 a[30:31], v6 offset:30720
  v_cvt_pk_bf16_f32 v23, v118, v119
  v_mfma_f32_16x16x32_bf16 v[124:127], a[60:63], v[252:255], v[124:127]
  s_waitcnt lgkmcnt(15)
  v_mfma_f32_16x16x32_bf16 v[96:99], a[0:3], v[128:131], 0
  ds_read_b64_tr_b16 a[32:33], v7 offset:0
  v_mul_f32 v120, v120, v14
  v_mfma_f32_16x16x32_bf16 v[96:99], a[4:7], v[132:135], v[96:99]
  s_waitcnt lgkmcnt(12)
  v_mul_f32 v121, v121, v14
  v_mul_f32 v122, v122, v14
  v_mfma_f32_16x16x32_bf16 v[96:99], a[8:11], v[136:139], v[96:99]
  ds_read_b64_tr_b16 a[34:35], v7 offset:2048
  v_mul_f32 v123, v123, v14
  v_mfma_f32_16x16x32_bf16 v[96:99], a[12:15], v[140:143], v[96:99]
  s_waitcnt lgkmcnt(7)
  v_mfma_f32_16x16x32_bf16 v[96:99], a[16:19], v[144:147], v[96:99]
  ds_read_b64_tr_b16 a[36:37], v7 offset:4096
  v_cvt_pk_bf16_f32 v26, v120, v121
  v_mfma_f32_16x16x32_bf16 v[96:99], a[20:23], v[148:151], v[96:99]
  s_waitcnt lgkmcnt(3)
  v_mfma_f32_16x16x32_bf16 v[96:99], a[24:27], v[152:155], v[96:99]
  ds_read_b64_tr_b16 a[38:39], v7 offset:6144
  v_cvt_pk_bf16_f32 v27, v122, v123
  v_mfma_f32_16x16x32_bf16 v[96:99], a[28:31], v[156:159], v[96:99]
  v_mfma_f32_16x16x32_bf16 v[100:103], a[0:3], v[160:163], 0
  ds_read_b64_tr_b16 a[40:41], v7 offset:8192
  v_mul_f32 v124, v124, v15
  v_mfma_f32_16x16x32_bf16 v[100:103], a[4:7], v[164:167], v[100:103]
  v_mul_f32 v125, v125, v15
  v_mul_f32 v126, v126, v15
  v_mfma_f32_16x16x32_bf16 v[100:103], a[8:11], v[168:171], v[100:103]
  s_add_u32 s70, s77, 1606656
  ds_read_b64_tr_b16 a[42:43], v7 offset:10240
  v_mul_f32 v127, v127, v15
  v_mfma_f32_16x16x32_bf16 v[100:103], a[12:15], v[172:175], v[100:103]
  buffer_store_dwordx4 v[20:23], v11, s[24:27], s70 offen
  v_mfma_f32_16x16x32_bf16 v[100:103], a[16:19], v[176:179], v[100:103]
  ds_read_b64_tr_b16 a[44:45], v7 offset:12288
  v_cvt_pk_bf16_f32 v30, v124, v125
  v_mfma_f32_16x16x32_bf16 v[100:103], a[20:23], v[180:183], v[100:103]
  v_mfma_f32_16x16x32_bf16 v[100:103], a[24:27], v[184:187], v[100:103]
  ds_read_b64_tr_b16 a[46:47], v7 offset:14336
  v_cvt_pk_bf16_f32 v31, v126, v127
  v_mfma_f32_16x16x32_bf16 v[100:103], a[28:31], v[188:191], v[100:103]
  v_mfma_f32_16x16x32_bf16 v[104:107], a[0:3], v[192:195], 0
  ds_read_b64_tr_b16 a[48:49], v7 offset:16384
  v_mul_f32 v96, v96, v12
  v_mfma_f32_16x16x32_bf16 v[104:107], a[4:7], v[196:199], v[104:107]
  v_mul_f32 v97, v97, v12
  v_mul_f32 v98, v98, v12
  v_mfma_f32_16x16x32_bf16 v[104:107], a[8:11], v[200:203], v[104:107]
  ds_read_b64_tr_b16 a[50:51], v7 offset:18432
  v_mul_f32 v99, v99, v12
  v_mfma_f32_16x16x32_bf16 v[104:107], a[12:15], v[204:207], v[104:107]
  v_mfma_f32_16x16x32_bf16 v[104:107], a[16:19], v[208:211], v[104:107]
  ds_read_b64_tr_b16 a[52:53], v7 offset:20480
  v_cvt_pk_bf16_f32 v16, v96, v97
  v_mfma_f32_16x16x32_bf16 v[104:107], a[20:23], v[212:215], v[104:107]
  v_mfma_f32_16x16x32_bf16 v[104:107], a[24:27], v[216:219], v[104:107]
  ds_read_b64_tr_b16 a[54:55], v7 offset:22528
  v_cvt_pk_bf16_f32 v17, v98, v99
  v_mfma_f32_16x16x32_bf16 v[104:107], a[28:31], v[220:223], v[104:107]
  v_mfma_f32_16x16x32_bf16 v[108:111], a[0:3], v[224:227], 0
  ds_read_b64_tr_b16 a[56:57], v7 offset:24576
  v_mul_f32 v100, v100, v13
  v_mfma_f32_16x16x32_bf16 v[108:111], a[4:7], v[228:231], v[108:111]
  v_mul_f32 v101, v101, v13
  v_mul_f32 v102, v102, v13
  v_mfma_f32_16x16x32_bf16 v[108:111], a[8:11], v[232:235], v[108:111]
  s_add_u32 s69, s77, 1639424
  ds_read_b64_tr_b16 a[58:59], v7 offset:26624
  v_mul_f32 v103, v103, v13
  v_mfma_f32_16x16x32_bf16 v[108:111], a[12:15], v[236:239], v[108:111]
  buffer_store_dwordx4 v[24:27], v11, s[24:27], s69 offen
  v_mfma_f32_16x16x32_bf16 v[108:111], a[16:19], v[240:243], v[108:111]
  s_waitcnt lgkmcnt(8)
  ds_read_b64_tr_b16 a[60:61], v7 offset:28672
  v_cvt_pk_bf16_f32 v20, v100, v101
  v_mfma_f32_16x16x32_bf16 v[108:111], a[20:23], v[244:247], v[108:111]
  v_mfma_f32_16x16x32_bf16 v[108:111], a[24:27], v[248:251], v[108:111]
  ds_read_b64_tr_b16 a[62:63], v7 offset:30720
  v_cvt_pk_bf16_f32 v21, v102, v103
  v_mfma_f32_16x16x32_bf16 v[108:111], a[28:31], v[252:255], v[108:111]
  s_waitcnt lgkmcnt(12)
  v_mfma_f32_16x16x32_bf16 v[112:115], a[32:35], v[128:131], 0
  ds_read_b64_tr_b16 a[0:1], v8 offset:0
  v_mul_f32 v104, v104, v14
  v_mfma_f32_16x16x32_bf16 v[112:115], a[36:39], v[132:135], v[112:115]
  s_waitcnt lgkmcnt(9)
  v_mul_f32 v105, v105, v14
  v_mul_f32 v106, v106, v14
  v_mfma_f32_16x16x32_bf16 v[112:115], a[40:43], v[136:139], v[112:115]
  s_add_u32 s70, s77, 1672192
  ds_read_b64_tr_b16 a[2:3], v8 offset:2048
  v_mul_f32 v107, v107, v14
  v_mfma_f32_16x16x32_bf16 v[112:115], a[44:47], v[140:143], v[112:115]
  s_waitcnt lgkmcnt(6)
  buffer_store_dwordx4 v[28:31], v11, s[24:27], s70 offen
  v_mfma_f32_16x16x32_bf16 v[112:115], a[48:51], v[144:147], v[112:115]
  ds_read_b64_tr_b16 a[4:5], v8 offset:4096
  v_cvt_pk_bf16_f32 v24, v104, v105
  v_mfma_f32_16x16x32_bf16 v[112:115], a[52:55], v[148:151], v[112:115]
  s_waitcnt lgkmcnt(3)
  v_add_u32 v7, 32768, v7
  v_mfma_f32_16x16x32_bf16 v[112:115], a[56:59], v[152:155], v[112:115]
  ds_read_b64_tr_b16 a[6:7], v8 offset:6144
  v_cvt_pk_bf16_f32 v25, v106, v107
  v_mfma_f32_16x16x32_bf16 v[112:115], a[60:63], v[156:159], v[112:115]
  v_mfma_f32_16x16x32_bf16 v[116:119], a[32:35], v[160:163], 0
  ds_read_b64_tr_b16 a[8:9], v8 offset:8192
  v_mul_f32 v108, v108, v15
  v_mfma_f32_16x16x32_bf16 v[116:119], a[36:39], v[164:167], v[116:119]
  v_mul_f32 v109, v109, v15
  v_mul_f32 v110, v110, v15
  v_mfma_f32_16x16x32_bf16 v[116:119], a[40:43], v[168:171], v[116:119]
  ds_read_b64_tr_b16 a[10:11], v8 offset:10240
  v_mul_f32 v111, v111, v15
  v_mfma_f32_16x16x32_bf16 v[116:119], a[44:47], v[172:175], v[116:119]
  v_mfma_f32_16x16x32_bf16 v[116:119], a[48:51], v[176:179], v[116:119]
  ds_read_b64_tr_b16 a[12:13], v8 offset:12288
  v_cvt_pk_bf16_f32 v28, v108, v109
  v_mfma_f32_16x16x32_bf16 v[116:119], a[52:55], v[180:183], v[116:119]
  v_mfma_f32_16x16x32_bf16 v[116:119], a[56:59], v[184:187], v[116:119]
  ds_read_b64_tr_b16 a[14:15], v8 offset:14336
  v_cvt_pk_bf16_f32 v29, v110, v111
  v_mfma_f32_16x16x32_bf16 v[116:119], a[60:63], v[188:191], v[116:119]
  v_mfma_f32_16x16x32_bf16 v[120:123], a[32:35], v[192:195], 0
  ds_read_b64_tr_b16 a[16:17], v8 offset:16384
  v_mul_f32 v112, v112, v12
  v_mfma_f32_16x16x32_bf16 v[120:123], a[36:39], v[196:199], v[120:123]
  v_mul_f32 v113, v113, v12
  v_mul_f32 v114, v114, v12
  v_mfma_f32_16x16x32_bf16 v[120:123], a[40:43], v[200:203], v[120:123]
  ds_read_b64_tr_b16 a[18:19], v8 offset:18432
  v_mul_f32 v115, v115, v12
  v_mfma_f32_16x16x32_bf16 v[120:123], a[44:47], v[204:207], v[120:123]
  v_mfma_f32_16x16x32_bf16 v[120:123], a[48:51], v[208:211], v[120:123]
  ds_read_b64_tr_b16 a[20:21], v8 offset:20480
  v_cvt_pk_bf16_f32 v18, v112, v113
  v_mfma_f32_16x16x32_bf16 v[120:123], a[52:55], v[212:215], v[120:123]
  v_mfma_f32_16x16x32_bf16 v[120:123], a[56:59], v[216:219], v[120:123]
  ds_read_b64_tr_b16 a[22:23], v8 offset:22528
  v_cvt_pk_bf16_f32 v19, v114, v115
  v_mfma_f32_16x16x32_bf16 v[120:123], a[60:63], v[220:223], v[120:123]
  v_mfma_f32_16x16x32_bf16 v[124:127], a[32:35], v[224:227], 0
  ds_read_b64_tr_b16 a[24:25], v8 offset:24576
  v_mul_f32 v116, v116, v13
  v_mfma_f32_16x16x32_bf16 v[124:127], a[36:39], v[228:231], v[124:127]
  v_mul_f32 v117, v117, v13
  v_mul_f32 v118, v118, v13
  v_mfma_f32_16x16x32_bf16 v[124:127], a[40:43], v[232:235], v[124:127]
  s_add_u32 s69, s77, 2097152
  ds_read_b64_tr_b16 a[26:27], v8 offset:26624
  v_mul_f32 v119, v119, v13
  v_mfma_f32_16x16x32_bf16 v[124:127], a[44:47], v[236:239], v[124:127]
  buffer_store_dwordx4 v[16:19], v11, s[24:27], s69 offen
  v_mfma_f32_16x16x32_bf16 v[124:127], a[48:51], v[240:243], v[124:127]
  s_waitcnt lgkmcnt(8)
  ds_read_b64_tr_b16 a[28:29], v8 offset:28672
  v_cvt_pk_bf16_f32 v22, v116, v117
  v_mfma_f32_16x16x32_bf16 v[124:127], a[52:55], v[244:247], v[124:127]
  v_mfma_f32_16x16x32_bf16 v[124:127], a[56:59], v[248:251], v[124:127]
  ds_read_b64_tr_b16 a[30:31], v8 offset:30720
  v_cvt_pk_bf16_f32 v23, v118, v119
  v_mfma_f32_16x16x32_bf16 v[124:127], a[60:63], v[252:255], v[124:127]
  s_waitcnt lgkmcnt(12)
  v_mfma_f32_16x16x32_bf16 v[96:99], a[0:3], v[128:131], 0
  ds_read_b64_tr_b16 a[32:33], v9 offset:0
  v_mul_f32 v120, v120, v14
  v_mfma_f32_16x16x32_bf16 v[96:99], a[4:7], v[132:135], v[96:99]
  s_waitcnt lgkmcnt(9)
  v_mul_f32 v121, v121, v14
  v_mul_f32 v122, v122, v14
  v_mfma_f32_16x16x32_bf16 v[96:99], a[8:11], v[136:139], v[96:99]
  ds_read_b64_tr_b16 a[34:35], v9 offset:2048
  v_mul_f32 v123, v123, v14
  v_mfma_f32_16x16x32_bf16 v[96:99], a[12:15], v[140:143], v[96:99]
  s_waitcnt lgkmcnt(6)
  v_mfma_f32_16x16x32_bf16 v[96:99], a[16:19], v[144:147], v[96:99]
  ds_read_b64_tr_b16 a[36:37], v9 offset:4096
  v_cvt_pk_bf16_f32 v26, v120, v121
  v_mfma_f32_16x16x32_bf16 v[96:99], a[20:23], v[148:151], v[96:99]
  s_waitcnt lgkmcnt(3)
  v_add_u32 v8, 32768, v8
  v_mfma_f32_16x16x32_bf16 v[96:99], a[24:27], v[152:155], v[96:99]
  ds_read_b64_tr_b16 a[38:39], v9 offset:6144
  v_cvt_pk_bf16_f32 v27, v122, v123
  v_mfma_f32_16x16x32_bf16 v[96:99], a[28:31], v[156:159], v[96:99]
  v_mfma_f32_16x16x32_bf16 v[100:103], a[0:3], v[160:163], 0
  ds_read_b64_tr_b16 a[40:41], v9 offset:8192
  v_mul_f32 v124, v124, v15
  v_mfma_f32_16x16x32_bf16 v[100:103], a[4:7], v[164:167], v[100:103]
  v_mul_f32 v125, v125, v15
  v_mul_f32 v126, v126, v15
  v_mfma_f32_16x16x32_bf16 v[100:103], a[8:11], v[168:171], v[100:103]
  s_add_u32 s70, s77, 2129920
  ds_read_b64_tr_b16 a[42:43], v9 offset:10240
  v_mul_f32 v127, v127, v15
  v_mfma_f32_16x16x32_bf16 v[100:103], a[12:15], v[172:175], v[100:103]
  buffer_store_dwordx4 v[20:23], v11, s[24:27], s70 offen
  v_mfma_f32_16x16x32_bf16 v[100:103], a[16:19], v[176:179], v[100:103]
  ds_read_b64_tr_b16 a[44:45], v9 offset:12288
  v_cvt_pk_bf16_f32 v30, v124, v125
  v_mfma_f32_16x16x32_bf16 v[100:103], a[20:23], v[180:183], v[100:103]
  v_mfma_f32_16x16x32_bf16 v[100:103], a[24:27], v[184:187], v[100:103]
  ds_read_b64_tr_b16 a[46:47], v9 offset:14336
  v_cvt_pk_bf16_f32 v31, v126, v127
  v_mfma_f32_16x16x32_bf16 v[100:103], a[28:31], v[188:191], v[100:103]
  v_mfma_f32_16x16x32_bf16 v[104:107], a[0:3], v[192:195], 0
  ds_read_b64_tr_b16 a[48:49], v9 offset:16384
  v_mul_f32 v96, v96, v12
  v_mfma_f32_16x16x32_bf16 v[104:107], a[4:7], v[196:199], v[104:107]
  v_mul_f32 v97, v97, v12
  v_mul_f32 v98, v98, v12
  v_mfma_f32_16x16x32_bf16 v[104:107], a[8:11], v[200:203], v[104:107]
  ds_read_b64_tr_b16 a[50:51], v9 offset:18432
  v_mul_f32 v99, v99, v12
  v_mfma_f32_16x16x32_bf16 v[104:107], a[12:15], v[204:207], v[104:107]
  v_mfma_f32_16x16x32_bf16 v[104:107], a[16:19], v[208:211], v[104:107]
  ds_read_b64_tr_b16 a[52:53], v9 offset:20480
  v_cvt_pk_bf16_f32 v16, v96, v97
  v_mfma_f32_16x16x32_bf16 v[104:107], a[20:23], v[212:215], v[104:107]
  v_add_u32 v6, 32768, v6
  v_mfma_f32_16x16x32_bf16 v[104:107], a[24:27], v[216:219], v[104:107]
  ds_read_b64_tr_b16 a[54:55], v9 offset:22528
  v_cvt_pk_bf16_f32 v17, v98, v99
  v_mfma_f32_16x16x32_bf16 v[104:107], a[28:31], v[220:223], v[104:107]
  v_mfma_f32_16x16x32_bf16 v[108:111], a[0:3], v[224:227], 0
  ds_read_b64_tr_b16 a[56:57], v9 offset:24576
  v_mul_f32 v100, v100, v13
  v_mfma_f32_16x16x32_bf16 v[108:111], a[4:7], v[228:231], v[108:111]
  v_mul_f32 v101, v101, v13
  v_mul_f32 v102, v102, v13
  v_mfma_f32_16x16x32_bf16 v[108:111], a[8:11], v[232:235], v[108:111]
  s_add_u32 s69, s77, 2162688
  ds_read_b64_tr_b16 a[58:59], v9 offset:26624
  v_mul_f32 v103, v103, v13
  v_mfma_f32_16x16x32_bf16 v[108:111], a[12:15], v[236:239], v[108:111]
  s_barrier
  buffer_store_dwordx4 v[24:27], v11, s[24:27], s69 offen
  v_mfma_f32_16x16x32_bf16 v[108:111], a[16:19], v[240:243], v[108:111]
  s_waitcnt lgkmcnt(8)
  ds_read_b64_tr_b16 a[60:61], v9 offset:28672
  v_cvt_pk_bf16_f32 v20, v100, v101
  v_mfma_f32_16x16x32_bf16 v[108:111], a[20:23], v[244:247], v[108:111]
  v_mfma_f32_16x16x32_bf16 v[108:111], a[24:27], v[248:251], v[108:111]
  ds_read_b64_tr_b16 a[62:63], v9 offset:30720
  v_cvt_pk_bf16_f32 v21, v102, v103
  v_mfma_f32_16x16x32_bf16 v[108:111], a[28:31], v[252:255], v[108:111]
  s_waitcnt lgkmcnt(12)
  v_mfma_f32_16x16x32_bf16 v[112:115], a[32:35], v[128:131], 0
  ds_read_b64_tr_b16 a[0:1], v6 offset:0
  v_mul_f32 v104, v104, v14
  v_mfma_f32_16x16x32_bf16 v[112:115], a[36:39], v[132:135], v[112:115]
  s_waitcnt lgkmcnt(9)
  v_mul_f32 v105, v105, v14
  v_mul_f32 v106, v106, v14
  v_mfma_f32_16x16x32_bf16 v[112:115], a[40:43], v[136:139], v[112:115]
  s_add_u32 s70, s77, 2195456
  ds_read_b64_tr_b16 a[2:3], v6 offset:2048
  v_mul_f32 v107, v107, v14
  v_mfma_f32_16x16x32_bf16 v[112:115], a[44:47], v[140:143], v[112:115]
  s_waitcnt lgkmcnt(6)
  buffer_store_dwordx4 v[28:31], v11, s[24:27], s70 offen
  v_mfma_f32_16x16x32_bf16 v[112:115], a[48:51], v[144:147], v[112:115]
  ds_read_b64_tr_b16 a[4:5], v6 offset:4096
  v_cvt_pk_bf16_f32 v24, v104, v105
  v_mfma_f32_16x16x32_bf16 v[112:115], a[52:55], v[148:151], v[112:115]
  s_waitcnt lgkmcnt(3)
  v_add_u32 v9, 32768, v9
  v_mfma_f32_16x16x32_bf16 v[112:115], a[56:59], v[152:155], v[112:115]
  ds_read_b64_tr_b16 a[6:7], v6 offset:6144
  v_cvt_pk_bf16_f32 v25, v106, v107
  v_mfma_f32_16x16x32_bf16 v[112:115], a[60:63], v[156:159], v[112:115]
  v_mfma_f32_16x16x32_bf16 v[116:119], a[32:35], v[160:163], 0
  ds_read_b64_tr_b16 a[8:9], v6 offset:8192
  v_mul_f32 v108, v108, v15
  v_mfma_f32_16x16x32_bf16 v[116:119], a[36:39], v[164:167], v[116:119]
  v_mul_f32 v109, v109, v15
  v_mul_f32 v110, v110, v15
  v_mfma_f32_16x16x32_bf16 v[116:119], a[40:43], v[168:171], v[116:119]
  ds_read_b64_tr_b16 a[10:11], v6 offset:10240
  v_mul_f32 v111, v111, v15
  v_mfma_f32_16x16x32_bf16 v[116:119], a[44:47], v[172:175], v[116:119]
  v_mfma_f32_16x16x32_bf16 v[116:119], a[48:51], v[176:179], v[116:119]
  ds_read_b64_tr_b16 a[12:13], v6 offset:12288
  v_cvt_pk_bf16_f32 v28, v108, v109
  v_mfma_f32_16x16x32_bf16 v[116:119], a[52:55], v[180:183], v[116:119]
  v_mfma_f32_16x16x32_bf16 v[116:119], a[56:59], v[184:187], v[116:119]
  ds_read_b64_tr_b16 a[14:15], v6 offset:14336
  v_cvt_pk_bf16_f32 v29, v110, v111
  v_mfma_f32_16x16x32_bf16 v[116:119], a[60:63], v[188:191], v[116:119]
  v_mfma_f32_16x16x32_bf16 v[120:123], a[32:35], v[192:195], 0
  ds_read_b64_tr_b16 a[16:17], v6 offset:16384
  v_mul_f32 v112, v112, v12
  v_mfma_f32_16x16x32_bf16 v[120:123], a[36:39], v[196:199], v[120:123]
  v_mul_f32 v113, v113, v12
  v_mul_f32 v114, v114, v12
  v_mfma_f32_16x16x32_bf16 v[120:123], a[40:43], v[200:203], v[120:123]
  ds_read_b64_tr_b16 a[18:19], v6 offset:18432
  v_mul_f32 v115, v115, v12
  v_mfma_f32_16x16x32_bf16 v[120:123], a[44:47], v[204:207], v[120:123]
  v_mfma_f32_16x16x32_bf16 v[120:123], a[48:51], v[208:211], v[120:123]
  ds_read_b64_tr_b16 a[20:21], v6 offset:20480
  v_cvt_pk_bf16_f32 v18, v112, v113
  v_mfma_f32_16x16x32_bf16 v[120:123], a[52:55], v[212:215], v[120:123]
  v_mfma_f32_16x16x32_bf16 v[120:123], a[56:59], v[216:219], v[120:123]
  ds_read_b64_tr_b16 a[22:23], v6 offset:22528
  v_cvt_pk_bf16_f32 v19, v114, v115
  v_mfma_f32_16x16x32_bf16 v[120:123], a[60:63], v[220:223], v[120:123]
  v_mfma_f32_16x16x32_bf16 v[124:127], a[32:35], v[224:227], 0
  ds_read_b64_tr_b16 a[24:25], v6 offset:24576
  v_mul_f32 v116, v116, v13
  v_mfma_f32_16x16x32_bf16 v[124:127], a[36:39], v[228:231], v[124:127]
  v_mul_f32 v117, v117, v13
  v_mul_f32 v118, v118, v13
  v_mfma_f32_16x16x32_bf16 v[124:127], a[40:43], v[232:235], v[124:127]
  s_add_u32 s69, s77, 2098176
  ds_read_b64_tr_b16 a[26:27], v6 offset:26624
  v_mul_f32 v119, v119, v13
  v_mfma_f32_16x16x32_bf16 v[124:127], a[44:47], v[236:239], v[124:127]
  buffer_store_dwordx4 v[16:19], v11, s[24:27], s69 offen
  v_mfma_f32_16x16x32_bf16 v[124:127], a[48:51], v[240:243], v[124:127]
  s_waitcnt lgkmcnt(8)
  ds_read_b64_tr_b16 a[28:29], v6 offset:28672
  v_cvt_pk_bf16_f32 v22, v116, v117
  v_mfma_f32_16x16x32_bf16 v[124:127], a[52:55], v[244:247], v[124:127]
  v_mfma_f32_16x16x32_bf16 v[124:127], a[56:59], v[248:251], v[124:127]
  ds_read_b64_tr_b16 a[30:31], v6 offset:30720
  v_cvt_pk_bf16_f32 v23, v118, v119
  v_mfma_f32_16x16x32_bf16 v[124:127], a[60:63], v[252:255], v[124:127]
  s_waitcnt lgkmcnt(12)
  v_mfma_f32_16x16x32_bf16 v[96:99], a[0:3], v[128:131], 0
  ds_read_b64_tr_b16 a[32:33], v7 offset:0
  v_mul_f32 v120, v120, v14
  v_mfma_f32_16x16x32_bf16 v[96:99], a[4:7], v[132:135], v[96:99]
  s_waitcnt lgkmcnt(9)
  v_mul_f32 v121, v121, v14
  v_mul_f32 v122, v122, v14
  v_mfma_f32_16x16x32_bf16 v[96:99], a[8:11], v[136:139], v[96:99]
  ds_read_b64_tr_b16 a[34:35], v7 offset:2048
  v_mul_f32 v123, v123, v14
  v_mfma_f32_16x16x32_bf16 v[96:99], a[12:15], v[140:143], v[96:99]
  s_waitcnt lgkmcnt(6)
  v_mfma_f32_16x16x32_bf16 v[96:99], a[16:19], v[144:147], v[96:99]
  ds_read_b64_tr_b16 a[36:37], v7 offset:4096
  v_cvt_pk_bf16_f32 v26, v120, v121
  v_mfma_f32_16x16x32_bf16 v[96:99], a[20:23], v[148:151], v[96:99]
  s_waitcnt lgkmcnt(3)
  v_mfma_f32_16x16x32_bf16 v[96:99], a[24:27], v[152:155], v[96:99]
  ds_read_b64_tr_b16 a[38:39], v7 offset:6144
  v_cvt_pk_bf16_f32 v27, v122, v123
  v_mfma_f32_16x16x32_bf16 v[96:99], a[28:31], v[156:159], v[96:99]
  v_mfma_f32_16x16x32_bf16 v[100:103], a[0:3], v[160:163], 0
  ds_read_b64_tr_b16 a[40:41], v7 offset:8192
  v_mul_f32 v124, v124, v15
  v_mfma_f32_16x16x32_bf16 v[100:103], a[4:7], v[164:167], v[100:103]
  v_mul_f32 v125, v125, v15
  v_mul_f32 v126, v126, v15
  v_mfma_f32_16x16x32_bf16 v[100:103], a[8:11], v[168:171], v[100:103]
  s_add_u32 s70, s77, 2130944
  ds_read_b64_tr_b16 a[42:43], v7 offset:10240
  v_mul_f32 v127, v127, v15
  v_mfma_f32_16x16x32_bf16 v[100:103], a[12:15], v[172:175], v[100:103]
  buffer_store_dwordx4 v[20:23], v11, s[24:27], s70 offen
  v_mfma_f32_16x16x32_bf16 v[100:103], a[16:19], v[176:179], v[100:103]
  ds_read_b64_tr_b16 a[44:45], v7 offset:12288
  v_cvt_pk_bf16_f32 v30, v124, v125
  v_mfma_f32_16x16x32_bf16 v[100:103], a[20:23], v[180:183], v[100:103]
  v_mfma_f32_16x16x32_bf16 v[100:103], a[24:27], v[184:187], v[100:103]
  ds_read_b64_tr_b16 a[46:47], v7 offset:14336
  v_cvt_pk_bf16_f32 v31, v126, v127
  v_mfma_f32_16x16x32_bf16 v[100:103], a[28:31], v[188:191], v[100:103]
  v_mfma_f32_16x16x32_bf16 v[104:107], a[0:3], v[192:195], 0
  ds_read_b64_tr_b16 a[48:49], v7 offset:16384
  v_mul_f32 v96, v96, v12
  v_mfma_f32_16x16x32_bf16 v[104:107], a[4:7], v[196:199], v[104:107]
  v_mul_f32 v97, v97, v12
  v_mul_f32 v98, v98, v12
  v_mfma_f32_16x16x32_bf16 v[104:107], a[8:11], v[200:203], v[104:107]
  ds_read_b64_tr_b16 a[50:51], v7 offset:18432
  v_mul_f32 v99, v99, v12
  v_mfma_f32_16x16x32_bf16 v[104:107], a[12:15], v[204:207], v[104:107]
  v_mfma_f32_16x16x32_bf16 v[104:107], a[16:19], v[208:211], v[104:107]
  ds_read_b64_tr_b16 a[52:53], v7 offset:20480
  v_cvt_pk_bf16_f32 v16, v96, v97
  v_mfma_f32_16x16x32_bf16 v[104:107], a[20:23], v[212:215], v[104:107]
  v_mfma_f32_16x16x32_bf16 v[104:107], a[24:27], v[216:219], v[104:107]
  ds_read_b64_tr_b16 a[54:55], v7 offset:22528
  v_cvt_pk_bf16_f32 v17, v98, v99
  v_mfma_f32_16x16x32_bf16 v[104:107], a[28:31], v[220:223], v[104:107]
  v_mfma_f32_16x16x32_bf16 v[108:111], a[0:3], v[224:227], 0
  ds_read_b64_tr_b16 a[56:57], v7 offset:24576
  v_mul_f32 v100, v100, v13
  v_mfma_f32_16x16x32_bf16 v[108:111], a[4:7], v[228:231], v[108:111]
  v_mul_f32 v101, v101, v13
  v_mul_f32 v102, v102, v13
  v_mfma_f32_16x16x32_bf16 v[108:111], a[8:11], v[232:235], v[108:111]
  s_add_u32 s69, s77, 2163712
  ds_read_b64_tr_b16 a[58:59], v7 offset:26624
  v_mul_f32 v103, v103, v13
  v_mfma_f32_16x16x32_bf16 v[108:111], a[12:15], v[236:239], v[108:111]
  buffer_store_dwordx4 v[24:27], v11, s[24:27], s69 offen
  v_mfma_f32_16x16x32_bf16 v[108:111], a[16:19], v[240:243], v[108:111]
  s_waitcnt lgkmcnt(8)
  ds_read_b64_tr_b16 a[60:61], v7 offset:28672
  v_cvt_pk_bf16_f32 v20, v100, v101
  v_mfma_f32_16x16x32_bf16 v[108:111], a[20:23], v[244:247], v[108:111]
  v_mfma_f32_16x16x32_bf16 v[108:111], a[24:27], v[248:251], v[108:111]
  ds_read_b64_tr_b16 a[62:63], v7 offset:30720
  v_cvt_pk_bf16_f32 v21, v102, v103
  v_mfma_f32_16x16x32_bf16 v[108:111], a[28:31], v[252:255], v[108:111]
  s_waitcnt lgkmcnt(12)
  v_mfma_f32_16x16x32_bf16 v[112:115], a[32:35], v[128:131], 0
  ds_read_b64_tr_b16 a[0:1], v8 offset:0
  v_mul_f32 v104, v104, v14
  v_mfma_f32_16x16x32_bf16 v[112:115], a[36:39], v[132:135], v[112:115]
  s_waitcnt lgkmcnt(9)
  v_mul_f32 v105, v105, v14
  v_mul_f32 v106, v106, v14
  v_mfma_f32_16x16x32_bf16 v[112:115], a[40:43], v[136:139], v[112:115]
  s_add_u32 s70, s77, 2196480
  ds_read_b64_tr_b16 a[2:3], v8 offset:2048
  v_mul_f32 v107, v107, v14
  v_mfma_f32_16x16x32_bf16 v[112:115], a[44:47], v[140:143], v[112:115]
  s_waitcnt lgkmcnt(6)
  buffer_store_dwordx4 v[28:31], v11, s[24:27], s70 offen
  v_mfma_f32_16x16x32_bf16 v[112:115], a[48:51], v[144:147], v[112:115]
  ds_read_b64_tr_b16 a[4:5], v8 offset:4096
  v_cvt_pk_bf16_f32 v24, v104, v105
  v_mfma_f32_16x16x32_bf16 v[112:115], a[52:55], v[148:151], v[112:115]
  s_waitcnt lgkmcnt(3)
  v_subrev_u32 v7, 131072, v7
  v_mfma_f32_16x16x32_bf16 v[112:115], a[56:59], v[152:155], v[112:115]
  ds_read_b64_tr_b16 a[6:7], v8 offset:6144
  v_cvt_pk_bf16_f32 v25, v106, v107
  v_mfma_f32_16x16x32_bf16 v[112:115], a[60:63], v[156:159], v[112:115]
  v_mfma_f32_16x16x32_bf16 v[116:119], a[32:35], v[160:163], 0
  ds_read_b64_tr_b16 a[8:9], v8 offset:8192
  v_mul_f32 v108, v108, v15
  v_mfma_f32_16x16x32_bf16 v[116:119], a[36:39], v[164:167], v[116:119]
  v_mul_f32 v109, v109, v15
  v_mul_f32 v110, v110, v15
  v_mfma_f32_16x16x32_bf16 v[116:119], a[40:43], v[168:171], v[116:119]
  ds_read_b64_tr_b16 a[10:11], v8 offset:10240
  v_mul_f32 v111, v111, v15
  v_mfma_f32_16x16x32_bf16 v[116:119], a[44:47], v[172:175], v[116:119]
  v_mfma_f32_16x16x32_bf16 v[116:119], a[48:51], v[176:179], v[116:119]
  ds_read_b64_tr_b16 a[12:13], v8 offset:12288
  v_cvt_pk_bf16_f32 v28, v108, v109
  v_mfma_f32_16x16x32_bf16 v[116:119], a[52:55], v[180:183], v[116:119]
  v_mfma_f32_16x16x32_bf16 v[116:119], a[56:59], v[184:187], v[116:119]
  ds_read_b64_tr_b16 a[14:15], v8 offset:14336
  v_cvt_pk_bf16_f32 v29, v110, v111
  v_mfma_f32_16x16x32_bf16 v[116:119], a[60:63], v[188:191], v[116:119]
  v_mfma_f32_16x16x32_bf16 v[120:123], a[32:35], v[192:195], 0
  ds_read_b64_tr_b16 a[16:17], v8 offset:16384
  v_mul_f32 v112, v112, v12
  v_mfma_f32_16x16x32_bf16 v[120:123], a[36:39], v[196:199], v[120:123]
  v_mul_f32 v113, v113, v12
  v_mul_f32 v114, v114, v12
  v_mfma_f32_16x16x32_bf16 v[120:123], a[40:43], v[200:203], v[120:123]
  ds_read_b64_tr_b16 a[18:19], v8 offset:18432
  v_mul_f32 v115, v115, v12
  v_mfma_f32_16x16x32_bf16 v[120:123], a[44:47], v[204:207], v[120:123]
  v_mfma_f32_16x16x32_bf16 v[120:123], a[48:51], v[208:211], v[120:123]
  ds_read_b64_tr_b16 a[20:21], v8 offset:20480
  v_cvt_pk_bf16_f32 v18, v112, v113
  v_mfma_f32_16x16x32_bf16 v[120:123], a[52:55], v[212:215], v[120:123]
  v_mfma_f32_16x16x32_bf16 v[120:123], a[56:59], v[216:219], v[120:123]
  ds_read_b64_tr_b16 a[22:23], v8 offset:22528
  v_cvt_pk_bf16_f32 v19, v114, v115
  v_mfma_f32_16x16x32_bf16 v[120:123], a[60:63], v[220:223], v[120:123]
  v_mfma_f32_16x16x32_bf16 v[124:127], a[32:35], v[224:227], 0
  ds_read_b64_tr_b16 a[24:25], v8 offset:24576
  v_mul_f32 v116, v116, v13
  v_mfma_f32_16x16x32_bf16 v[124:127], a[36:39], v[228:231], v[124:127]
  v_mul_f32 v117, v117, v13
  v_mul_f32 v118, v118, v13
  v_mfma_f32_16x16x32_bf16 v[124:127], a[40:43], v[232:235], v[124:127]
  s_add_u32 s69, s77, 2621440
  ds_read_b64_tr_b16 a[26:27], v8 offset:26624
  v_mul_f32 v119, v119, v13
  v_mfma_f32_16x16x32_bf16 v[124:127], a[44:47], v[236:239], v[124:127]
  buffer_store_dwordx4 v[16:19], v11, s[24:27], s69 offen
  v_mfma_f32_16x16x32_bf16 v[124:127], a[48:51], v[240:243], v[124:127]
  s_waitcnt lgkmcnt(8)
  ds_read_b64_tr_b16 a[28:29], v8 offset:28672
  v_cvt_pk_bf16_f32 v22, v116, v117
  v_mfma_f32_16x16x32_bf16 v[124:127], a[52:55], v[244:247], v[124:127]
  v_mfma_f32_16x16x32_bf16 v[124:127], a[56:59], v[248:251], v[124:127]
  ds_read_b64_tr_b16 a[30:31], v8 offset:30720
  v_cvt_pk_bf16_f32 v23, v118, v119
  v_mfma_f32_16x16x32_bf16 v[124:127], a[60:63], v[252:255], v[124:127]
  s_waitcnt lgkmcnt(12)
  v_mfma_f32_16x16x32_bf16 v[96:99], a[0:3], v[128:131], 0
  ds_read_b64_tr_b16 a[32:33], v9 offset:0
  v_mul_f32 v120, v120, v14
  v_mfma_f32_16x16x32_bf16 v[96:99], a[4:7], v[132:135], v[96:99]
  s_waitcnt lgkmcnt(9)
  v_mul_f32 v121, v121, v14
  v_mul_f32 v122, v122, v14
  v_mfma_f32_16x16x32_bf16 v[96:99], a[8:11], v[136:139], v[96:99]
  ds_read_b64_tr_b16 a[34:35], v9 offset:2048
  v_mul_f32 v123, v123, v14
  v_mfma_f32_16x16x32_bf16 v[96:99], a[12:15], v[140:143], v[96:99]
  s_waitcnt lgkmcnt(6)
  v_mfma_f32_16x16x32_bf16 v[96:99], a[16:19], v[144:147], v[96:99]
  ds_read_b64_tr_b16 a[36:37], v9 offset:4096
  v_cvt_pk_bf16_f32 v26, v120, v121
  v_mfma_f32_16x16x32_bf16 v[96:99], a[20:23], v[148:151], v[96:99]
  s_waitcnt lgkmcnt(3)
  v_subrev_u32 v8, 131072, v8
  v_mfma_f32_16x16x32_bf16 v[96:99], a[24:27], v[152:155], v[96:99]
  ds_read_b64_tr_b16 a[38:39], v9 offset:6144
  v_cvt_pk_bf16_f32 v27, v122, v123
  v_mfma_f32_16x16x32_bf16 v[96:99], a[28:31], v[156:159], v[96:99]
  v_mfma_f32_16x16x32_bf16 v[100:103], a[0:3], v[160:163], 0
  ds_read_b64_tr_b16 a[40:41], v9 offset:8192
  v_mul_f32 v124, v124, v15
  v_mfma_f32_16x16x32_bf16 v[100:103], a[4:7], v[164:167], v[100:103]
  v_mul_f32 v125, v125, v15
  v_mul_f32 v126, v126, v15
  v_mfma_f32_16x16x32_bf16 v[100:103], a[8:11], v[168:171], v[100:103]
  s_add_u32 s70, s77, 2654208
  ds_read_b64_tr_b16 a[42:43], v9 offset:10240
  v_mul_f32 v127, v127, v15
  v_mfma_f32_16x16x32_bf16 v[100:103], a[12:15], v[172:175], v[100:103]
  buffer_store_dwordx4 v[20:23], v11, s[24:27], s70 offen
  v_mfma_f32_16x16x32_bf16 v[100:103], a[16:19], v[176:179], v[100:103]
  ds_read_b64_tr_b16 a[44:45], v9 offset:12288
  v_cvt_pk_bf16_f32 v30, v124, v125
  v_mfma_f32_16x16x32_bf16 v[100:103], a[20:23], v[180:183], v[100:103]
  v_mfma_f32_16x16x32_bf16 v[100:103], a[24:27], v[184:187], v[100:103]
  ds_read_b64_tr_b16 a[46:47], v9 offset:14336
  v_cvt_pk_bf16_f32 v31, v126, v127
  v_mfma_f32_16x16x32_bf16 v[100:103], a[28:31], v[188:191], v[100:103]
  v_mfma_f32_16x16x32_bf16 v[104:107], a[0:3], v[192:195], 0
  ds_read_b64_tr_b16 a[48:49], v9 offset:16384
  v_mul_f32 v96, v96, v12
  v_mfma_f32_16x16x32_bf16 v[104:107], a[4:7], v[196:199], v[104:107]
  v_mul_f32 v97, v97, v12
  v_mul_f32 v98, v98, v12
  v_mfma_f32_16x16x32_bf16 v[104:107], a[8:11], v[200:203], v[104:107]
  ds_read_b64_tr_b16 a[50:51], v9 offset:18432
  v_mul_f32 v99, v99, v12
  v_mfma_f32_16x16x32_bf16 v[104:107], a[12:15], v[204:207], v[104:107]
  v_mfma_f32_16x16x32_bf16 v[104:107], a[16:19], v[208:211], v[104:107]
  ds_read_b64_tr_b16 a[52:53], v9 offset:20480
  v_cvt_pk_bf16_f32 v16, v96, v97
  v_mfma_f32_16x16x32_bf16 v[104:107], a[20:23], v[212:215], v[104:107]
  v_subrev_u32 v6, 131072, v6
  v_mfma_f32_16x16x32_bf16 v[104:107], a[24:27], v[216:219], v[104:107]
  ds_read_b64_tr_b16 a[54:55], v9 offset:22528
  v_cvt_pk_bf16_f32 v17, v98, v99
  v_mfma_f32_16x16x32_bf16 v[104:107], a[28:31], v[220:223], v[104:107]
  v_mfma_f32_16x16x32_bf16 v[108:111], a[0:3], v[224:227], 0
  ds_read_b64_tr_b16 a[56:57], v9 offset:24576
  v_mul_f32 v100, v100, v13
  v_mfma_f32_16x16x32_bf16 v[108:111], a[4:7], v[228:231], v[108:111]
  v_mul_f32 v101, v101, v13
  v_mul_f32 v102, v102, v13
  v_mfma_f32_16x16x32_bf16 v[108:111], a[8:11], v[232:235], v[108:111]
  s_add_u32 s69, s77, 2686976
  ds_read_b64_tr_b16 a[58:59], v9 offset:26624
  v_mul_f32 v103, v103, v13
  v_mfma_f32_16x16x32_bf16 v[108:111], a[12:15], v[236:239], v[108:111]
  s_barrier
  buffer_store_dwordx4 v[24:27], v11, s[24:27], s69 offen
  v_mfma_f32_16x16x32_bf16 v[108:111], a[16:19], v[240:243], v[108:111]
  s_waitcnt lgkmcnt(8)
  ds_read_b64_tr_b16 a[60:61], v9 offset:28672
  v_cvt_pk_bf16_f32 v20, v100, v101
  v_mfma_f32_16x16x32_bf16 v[108:111], a[20:23], v[244:247], v[108:111]
  v_mfma_f32_16x16x32_bf16 v[108:111], a[24:27], v[248:251], v[108:111]
  ds_read_b64_tr_b16 a[62:63], v9 offset:30720
  v_cvt_pk_bf16_f32 v21, v102, v103
  v_mfma_f32_16x16x32_bf16 v[108:111], a[28:31], v[252:255], v[108:111]
  s_waitcnt lgkmcnt(12)
  v_mfma_f32_16x16x32_bf16 v[112:115], a[32:35], v[128:131], 0
  ds_read_b64_tr_b16 a[0:1], v6 offset:0
  v_mul_f32 v104, v104, v14
  v_mfma_f32_16x16x32_bf16 v[112:115], a[36:39], v[132:135], v[112:115]
  s_waitcnt lgkmcnt(9)
  v_mul_f32 v105, v105, v14
  v_mul_f32 v106, v106, v14
  v_mfma_f32_16x16x32_bf16 v[112:115], a[40:43], v[136:139], v[112:115]
  s_add_u32 s70, s77, 2719744
  ds_read_b64_tr_b16 a[2:3], v6 offset:2048
  v_mul_f32 v107, v107, v14
  v_mfma_f32_16x16x32_bf16 v[112:115], a[44:47], v[140:143], v[112:115]
  s_waitcnt lgkmcnt(6)
  buffer_store_dwordx4 v[28:31], v11, s[24:27], s70 offen
  v_mfma_f32_16x16x32_bf16 v[112:115], a[48:51], v[144:147], v[112:115]
  ds_read_b64_tr_b16 a[4:5], v6 offset:4096
  v_cvt_pk_bf16_f32 v24, v104, v105
  v_mfma_f32_16x16x32_bf16 v[112:115], a[52:55], v[148:151], v[112:115]
  s_waitcnt lgkmcnt(3)
  v_subrev_u32 v9, 131072, v9
  v_mfma_f32_16x16x32_bf16 v[112:115], a[56:59], v[152:155], v[112:115]
  ds_read_b64_tr_b16 a[6:7], v6 offset:6144
  v_cvt_pk_bf16_f32 v25, v106, v107
  v_mfma_f32_16x16x32_bf16 v[112:115], a[60:63], v[156:159], v[112:115]
  v_mfma_f32_16x16x32_bf16 v[116:119], a[32:35], v[160:163], 0
  ds_read_b64_tr_b16 a[8:9], v6 offset:8192
  v_mul_f32 v108, v108, v15
  v_mfma_f32_16x16x32_bf16 v[116:119], a[36:39], v[164:167], v[116:119]
  v_mul_f32 v109, v109, v15
  v_mul_f32 v110, v110, v15
  v_mfma_f32_16x16x32_bf16 v[116:119], a[40:43], v[168:171], v[116:119]
  ds_read_b64_tr_b16 a[10:11], v6 offset:10240
  v_mul_f32 v111, v111, v15
  v_mfma_f32_16x16x32_bf16 v[116:119], a[44:47], v[172:175], v[116:119]
  v_mfma_f32_16x16x32_bf16 v[116:119], a[48:51], v[176:179], v[116:119]
  ds_read_b64_tr_b16 a[12:13], v6 offset:12288
  v_cvt_pk_bf16_f32 v28, v108, v109
  v_mfma_f32_16x16x32_bf16 v[116:119], a[52:55], v[180:183], v[116:119]
  v_mfma_f32_16x16x32_bf16 v[116:119], a[56:59], v[184:187], v[116:119]
  ds_read_b64_tr_b16 a[14:15], v6 offset:14336
  v_cvt_pk_bf16_f32 v29, v110, v111
  v_mfma_f32_16x16x32_bf16 v[116:119], a[60:63], v[188:191], v[116:119]
  v_mfma_f32_16x16x32_bf16 v[120:123], a[32:35], v[192:195], 0
  ds_read_b64_tr_b16 a[16:17], v6 offset:16384
  v_mul_f32 v112, v112, v12
  v_mfma_f32_16x16x32_bf16 v[120:123], a[36:39], v[196:199], v[120:123]
  v_mul_f32 v113, v113, v12
  v_mul_f32 v114, v114, v12
  v_mfma_f32_16x16x32_bf16 v[120:123], a[40:43], v[200:203], v[120:123]
  ds_read_b64_tr_b16 a[18:19], v6 offset:18432
  v_mul_f32 v115, v115, v12
  v_mfma_f32_16x16x32_bf16 v[120:123], a[44:47], v[204:207], v[120:123]
  v_mfma_f32_16x16x32_bf16 v[120:123], a[48:51], v[208:211], v[120:123]
  ds_read_b64_tr_b16 a[20:21], v6 offset:20480
  v_cvt_pk_bf16_f32 v18, v112, v113
  v_mfma_f32_16x16x32_bf16 v[120:123], a[52:55], v[212:215], v[120:123]
  v_mfma_f32_16x16x32_bf16 v[120:123], a[56:59], v[216:219], v[120:123]
  ds_read_b64_tr_b16 a[22:23], v6 offset:22528
  v_cvt_pk_bf16_f32 v19, v114, v115
  v_mfma_f32_16x16x32_bf16 v[120:123], a[60:63], v[220:223], v[120:123]
  v_mfma_f32_16x16x32_bf16 v[124:127], a[32:35], v[224:227], 0
  ds_read_b64_tr_b16 a[24:25], v6 offset:24576
  v_mul_f32 v116, v116, v13
  v_mfma_f32_16x16x32_bf16 v[124:127], a[36:39], v[228:231], v[124:127]
  v_mul_f32 v117, v117, v13
  v_mul_f32 v118, v118, v13
  v_mfma_f32_16x16x32_bf16 v[124:127], a[40:43], v[232:235], v[124:127]
  s_add_u32 s69, s77, 2622464
  ds_read_b64_tr_b16 a[26:27], v6 offset:26624
  v_mul_f32 v119, v119, v13
  v_mfma_f32_16x16x32_bf16 v[124:127], a[44:47], v[236:239], v[124:127]
  buffer_store_dwordx4 v[16:19], v11, s[24:27], s69 offen
  v_mfma_f32_16x16x32_bf16 v[124:127], a[48:51], v[240:243], v[124:127]
  s_waitcnt lgkmcnt(8)
  ds_read_b64_tr_b16 a[28:29], v6 offset:28672
  v_cvt_pk_bf16_f32 v22, v116, v117
  v_mfma_f32_16x16x32_bf16 v[124:127], a[52:55], v[244:247], v[124:127]
  v_mfma_f32_16x16x32_bf16 v[124:127], a[56:59], v[248:251], v[124:127]
  ds_read_b64_tr_b16 a[30:31], v6 offset:30720
  v_cvt_pk_bf16_f32 v23, v118, v119
  v_mfma_f32_16x16x32_bf16 v[124:127], a[60:63], v[252:255], v[124:127]
  s_waitcnt lgkmcnt(12)
  v_mfma_f32_16x16x32_bf16 v[96:99], a[0:3], v[128:131], 0
  ds_read_b64_tr_b16 a[32:33], v7 offset:0
  v_mul_f32 v120, v120, v14
  v_mfma_f32_16x16x32_bf16 v[96:99], a[4:7], v[132:135], v[96:99]
  s_waitcnt lgkmcnt(9)
  v_mul_f32 v121, v121, v14
  v_mul_f32 v122, v122, v14
  v_mfma_f32_16x16x32_bf16 v[96:99], a[8:11], v[136:139], v[96:99]
  ds_read_b64_tr_b16 a[34:35], v7 offset:2048
  v_mul_f32 v123, v123, v14
  v_mfma_f32_16x16x32_bf16 v[96:99], a[12:15], v[140:143], v[96:99]
  s_waitcnt lgkmcnt(6)
  v_mfma_f32_16x16x32_bf16 v[96:99], a[16:19], v[144:147], v[96:99]
  ds_read_b64_tr_b16 a[36:37], v7 offset:4096
  v_cvt_pk_bf16_f32 v26, v120, v121
  v_mfma_f32_16x16x32_bf16 v[96:99], a[20:23], v[148:151], v[96:99]
  s_waitcnt lgkmcnt(3)
  v_mfma_f32_16x16x32_bf16 v[96:99], a[24:27], v[152:155], v[96:99]
  ds_read_b64_tr_b16 a[38:39], v7 offset:6144
  v_cvt_pk_bf16_f32 v27, v122, v123
  v_mfma_f32_16x16x32_bf16 v[96:99], a[28:31], v[156:159], v[96:99]
  v_mfma_f32_16x16x32_bf16 v[100:103], a[0:3], v[160:163], 0
  ds_read_b64_tr_b16 a[40:41], v7 offset:8192
  v_mul_f32 v124, v124, v15
  v_mfma_f32_16x16x32_bf16 v[100:103], a[4:7], v[164:167], v[100:103]
  v_mul_f32 v125, v125, v15
  v_mul_f32 v126, v126, v15
  v_mfma_f32_16x16x32_bf16 v[100:103], a[8:11], v[168:171], v[100:103]
  s_add_u32 s70, s77, 2655232
  ds_read_b64_tr_b16 a[42:43], v7 offset:10240
  v_mul_f32 v127, v127, v15
  v_mfma_f32_16x16x32_bf16 v[100:103], a[12:15], v[172:175], v[100:103]
  buffer_store_dwordx4 v[20:23], v11, s[24:27], s70 offen
  v_mfma_f32_16x16x32_bf16 v[100:103], a[16:19], v[176:179], v[100:103]
  ds_read_b64_tr_b16 a[44:45], v7 offset:12288
  v_cvt_pk_bf16_f32 v30, v124, v125
  v_mfma_f32_16x16x32_bf16 v[100:103], a[20:23], v[180:183], v[100:103]
  v_mfma_f32_16x16x32_bf16 v[100:103], a[24:27], v[184:187], v[100:103]
  ds_read_b64_tr_b16 a[46:47], v7 offset:14336
  v_cvt_pk_bf16_f32 v31, v126, v127
  v_mfma_f32_16x16x32_bf16 v[100:103], a[28:31], v[188:191], v[100:103]
  v_mfma_f32_16x16x32_bf16 v[104:107], a[0:3], v[192:195], 0
  ds_read_b64_tr_b16 a[48:49], v7 offset:16384
  v_mul_f32 v96, v96, v12
  v_mfma_f32_16x16x32_bf16 v[104:107], a[4:7], v[196:199], v[104:107]
  v_mul_f32 v97, v97, v12
  v_mul_f32 v98, v98, v12
  v_mfma_f32_16x16x32_bf16 v[104:107], a[8:11], v[200:203], v[104:107]
  ds_read_b64_tr_b16 a[50:51], v7 offset:18432
  v_mul_f32 v99, v99, v12
  v_mfma_f32_16x16x32_bf16 v[104:107], a[12:15], v[204:207], v[104:107]
  v_mfma_f32_16x16x32_bf16 v[104:107], a[16:19], v[208:211], v[104:107]
  ds_read_b64_tr_b16 a[52:53], v7 offset:20480
  v_cvt_pk_bf16_f32 v16, v96, v97
  v_mfma_f32_16x16x32_bf16 v[104:107], a[20:23], v[212:215], v[104:107]
  v_mfma_f32_16x16x32_bf16 v[104:107], a[24:27], v[216:219], v[104:107]
  ds_read_b64_tr_b16 a[54:55], v7 offset:22528
  v_cvt_pk_bf16_f32 v17, v98, v99
  v_mfma_f32_16x16x32_bf16 v[104:107], a[28:31], v[220:223], v[104:107]
  v_mfma_f32_16x16x32_bf16 v[108:111], a[0:3], v[224:227], 0
  ds_read_b64_tr_b16 a[56:57], v7 offset:24576
  v_mul_f32 v100, v100, v13
  v_mfma_f32_16x16x32_bf16 v[108:111], a[4:7], v[228:231], v[108:111]
  v_mul_f32 v101, v101, v13
  v_mul_f32 v102, v102, v13
  v_mfma_f32_16x16x32_bf16 v[108:111], a[8:11], v[232:235], v[108:111]
  s_add_u32 s69, s77, 2688000
  ds_read_b64_tr_b16 a[58:59], v7 offset:26624
  v_mul_f32 v103, v103, v13
  v_mfma_f32_16x16x32_bf16 v[108:111], a[12:15], v[236:239], v[108:111]
  buffer_store_dwordx4 v[24:27], v11, s[24:27], s69 offen
  v_mfma_f32_16x16x32_bf16 v[108:111], a[16:19], v[240:243], v[108:111]
  s_waitcnt lgkmcnt(8)
  ds_read_b64_tr_b16 a[60:61], v7 offset:28672
  v_cvt_pk_bf16_f32 v20, v100, v101
  v_mfma_f32_16x16x32_bf16 v[108:111], a[20:23], v[244:247], v[108:111]
  v_mfma_f32_16x16x32_bf16 v[108:111], a[24:27], v[248:251], v[108:111]
  ds_read_b64_tr_b16 a[62:63], v7 offset:30720
  v_cvt_pk_bf16_f32 v21, v102, v103
  v_mfma_f32_16x16x32_bf16 v[108:111], a[28:31], v[252:255], v[108:111]
  s_waitcnt lgkmcnt(12)
  v_mfma_f32_16x16x32_bf16 v[112:115], a[32:35], v[128:131], 0
  ds_read_b64_tr_b16 a[0:1], v8 offset:0
  v_mul_f32 v104, v104, v14
  v_mfma_f32_16x16x32_bf16 v[112:115], a[36:39], v[132:135], v[112:115]
  s_waitcnt lgkmcnt(9)
  v_mul_f32 v105, v105, v14
  v_mul_f32 v106, v106, v14
  v_mfma_f32_16x16x32_bf16 v[112:115], a[40:43], v[136:139], v[112:115]
  s_add_u32 s70, s77, 2720768
  ds_read_b64_tr_b16 a[2:3], v8 offset:2048
  v_mul_f32 v107, v107, v14
  v_mfma_f32_16x16x32_bf16 v[112:115], a[44:47], v[140:143], v[112:115]
  s_waitcnt lgkmcnt(6)
  buffer_store_dwordx4 v[28:31], v11, s[24:27], s70 offen
  v_mfma_f32_16x16x32_bf16 v[112:115], a[48:51], v[144:147], v[112:115]
  ds_read_b64_tr_b16 a[4:5], v8 offset:4096
  v_cvt_pk_bf16_f32 v24, v104, v105
  v_mfma_f32_16x16x32_bf16 v[112:115], a[52:55], v[148:151], v[112:115]
  s_waitcnt lgkmcnt(3)
  v_mfma_f32_16x16x32_bf16 v[112:115], a[56:59], v[152:155], v[112:115]
  ds_read_b64_tr_b16 a[6:7], v8 offset:6144
  v_cvt_pk_bf16_f32 v25, v106, v107
  v_mfma_f32_16x16x32_bf16 v[112:115], a[60:63], v[156:159], v[112:115]
  v_mfma_f32_16x16x32_bf16 v[116:119], a[32:35], v[160:163], 0
  ds_read_b64_tr_b16 a[8:9], v8 offset:8192
  v_mul_f32 v108, v108, v15
  v_mfma_f32_16x16x32_bf16 v[116:119], a[36:39], v[164:167], v[116:119]
  v_mul_f32 v109, v109, v15
  v_mul_f32 v110, v110, v15
  v_mfma_f32_16x16x32_bf16 v[116:119], a[40:43], v[168:171], v[116:119]
  ds_read_b64_tr_b16 a[10:11], v8 offset:10240
  v_mul_f32 v111, v111, v15
  v_mfma_f32_16x16x32_bf16 v[116:119], a[44:47], v[172:175], v[116:119]
  v_mfma_f32_16x16x32_bf16 v[116:119], a[48:51], v[176:179], v[116:119]
  ds_read_b64_tr_b16 a[12:13], v8 offset:12288
  v_cvt_pk_bf16_f32 v28, v108, v109
  v_mfma_f32_16x16x32_bf16 v[116:119], a[52:55], v[180:183], v[116:119]
  v_mfma_f32_16x16x32_bf16 v[116:119], a[56:59], v[184:187], v[116:119]
  ds_read_b64_tr_b16 a[14:15], v8 offset:14336
  v_cvt_pk_bf16_f32 v29, v110, v111
  v_mfma_f32_16x16x32_bf16 v[116:119], a[60:63], v[188:191], v[116:119]
  v_mfma_f32_16x16x32_bf16 v[120:123], a[32:35], v[192:195], 0
  ds_read_b64_tr_b16 a[16:17], v8 offset:16384
  v_mul_f32 v112, v112, v12
  v_mfma_f32_16x16x32_bf16 v[120:123], a[36:39], v[196:199], v[120:123]
  v_mul_f32 v113, v113, v12
  v_mul_f32 v114, v114, v12
  v_mfma_f32_16x16x32_bf16 v[120:123], a[40:43], v[200:203], v[120:123]
  ds_read_b64_tr_b16 a[18:19], v8 offset:18432
  v_mul_f32 v115, v115, v12
  v_mfma_f32_16x16x32_bf16 v[120:123], a[44:47], v[204:207], v[120:123]
  v_mfma_f32_16x16x32_bf16 v[120:123], a[48:51], v[208:211], v[120:123]
  ds_read_b64_tr_b16 a[20:21], v8 offset:20480
  v_cvt_pk_bf16_f32 v18, v112, v113
  v_mfma_f32_16x16x32_bf16 v[120:123], a[52:55], v[212:215], v[120:123]
  v_mfma_f32_16x16x32_bf16 v[120:123], a[56:59], v[216:219], v[120:123]
  ds_read_b64_tr_b16 a[22:23], v8 offset:22528
  v_cvt_pk_bf16_f32 v19, v114, v115
  v_mfma_f32_16x16x32_bf16 v[120:123], a[60:63], v[220:223], v[120:123]
  v_mfma_f32_16x16x32_bf16 v[124:127], a[32:35], v[224:227], 0
  ds_read_b64_tr_b16 a[24:25], v8 offset:24576
  v_mul_f32 v116, v116, v13
  v_mfma_f32_16x16x32_bf16 v[124:127], a[36:39], v[228:231], v[124:127]
  v_mul_f32 v117, v117, v13
  v_mul_f32 v118, v118, v13
  v_mfma_f32_16x16x32_bf16 v[124:127], a[40:43], v[232:235], v[124:127]
  s_add_u32 s69, s77, 3145728
  ds_read_b64_tr_b16 a[26:27], v8 offset:26624
  v_mul_f32 v119, v119, v13
  v_mfma_f32_16x16x32_bf16 v[124:127], a[44:47], v[236:239], v[124:127]
  buffer_store_dwordx4 v[16:19], v11, s[24:27], s69 offen
  v_mfma_f32_16x16x32_bf16 v[124:127], a[48:51], v[240:243], v[124:127]
  s_waitcnt lgkmcnt(8)
  ds_read_b64_tr_b16 a[28:29], v8 offset:28672
  v_cvt_pk_bf16_f32 v22, v116, v117
  v_mfma_f32_16x16x32_bf16 v[124:127], a[52:55], v[244:247], v[124:127]
  v_mfma_f32_16x16x32_bf16 v[124:127], a[56:59], v[248:251], v[124:127]
  ds_read_b64_tr_b16 a[30:31], v8 offset:30720
  v_cvt_pk_bf16_f32 v23, v118, v119
  v_mfma_f32_16x16x32_bf16 v[124:127], a[60:63], v[252:255], v[124:127]
  s_waitcnt lgkmcnt(12)
  v_mfma_f32_16x16x32_bf16 v[96:99], a[0:3], v[128:131], 0
  ds_read_b64_tr_b16 a[32:33], v9 offset:0
  v_mul_f32 v120, v120, v14
  v_mfma_f32_16x16x32_bf16 v[96:99], a[4:7], v[132:135], v[96:99]
  s_waitcnt lgkmcnt(9)
  v_mul_f32 v121, v121, v14
  v_mul_f32 v122, v122, v14
  v_mfma_f32_16x16x32_bf16 v[96:99], a[8:11], v[136:139], v[96:99]
  ds_read_b64_tr_b16 a[34:35], v9 offset:2048
  v_mul_f32 v123, v123, v14
  v_mfma_f32_16x16x32_bf16 v[96:99], a[12:15], v[140:143], v[96:99]
  s_waitcnt lgkmcnt(6)
  v_mfma_f32_16x16x32_bf16 v[96:99], a[16:19], v[144:147], v[96:99]
  ds_read_b64_tr_b16 a[36:37], v9 offset:4096
  v_cvt_pk_bf16_f32 v26, v120, v121
  v_mfma_f32_16x16x32_bf16 v[96:99], a[20:23], v[148:151], v[96:99]
  s_waitcnt lgkmcnt(3)
  v_mfma_f32_16x16x32_bf16 v[96:99], a[24:27], v[152:155], v[96:99]
  ds_read_b64_tr_b16 a[38:39], v9 offset:6144
  v_cvt_pk_bf16_f32 v27, v122, v123
  v_mfma_f32_16x16x32_bf16 v[96:99], a[28:31], v[156:159], v[96:99]
  v_mfma_f32_16x16x32_bf16 v[100:103], a[0:3], v[160:163], 0
  ds_read_b64_tr_b16 a[40:41], v9 offset:8192
  v_mul_f32 v124, v124, v15
  v_mfma_f32_16x16x32_bf16 v[100:103], a[4:7], v[164:167], v[100:103]
  v_mul_f32 v125, v125, v15
  v_mul_f32 v126, v126, v15
  v_mfma_f32_16x16x32_bf16 v[100:103], a[8:11], v[168:171], v[100:103]
  s_add_u32 s70, s77, 3178496
  ds_read_b64_tr_b16 a[42:43], v9 offset:10240
  v_mul_f32 v127, v127, v15
  v_mfma_f32_16x16x32_bf16 v[100:103], a[12:15], v[172:175], v[100:103]
  buffer_store_dwordx4 v[20:23], v11, s[24:27], s70 offen
  v_mfma_f32_16x16x32_bf16 v[100:103], a[16:19], v[176:179], v[100:103]
  ds_read_b64_tr_b16 a[44:45], v9 offset:12288
  v_cvt_pk_bf16_f32 v30, v124, v125
  v_mfma_f32_16x16x32_bf16 v[100:103], a[20:23], v[180:183], v[100:103]
  v_mfma_f32_16x16x32_bf16 v[100:103], a[24:27], v[184:187], v[100:103]
  ds_read_b64_tr_b16 a[46:47], v9 offset:14336
  v_cvt_pk_bf16_f32 v31, v126, v127
  v_mfma_f32_16x16x32_bf16 v[100:103], a[28:31], v[188:191], v[100:103]
  v_mfma_f32_16x16x32_bf16 v[104:107], a[0:3], v[192:195], 0
  ds_read_b64_tr_b16 a[48:49], v9 offset:16384
  v_mul_f32 v96, v96, v12
  v_mfma_f32_16x16x32_bf16 v[104:107], a[4:7], v[196:199], v[104:107]
  v_mul_f32 v97, v97, v12
  v_mul_f32 v98, v98, v12
  v_mfma_f32_16x16x32_bf16 v[104:107], a[8:11], v[200:203], v[104:107]
  ds_read_b64_tr_b16 a[50:51], v9 offset:18432
  v_mul_f32 v99, v99, v12
  v_mfma_f32_16x16x32_bf16 v[104:107], a[12:15], v[204:207], v[104:107]
  v_mfma_f32_16x16x32_bf16 v[104:107], a[16:19], v[208:211], v[104:107]
  ds_read_b64_tr_b16 a[52:53], v9 offset:20480
  v_cvt_pk_bf16_f32 v16, v96, v97
  v_mfma_f32_16x16x32_bf16 v[104:107], a[20:23], v[212:215], v[104:107]
  v_mfma_f32_16x16x32_bf16 v[104:107], a[24:27], v[216:219], v[104:107]
  ds_read_b64_tr_b16 a[54:55], v9 offset:22528
  v_cvt_pk_bf16_f32 v17, v98, v99
  v_mfma_f32_16x16x32_bf16 v[104:107], a[28:31], v[220:223], v[104:107]
  v_mfma_f32_16x16x32_bf16 v[108:111], a[0:3], v[224:227], 0
  ds_read_b64_tr_b16 a[56:57], v9 offset:24576
  v_mul_f32 v100, v100, v13
  v_mfma_f32_16x16x32_bf16 v[108:111], a[4:7], v[228:231], v[108:111]
  v_mul_f32 v101, v101, v13
  v_mul_f32 v102, v102, v13
  v_mfma_f32_16x16x32_bf16 v[108:111], a[8:11], v[232:235], v[108:111]
  s_add_u32 s69, s77, 3211264
  ds_read_b64_tr_b16 a[58:59], v9 offset:26624
  v_mul_f32 v103, v103, v13
  v_mfma_f32_16x16x32_bf16 v[108:111], a[12:15], v[236:239], v[108:111]
  buffer_store_dwordx4 v[24:27], v11, s[24:27], s69 offen
  v_mfma_f32_16x16x32_bf16 v[108:111], a[16:19], v[240:243], v[108:111]
  s_waitcnt lgkmcnt(8)
  ds_read_b64_tr_b16 a[60:61], v9 offset:28672
  v_cvt_pk_bf16_f32 v20, v100, v101
  v_mfma_f32_16x16x32_bf16 v[108:111], a[20:23], v[244:247], v[108:111]
  v_mfma_f32_16x16x32_bf16 v[108:111], a[24:27], v[248:251], v[108:111]
  ds_read_b64_tr_b16 a[62:63], v9 offset:30720
  v_cvt_pk_bf16_f32 v21, v102, v103
  v_mfma_f32_16x16x32_bf16 v[108:111], a[28:31], v[252:255], v[108:111]
  s_waitcnt lgkmcnt(12)
  v_mfma_f32_16x16x32_bf16 v[112:115], a[32:35], v[128:131], 0
  v_mul_f32 v104, v104, v14
  v_mfma_f32_16x16x32_bf16 v[112:115], a[36:39], v[132:135], v[112:115]
  s_waitcnt lgkmcnt(8)
  v_mul_f32 v105, v105, v14
  v_mul_f32 v106, v106, v14
  v_mfma_f32_16x16x32_bf16 v[112:115], a[40:43], v[136:139], v[112:115]
  s_add_u32 s70, s77, 3244032
  v_mul_f32 v107, v107, v14
  v_mfma_f32_16x16x32_bf16 v[112:115], a[44:47], v[140:143], v[112:115]
  s_waitcnt lgkmcnt(4)
  buffer_store_dwordx4 v[28:31], v11, s[24:27], s70 offen
  v_mfma_f32_16x16x32_bf16 v[112:115], a[48:51], v[144:147], v[112:115]
  v_cvt_pk_bf16_f32 v24, v104, v105
  v_mfma_f32_16x16x32_bf16 v[112:115], a[52:55], v[148:151], v[112:115]
  s_waitcnt lgkmcnt(0)
  v_mfma_f32_16x16x32_bf16 v[112:115], a[56:59], v[152:155], v[112:115]
  v_cvt_pk_bf16_f32 v25, v106, v107
  v_mfma_f32_16x16x32_bf16 v[112:115], a[60:63], v[156:159], v[112:115]
  v_mfma_f32_16x16x32_bf16 v[116:119], a[32:35], v[160:163], 0
  v_mul_f32 v108, v108, v15
  v_mfma_f32_16x16x32_bf16 v[116:119], a[36:39], v[164:167], v[116:119]
  v_mul_f32 v109, v109, v15
  v_mul_f32 v110, v110, v15
  v_mfma_f32_16x16x32_bf16 v[116:119], a[40:43], v[168:171], v[116:119]
  v_mul_f32 v111, v111, v15
  v_mfma_f32_16x16x32_bf16 v[116:119], a[44:47], v[172:175], v[116:119]
  v_mfma_f32_16x16x32_bf16 v[116:119], a[48:51], v[176:179], v[116:119]
  v_cvt_pk_bf16_f32 v28, v108, v109
  v_mfma_f32_16x16x32_bf16 v[116:119], a[52:55], v[180:183], v[116:119]
  v_mfma_f32_16x16x32_bf16 v[116:119], a[56:59], v[184:187], v[116:119]
  v_cvt_pk_bf16_f32 v29, v110, v111
  v_mfma_f32_16x16x32_bf16 v[116:119], a[60:63], v[188:191], v[116:119]
  v_mfma_f32_16x16x32_bf16 v[120:123], a[32:35], v[192:195], 0
  v_mul_f32 v112, v112, v12
  v_mfma_f32_16x16x32_bf16 v[120:123], a[36:39], v[196:199], v[120:123]
  v_mul_f32 v113, v113, v12
  v_mul_f32 v114, v114, v12
  v_mfma_f32_16x16x32_bf16 v[120:123], a[40:43], v[200:203], v[120:123]
  v_mul_f32 v115, v115, v12
  v_mfma_f32_16x16x32_bf16 v[120:123], a[44:47], v[204:207], v[120:123]
  v_mfma_f32_16x16x32_bf16 v[120:123], a[48:51], v[208:211], v[120:123]
  v_cvt_pk_bf16_f32 v18, v112, v113
  v_mfma_f32_16x16x32_bf16 v[120:123], a[52:55], v[212:215], v[120:123]
  v_mfma_f32_16x16x32_bf16 v[120:123], a[56:59], v[216:219], v[120:123]
  v_cvt_pk_bf16_f32 v19, v114, v115
  v_mfma_f32_16x16x32_bf16 v[120:123], a[60:63], v[220:223], v[120:123]
  v_mfma_f32_16x16x32_bf16 v[124:127], a[32:35], v[224:227], 0
  v_mul_f32 v116, v116, v13
  v_mfma_f32_16x16x32_bf16 v[124:127], a[36:39], v[228:231], v[124:127]
  v_mul_f32 v117, v117, v13
  v_mul_f32 v118, v118, v13
  v_mfma_f32_16x16x32_bf16 v[124:127], a[40:43], v[232:235], v[124:127]
  s_add_u32 s69, s77, 3146752
  v_mul_f32 v119, v119, v13
  v_mfma_f32_16x16x32_bf16 v[124:127], a[44:47], v[236:239], v[124:127]
  buffer_store_dwordx4 v[16:19], v11, s[24:27], s69 offen
  v_mfma_f32_16x16x32_bf16 v[124:127], a[48:51], v[240:243], v[124:127]
  v_cvt_pk_bf16_f32 v22, v116, v117
  v_mfma_f32_16x16x32_bf16 v[124:127], a[52:55], v[244:247], v[124:127]
  v_mfma_f32_16x16x32_bf16 v[124:127], a[56:59], v[248:251], v[124:127]
  v_cvt_pk_bf16_f32 v23, v118, v119
  v_mfma_f32_16x16x32_bf16 v[124:127], a[60:63], v[252:255], v[124:127]
  s_nop 7
  s_add_u32 s70, s77, 3179520
  s_nop 1
  buffer_store_dwordx4 v[20:23], v11, s[24:27], s70 offen
  v_mul_f32 v120, v120, v14
  v_mul_f32 v121, v121, v14
  v_mul_f32 v122, v122, v14
  v_mul_f32 v123, v123, v14
  v_cvt_pk_bf16_f32 v26, v120, v121
  v_cvt_pk_bf16_f32 v27, v122, v123
  s_add_u32 s69, s77, 3212288
  s_nop 1
  buffer_store_dwordx4 v[24:27], v11, s[24:27], s69 offen
  v_mul_f32 v124, v124, v15
  v_mul_f32 v125, v125, v15
  v_mul_f32 v126, v126, v15
  v_mul_f32 v127, v127, v15
  v_cvt_pk_bf16_f32 v30, v124, v125
  v_cvt_pk_bf16_f32 v31, v126, v127
  s_add_u32 s70, s77, 3245056
  s_nop 1
  buffer_store_dwordx4 v[28:31], v11, s[24:27], s70 offen
  s_waitcnt vmcnt(0)
  s_barrier
  buffer_wbl2 sc1
  s_waitcnt vmcnt(0)
  s_barrier
  buffer_store_byte v34, v35, s[40:43], s47 offen sc1
  s_waitcnt vmcnt(0)
  s_mov_b32 s62, 524288
L_far_poll:
  s_sub_u32 s62, s62, 1
  s_cmp_eq_u32 s62, 0
  s_cbranch_scc1 L_far_done
  v_mov_b32 v33, 0
  v_cmp_gt_u32 vcc, 4, v0
  s_and_saveexec_b64 s[54:55], vcc
  buffer_atomic_add v33, v38, s[40:43], 0 offen sc0 sc1
  s_waitcnt vmcnt(0)
  s_mov_b64 exec, s[54:55]
  v_and_b32 v33, 0xf0f0f0f0, v33
  v_cmp_eq_u32 vcc, 0xf0f0f0f0, v33
  s_nop 0
  s_and_b64 s[52:53], vcc, 15
  s_cmp_eq_u64 s[52:53], 15
  s_cbranch_scc0 L_far_poll
L_far_done:
  buffer_inv sc1
  s_waitcnt vmcnt(0)
  s_add_u32 s52, s46, 0
  buffer_load_dwordx4 a[0:3], v36, s[24:27], s52 offen sc1
  s_add_u32 s53, s46, 4096
  buffer_load_dwordx4 a[4:7], v36, s[24:27], s53 offen sc1
  s_add_u32 s52, s46, 8192
  buffer_load_dwordx4 a[8:11], v36, s[24:27], s52 offen sc1
  s_add_u32 s53, s46, 12288
  buffer_load_dwordx4 a[12:15], v36, s[24:27], s53 offen sc1
  s_add_u32 s52, s46, 16384
  buffer_load_dwordx4 a[16:19], v36, s[24:27], s52 offen sc1
  s_add_u32 s53, s46, 20480
  buffer_load_dwordx4 a[20:23], v36, s[24:27], s53 offen sc1
  s_add_u32 s52, s46, 24576
  buffer_load_dwordx4 a[24:27], v36, s[24:27], s52 offen sc1
  s_add_u32 s53, s46, 28672
  buffer_load_dwordx4 a[28:31], v36, s[24:27], s53 offen sc1
  s_add_u32 s52, s46, 524288
  buffer_load_dwordx4 a[32:35], v36, s[24:27], s52 offen sc1
  s_add_u32 s53, s46, 528384
  buffer_load_dwordx4 a[36:39], v36, s[24:27], s53 offen sc1
  s_add_u32 s52, s46, 532480
  buffer_load_dwordx4 a[40:43], v36, s[24:27], s52 offen sc1
  s_add_u32 s53, s46, 536576
  buffer_load_dwordx4 a[44:47], v36, s[24:27], s53 offen sc1
  s_add_u32 s52, s46, 540672
  buffer_load_dwordx4 a[48:51], v36, s[24:27], s52 offen sc1
  s_add_u32 s53, s46, 544768
  buffer_load_dwordx4 a[52:55], v36, s[24:27], s53 offen sc1
  s_add_u32 s52, s46, 548864
  buffer_load_dwordx4 a[56:59], v36, s[24:27], s52 offen sc1
  s_add_u32 s53, s46, 552960
  buffer_load_dwordx4 a[60:63], v36, s[24:27], s53 offen sc1
  s_add_u32 s52, s46, 1048576
  buffer_load_dwordx4 a[64:67], v36, s[24:27], s52 offen sc1
  s_add_u32 s53, s46, 1052672
  buffer_load_dwordx4 a[68:71], v36, s[24:27], s53 offen sc1
  s_add_u32 s52, s46, 1056768
  buffer_load_dwordx4 a[72:75], v36, s[24:27], s52 offen sc1
  s_add_u32 s53, s46, 1060864
  buffer_load_dwordx4 a[76:79], v36, s[24:27], s53 offen sc1
  s_add_u32 s52, s46, 1064960
  buffer_load_dwordx4 a[80:83], v36, s[24:27], s52 offen sc1
  s_add_u32 s53, s46, 1069056
  buffer_load_dwordx4 a[84:87], v36, s[24:27], s53 offen sc1
  s_add_u32 s52, s46, 1073152
  buffer_load_dwordx4 a[88:91], v36, s[24:27], s52 offen sc1
  s_add_u32 s53, s46, 1077248
  buffer_load_dwordx4 a[92:95], v36, s[24:27], s53 offen sc1
  s_add_u32 s52, s46, 1572864
  buffer_load_dwordx4 a[96:99], v36, s[24:27], s52 offen sc1
  s_add_u32 s53, s46, 1576960
  buffer_load_dwordx4 a[100:103], v36, s[24:27], s53 offen sc1
  s_add_u32 s52, s46, 1581056
  buffer_load_dwordx4 a[104:107], v36, s[24:27], s52 offen sc1
  s_add_u32 s53, s46, 1585152
  buffer_load_dwordx4 a[108:111], v36, s[24:27], s53 offen sc1
  s_add_u32 s52, s46, 1589248
  buffer_load_dwordx4 a[112:115], v36, s[24:27], s52 offen sc1
  s_add_u32 s53, s46, 1593344
  buffer_load_dwordx4 a[116:119], v36, s[24:27], s53 offen sc1
  s_add_u32 s52, s46, 1597440
  buffer_load_dwordx4 a[120:123], v36, s[24:27], s52 offen sc1
  s_add_u32 s53, s46, 1601536
  buffer_load_dwordx4 a[124:127], v36, s[24:27], s53 offen sc1
  s_add_u32 s52, s46, 2097152
  buffer_load_dwordx4 a[128:131], v36, s[24:27], s52 offen sc1
  s_add_u32 s53, s46, 2101248
  buffer_load_dwordx4 a[132:135], v36, s[24:27], s53 offen sc1
  s_add_u32 s52, s46, 2105344
  buffer_load_dwordx4 a[136:139], v36, s[24:27], s52 offen sc1
  s_add_u32 s53, s46, 2109440
  buffer_load_dwordx4 a[140:143], v36, s[24:27], s53 offen sc1
  s_add_u32 s52, s46, 2113536
  buffer_load_dwordx4 a[144:147], v36, s[24:27], s52 offen sc1
  s_add_u32 s53, s46, 2117632
  buffer_load_dwordx4 a[148:151], v36, s[24:27], s53 offen sc1
  s_add_u32 s52, s46, 2121728
  buffer_load_dwordx4 a[152:155], v36, s[24:27], s52 offen sc1
  s_add_u32 s53, s46, 2125824
  buffer_load_dwordx4 a[156:159], v36, s[24:27], s53 offen sc1
  s_add_u32 s52, s46, 2621440
  buffer_load_dwordx4 a[160:163], v36, s[24:27], s52 offen sc1
  s_add_u32 s53, s46, 2625536
  buffer_load_dwordx4 a[164:167], v36, s[24:27], s53 offen sc1
  s_add_u32 s52, s46, 2629632
  buffer_load_dwordx4 a[168:171], v36, s[24:27], s52 offen sc1
  s_add_u32 s53, s46, 2633728
  buffer_load_dwordx4 a[172:175], v36, s[24:27], s53 offen sc1
  s_add_u32 s52, s46, 2637824
  buffer_load_dwordx4 a[176:179], v36, s[24:27], s52 offen sc1
  s_add_u32 s53, s46, 2641920
  buffer_load_dwordx4 a[180:183], v36, s[24:27], s53 offen sc1
  s_add_u32 s52, s46, 2646016
  buffer_load_dwordx4 a[184:187], v36, s[24:27], s52 offen sc1
  s_add_u32 s53, s46, 2650112
  buffer_load_dwordx4 a[188:191], v36, s[24:27], s53 offen sc1
  s_add_u32 s52, s46, 3145728
  buffer_load_dwordx4 a[192:195], v36, s[24:27], s52 offen sc1
  s_add_u32 s53, s46, 3149824
  buffer_load_dwordx4 a[196:199], v36, s[24:27], s53 offen sc1
  s_add_u32 s52, s46, 3153920
  buffer_load_dwordx4 a[200:203], v36, s[24:27], s52 offen sc1
  s_add_u32 s53, s46, 3158016
  buffer_load_dwordx4 a[204:207], v36, s[24:27], s53 offen sc1
  s_add_u32 s52, s46, 3162112
  buffer_load_dwordx4 a[208:211], v36, s[24:27], s52 offen sc1
  s_add_u32 s53, s46, 3166208
  buffer_load_dwordx4 a[212:215], v36, s[24:27], s53 offen sc1
  s_add_u32 s52, s46, 3170304
  buffer_load_dwordx4 a[216:219], v36, s[24:27], s52 offen sc1
  s_add_u32 s53, s46, 3174400
  buffer_load_dwordx4 a[220:223], v36, s[24:27], s53 offen sc1
  s_waitcnt vmcnt(48)
  v_mfma_f32_16x16x32_bf16 v[40:43], a[224:227], a[0:3], 0
  v_mfma_f32_16x16x32_bf16 v[40:43], a[224:227], a[4:7], v[40:43]
  v_mfma_f32_16x16x32_bf16 v[40:43], a[224:227], a[8:11], v[40:43]
  v_mfma_f32_16x16x32_bf16 v[40:43], a[224:227], a[12:15], v[40:43]
  v_mfma_f32_16x16x32_bf16 v[40:43], a[224:227], a[16:19], v[40:43]
  v_mfma_f32_16x16x32_bf16 v[40:43], a[224:227], a[20:23], v[40:43]
  v_mfma_f32_16x16x32_bf16 v[40:43], a[224:227], a[24:27], v[40:43]
  v_mfma_f32_16x16x32_bf16 v[40:43], a[224:227], a[28:31], v[40:43]
  s_waitcnt vmcnt(40)
  v_mfma_f32_16x16x32_bf16 v[44:47], a[224:227], a[32:35], 0
  v_mfma_f32_16x16x32_bf16 v[44:47], a[224:227], a[36:39], v[44:47]
  v_mfma_f32_16x16x32_bf16 v[44:47], a[224:227], a[40:43], v[44:47]
  v_mfma_f32_16x16x32_bf16 v[44:47], a[224:227], a[44:47], v[44:47]
  v_mfma_f32_16x16x32_bf16 v[44:47], a[224:227], a[48:51], v[44:47]
  v_mfma_f32_16x16x32_bf16 v[44:47], a[224:227], a[52:55], v[44:47]
  v_mfma_f32_16x16x32_bf16 v[44:47], a[224:227], a[56:59], v[44:47]
  v_mfma_f32_16x16x32_bf16 v[44:47], a[224:227], a[60:63], v[44:47]
  v_cvt_pk_bf16_f32 v40, v40, v41
  v_cvt_pk_bf16_f32 v41, v42, v43
  buffer_store_dwordx2 v[40:41], v37, s[28:31], 0 offen
  s_waitcnt vmcnt(33)
  v_mfma_f32_16x16x32_bf16 v[40:43], a[224:227], a[64:67], 0
  v_mfma_f32_16x16x32_bf16 v[40:43], a[224:227], a[68:71], v[40:43]
  v_mfma_f32_16x16x32_bf16 v[40:43], a[224:227], a[72:75], v[40:43]
  v_mfma_f32_16x16x32_bf16 v[40:43], a[224:227], a[76:79], v[40:43]
  v_mfma_f32_16x16x32_bf16 v[40:43], a[224:227], a[80:83], v[40:43]
  v_mfma_f32_16x16x32_bf16 v[40:43], a[224:227], a[84:87], v[40:43]
  v_mfma_f32_16x16x32_bf16 v[40:43], a[224:227], a[88:91], v[40:43]
  v_mfma_f32_16x16x32_bf16 v[40:43], a[224:227], a[92:95], v[40:43]
  v_cvt_pk_bf16_f32 v44, v44, v45
  v_cvt_pk_bf16_f32 v45, v46, v47
  buffer_store_dwordx2 v[44:45], v37, s[28:31], 0 offen offset:128
  s_waitcnt vmcnt(26)
  v_mfma_f32_16x16x32_bf16 v[44:47], a[224:227], a[96:99], 0
  v_mfma_f32_16x16x32_bf16 v[44:47], a[224:227], a[100:103], v[44:47]
  v_mfma_f32_16x16x32_bf16 v[44:47], a[224:227], a[104:107], v[44:47]
  v_mfma_f32_16x16x32_bf16 v[44:47], a[224:227], a[108:111], v[44:47]
  v_mfma_f32_16x16x32_bf16 v[44:47], a[224:227], a[112:115], v[44:47]
  v_mfma_f32_16x16x32_bf16 v[44:47], a[224:227], a[116:119], v[44:47]
  v_mfma_f32_16x16x32_bf16 v[44:47], a[224:227], a[120:123], v[44:47]
  v_mfma_f32_16x16x32_bf16 v[44:47], a[224:227], a[124:127], v[44:47]
  v_cvt_pk_bf16_f32 v40, v40, v41
  v_cvt_pk_bf16_f32 v41, v42, v43
  buffer_store_dwordx2 v[40:41], v37, s[28:31], 0 offen offset:256
  s_waitcnt vmcnt(19)
  v_mfma_f32_16x16x32_bf16 v[40:43], a[224:227], a[128:131], 0
  v_mfma_f32_16x16x32_bf16 v[40:43], a[224:227], a[132:135], v[40:43]
  v_mfma_f32_16x16x32_bf16 v[40:43], a[224:227], a[136:139], v[40:43]
  v_mfma_f32_16x16x32_bf16 v[40:43], a[224:227], a[140:143], v[40:43]
  v_mfma_f32_16x16x32_bf16 v[40:43], a[224:227], a[144:147], v[40:43]
  v_mfma_f32_16x16x32_bf16 v[40:43], a[224:227], a[148:151], v[40:43]
  v_mfma_f32_16x16x32_bf16 v[40:43], a[224:227], a[152:155], v[40:43]
  v_mfma_f32_16x16x32_bf16 v[40:43], a[224:227], a[156:159], v[40:43]
  v_cvt_pk_bf16_f32 v44, v44, v45
  v_cvt_pk_bf16_f32 v45, v46, v47
  buffer_store_dwordx2 v[44:45], v37, s[28:31], 0 offen offset:384
  s_waitcnt vmcnt(12)
  v_mfma_f32_16x16x32_bf16 v[44:47], a[224:227], a[160:163], 0
  v_mfma_f32_16x16x32_bf16 v[44:47], a[224:227], a[164:167], v[44:47]
  v_mfma_f32_16x16x32_bf16 v[44:47], a[224:227], a[168:171], v[44:47]
  v_mfma_f32_16x16x32_bf16 v[44:47], a[224:227], a[172:175], v[44:47]
  v_mfma_f32_16x16x32_bf16 v[44:47], a[224:227], a[176:179], v[44:47]
  v_mfma_f32_16x16x32_bf16 v[44:47], a[224:227], a[180:183], v[44:47]
  v_mfma_f32_16x16x32_bf16 v[44:47], a[224:227], a[184:187], v[44:47]
  v_mfma_f32_16x16x32_bf16 v[44:47], a[224:227], a[188:191], v[44:47]
  v_cvt_pk_bf16_f32 v40, v40, v41
  v_cvt_pk_bf16_f32 v41, v42, v43
  buffer_store_dwordx2 v[40:41], v37, s[28:31], 0 offen offset:512
  s_waitcnt vmcnt(5)
  v_mfma_f32_16x16x32_bf16 v[40:43], a[224:227], a[192:195], 0
  v_mfma_f32_16x16x32_bf16 v[40:43], a[224:227], a[196:199], v[40:43]
  v_mfma_f32_16x16x32_bf16 v[40:43], a[224:227], a[200:203], v[40:43]
  v_mfma_f32_16x16x32_bf16 v[40:43], a[224:227], a[204:207], v[40:43]
  v_mfma_f32_16x16x32_bf16 v[40:43], a[224:227], a[208:211], v[40:43]
  v_mfma_f32_16x16x32_bf16 v[40:43], a[224:227], a[212:215], v[40:43]
  v_mfma_f32_16x16x32_bf16 v[40:43], a[224:227], a[216:219], v[40:43]
  v_mfma_f32_16x16x32_bf16 v[40:43], a[224:227], a[220:223], v[40:43]
  v_cvt_pk_bf16_f32 v44, v44, v45
  v_cvt_pk_bf16_f32 v45, v46, v47
  buffer_store_dwordx2 v[44:45], v37, s[28:31], 0 offen offset:640
  s_nop 7
  v_cvt_pk_bf16_f32 v40, v40, v41
  v_cvt_pk_bf16_f32 v41, v42, v43
  buffer_store_dwordx2 v[40:41], v37, s[28:31], 0 offen offset:768
  s_waitcnt vmcnt(0)
  s_endpgm
L_safe_attn:
  s_waitcnt vmcnt(0)
  s_waitcnt lgkmcnt(0)
  s_barrier
  v_accvgpr_write_b32 a0, 0
  v_accvgpr_write_b32 a1, 0
  v_accvgpr_write_b32 a2, 0
  v_accvgpr_write_b32 a3, 0
  v_accvgpr_write_b32 a4, 0
  v_accvgpr_write_b32 a5, 0
  v_accvgpr_write_b32 a6, 0
  v_accvgpr_write_b32 a7, 0
  v_accvgpr_write_b32 a8, 0
  v_accvgpr_write_b32 a9, 0
  v_accvgpr_write_b32 a10, 0
  v_accvgpr_write_b32 a11, 0
  v_accvgpr_write_b32 a12, 0
  v_accvgpr_write_b32 a13, 0
  v_accvgpr_write_b32 a14, 0
  v_accvgpr_write_b32 a15, 0
  v_accvgpr_write_b32 a16, 0
  v_accvgpr_write_b32 a17, 0
  v_accvgpr_write_b32 a18, 0
  v_accvgpr_write_b32 a19, 0
  v_accvgpr_write_b32 a20, 0
  v_accvgpr_write_b32 a21, 0
  v_accvgpr_write_b32 a22, 0
  v_accvgpr_write_b32 a23, 0
  v_accvgpr_write_b32 a24, 0
  v_accvgpr_write_b32 a25, 0
  v_accvgpr_write_b32 a26, 0
  v_accvgpr_write_b32 a27, 0
  v_accvgpr_write_b32 a28, 0
  v_accvgpr_write_b32 a29, 0
  v_accvgpr_write_b32 a30, 0
  v_accvgpr_write_b32 a31, 0
  v_accvgpr_write_b32 a32, 0
  v_accvgpr_write_b32 a33, 0
  v_accvgpr_write_b32 a34, 0
  v_accvgpr_write_b32 a35, 0
  v_accvgpr_write_b32 a36, 0
  v_accvgpr_write_b32 a37, 0
  v_accvgpr_write_b32 a38, 0
  v_accvgpr_write_b32 a39, 0
  v_accvgpr_write_b32 a40, 0
  v_accvgpr_write_b32 a41, 0
  v_accvgpr_write_b32 a42, 0
  v_accvgpr_write_b32 a43, 0
  v_accvgpr_write_b32 a44, 0
  v_accvgpr_write_b32 a45, 0
  v_accvgpr_write_b32 a46, 0
  v_accvgpr_write_b32 a47, 0
  v_accvgpr_write_b32 a48, 0
  v_accvgpr_write_b32 a49, 0
  v_accvgpr_write_b32 a50, 0
  v_accvgpr_write_b32 a51, 0
  v_accvgpr_write_b32 a52, 0
  v_accvgpr_write_b32 a53, 0
  v_accvgpr_write_b32 a54, 0
  v_accvgpr_write_b32 a55, 0
  v_accvgpr_write_b32 a56, 0
  v_accvgpr_write_b32 a57, 0
  v_accvgpr_write_b32 a58, 0
  v_accvgpr_write_b32 a59, 0
  v_accvgpr_write_b32 a60, 0
  v_accvgpr_write_b32 a61, 0
  v_accvgpr_write_b32 a62, 0
  v_accvgpr_write_b32 a63, 0
  v_accvgpr_write_b32 a64, 0
  v_accvgpr_write_b32 a65, 0
  v_accvgpr_write_b32 a66, 0
  v_accvgpr_write_b32 a67, 0
  v_accvgpr_write_b32 a68, 0
  v_accvgpr_write_b32 a69, 0
  v_accvgpr_write_b32 a70, 0
  v_accvgpr_write_b32 a71, 0
  v_accvgpr_write_b32 a72, 0
  v_accvgpr_write_b32 a73, 0
  v_accvgpr_write_b32 a74, 0
  v_accvgpr_write_b32 a75, 0
  v_accvgpr_write_b32 a76, 0
  v_accvgpr_write_b32 a77, 0
  v_accvgpr_write_b32 a78, 0
  v_accvgpr_write_b32 a79, 0
  v_accvgpr_write_b32 a80, 0
  v_accvgpr_write_b32 a81, 0
  v_accvgpr_write_b32 a82, 0
  v_accvgpr_write_b32 a83, 0
  v_accvgpr_write_b32 a84, 0
  v_accvgpr_write_b32 a85, 0
  v_accvgpr_write_b32 a86, 0
  v_accvgpr_write_b32 a87, 0
  v_accvgpr_write_b32 a88, 0
  v_accvgpr_write_b32 a89, 0
  v_accvgpr_write_b32 a90, 0
  v_accvgpr_write_b32 a91, 0
  v_accvgpr_write_b32 a92, 0
  v_accvgpr_write_b32 a93, 0
  v_accvgpr_write_b32 a94, 0
  v_accvgpr_write_b32 a95, 0
  v_accvgpr_write_b32 a96, 0
  v_accvgpr_write_b32 a97, 0
  v_accvgpr_write_b32 a98, 0
  v_accvgpr_write_b32 a99, 0
  v_accvgpr_write_b32 a100, 0
  v_accvgpr_write_b32 a101, 0
  v_accvgpr_write_b32 a102, 0
  v_accvgpr_write_b32 a103, 0
  v_accvgpr_write_b32 a104, 0
  v_accvgpr_write_b32 a105, 0
  v_accvgpr_write_b32 a106, 0
  v_accvgpr_write_b32 a107, 0
  v_accvgpr_write_b32 a108, 0
  v_accvgpr_write_b32 a109, 0
  v_accvgpr_write_b32 a110, 0
  v_accvgpr_write_b32 a111, 0
  v_accvgpr_write_b32 a112, 0
  v_accvgpr_write_b32 a113, 0
  v_accvgpr_write_b32 a114, 0
  v_accvgpr_write_b32 a115, 0
  v_accvgpr_write_b32 a116, 0
  v_accvgpr_write_b32 a117, 0
  v_accvgpr_write_b32 a118, 0
  v_accvgpr_write_b32 a119, 0
  v_accvgpr_write_b32 a120, 0
  v_accvgpr_write_b32 a121, 0
  v_accvgpr_write_b32 a122, 0
  v_accvgpr_write_b32 a123, 0
  v_accvgpr_write_b32 a124, 0
  v_accvgpr_write_b32 a125, 0
  v_accvgpr_write_b32 a126, 0
  v_accvgpr_write_b32 a127, 0
  v_accvgpr_write_b32 a128, 0
  v_accvgpr_write_b32 a129, 0
  v_accvgpr_write_b32 a130, 0
  v_accvgpr_write_b32 a131, 0
  v_accvgpr_write_b32 a132, 0
  v_accvgpr_write_b32 a133, 0
  v_accvgpr_write_b32 a134, 0
  v_accvgpr_write_b32 a135, 0
  v_accvgpr_write_b32 a136, 0
  v_accvgpr_write_b32 a137, 0
  v_accvgpr_write_b32 a138, 0
  v_accvgpr_write_b32 a139, 0
  v_accvgpr_write_b32 a140, 0
  v_accvgpr_write_b32 a141, 0
  v_accvgpr_write_b32 a142, 0
  v_accvgpr_write_b32 a143, 0
  v_accvgpr_write_b32 a144, 0
  v_accvgpr_write_b32 a145, 0
  v_accvgpr_write_b32 a146, 0
  v_accvgpr_write_b32 a147, 0
  v_accvgpr_write_b32 a148, 0
  v_accvgpr_write_b32 a149, 0
  v_accvgpr_write_b32 a150, 0
  v_accvgpr_write_b32 a151, 0
  v_accvgpr_write_b32 a152, 0
  v_accvgpr_write_b32 a153, 0
  v_accvgpr_write_b32 a154, 0
  v_accvgpr_write_b32 a155, 0
  v_accvgpr_write_b32 a156, 0
  v_accvgpr_write_b32 a157, 0
  v_accvgpr_write_b32 a158, 0
  v_accvgpr_write_b32 a159, 0
  v_accvgpr_write_b32 a160, 0
  v_accvgpr_write_b32 a161, 0
  v_accvgpr_write_b32 a162, 0
  v_accvgpr_write_b32 a163, 0
  v_accvgpr_write_b32 a164, 0
  v_accvgpr_write_b32 a165, 0
  v_accvgpr_write_b32 a166, 0
  v_accvgpr_write_b32 a167, 0
  v_accvgpr_write_b32 a168, 0
  v_accvgpr_write_b32 a169, 0
  v_accvgpr_write_b32 a170, 0
  v_accvgpr_write_b32 a171, 0
  v_accvgpr_write_b32 a172, 0
  v_accvgpr_write_b32 a173, 0
  v_accvgpr_write_b32 a174, 0
  v_accvgpr_write_b32 a175, 0
  v_accvgpr_write_b32 a176, 0
  v_accvgpr_write_b32 a177, 0
  v_accvgpr_write_b32 a178, 0
  v_accvgpr_write_b32 a179, 0
  v_accvgpr_write_b32 a180, 0
  v_accvgpr_write_b32 a181, 0
  v_accvgpr_write_b32 a182, 0
  v_accvgpr_write_b32 a183, 0
  v_accvgpr_write_b32 a184, 0
  v_accvgpr_write_b32 a185, 0
  v_accvgpr_write_b32 a186, 0
  v_accvgpr_write_b32 a187, 0
  v_accvgpr_write_b32 a188, 0
  v_accvgpr_write_b32 a189, 0
  v_accvgpr_write_b32 a190, 0
  v_accvgpr_write_b32 a191, 0
  v_accvgpr_write_b32 a192, 0
  v_accvgpr_write_b32 a193, 0
  v_accvgpr_write_b32 a194, 0
  v_accvgpr_write_b32 a195, 0
  v_accvgpr_write_b32 a196, 0
  v_accvgpr_write_b32 a197, 0
  v_accvgpr_write_b32 a198, 0
  v_accvgpr_write_b32 a199, 0
  v_accvgpr_write_b32 a200, 0
  v_accvgpr_write_b32 a201, 0
  v_accvgpr_write_b32 a202, 0
  v_accvgpr_write_b32 a203, 0
  v_accvgpr_write_b32 a204, 0
  v_accvgpr_write_b32 a205, 0
  v_accvgpr_write_b32 a206, 0
  v_accvgpr_write_b32 a207, 0
  v_accvgpr_write_b32 a208, 0
  v_accvgpr_write_b32 a209, 0
  v_accvgpr_write_b32 a210, 0
  v_accvgpr_write_b32 a211, 0
  v_accvgpr_write_b32 a212, 0
  v_accvgpr_write_b32 a213, 0
  v_accvgpr_write_b32 a214, 0
  v_accvgpr_write_b32 a215, 0
  v_accvgpr_write_b32 a216, 0
  v_accvgpr_write_b32 a217, 0
  v_accvgpr_write_b32 a218, 0
  v_accvgpr_write_b32 a219, 0
  v_accvgpr_write_b32 a220, 0
  v_accvgpr_write_b32 a221, 0
  v_accvgpr_write_b32 a222, 0
  v_accvgpr_write_b32 a223, 0
  v_accvgpr_write_b32 a224, 0
  v_accvgpr_write_b32 a225, 0
  v_accvgpr_write_b32 a226, 0
  v_accvgpr_write_b32 a227, 0
  v_accvgpr_write_b32 a228, 0
  v_accvgpr_write_b32 a229, 0
  v_accvgpr_write_b32 a230, 0
  v_accvgpr_write_b32 a231, 0
  v_accvgpr_write_b32 a232, 0
  v_accvgpr_write_b32 a233, 0
  v_accvgpr_write_b32 a234, 0
  v_accvgpr_write_b32 a235, 0
  v_accvgpr_write_b32 a236, 0
  v_accvgpr_write_b32 a237, 0
  v_accvgpr_write_b32 a238, 0
  v_accvgpr_write_b32 a239, 0
  v_accvgpr_write_b32 a240, 0
  v_accvgpr_write_b32 a241, 0
  v_accvgpr_write_b32 a242, 0
  v_accvgpr_write_b32 a243, 0
  v_accvgpr_write_b32 a244, 0
  v_accvgpr_write_b32 a245, 0
  v_accvgpr_write_b32 a246, 0
  v_accvgpr_write_b32 a247, 0
  v_accvgpr_write_b32 a248, 0
  v_accvgpr_write_b32 a249, 0
  v_accvgpr_write_b32 a250, 0
  v_accvgpr_write_b32 a251, 0
  v_accvgpr_write_b32 a252, 0
  v_accvgpr_write_b32 a253, 0
  v_accvgpr_write_b32 a254, 0
  v_accvgpr_write_b32 a255, 0
  v_mov_b32 v20, 0xff800000
  v_mov_b32 v12, 0
  v_mov_b32 v21, 0xff800000
  v_mov_b32 v13, 0
  v_mov_b32 v22, 0xff800000
  v_mov_b32 v14, 0
  v_mov_b32 v23, 0xff800000
  v_mov_b32 v15, 0
  s_mov_b32 s64, 0
  s_mov_b32 s66, 32
L_safe_loop:
  s_add_u32 m0, s33, 0
  s_nop 0
  buffer_load_dwordx4 v10, s[12:15], s64 offen nt lds
  s_add_u32 m0, s33, 3968
  s_nop 0
  buffer_load_dwordx4 v10, s[12:15], s64 offen offset:128 nt lds
  s_add_u32 m0, s33, 7936
  s_nop 0
  buffer_load_dwordx4 v10, s[12:15], s64 offen offset:256 nt lds
  s_add_u32 m0, s33, 11904
  s_nop 0
  buffer_load_dwordx4 v10, s[12:15], s64 offen offset:384 nt lds
  s_add_u32 m0, s33, 65536
  s_nop 0
  buffer_load_dwordx4 v11, s[16:19], s64 offen nt lds
  s_add_u32 m0, s33, 69504
  s_nop 0
  buffer_load_dwordx4 v11, s[16:19], s64 offen offset:128 nt lds
  s_add_u32 m0, s33, 73472
  s_nop 0
  buffer_load_dwordx4 v11, s[16:19], s64 offen offset:256 nt lds
  s_add_u32 m0, s33, 77440
  s_nop 0
  buffer_load_dwordx4 v11, s[16:19], s64 offen offset:384 nt lds
  s_waitcnt vmcnt(0)
  s_barrier
  ds_read_b128 v[32:35], v4 offset:0
  ds_read_b128 v[36:39], v5 offset:0
  ds_read_b128 v[40:43], v4 offset:4096
  ds_read_b128 v[44:47], v5 offset:4096
  ds_read_b128 v[48:51], v4 offset:8192
  ds_read_b128 v[52:55], v5 offset:8192
  ds_read_b128 v[56:59], v4 offset:12288
  ds_read_b128 v[60:63], v5 offset:12288
  s_waitcnt lgkmcnt(0)
  v_mfma_f32_16x16x32_bf16 v[64:67], v[32:35], v[128:131], 0
  v_mfma_f32_16x16x32_bf16 v[64:67], v[36:39], v[132:135], v[64:67]
  v_mfma_f32_16x16x32_bf16 v[68:71], v[32:35], v[160:163], 0
  v_mfma_f32_16x16x32_bf16 v[68:71], v[36:39], v[164:167], v[68:71]
  v_mfma_f32_16x16x32_bf16 v[72:75], v[32:35], v[192:195], 0
  v_mfma_f32_16x16x32_bf16 v[72:75], v[36:39], v[196:199], v[72:75]
  v_mfma_f32_16x16x32_bf16 v[76:79], v[32:35], v[224:227], 0
  v_mfma_f32_16x16x32_bf16 v[76:79], v[36:39], v[228:231], v[76:79]
  v_mfma_f32_16x16x32_bf16 v[64:67], v[40:43], v[136:139], v[64:67]
  v_mfma_f32_16x16x32_bf16 v[64:67], v[44:47], v[140:143], v[64:67]
  v_mfma_f32_16x16x32_bf16 v[68:71], v[40:43], v[168:171], v[68:71]
  v_mfma_f32_16x16x32_bf16 v[68:71], v[44:47], v[172:175], v[68:71]
  v_mfma_f32_16x16x32_bf16 v[72:75], v[40:43], v[200:203], v[72:75]
  v_mfma_f32_16x16x32_bf16 v[72:75], v[44:47], v[204:207], v[72:75]
  v_mfma_f32_16x16x32_bf16 v[76:79], v[40:43], v[232:235], v[76:79]
  v_mfma_f32_16x16x32_bf16 v[76:79], v[44:47], v[236:239], v[76:79]
  v_mfma_f32_16x16x32_bf16 v[64:67], v[48:51], v[144:147], v[64:67]
  v_mfma_f32_16x16x32_bf16 v[64:67], v[52:55], v[148:151], v[64:67]
  v_mfma_f32_16x16x32_bf16 v[68:71], v[48:51], v[176:179], v[68:71]
  v_mfma_f32_16x16x32_bf16 v[68:71], v[52:55], v[180:183], v[68:71]
  v_mfma_f32_16x16x32_bf16 v[72:75], v[48:51], v[208:211], v[72:75]
  v_mfma_f32_16x16x32_bf16 v[72:75], v[52:55], v[212:215], v[72:75]
  v_mfma_f32_16x16x32_bf16 v[76:79], v[48:51], v[240:243], v[76:79]
  v_mfma_f32_16x16x32_bf16 v[76:79], v[52:55], v[244:247], v[76:79]
  v_mfma_f32_16x16x32_bf16 v[64:67], v[56:59], v[152:155], v[64:67]
  v_mfma_f32_16x16x32_bf16 v[64:67], v[60:63], v[156:159], v[64:67]
  v_mfma_f32_16x16x32_bf16 v[68:71], v[56:59], v[184:187], v[68:71]
  v_mfma_f32_16x16x32_bf16 v[68:71], v[60:63], v[188:191], v[68:71]
  v_mfma_f32_16x16x32_bf16 v[72:75], v[56:59], v[216:219], v[72:75]
  v_mfma_f32_16x16x32_bf16 v[72:75], v[60:63], v[220:223], v[72:75]
  v_mfma_f32_16x16x32_bf16 v[76:79], v[56:59], v[248:251], v[76:79]
  v_mfma_f32_16x16x32_bf16 v[76:79], v[60:63], v[252:255], v[76:79]
  ds_read_b128 v[32:35], v4 offset:2048
  ds_read_b128 v[36:39], v5 offset:2048
  ds_read_b128 v[40:43], v4 offset:6144
  ds_read_b128 v[44:47], v5 offset:6144
  ds_read_b128 v[48:51], v4 offset:10240
  ds_read_b128 v[52:55], v5 offset:10240
  ds_read_b128 v[56:59], v4 offset:14336
  ds_read_b128 v[60:63], v5 offset:14336
  s_waitcnt lgkmcnt(0)
  v_mfma_f32_16x16x32_bf16 v[80:83], v[32:35], v[128:131], 0
  v_mfma_f32_16x16x32_bf16 v[80:83], v[36:39], v[132:135], v[80:83]
  v_mfma_f32_16x16x32_bf16 v[84:87], v[32:35], v[160:163], 0
  v_mfma_f32_16x16x32_bf16 v[84:87], v[36:39], v[164:167], v[84:87]
  v_mfma_f32_16x16x32_bf16 v[88:91], v[32:35], v[192:195], 0
  v_mfma_f32_16x16x32_bf16 v[88:91], v[36:39], v[196:199], v[88:91]
  v_mfma_f32_16x16x32_bf16 v[92:95], v[32:35], v[224:227], 0
  v_mfma_f32_16x16x32_bf16 v[92:95], v[36:39], v[228:231], v[92:95]
  v_mfma_f32_16x16x32_bf16 v[80:83], v[40:43], v[136:139], v[80:83]
  v_mfma_f32_16x16x32_bf16 v[80:83], v[44:47], v[140:143], v[80:83]
  v_mfma_f32_16x16x32_bf16 v[84:87], v[40:43], v[168:171], v[84:87]
  v_mfma_f32_16x16x32_bf16 v[84:87], v[44:47], v[172:175], v[84:87]
  v_mfma_f32_16x16x32_bf16 v[88:91], v[40:43], v[200:203], v[88:91]
  v_mfma_f32_16x16x32_bf16 v[88:91], v[44:47], v[204:207], v[88:91]
  v_mfma_f32_16x16x32_bf16 v[92:95], v[40:43], v[232:235], v[92:95]
  v_mfma_f32_16x16x32_bf16 v[92:95], v[44:47], v[236:239], v[92:95]
  v_mfma_f32_16x16x32_bf16 v[80:83], v[48:51], v[144:147], v[80:83]
  v_mfma_f32_16x16x32_bf16 v[80:83], v[52:55], v[148:151], v[80:83]
  v_mfma_f32_16x16x32_bf16 v[84:87], v[48:51], v[176:179], v[84:87]
  v_mfma_f32_16x16x32_bf16 v[84:87], v[52:55], v[180:183], v[84:87]
  v_mfma_f32_16x16x32_bf16 v[88:91], v[48:51], v[208:211], v[88:91]
  v_mfma_f32_16x16x32_bf16 v[88:91], v[52:55], v[212:215], v[88:91]
  v_mfma_f32_16x16x32_bf16 v[92:95], v[48:51], v[240:243], v[92:95]
  v_mfma_f32_16x16x32_bf16 v[92:95], v[52:55], v[244:247], v[92:95]
  v_mfma_f32_16x16x32_bf16 v[80:83], v[56:59], v[152:155], v[80:83]
  v_mfma_f32_16x16x32_bf16 v[80:83], v[60:63], v[156:159], v[80:83]
  v_mfma_f32_16x16x32_bf16 v[84:87], v[56:59], v[184:187], v[84:87]
  v_mfma_f32_16x16x32_bf16 v[84:87], v[60:63], v[188:191], v[84:87]
  v_mfma_f32_16x16x32_bf16 v[88:91], v[56:59], v[216:219], v[88:91]
  v_mfma_f32_16x16x32_bf16 v[88:91], v[60:63], v[220:223], v[88:91]
  v_mfma_f32_16x16x32_bf16 v[92:95], v[56:59], v[248:251], v[92:95]
  v_mfma_f32_16x16x32_bf16 v[92:95], v[60:63], v[252:255], v[92:95]
  s_nop 7
  s_nop 7
  v_max3_f32 v24, v64, v65, v66
  v_max3_f32 v24, v24, v67, v80
  v_max3_f32 v24, v24, v81, v82
  v_max_f32 v24, v24, v83
  v_max3_f32 v25, v68, v69, v70
  v_max3_f32 v25, v25, v71, v84
  v_max3_f32 v25, v25, v85, v86
  v_max_f32 v25, v25, v87
  v_max3_f32 v26, v72, v73, v74
  v_max3_f32 v26, v26, v75, v88
  v_max3_f32 v26, v26, v89, v90
  v_max_f32 v26, v26, v91
  v_max3_f32 v27, v76, v77, v78
  v_max3_f32 v27, v27, v79, v92
  v_max3_f32 v27, v27, v93, v94
  v_max_f32 v27, v27, v95
  v_mov_b32 v112, v24
  v_mov_b32 v113, v25
  v_mov_b32 v114, v26
  v_mov_b32 v115, v27
  s_nop 1
  v_permlane32_swap_b32 v24, v112
  v_permlane32_swap_b32 v25, v113
  v_permlane32_swap_b32 v26, v114
  v_permlane32_swap_b32 v27, v115
  s_nop 1
  v_max_f32 v24, v24, v112
  v_max_f32 v25, v25, v113
  v_max_f32 v26, v26, v114
  v_max_f32 v27, v27, v115
  v_mov_b32 v112, v24
  v_mov_b32 v113, v25
  v_mov_b32 v114, v26
  v_mov_b32 v115, v27
  s_nop 1
  v_permlane16_swap_b32 v24, v112
  v_permlane16_swap_b32 v25, v113
  v_permlane16_swap_b32 v26, v114
  v_permlane16_swap_b32 v27, v115
  s_nop 1
  v_max_f32 v24, v24, v112
  v_max_f32 v25, v25, v113
  v_max_f32 v26, v26, v114
  v_max_f32 v27, v27, v115
  v_max_f32 v24, v24, v20
  v_sub_f32 v28, v20, v24
  v_mul_f32 v28, s63, v28
  v_exp_f32 v28, v28
  v_mov_b32 v20, v24
  v_mul_f32 v16, s63, v24
  v_sub_f32 v16, 0, v16
  v_mul_f32 v12, v12, v28
  v_max_f32 v25, v25, v21
  v_sub_f32 v29, v21, v25
  v_mul_f32 v29, s63, v29
  v_exp_f32 v29, v29
  v_mov_b32 v21, v25
  v_mul_f32 v17, s63, v25
  v_sub_f32 v17, 0, v17
  v_mul_f32 v13, v13, v29
  v_max_f32 v26, v26, v22
  v_sub_f32 v30, v22, v26
  v_mul_f32 v30, s63, v30
  v_exp_f32 v30, v30
  v_mov_b32 v22, v26
  v_mul_f32 v18, s63, v26
  v_sub_f32 v18, 0, v18
  v_mul_f32 v14, v14, v30
  v_max_f32 v27, v27, v23
  v_sub_f32 v31, v23, v27
  v_mul_f32 v31, s63, v31
  v_exp_f32 v31, v31
  v_mov_b32 v23, v27
  v_mul_f32 v19, s63, v27
  v_sub_f32 v19, 0, v19
  v_mul_f32 v15, v15, v31
  v_accvgpr_read_b32 v112, a0
  v_mul_f32 v112, v112, v28
  v_accvgpr_write_b32 a0, v112
  v_accvgpr_read_b32 v113, a1
  v_mul_f32 v113, v113, v28
  v_accvgpr_write_b32 a1, v113
  v_accvgpr_read_b32 v114, a2
  v_mul_f32 v114, v114, v28
  v_accvgpr_write_b32 a2, v114
  v_accvgpr_read_b32 v115, a3
  v_mul_f32 v115, v115, v28
  v_accvgpr_write_b32 a3, v115
  v_accvgpr_read_b32 v116, a4
  v_mul_f32 v116, v116, v29
  v_accvgpr_write_b32 a4, v116
  v_accvgpr_read_b32 v117, a5
  v_mul_f32 v117, v117, v29
  v_accvgpr_write_b32 a5, v117
  v_accvgpr_read_b32 v118, a6
  v_mul_f32 v118, v118, v29
  v_accvgpr_write_b32 a6, v118
  v_accvgpr_read_b32 v119, a7
  v_mul_f32 v119, v119, v29
  v_accvgpr_write_b32 a7, v119
  v_accvgpr_read_b32 v112, a8
  v_mul_f32 v112, v112, v30
  v_accvgpr_write_b32 a8, v112
  v_accvgpr_read_b32 v113, a9
  v_mul_f32 v113, v113, v30
  v_accvgpr_write_b32 a9, v113
  v_accvgpr_read_b32 v114, a10
  v_mul_f32 v114, v114, v30
  v_accvgpr_write_b32 a10, v114
  v_accvgpr_read_b32 v115, a11
  v_mul_f32 v115, v115, v30
  v_accvgpr_write_b32 a11, v115
  v_accvgpr_read_b32 v116, a12
  v_mul_f32 v116, v116, v31
  v_accvgpr_write_b32 a12, v116
  v_accvgpr_read_b32 v117, a13
  v_mul_f32 v117, v117, v31
  v_accvgpr_write_b32 a13, v117
  v_accvgpr_read_b32 v118, a14
  v_mul_f32 v118, v118, v31
  v_accvgpr_write_b32 a14, v118
  v_accvgpr_read_b32 v119, a15
  v_mul_f32 v119, v119, v31
  v_accvgpr_write_b32 a15, v119
  v_accvgpr_read_b32 v112, a16
  v_mul_f32 v112, v112, v28
  v_accvgpr_write_b32 a16, v112
  v_accvgpr_read_b32 v113, a17
  v_mul_f32 v113, v113, v28
  v_accvgpr_write_b32 a17, v113
  v_accvgpr_read_b32 v114, a18
  v_mul_f32 v114, v114, v28
  v_accvgpr_write_b32 a18, v114
  v_accvgpr_read_b32 v115, a19
  v_mul_f32 v115, v115, v28
  v_accvgpr_write_b32 a19, v115
  v_accvgpr_read_b32 v116, a20
  v_mul_f32 v116, v116, v29
  v_accvgpr_write_b32 a20, v116
  v_accvgpr_read_b32 v117, a21
  v_mul_f32 v117, v117, v29
  v_accvgpr_write_b32 a21, v117
  v_accvgpr_read_b32 v118, a22
  v_mul_f32 v118, v118, v29
  v_accvgpr_write_b32 a22, v118
  v_accvgpr_read_b32 v119, a23
  v_mul_f32 v119, v119, v29
  v_accvgpr_write_b32 a23, v119
  v_accvgpr_read_b32 v112, a24
  v_mul_f32 v112, v112, v30
  v_accvgpr_write_b32 a24, v112
  v_accvgpr_read_b32 v113, a25
  v_mul_f32 v113, v113, v30
  v_accvgpr_write_b32 a25, v113
  v_accvgpr_read_b32 v114, a26
  v_mul_f32 v114, v114, v30
  v_accvgpr_write_b32 a26, v114
  v_accvgpr_read_b32 v115, a27
  v_mul_f32 v115, v115, v30
  v_accvgpr_write_b32 a27, v115
  v_accvgpr_read_b32 v116, a28
  v_mul_f32 v116, v116, v31
  v_accvgpr_write_b32 a28, v116
  v_accvgpr_read_b32 v117, a29
  v_mul_f32 v117, v117, v31
  v_accvgpr_write_b32 a29, v117
  v_accvgpr_read_b32 v118, a30
  v_mul_f32 v118, v118, v31
  v_accvgpr_write_b32 a30, v118
  v_accvgpr_read_b32 v119, a31
  v_mul_f32 v119, v119, v31
  v_accvgpr_write_b32 a31, v119
  v_accvgpr_read_b32 v112, a32
  v_mul_f32 v112, v112, v28
  v_accvgpr_write_b32 a32, v112
  v_accvgpr_read_b32 v113, a33
  v_mul_f32 v113, v113, v28
  v_accvgpr_write_b32 a33, v113
  v_accvgpr_read_b32 v114, a34
  v_mul_f32 v114, v114, v28
  v_accvgpr_write_b32 a34, v114
  v_accvgpr_read_b32 v115, a35
  v_mul_f32 v115, v115, v28
  v_accvgpr_write_b32 a35, v115
  v_accvgpr_read_b32 v116, a36
  v_mul_f32 v116, v116, v29
  v_accvgpr_write_b32 a36, v116
  v_accvgpr_read_b32 v117, a37
  v_mul_f32 v117, v117, v29
  v_accvgpr_write_b32 a37, v117
  v_accvgpr_read_b32 v118, a38
  v_mul_f32 v118, v118, v29
  v_accvgpr_write_b32 a38, v118
  v_accvgpr_read_b32 v119, a39
  v_mul_f32 v119, v119, v29
  v_accvgpr_write_b32 a39, v119
  v_accvgpr_read_b32 v112, a40
  v_mul_f32 v112, v112, v30
  v_accvgpr_write_b32 a40, v112
  v_accvgpr_read_b32 v113, a41
  v_mul_f32 v113, v113, v30
  v_accvgpr_write_b32 a41, v113
  v_accvgpr_read_b32 v114, a42
  v_mul_f32 v114, v114, v30
  v_accvgpr_write_b32 a42, v114
  v_accvgpr_read_b32 v115, a43
  v_mul_f32 v115, v115, v30
  v_accvgpr_write_b32 a43, v115
  v_accvgpr_read_b32 v116, a44
  v_mul_f32 v116, v116, v31
  v_accvgpr_write_b32 a44, v116
  v_accvgpr_read_b32 v117, a45
  v_mul_f32 v117, v117, v31
  v_accvgpr_write_b32 a45, v117
  v_accvgpr_read_b32 v118, a46
  v_mul_f32 v118, v118, v31
  v_accvgpr_write_b32 a46, v118
  v_accvgpr_read_b32 v119, a47
  v_mul_f32 v119, v119, v31
  v_accvgpr_write_b32 a47, v119
  v_accvgpr_read_b32 v112, a48
  v_mul_f32 v112, v112, v28
  v_accvgpr_write_b32 a48, v112
  v_accvgpr_read_b32 v113, a49
  v_mul_f32 v113, v113, v28
  v_accvgpr_write_b32 a49, v113
  v_accvgpr_read_b32 v114, a50
  v_mul_f32 v114, v114, v28
  v_accvgpr_write_b32 a50, v114
  v_accvgpr_read_b32 v115, a51
  v_mul_f32 v115, v115, v28
  v_accvgpr_write_b32 a51, v115
  v_accvgpr_read_b32 v116, a52
  v_mul_f32 v116, v116, v29
  v_accvgpr_write_b32 a52, v116
  v_accvgpr_read_b32 v117, a53
  v_mul_f32 v117, v117, v29
  v_accvgpr_write_b32 a53, v117
  v_accvgpr_read_b32 v118, a54
  v_mul_f32 v118, v118, v29
  v_accvgpr_write_b32 a54, v118
  v_accvgpr_read_b32 v119, a55
  v_mul_f32 v119, v119, v29
  v_accvgpr_write_b32 a55, v119
  v_accvgpr_read_b32 v112, a56
  v_mul_f32 v112, v112, v30
  v_accvgpr_write_b32 a56, v112
  v_accvgpr_read_b32 v113, a57
  v_mul_f32 v113, v113, v30
  v_accvgpr_write_b32 a57, v113
  v_accvgpr_read_b32 v114, a58
  v_mul_f32 v114, v114, v30
  v_accvgpr_write_b32 a58, v114
  v_accvgpr_read_b32 v115, a59
  v_mul_f32 v115, v115, v30
  v_accvgpr_write_b32 a59, v115
  v_accvgpr_read_b32 v116, a60
  v_mul_f32 v116, v116, v31
  v_accvgpr_write_b32 a60, v116
  v_accvgpr_read_b32 v117, a61
  v_mul_f32 v117, v117, v31
  v_accvgpr_write_b32 a61, v117
  v_accvgpr_read_b32 v118, a62
  v_mul_f32 v118, v118, v31
  v_accvgpr_write_b32 a62, v118
  v_accvgpr_read_b32 v119, a63
  v_mul_f32 v119, v119, v31
  v_accvgpr_write_b32 a63, v119
  v_accvgpr_read_b32 v112, a64
  v_mul_f32 v112, v112, v28
  v_accvgpr_write_b32 a64, v112
  v_accvgpr_read_b32 v113, a65
  v_mul_f32 v113, v113, v28
  v_accvgpr_write_b32 a65, v113
  v_accvgpr_read_b32 v114, a66
  v_mul_f32 v114, v114, v28
  v_accvgpr_write_b32 a66, v114
  v_accvgpr_read_b32 v115, a67
  v_mul_f32 v115, v115, v28
  v_accvgpr_write_b32 a67, v115
  v_accvgpr_read_b32 v116, a68
  v_mul_f32 v116, v116, v29
  v_accvgpr_write_b32 a68, v116
  v_accvgpr_read_b32 v117, a69
  v_mul_f32 v117, v117, v29
  v_accvgpr_write_b32 a69, v117
  v_accvgpr_read_b32 v118, a70
  v_mul_f32 v118, v118, v29
  v_accvgpr_write_b32 a70, v118
  v_accvgpr_read_b32 v119, a71
  v_mul_f32 v119, v119, v29
  v_accvgpr_write_b32 a71, v119
  v_accvgpr_read_b32 v112, a72
  v_mul_f32 v112, v112, v30
  v_accvgpr_write_b32 a72, v112
  v_accvgpr_read_b32 v113, a73
  v_mul_f32 v113, v113, v30
  v_accvgpr_write_b32 a73, v113
  v_accvgpr_read_b32 v114, a74
  v_mul_f32 v114, v114, v30
  v_accvgpr_write_b32 a74, v114
  v_accvgpr_read_b32 v115, a75
  v_mul_f32 v115, v115, v30
  v_accvgpr_write_b32 a75, v115
  v_accvgpr_read_b32 v116, a76
  v_mul_f32 v116, v116, v31
  v_accvgpr_write_b32 a76, v116
  v_accvgpr_read_b32 v117, a77
  v_mul_f32 v117, v117, v31
  v_accvgpr_write_b32 a77, v117
  v_accvgpr_read_b32 v118, a78
  v_mul_f32 v118, v118, v31
  v_accvgpr_write_b32 a78, v118
  v_accvgpr_read_b32 v119, a79
  v_mul_f32 v119, v119, v31
  v_accvgpr_write_b32 a79, v119
  v_accvgpr_read_b32 v112, a80
  v_mul_f32 v112, v112, v28
  v_accvgpr_write_b32 a80, v112
  v_accvgpr_read_b32 v113, a81
  v_mul_f32 v113, v113, v28
  v_accvgpr_write_b32 a81, v113
  v_accvgpr_read_b32 v114, a82
  v_mul_f32 v114, v114, v28
  v_accvgpr_write_b32 a82, v114
  v_accvgpr_read_b32 v115, a83
  v_mul_f32 v115, v115, v28
  v_accvgpr_write_b32 a83, v115
  v_accvgpr_read_b32 v116, a84
  v_mul_f32 v116, v116, v29
  v_accvgpr_write_b32 a84, v116
  v_accvgpr_read_b32 v117, a85
  v_mul_f32 v117, v117, v29
  v_accvgpr_write_b32 a85, v117
  v_accvgpr_read_b32 v118, a86
  v_mul_f32 v118, v118, v29
  v_accvgpr_write_b32 a86, v118
  v_accvgpr_read_b32 v119, a87
  v_mul_f32 v119, v119, v29
  v_accvgpr_write_b32 a87, v119
  v_accvgpr_read_b32 v112, a88
  v_mul_f32 v112, v112, v30
  v_accvgpr_write_b32 a88, v112
  v_accvgpr_read_b32 v113, a89
  v_mul_f32 v113, v113, v30
  v_accvgpr_write_b32 a89, v113
  v_accvgpr_read_b32 v114, a90
  v_mul_f32 v114, v114, v30
  v_accvgpr_write_b32 a90, v114
  v_accvgpr_read_b32 v115, a91
  v_mul_f32 v115, v115, v30
  v_accvgpr_write_b32 a91, v115
  v_accvgpr_read_b32 v116, a92
  v_mul_f32 v116, v116, v31
  v_accvgpr_write_b32 a92, v116
  v_accvgpr_read_b32 v117, a93
  v_mul_f32 v117, v117, v31
  v_accvgpr_write_b32 a93, v117
  v_accvgpr_read_b32 v118, a94
  v_mul_f32 v118, v118, v31
  v_accvgpr_write_b32 a94, v118
  v_accvgpr_read_b32 v119, a95
  v_mul_f32 v119, v119, v31
  v_accvgpr_write_b32 a95, v119
  v_accvgpr_read_b32 v112, a96
  v_mul_f32 v112, v112, v28
  v_accvgpr_write_b32 a96, v112
  v_accvgpr_read_b32 v113, a97
  v_mul_f32 v113, v113, v28
  v_accvgpr_write_b32 a97, v113
  v_accvgpr_read_b32 v114, a98
  v_mul_f32 v114, v114, v28
  v_accvgpr_write_b32 a98, v114
  v_accvgpr_read_b32 v115, a99
  v_mul_f32 v115, v115, v28
  v_accvgpr_write_b32 a99, v115
  v_accvgpr_read_b32 v116, a100
  v_mul_f32 v116, v116, v29
  v_accvgpr_write_b32 a100, v116
  v_accvgpr_read_b32 v117, a101
  v_mul_f32 v117, v117, v29
  v_accvgpr_write_b32 a101, v117
  v_accvgpr_read_b32 v118, a102
  v_mul_f32 v118, v118, v29
  v_accvgpr_write_b32 a102, v118
  v_accvgpr_read_b32 v119, a103
  v_mul_f32 v119, v119, v29
  v_accvgpr_write_b32 a103, v119
  v_accvgpr_read_b32 v112, a104
  v_mul_f32 v112, v112, v30
  v_accvgpr_write_b32 a104, v112
  v_accvgpr_read_b32 v113, a105
  v_mul_f32 v113, v113, v30
  v_accvgpr_write_b32 a105, v113
  v_accvgpr_read_b32 v114, a106
  v_mul_f32 v114, v114, v30
  v_accvgpr_write_b32 a106, v114
  v_accvgpr_read_b32 v115, a107
  v_mul_f32 v115, v115, v30
  v_accvgpr_write_b32 a107, v115
  v_accvgpr_read_b32 v116, a108
  v_mul_f32 v116, v116, v31
  v_accvgpr_write_b32 a108, v116
  v_accvgpr_read_b32 v117, a109
  v_mul_f32 v117, v117, v31
  v_accvgpr_write_b32 a109, v117
  v_accvgpr_read_b32 v118, a110
  v_mul_f32 v118, v118, v31
  v_accvgpr_write_b32 a110, v118
  v_accvgpr_read_b32 v119, a111
  v_mul_f32 v119, v119, v31
  v_accvgpr_write_b32 a111, v119
  v_accvgpr_read_b32 v112, a112
  v_mul_f32 v112, v112, v28
  v_accvgpr_write_b32 a112, v112
  v_accvgpr_read_b32 v113, a113
  v_mul_f32 v113, v113, v28
  v_accvgpr_write_b32 a113, v113
  v_accvgpr_read_b32 v114, a114
  v_mul_f32 v114, v114, v28
  v_accvgpr_write_b32 a114, v114
  v_accvgpr_read_b32 v115, a115
  v_mul_f32 v115, v115, v28
  v_accvgpr_write_b32 a115, v115
  v_accvgpr_read_b32 v116, a116
  v_mul_f32 v116, v116, v29
  v_accvgpr_write_b32 a116, v116
  v_accvgpr_read_b32 v117, a117
  v_mul_f32 v117, v117, v29
  v_accvgpr_write_b32 a117, v117
  v_accvgpr_read_b32 v118, a118
  v_mul_f32 v118, v118, v29
  v_accvgpr_write_b32 a118, v118
  v_accvgpr_read_b32 v119, a119
  v_mul_f32 v119, v119, v29
  v_accvgpr_write_b32 a119, v119
  v_accvgpr_read_b32 v112, a120
  v_mul_f32 v112, v112, v30
  v_accvgpr_write_b32 a120, v112
  v_accvgpr_read_b32 v113, a121
  v_mul_f32 v113, v113, v30
  v_accvgpr_write_b32 a121, v113
  v_accvgpr_read_b32 v114, a122
  v_mul_f32 v114, v114, v30
  v_accvgpr_write_b32 a122, v114
  v_accvgpr_read_b32 v115, a123
  v_mul_f32 v115, v115, v30
  v_accvgpr_write_b32 a123, v115
  v_accvgpr_read_b32 v116, a124
  v_mul_f32 v116, v116, v31
  v_accvgpr_write_b32 a124, v116
  v_accvgpr_read_b32 v117, a125
  v_mul_f32 v117, v117, v31
  v_accvgpr_write_b32 a125, v117
  v_accvgpr_read_b32 v118, a126
  v_mul_f32 v118, v118, v31
  v_accvgpr_write_b32 a126, v118
  v_accvgpr_read_b32 v119, a127
  v_mul_f32 v119, v119, v31
  v_accvgpr_write_b32 a127, v119
  v_accvgpr_read_b32 v112, a128
  v_mul_f32 v112, v112, v28
  v_accvgpr_write_b32 a128, v112
  v_accvgpr_read_b32 v113, a129
  v_mul_f32 v113, v113, v28
  v_accvgpr_write_b32 a129, v113
  v_accvgpr_read_b32 v114, a130
  v_mul_f32 v114, v114, v28
  v_accvgpr_write_b32 a130, v114
  v_accvgpr_read_b32 v115, a131
  v_mul_f32 v115, v115, v28
  v_accvgpr_write_b32 a131, v115
  v_accvgpr_read_b32 v116, a132
  v_mul_f32 v116, v116, v29
  v_accvgpr_write_b32 a132, v116
  v_accvgpr_read_b32 v117, a133
  v_mul_f32 v117, v117, v29
  v_accvgpr_write_b32 a133, v117
  v_accvgpr_read_b32 v118, a134
  v_mul_f32 v118, v118, v29
  v_accvgpr_write_b32 a134, v118
  v_accvgpr_read_b32 v119, a135
  v_mul_f32 v119, v119, v29
  v_accvgpr_write_b32 a135, v119
  v_accvgpr_read_b32 v112, a136
  v_mul_f32 v112, v112, v30
  v_accvgpr_write_b32 a136, v112
  v_accvgpr_read_b32 v113, a137
  v_mul_f32 v113, v113, v30
  v_accvgpr_write_b32 a137, v113
  v_accvgpr_read_b32 v114, a138
  v_mul_f32 v114, v114, v30
  v_accvgpr_write_b32 a138, v114
  v_accvgpr_read_b32 v115, a139
  v_mul_f32 v115, v115, v30
  v_accvgpr_write_b32 a139, v115
  v_accvgpr_read_b32 v116, a140
  v_mul_f32 v116, v116, v31
  v_accvgpr_write_b32 a140, v116
  v_accvgpr_read_b32 v117, a141
  v_mul_f32 v117, v117, v31
  v_accvgpr_write_b32 a141, v117
  v_accvgpr_read_b32 v118, a142
  v_mul_f32 v118, v118, v31
  v_accvgpr_write_b32 a142, v118
  v_accvgpr_read_b32 v119, a143
  v_mul_f32 v119, v119, v31
  v_accvgpr_write_b32 a143, v119
  v_accvgpr_read_b32 v112, a144
  v_mul_f32 v112, v112, v28
  v_accvgpr_write_b32 a144, v112
  v_accvgpr_read_b32 v113, a145
  v_mul_f32 v113, v113, v28
  v_accvgpr_write_b32 a145, v113
  v_accvgpr_read_b32 v114, a146
  v_mul_f32 v114, v114, v28
  v_accvgpr_write_b32 a146, v114
  v_accvgpr_read_b32 v115, a147
  v_mul_f32 v115, v115, v28
  v_accvgpr_write_b32 a147, v115
  v_accvgpr_read_b32 v116, a148
  v_mul_f32 v116, v116, v29
  v_accvgpr_write_b32 a148, v116
  v_accvgpr_read_b32 v117, a149
  v_mul_f32 v117, v117, v29
  v_accvgpr_write_b32 a149, v117
  v_accvgpr_read_b32 v118, a150
  v_mul_f32 v118, v118, v29
  v_accvgpr_write_b32 a150, v118
  v_accvgpr_read_b32 v119, a151
  v_mul_f32 v119, v119, v29
  v_accvgpr_write_b32 a151, v119
  v_accvgpr_read_b32 v112, a152
  v_mul_f32 v112, v112, v30
  v_accvgpr_write_b32 a152, v112
  v_accvgpr_read_b32 v113, a153
  v_mul_f32 v113, v113, v30
  v_accvgpr_write_b32 a153, v113
  v_accvgpr_read_b32 v114, a154
  v_mul_f32 v114, v114, v30
  v_accvgpr_write_b32 a154, v114
  v_accvgpr_read_b32 v115, a155
  v_mul_f32 v115, v115, v30
  v_accvgpr_write_b32 a155, v115
  v_accvgpr_read_b32 v116, a156
  v_mul_f32 v116, v116, v31
  v_accvgpr_write_b32 a156, v116
  v_accvgpr_read_b32 v117, a157
  v_mul_f32 v117, v117, v31
  v_accvgpr_write_b32 a157, v117
  v_accvgpr_read_b32 v118, a158
  v_mul_f32 v118, v118, v31
  v_accvgpr_write_b32 a158, v118
  v_accvgpr_read_b32 v119, a159
  v_mul_f32 v119, v119, v31
  v_accvgpr_write_b32 a159, v119
  v_accvgpr_read_b32 v112, a160
  v_mul_f32 v112, v112, v28
  v_accvgpr_write_b32 a160, v112
  v_accvgpr_read_b32 v113, a161
  v_mul_f32 v113, v113, v28
  v_accvgpr_write_b32 a161, v113
  v_accvgpr_read_b32 v114, a162
  v_mul_f32 v114, v114, v28
  v_accvgpr_write_b32 a162, v114
  v_accvgpr_read_b32 v115, a163
  v_mul_f32 v115, v115, v28
  v_accvgpr_write_b32 a163, v115
  v_accvgpr_read_b32 v116, a164
  v_mul_f32 v116, v116, v29
  v_accvgpr_write_b32 a164, v116
  v_accvgpr_read_b32 v117, a165
  v_mul_f32 v117, v117, v29
  v_accvgpr_write_b32 a165, v117
  v_accvgpr_read_b32 v118, a166
  v_mul_f32 v118, v118, v29
  v_accvgpr_write_b32 a166, v118
  v_accvgpr_read_b32 v119, a167
  v_mul_f32 v119, v119, v29
  v_accvgpr_write_b32 a167, v119
  v_accvgpr_read_b32 v112, a168
  v_mul_f32 v112, v112, v30
  v_accvgpr_write_b32 a168, v112
  v_accvgpr_read_b32 v113, a169
  v_mul_f32 v113, v113, v30
  v_accvgpr_write_b32 a169, v113
  v_accvgpr_read_b32 v114, a170
  v_mul_f32 v114, v114, v30
  v_accvgpr_write_b32 a170, v114
  v_accvgpr_read_b32 v115, a171
  v_mul_f32 v115, v115, v30
  v_accvgpr_write_b32 a171, v115
  v_accvgpr_read_b32 v116, a172
  v_mul_f32 v116, v116, v31
  v_accvgpr_write_b32 a172, v116
  v_accvgpr_read_b32 v117, a173
  v_mul_f32 v117, v117, v31
  v_accvgpr_write_b32 a173, v117
  v_accvgpr_read_b32 v118, a174
  v_mul_f32 v118, v118, v31
  v_accvgpr_write_b32 a174, v118
  v_accvgpr_read_b32 v119, a175
  v_mul_f32 v119, v119, v31
  v_accvgpr_write_b32 a175, v119
  v_accvgpr_read_b32 v112, a176
  v_mul_f32 v112, v112, v28
  v_accvgpr_write_b32 a176, v112
  v_accvgpr_read_b32 v113, a177
  v_mul_f32 v113, v113, v28
  v_accvgpr_write_b32 a177, v113
  v_accvgpr_read_b32 v114, a178
  v_mul_f32 v114, v114, v28
  v_accvgpr_write_b32 a178, v114
  v_accvgpr_read_b32 v115, a179
  v_mul_f32 v115, v115, v28
  v_accvgpr_write_b32 a179, v115
  v_accvgpr_read_b32 v116, a180
  v_mul_f32 v116, v116, v29
  v_accvgpr_write_b32 a180, v116
  v_accvgpr_read_b32 v117, a181
  v_mul_f32 v117, v117, v29
  v_accvgpr_write_b32 a181, v117
  v_accvgpr_read_b32 v118, a182
  v_mul_f32 v118, v118, v29
  v_accvgpr_write_b32 a182, v118
  v_accvgpr_read_b32 v119, a183
  v_mul_f32 v119, v119, v29
  v_accvgpr_write_b32 a183, v119
  v_accvgpr_read_b32 v112, a184
  v_mul_f32 v112, v112, v30
  v_accvgpr_write_b32 a184, v112
  v_accvgpr_read_b32 v113, a185
  v_mul_f32 v113, v113, v30
  v_accvgpr_write_b32 a185, v113
  v_accvgpr_read_b32 v114, a186
  v_mul_f32 v114, v114, v30
  v_accvgpr_write_b32 a186, v114
  v_accvgpr_read_b32 v115, a187
  v_mul_f32 v115, v115, v30
  v_accvgpr_write_b32 a187, v115
  v_accvgpr_read_b32 v116, a188
  v_mul_f32 v116, v116, v31
  v_accvgpr_write_b32 a188, v116
  v_accvgpr_read_b32 v117, a189
  v_mul_f32 v117, v117, v31
  v_accvgpr_write_b32 a189, v117
  v_accvgpr_read_b32 v118, a190
  v_mul_f32 v118, v118, v31
  v_accvgpr_write_b32 a190, v118
  v_accvgpr_read_b32 v119, a191
  v_mul_f32 v119, v119, v31
  v_accvgpr_write_b32 a191, v119
  v_accvgpr_read_b32 v112, a192
  v_mul_f32 v112, v112, v28
  v_accvgpr_write_b32 a192, v112
  v_accvgpr_read_b32 v113, a193
  v_mul_f32 v113, v113, v28
  v_accvgpr_write_b32 a193, v113
  v_accvgpr_read_b32 v114, a194
  v_mul_f32 v114, v114, v28
  v_accvgpr_write_b32 a194, v114
  v_accvgpr_read_b32 v115, a195
  v_mul_f32 v115, v115, v28
  v_accvgpr_write_b32 a195, v115
  v_accvgpr_read_b32 v116, a196
  v_mul_f32 v116, v116, v29
  v_accvgpr_write_b32 a196, v116
  v_accvgpr_read_b32 v117, a197
  v_mul_f32 v117, v117, v29
  v_accvgpr_write_b32 a197, v117
  v_accvgpr_read_b32 v118, a198
  v_mul_f32 v118, v118, v29
  v_accvgpr_write_b32 a198, v118
  v_accvgpr_read_b32 v119, a199
  v_mul_f32 v119, v119, v29
  v_accvgpr_write_b32 a199, v119
  v_accvgpr_read_b32 v112, a200
  v_mul_f32 v112, v112, v30
  v_accvgpr_write_b32 a200, v112
  v_accvgpr_read_b32 v113, a201
  v_mul_f32 v113, v113, v30
  v_accvgpr_write_b32 a201, v113
  v_accvgpr_read_b32 v114, a202
  v_mul_f32 v114, v114, v30
  v_accvgpr_write_b32 a202, v114
  v_accvgpr_read_b32 v115, a203
  v_mul_f32 v115, v115, v30
  v_accvgpr_write_b32 a203, v115
  v_accvgpr_read_b32 v116, a204
  v_mul_f32 v116, v116, v31
  v_accvgpr_write_b32 a204, v116
  v_accvgpr_read_b32 v117, a205
  v_mul_f32 v117, v117, v31
  v_accvgpr_write_b32 a205, v117
  v_accvgpr_read_b32 v118, a206
  v_mul_f32 v118, v118, v31
  v_accvgpr_write_b32 a206, v118
  v_accvgpr_read_b32 v119, a207
  v_mul_f32 v119, v119, v31
  v_accvgpr_write_b32 a207, v119
  v_accvgpr_read_b32 v112, a208
  v_mul_f32 v112, v112, v28
  v_accvgpr_write_b32 a208, v112
  v_accvgpr_read_b32 v113, a209
  v_mul_f32 v113, v113, v28
  v_accvgpr_write_b32 a209, v113
  v_accvgpr_read_b32 v114, a210
  v_mul_f32 v114, v114, v28
  v_accvgpr_write_b32 a210, v114
  v_accvgpr_read_b32 v115, a211
  v_mul_f32 v115, v115, v28
  v_accvgpr_write_b32 a211, v115
  v_accvgpr_read_b32 v116, a212
  v_mul_f32 v116, v116, v29
  v_accvgpr_write_b32 a212, v116
  v_accvgpr_read_b32 v117, a213
  v_mul_f32 v117, v117, v29
  v_accvgpr_write_b32 a213, v117
  v_accvgpr_read_b32 v118, a214
  v_mul_f32 v118, v118, v29
  v_accvgpr_write_b32 a214, v118
  v_accvgpr_read_b32 v119, a215
  v_mul_f32 v119, v119, v29
  v_accvgpr_write_b32 a215, v119
  v_accvgpr_read_b32 v112, a216
  v_mul_f32 v112, v112, v30
  v_accvgpr_write_b32 a216, v112
  v_accvgpr_read_b32 v113, a217
  v_mul_f32 v113, v113, v30
  v_accvgpr_write_b32 a217, v113
  v_accvgpr_read_b32 v114, a218
  v_mul_f32 v114, v114, v30
  v_accvgpr_write_b32 a218, v114
  v_accvgpr_read_b32 v115, a219
  v_mul_f32 v115, v115, v30
  v_accvgpr_write_b32 a219, v115
  v_accvgpr_read_b32 v116, a220
  v_mul_f32 v116, v116, v31
  v_accvgpr_write_b32 a220, v116
  v_accvgpr_read_b32 v117, a221
  v_mul_f32 v117, v117, v31
  v_accvgpr_write_b32 a221, v117
  v_accvgpr_read_b32 v118, a222
  v_mul_f32 v118, v118, v31
  v_accvgpr_write_b32 a222, v118
  v_accvgpr_read_b32 v119, a223
  v_mul_f32 v119, v119, v31
  v_accvgpr_write_b32 a223, v119
  v_accvgpr_read_b32 v112, a224
  v_mul_f32 v112, v112, v28
  v_accvgpr_write_b32 a224, v112
  v_accvgpr_read_b32 v113, a225
  v_mul_f32 v113, v113, v28
  v_accvgpr_write_b32 a225, v113
  v_accvgpr_read_b32 v114, a226
  v_mul_f32 v114, v114, v28
  v_accvgpr_write_b32 a226, v114
  v_accvgpr_read_b32 v115, a227
  v_mul_f32 v115, v115, v28
  v_accvgpr_write_b32 a227, v115
  v_accvgpr_read_b32 v116, a228
  v_mul_f32 v116, v116, v29
  v_accvgpr_write_b32 a228, v116
  v_accvgpr_read_b32 v117, a229
  v_mul_f32 v117, v117, v29
  v_accvgpr_write_b32 a229, v117
  v_accvgpr_read_b32 v118, a230
  v_mul_f32 v118, v118, v29
  v_accvgpr_write_b32 a230, v118
  v_accvgpr_read_b32 v119, a231
  v_mul_f32 v119, v119, v29
  v_accvgpr_write_b32 a231, v119
  v_accvgpr_read_b32 v112, a232
  v_mul_f32 v112, v112, v30
  v_accvgpr_write_b32 a232, v112
  v_accvgpr_read_b32 v113, a233
  v_mul_f32 v113, v113, v30
  v_accvgpr_write_b32 a233, v113
  v_accvgpr_read_b32 v114, a234
  v_mul_f32 v114, v114, v30
  v_accvgpr_write_b32 a234, v114
  v_accvgpr_read_b32 v115, a235
  v_mul_f32 v115, v115, v30
  v_accvgpr_write_b32 a235, v115
  v_accvgpr_read_b32 v116, a236
  v_mul_f32 v116, v116, v31
  v_accvgpr_write_b32 a236, v116
  v_accvgpr_read_b32 v117, a237
  v_mul_f32 v117, v117, v31
  v_accvgpr_write_b32 a237, v117
  v_accvgpr_read_b32 v118, a238
  v_mul_f32 v118, v118, v31
  v_accvgpr_write_b32 a238, v118
  v_accvgpr_read_b32 v119, a239
  v_mul_f32 v119, v119, v31
  v_accvgpr_write_b32 a239, v119
  v_accvgpr_read_b32 v112, a240
  v_mul_f32 v112, v112, v28
  v_accvgpr_write_b32 a240, v112
  v_accvgpr_read_b32 v113, a241
  v_mul_f32 v113, v113, v28
  v_accvgpr_write_b32 a241, v113
  v_accvgpr_read_b32 v114, a242
  v_mul_f32 v114, v114, v28
  v_accvgpr_write_b32 a242, v114
  v_accvgpr_read_b32 v115, a243
  v_mul_f32 v115, v115, v28
  v_accvgpr_write_b32 a243, v115
  v_accvgpr_read_b32 v116, a244
  v_mul_f32 v116, v116, v29
  v_accvgpr_write_b32 a244, v116
  v_accvgpr_read_b32 v117, a245
  v_mul_f32 v117, v117, v29
  v_accvgpr_write_b32 a245, v117
  v_accvgpr_read_b32 v118, a246
  v_mul_f32 v118, v118, v29
  v_accvgpr_write_b32 a246, v118
  v_accvgpr_read_b32 v119, a247
  v_mul_f32 v119, v119, v29
  v_accvgpr_write_b32 a247, v119
  v_accvgpr_read_b32 v112, a248
  v_mul_f32 v112, v112, v30
  v_accvgpr_write_b32 a248, v112
  v_accvgpr_read_b32 v113, a249
  v_mul_f32 v113, v113, v30
  v_accvgpr_write_b32 a249, v113
  v_accvgpr_read_b32 v114, a250
  v_mul_f32 v114, v114, v30
  v_accvgpr_write_b32 a250, v114
  v_accvgpr_read_b32 v115, a251
  v_mul_f32 v115, v115, v30
  v_accvgpr_write_b32 a251, v115
  v_accvgpr_read_b32 v116, a252
  v_mul_f32 v116, v116, v31
  v_accvgpr_write_b32 a252, v116
  v_accvgpr_read_b32 v117, a253
  v_mul_f32 v117, v117, v31
  v_accvgpr_write_b32 a253, v117
  v_accvgpr_read_b32 v118, a254
  v_mul_f32 v118, v118, v31
  v_accvgpr_write_b32 a254, v118
  v_accvgpr_read_b32 v119, a255
  v_mul_f32 v119, v119, v31
  v_accvgpr_write_b32 a255, v119
  v_fma_f32 v64, v64, s63, v16
  v_fma_f32 v65, v65, s63, v16
  v_exp_f32 v64, v64
  v_exp_f32 v65, v65
  s_nop 0
  v_fma_f32 v66, v66, s63, v16
  v_fma_f32 v67, v67, s63, v16
  v_exp_f32 v66, v66
  v_exp_f32 v67, v67
  s_nop 0
  v_add_f32 v12, v12, v64
  v_add_f32 v12, v12, v65
  v_cvt_pk_bf16_f32 v96, v64, v65
  v_add_f32 v12, v12, v66
  v_add_f32 v12, v12, v67
  v_cvt_pk_bf16_f32 v97, v66, v67
  v_fma_f32 v68, v68, s63, v17
  v_fma_f32 v69, v69, s63, v17
  v_exp_f32 v68, v68
  v_exp_f32 v69, v69
  s_nop 0
  v_fma_f32 v70, v70, s63, v17
  v_fma_f32 v71, v71, s63, v17
  v_exp_f32 v70, v70
  v_exp_f32 v71, v71
  s_nop 0
  v_add_f32 v13, v13, v68
  v_add_f32 v13, v13, v69
  v_cvt_pk_bf16_f32 v100, v68, v69
  v_add_f32 v13, v13, v70
  v_add_f32 v13, v13, v71
  v_cvt_pk_bf16_f32 v101, v70, v71
  v_fma_f32 v72, v72, s63, v18
  v_fma_f32 v73, v73, s63, v18
  v_exp_f32 v72, v72
  v_exp_f32 v73, v73
  s_nop 0
  v_fma_f32 v74, v74, s63, v18
  v_fma_f32 v75, v75, s63, v18
  v_exp_f32 v74, v74
  v_exp_f32 v75, v75
  s_nop 0
  v_add_f32 v14, v14, v72
  v_add_f32 v14, v14, v73
  v_cvt_pk_bf16_f32 v104, v72, v73
  v_add_f32 v14, v14, v74
  v_add_f32 v14, v14, v75
  v_cvt_pk_bf16_f32 v105, v74, v75
  v_fma_f32 v76, v76, s63, v19
  v_fma_f32 v77, v77, s63, v19
  v_exp_f32 v76, v76
  v_exp_f32 v77, v77
  s_nop 0
  v_fma_f32 v78, v78, s63, v19
  v_fma_f32 v79, v79, s63, v19
  v_exp_f32 v78, v78
  v_exp_f32 v79, v79
  s_nop 0
  v_add_f32 v15, v15, v76
  v_add_f32 v15, v15, v77
  v_cvt_pk_bf16_f32 v108, v76, v77
  v_add_f32 v15, v15, v78
  v_add_f32 v15, v15, v79
  v_cvt_pk_bf16_f32 v109, v78, v79
  v_fma_f32 v80, v80, s63, v16
  v_fma_f32 v81, v81, s63, v16
  v_exp_f32 v80, v80
  v_exp_f32 v81, v81
  s_nop 0
  v_fma_f32 v82, v82, s63, v16
  v_fma_f32 v83, v83, s63, v16
  v_exp_f32 v82, v82
  v_exp_f32 v83, v83
  s_nop 0
  v_add_f32 v12, v12, v80
  v_add_f32 v12, v12, v81
  v_cvt_pk_bf16_f32 v98, v80, v81
  v_add_f32 v12, v12, v82
  v_add_f32 v12, v12, v83
  v_cvt_pk_bf16_f32 v99, v82, v83
  v_fma_f32 v84, v84, s63, v17
  v_fma_f32 v85, v85, s63, v17
  v_exp_f32 v84, v84
  v_exp_f32 v85, v85
  s_nop 0
  v_fma_f32 v86, v86, s63, v17
  v_fma_f32 v87, v87, s63, v17
  v_exp_f32 v86, v86
  v_exp_f32 v87, v87
  s_nop 0
  v_add_f32 v13, v13, v84
  v_add_f32 v13, v13, v85
  v_cvt_pk_bf16_f32 v102, v84, v85
  v_add_f32 v13, v13, v86
  v_add_f32 v13, v13, v87
  v_cvt_pk_bf16_f32 v103, v86, v87
  v_fma_f32 v88, v88, s63, v18
  v_fma_f32 v89, v89, s63, v18
  v_exp_f32 v88, v88
  v_exp_f32 v89, v89
  s_nop 0
  v_fma_f32 v90, v90, s63, v18
  v_fma_f32 v91, v91, s63, v18
  v_exp_f32 v90, v90
  v_exp_f32 v91, v91
  s_nop 0
  v_add_f32 v14, v14, v88
  v_add_f32 v14, v14, v89
  v_cvt_pk_bf16_f32 v106, v88, v89
  v_add_f32 v14, v14, v90
  v_add_f32 v14, v14, v91
  v_cvt_pk_bf16_f32 v107, v90, v91
  v_fma_f32 v92, v92, s63, v19
  v_fma_f32 v93, v93, s63, v19
  v_exp_f32 v92, v92
  v_exp_f32 v93, v93
  s_nop 0
  v_fma_f32 v94, v94, s63, v19
  v_fma_f32 v95, v95, s63, v19
  v_exp_f32 v94, v94
  v_exp_f32 v95, v95
  s_nop 0
  v_add_f32 v15, v15, v92
  v_add_f32 v15, v15, v93
  v_cvt_pk_bf16_f32 v110, v92, v93
  v_add_f32 v15, v15, v94
  v_add_f32 v15, v15, v95
  v_cvt_pk_bf16_f32 v111, v94, v95
  ds_read_b64_tr_b16 v[32:33], v6 offset:0
  ds_read_b64_tr_b16 v[34:35], v6 offset:2048
  ds_read_b64_tr_b16 v[36:37], v7 offset:0
  ds_read_b64_tr_b16 v[38:39], v7 offset:2048
  ds_read_b64_tr_b16 v[40:41], v8 offset:0
  ds_read_b64_tr_b16 v[42:43], v8 offset:2048
  ds_read_b64_tr_b16 v[44:45], v9 offset:0
  ds_read_b64_tr_b16 v[46:47], v9 offset:2048
  s_waitcnt lgkmcnt(0)
  ds_read_b64_tr_b16 v[48:49], v6 offset:4096
  ds_read_b64_tr_b16 v[50:51], v6 offset:6144
  ds_read_b64_tr_b16 v[52:53], v7 offset:4096
  ds_read_b64_tr_b16 v[54:55], v7 offset:6144
  ds_read_b64_tr_b16 v[56:57], v8 offset:4096
  ds_read_b64_tr_b16 v[58:59], v8 offset:6144
  ds_read_b64_tr_b16 v[60:61], v9 offset:4096
  ds_read_b64_tr_b16 v[62:63], v9 offset:6144
  s_waitcnt lgkmcnt(0)
  s_nop 1
  v_mfma_f32_16x16x32_bf16 a[0:3], v[32:35], v[96:99], a[0:3]
  v_mfma_f32_16x16x32_bf16 a[4:7], v[32:35], v[100:103], a[4:7]
  v_mfma_f32_16x16x32_bf16 a[8:11], v[32:35], v[104:107], a[8:11]
  v_mfma_f32_16x16x32_bf16 a[12:15], v[32:35], v[108:111], a[12:15]
  v_mfma_f32_16x16x32_bf16 a[16:19], v[36:39], v[96:99], a[16:19]
  v_mfma_f32_16x16x32_bf16 a[20:23], v[36:39], v[100:103], a[20:23]
  v_mfma_f32_16x16x32_bf16 a[24:27], v[36:39], v[104:107], a[24:27]
  v_mfma_f32_16x16x32_bf16 a[28:31], v[36:39], v[108:111], a[28:31]
  v_mfma_f32_16x16x32_bf16 a[32:35], v[40:43], v[96:99], a[32:35]
  v_mfma_f32_16x16x32_bf16 a[36:39], v[40:43], v[100:103], a[36:39]
  v_mfma_f32_16x16x32_bf16 a[40:43], v[40:43], v[104:107], a[40:43]
  v_mfma_f32_16x16x32_bf16 a[44:47], v[40:43], v[108:111], a[44:47]
  v_mfma_f32_16x16x32_bf16 a[48:51], v[44:47], v[96:99], a[48:51]
  v_mfma_f32_16x16x32_bf16 a[52:55], v[44:47], v[100:103], a[52:55]
  v_mfma_f32_16x16x32_bf16 a[56:59], v[44:47], v[104:107], a[56:59]
  v_mfma_f32_16x16x32_bf16 a[60:63], v[44:47], v[108:111], a[60:63]
  v_mfma_f32_16x16x32_bf16 a[64:67], v[48:51], v[96:99], a[64:67]
  v_mfma_f32_16x16x32_bf16 a[68:71], v[48:51], v[100:103], a[68:71]
  v_mfma_f32_16x16x32_bf16 a[72:75], v[48:51], v[104:107], a[72:75]
  v_mfma_f32_16x16x32_bf16 a[76:79], v[48:51], v[108:111], a[76:79]
  v_mfma_f32_16x16x32_bf16 a[80:83], v[52:55], v[96:99], a[80:83]
  v_mfma_f32_16x16x32_bf16 a[84:87], v[52:55], v[100:103], a[84:87]
  v_mfma_f32_16x16x32_bf16 a[88:91], v[52:55], v[104:107], a[88:91]
  v_mfma_f32_16x16x32_bf16 a[92:95], v[52:55], v[108:111], a[92:95]
  v_mfma_f32_16x16x32_bf16 a[96:99], v[56:59], v[96:99], a[96:99]
  v_mfma_f32_16x16x32_bf16 a[100:103], v[56:59], v[100:103], a[100:103]
  v_mfma_f32_16x16x32_bf16 a[104:107], v[56:59], v[104:107], a[104:107]
  v_mfma_f32_16x16x32_bf16 a[108:111], v[56:59], v[108:111], a[108:111]
  v_mfma_f32_16x16x32_bf16 a[112:115], v[60:63], v[96:99], a[112:115]
  v_mfma_f32_16x16x32_bf16 a[116:119], v[60:63], v[100:103], a[116:119]
  v_mfma_f32_16x16x32_bf16 a[120:123], v[60:63], v[104:107], a[120:123]
  v_mfma_f32_16x16x32_bf16 a[124:127], v[60:63], v[108:111], a[124:127]
  ds_read_b64_tr_b16 v[32:33], v6 offset:8192
  ds_read_b64_tr_b16 v[34:35], v6 offset:10240
  ds_read_b64_tr_b16 v[36:37], v7 offset:8192
  ds_read_b64_tr_b16 v[38:39], v7 offset:10240
  ds_read_b64_tr_b16 v[40:41], v8 offset:8192
  ds_read_b64_tr_b16 v[42:43], v8 offset:10240
  ds_read_b64_tr_b16 v[44:45], v9 offset:8192
  ds_read_b64_tr_b16 v[46:47], v9 offset:10240
  s_waitcnt lgkmcnt(0)
  ds_read_b64_tr_b16 v[48:49], v6 offset:12288
  ds_read_b64_tr_b16 v[50:51], v6 offset:14336
  ds_read_b64_tr_b16 v[52:53], v7 offset:12288
  ds_read_b64_tr_b16 v[54:55], v7 offset:14336
  ds_read_b64_tr_b16 v[56:57], v8 offset:12288
  ds_read_b64_tr_b16 v[58:59], v8 offset:14336
  ds_read_b64_tr_b16 v[60:61], v9 offset:12288
  ds_read_b64_tr_b16 v[62:63], v9 offset:14336
  s_waitcnt lgkmcnt(0)
  s_nop 1
  v_mfma_f32_16x16x32_bf16 a[128:131], v[32:35], v[96:99], a[128:131]
  v_mfma_f32_16x16x32_bf16 a[132:135], v[32:35], v[100:103], a[132:135]
  v_mfma_f32_16x16x32_bf16 a[136:139], v[32:35], v[104:107], a[136:139]
  v_mfma_f32_16x16x32_bf16 a[140:143], v[32:35], v[108:111], a[140:143]
  v_mfma_f32_16x16x32_bf16 a[144:147], v[36:39], v[96:99], a[144:147]
  v_mfma_f32_16x16x32_bf16 a[148:151], v[36:39], v[100:103], a[148:151]
  v_mfma_f32_16x16x32_bf16 a[152:155], v[36:39], v[104:107], a[152:155]
  v_mfma_f32_16x16x32_bf16 a[156:159], v[36:39], v[108:111], a[156:159]
  v_mfma_f32_16x16x32_bf16 a[160:163], v[40:43], v[96:99], a[160:163]
  v_mfma_f32_16x16x32_bf16 a[164:167], v[40:43], v[100:103], a[164:167]
  v_mfma_f32_16x16x32_bf16 a[168:171], v[40:43], v[104:107], a[168:171]
  v_mfma_f32_16x16x32_bf16 a[172:175], v[40:43], v[108:111], a[172:175]
  v_mfma_f32_16x16x32_bf16 a[176:179], v[44:47], v[96:99], a[176:179]
  v_mfma_f32_16x16x32_bf16 a[180:183], v[44:47], v[100:103], a[180:183]
  v_mfma_f32_16x16x32_bf16 a[184:187], v[44:47], v[104:107], a[184:187]
  v_mfma_f32_16x16x32_bf16 a[188:191], v[44:47], v[108:111], a[188:191]
  v_mfma_f32_16x16x32_bf16 a[192:195], v[48:51], v[96:99], a[192:195]
  v_mfma_f32_16x16x32_bf16 a[196:199], v[48:51], v[100:103], a[196:199]
  v_mfma_f32_16x16x32_bf16 a[200:203], v[48:51], v[104:107], a[200:203]
  v_mfma_f32_16x16x32_bf16 a[204:207], v[48:51], v[108:111], a[204:207]
  v_mfma_f32_16x16x32_bf16 a[208:211], v[52:55], v[96:99], a[208:211]
  v_mfma_f32_16x16x32_bf16 a[212:215], v[52:55], v[100:103], a[212:215]
  v_mfma_f32_16x16x32_bf16 a[216:219], v[52:55], v[104:107], a[216:219]
  v_mfma_f32_16x16x32_bf16 a[220:223], v[52:55], v[108:111], a[220:223]
  v_mfma_f32_16x16x32_bf16 a[224:227], v[56:59], v[96:99], a[224:227]
  v_mfma_f32_16x16x32_bf16 a[228:231], v[56:59], v[100:103], a[228:231]
  v_mfma_f32_16x16x32_bf16 a[232:235], v[56:59], v[104:107], a[232:235]
  v_mfma_f32_16x16x32_bf16 a[236:239], v[56:59], v[108:111], a[236:239]
  v_mfma_f32_16x16x32_bf16 a[240:243], v[60:63], v[96:99], a[240:243]
  v_mfma_f32_16x16x32_bf16 a[244:247], v[60:63], v[100:103], a[244:247]
  v_mfma_f32_16x16x32_bf16 a[248:251], v[60:63], v[104:107], a[248:251]
  v_mfma_f32_16x16x32_bf16 a[252:255], v[60:63], v[108:111], a[252:255]
  s_add_u32 s64, s64, 16384
  s_sub_u32 s66, s66, 1
  s_cmp_lg_u32 s66, 0
  s_barrier
  s_cbranch_scc1 L_safe_loop
  s_nop 7
  s_nop 7
  v_mov_b32 v112, v12
  v_mov_b32 v113, v13
  v_mov_b32 v114, v14
  v_mov_b32 v115, v15
  s_nop 1
  v_permlane32_swap_b32 v12, v112
  v_permlane32_swap_b32 v13, v113
  v_permlane32_swap_b32 v14, v114
  v_permlane32_swap_b32 v15, v115
  s_nop 1
  v_add_f32 v12, v12, v112
  v_add_f32 v13, v13, v113
  v_add_f32 v14, v14, v114
  v_add_f32 v15, v15, v115
  v_mov_b32 v112, v12
  v_mov_b32 v113, v13
  v_mov_b32 v114, v14
  v_mov_b32 v115, v15
  s_nop 1
  v_permlane16_swap_b32 v12, v112
  v_permlane16_swap_b32 v13, v113
  v_permlane16_swap_b32 v14, v114
  v_permlane16_swap_b32 v15, v115
  s_nop 1
  v_add_f32 v12, v12, v112
  v_add_f32 v13, v13, v113
  v_add_f32 v14, v14, v114
  v_add_f32 v15, v15, v115
  v_rcp_f32 v12, v12
  v_rcp_f32 v13, v13
  v_rcp_f32 v14, v14
  v_rcp_f32 v15, v15
  s_nop 0
  v_accvgpr_read_b32 v128, a0
  v_accvgpr_read_b32 v28, a1
  v_accvgpr_read_b32 v129, a2
  v_accvgpr_read_b32 v29, a3
  v_cvt_pk_bf16_f32 v128, v128, v28
  v_cvt_pk_bf16_f32 v129, v129, v29
  v_accvgpr_read_b32 v160, a4
  v_accvgpr_read_b32 v30, a5
  v_accvgpr_read_b32 v161, a6
  v_accvgpr_read_b32 v31, a7
  v_cvt_pk_bf16_f32 v160, v160, v30
  v_cvt_pk_bf16_f32 v161, v161, v31
  v_accvgpr_read_b32 v192, a8
  v_accvgpr_read_b32 v28, a9
  v_accvgpr_read_b32 v193, a10
  v_accvgpr_read_b32 v29, a11
  v_cvt_pk_bf16_f32 v192, v192, v28
  v_cvt_pk_bf16_f32 v193, v193, v29
  v_accvgpr_read_b32 v224, a12
  v_accvgpr_read_b32 v30, a13
  v_accvgpr_read_b32 v225, a14
  v_accvgpr_read_b32 v31, a15
  v_cvt_pk_bf16_f32 v224, v224, v30
  v_cvt_pk_bf16_f32 v225, v225, v31
  v_accvgpr_read_b32 v130, a16
  v_accvgpr_read_b32 v28, a17
  v_accvgpr_read_b32 v131, a18
  v_accvgpr_read_b32 v29, a19
  v_cvt_pk_bf16_f32 v130, v130, v28
  v_cvt_pk_bf16_f32 v131, v131, v29
  v_accvgpr_read_b32 v162, a20
  v_accvgpr_read_b32 v30, a21
  v_accvgpr_read_b32 v163, a22
  v_accvgpr_read_b32 v31, a23
  v_cvt_pk_bf16_f32 v162, v162, v30
  v_cvt_pk_bf16_f32 v163, v163, v31
  v_accvgpr_read_b32 v194, a24
  v_accvgpr_read_b32 v28, a25
  v_accvgpr_read_b32 v195, a26
  v_accvgpr_read_b32 v29, a27
  v_cvt_pk_bf16_f32 v194, v194, v28
  v_cvt_pk_bf16_f32 v195, v195, v29
  v_accvgpr_read_b32 v226, a28
  v_accvgpr_read_b32 v30, a29
  v_accvgpr_read_b32 v227, a30
  v_accvgpr_read_b32 v31, a31
  v_cvt_pk_bf16_f32 v226, v226, v30
  v_cvt_pk_bf16_f32 v227, v227, v31
  v_accvgpr_read_b32 v132, a32
  v_accvgpr_read_b32 v28, a33
  v_accvgpr_read_b32 v133, a34
  v_accvgpr_read_b32 v29, a35
  v_cvt_pk_bf16_f32 v132, v132, v28
  v_cvt_pk_bf16_f32 v133, v133, v29
  v_accvgpr_read_b32 v164, a36
  v_accvgpr_read_b32 v30, a37
  v_accvgpr_read_b32 v165, a38
  v_accvgpr_read_b32 v31, a39
  v_cvt_pk_bf16_f32 v164, v164, v30
  v_cvt_pk_bf16_f32 v165, v165, v31
  v_accvgpr_read_b32 v196, a40
  v_accvgpr_read_b32 v28, a41
  v_accvgpr_read_b32 v197, a42
  v_accvgpr_read_b32 v29, a43
  v_cvt_pk_bf16_f32 v196, v196, v28
  v_cvt_pk_bf16_f32 v197, v197, v29
  v_accvgpr_read_b32 v228, a44
  v_accvgpr_read_b32 v30, a45
  v_accvgpr_read_b32 v229, a46
  v_accvgpr_read_b32 v31, a47
  v_cvt_pk_bf16_f32 v228, v228, v30
  v_cvt_pk_bf16_f32 v229, v229, v31
  v_accvgpr_read_b32 v134, a48
  v_accvgpr_read_b32 v28, a49
  v_accvgpr_read_b32 v135, a50
  v_accvgpr_read_b32 v29, a51
  v_cvt_pk_bf16_f32 v134, v134, v28
  v_cvt_pk_bf16_f32 v135, v135, v29
  v_accvgpr_read_b32 v166, a52
  v_accvgpr_read_b32 v30, a53
  v_accvgpr_read_b32 v167, a54
  v_accvgpr_read_b32 v31, a55
  v_cvt_pk_bf16_f32 v166, v166, v30
  v_cvt_pk_bf16_f32 v167, v167, v31
  v_accvgpr_read_b32 v198, a56
  v_accvgpr_read_b32 v28, a57
  v_accvgpr_read_b32 v199, a58
  v_accvgpr_read_b32 v29, a59
  v_cvt_pk_bf16_f32 v198, v198, v28
  v_cvt_pk_bf16_f32 v199, v199, v29
  v_accvgpr_read_b32 v230, a60
  v_accvgpr_read_b32 v30, a61
  v_accvgpr_read_b32 v231, a62
  v_accvgpr_read_b32 v31, a63
  v_cvt_pk_bf16_f32 v230, v230, v30
  v_cvt_pk_bf16_f32 v231, v231, v31
  v_accvgpr_read_b32 v136, a64
  v_accvgpr_read_b32 v28, a65
  v_accvgpr_read_b32 v137, a66
  v_accvgpr_read_b32 v29, a67
  v_cvt_pk_bf16_f32 v136, v136, v28
  v_cvt_pk_bf16_f32 v137, v137, v29
  v_accvgpr_read_b32 v168, a68
  v_accvgpr_read_b32 v30, a69
  v_accvgpr_read_b32 v169, a70
  v_accvgpr_read_b32 v31, a71
  v_cvt_pk_bf16_f32 v168, v168, v30
  v_cvt_pk_bf16_f32 v169, v169, v31
  v_accvgpr_read_b32 v200, a72
  v_accvgpr_read_b32 v28, a73
  v_accvgpr_read_b32 v201, a74
  v_accvgpr_read_b32 v29, a75
  v_cvt_pk_bf16_f32 v200, v200, v28
  v_cvt_pk_bf16_f32 v201, v201, v29
  v_accvgpr_read_b32 v232, a76
  v_accvgpr_read_b32 v30, a77
  v_accvgpr_read_b32 v233, a78
  v_accvgpr_read_b32 v31, a79
  v_cvt_pk_bf16_f32 v232, v232, v30
  v_cvt_pk_bf16_f32 v233, v233, v31
  v_accvgpr_read_b32 v138, a80
  v_accvgpr_read_b32 v28, a81
  v_accvgpr_read_b32 v139, a82
  v_accvgpr_read_b32 v29, a83
  v_cvt_pk_bf16_f32 v138, v138, v28
  v_cvt_pk_bf16_f32 v139, v139, v29
  v_accvgpr_read_b32 v170, a84
  v_accvgpr_read_b32 v30, a85
  v_accvgpr_read_b32 v171, a86
  v_accvgpr_read_b32 v31, a87
  v_cvt_pk_bf16_f32 v170, v170, v30
  v_cvt_pk_bf16_f32 v171, v171, v31
  v_accvgpr_read_b32 v202, a88
  v_accvgpr_read_b32 v28, a89
  v_accvgpr_read_b32 v203, a90
  v_accvgpr_read_b32 v29, a91
  v_cvt_pk_bf16_f32 v202, v202, v28
  v_cvt_pk_bf16_f32 v203, v203, v29
  v_accvgpr_read_b32 v234, a92
  v_accvgpr_read_b32 v30, a93
  v_accvgpr_read_b32 v235, a94
  v_accvgpr_read_b32 v31, a95
  v_cvt_pk_bf16_f32 v234, v234, v30
  v_cvt_pk_bf16_f32 v235, v235, v31
  v_accvgpr_read_b32 v140, a96
  v_accvgpr_read_b32 v28, a97
  v_accvgpr_read_b32 v141, a98
  v_accvgpr_read_b32 v29, a99
  v_cvt_pk_bf16_f32 v140, v140, v28
  v_cvt_pk_bf16_f32 v141, v141, v29
  v_accvgpr_read_b32 v172, a100
  v_accvgpr_read_b32 v30, a101
  v_accvgpr_read_b32 v173, a102
  v_accvgpr_read_b32 v31, a103
  v_cvt_pk_bf16_f32 v172, v172, v30
  v_cvt_pk_bf16_f32 v173, v173, v31
  v_accvgpr_read_b32 v204, a104
  v_accvgpr_read_b32 v28, a105
  v_accvgpr_read_b32 v205, a106
  v_accvgpr_read_b32 v29, a107
  v_cvt_pk_bf16_f32 v204, v204, v28
  v_cvt_pk_bf16_f32 v205, v205, v29
  v_accvgpr_read_b32 v236, a108
  v_accvgpr_read_b32 v30, a109
  v_accvgpr_read_b32 v237, a110
  v_accvgpr_read_b32 v31, a111
  v_cvt_pk_bf16_f32 v236, v236, v30
  v_cvt_pk_bf16_f32 v237, v237, v31
  v_accvgpr_read_b32 v142, a112
  v_accvgpr_read_b32 v28, a113
  v_accvgpr_read_b32 v143, a114
  v_accvgpr_read_b32 v29, a115
  v_cvt_pk_bf16_f32 v142, v142, v28
  v_cvt_pk_bf16_f32 v143, v143, v29
  v_accvgpr_read_b32 v174, a116
  v_accvgpr_read_b32 v30, a117
  v_accvgpr_read_b32 v175, a118
  v_accvgpr_read_b32 v31, a119
  v_cvt_pk_bf16_f32 v174, v174, v30
  v_cvt_pk_bf16_f32 v175, v175, v31
  v_accvgpr_read_b32 v206, a120
  v_accvgpr_read_b32 v28, a121
  v_accvgpr_read_b32 v207, a122
  v_accvgpr_read_b32 v29, a123
  v_cvt_pk_bf16_f32 v206, v206, v28
  v_cvt_pk_bf16_f32 v207, v207, v29
  v_accvgpr_read_b32 v238, a124
  v_accvgpr_read_b32 v30, a125
  v_accvgpr_read_b32 v239, a126
  v_accvgpr_read_b32 v31, a127
  v_cvt_pk_bf16_f32 v238, v238, v30
  v_cvt_pk_bf16_f32 v239, v239, v31
  v_accvgpr_read_b32 v144, a128
  v_accvgpr_read_b32 v28, a129
  v_accvgpr_read_b32 v145, a130
  v_accvgpr_read_b32 v29, a131
  v_cvt_pk_bf16_f32 v144, v144, v28
  v_cvt_pk_bf16_f32 v145, v145, v29
  v_accvgpr_read_b32 v176, a132
  v_accvgpr_read_b32 v30, a133
  v_accvgpr_read_b32 v177, a134
  v_accvgpr_read_b32 v31, a135
  v_cvt_pk_bf16_f32 v176, v176, v30
  v_cvt_pk_bf16_f32 v177, v177, v31
  v_accvgpr_read_b32 v208, a136
  v_accvgpr_read_b32 v28, a137
  v_accvgpr_read_b32 v209, a138
  v_accvgpr_read_b32 v29, a139
  v_cvt_pk_bf16_f32 v208, v208, v28
  v_cvt_pk_bf16_f32 v209, v209, v29
  v_accvgpr_read_b32 v240, a140
  v_accvgpr_read_b32 v30, a141
  v_accvgpr_read_b32 v241, a142
  v_accvgpr_read_b32 v31, a143
  v_cvt_pk_bf16_f32 v240, v240, v30
  v_cvt_pk_bf16_f32 v241, v241, v31
  v_accvgpr_read_b32 v146, a144
  v_accvgpr_read_b32 v28, a145
  v_accvgpr_read_b32 v147, a146
  v_accvgpr_read_b32 v29, a147
  v_cvt_pk_bf16_f32 v146, v146, v28
  v_cvt_pk_bf16_f32 v147, v147, v29
  v_accvgpr_read_b32 v178, a148
  v_accvgpr_read_b32 v30, a149
  v_accvgpr_read_b32 v179, a150
  v_accvgpr_read_b32 v31, a151
  v_cvt_pk_bf16_f32 v178, v178, v30
  v_cvt_pk_bf16_f32 v179, v179, v31
  v_accvgpr_read_b32 v210, a152
  v_accvgpr_read_b32 v28, a153
  v_accvgpr_read_b32 v211, a154
  v_accvgpr_read_b32 v29, a155
  v_cvt_pk_bf16_f32 v210, v210, v28
  v_cvt_pk_bf16_f32 v211, v211, v29
  v_accvgpr_read_b32 v242, a156
  v_accvgpr_read_b32 v30, a157
  v_accvgpr_read_b32 v243, a158
  v_accvgpr_read_b32 v31, a159
  v_cvt_pk_bf16_f32 v242, v242, v30
  v_cvt_pk_bf16_f32 v243, v243, v31
  v_accvgpr_read_b32 v148, a160
  v_accvgpr_read_b32 v28, a161
  v_accvgpr_read_b32 v149, a162
  v_accvgpr_read_b32 v29, a163
  v_cvt_pk_bf16_f32 v148, v148, v28
  v_cvt_pk_bf16_f32 v149, v149, v29
  v_accvgpr_read_b32 v180, a164
  v_accvgpr_read_b32 v30, a165
  v_accvgpr_read_b32 v181, a166
  v_accvgpr_read_b32 v31, a167
  v_cvt_pk_bf16_f32 v180, v180, v30
  v_cvt_pk_bf16_f32 v181, v181, v31
  v_accvgpr_read_b32 v212, a168
  v_accvgpr_read_b32 v28, a169
  v_accvgpr_read_b32 v213, a170
  v_accvgpr_read_b32 v29, a171
  v_cvt_pk_bf16_f32 v212, v212, v28
  v_cvt_pk_bf16_f32 v213, v213, v29
  v_accvgpr_read_b32 v244, a172
  v_accvgpr_read_b32 v30, a173
  v_accvgpr_read_b32 v245, a174
  v_accvgpr_read_b32 v31, a175
  v_cvt_pk_bf16_f32 v244, v244, v30
  v_cvt_pk_bf16_f32 v245, v245, v31
  v_accvgpr_read_b32 v150, a176
  v_accvgpr_read_b32 v28, a177
  v_accvgpr_read_b32 v151, a178
  v_accvgpr_read_b32 v29, a179
  v_cvt_pk_bf16_f32 v150, v150, v28
  v_cvt_pk_bf16_f32 v151, v151, v29
  v_accvgpr_read_b32 v182, a180
  v_accvgpr_read_b32 v30, a181
  v_accvgpr_read_b32 v183, a182
  v_accvgpr_read_b32 v31, a183
  v_cvt_pk_bf16_f32 v182, v182, v30
  v_cvt_pk_bf16_f32 v183, v183, v31
  v_accvgpr_read_b32 v214, a184
  v_accvgpr_read_b32 v28, a185
  v_accvgpr_read_b32 v215, a186
  v_accvgpr_read_b32 v29, a187
  v_cvt_pk_bf16_f32 v214, v214, v28
  v_cvt_pk_bf16_f32 v215, v215, v29
  v_accvgpr_read_b32 v246, a188
  v_accvgpr_read_b32 v30, a189
  v_accvgpr_read_b32 v247, a190
  v_accvgpr_read_b32 v31, a191
  v_cvt_pk_bf16_f32 v246, v246, v30
  v_cvt_pk_bf16_f32 v247, v247, v31
  v_accvgpr_read_b32 v152, a192
  v_accvgpr_read_b32 v28, a193
  v_accvgpr_read_b32 v153, a194
  v_accvgpr_read_b32 v29, a195
  v_cvt_pk_bf16_f32 v152, v152, v28
  v_cvt_pk_bf16_f32 v153, v153, v29
  v_accvgpr_read_b32 v184, a196
  v_accvgpr_read_b32 v30, a197
  v_accvgpr_read_b32 v185, a198
  v_accvgpr_read_b32 v31, a199
  v_cvt_pk_bf16_f32 v184, v184, v30
  v_cvt_pk_bf16_f32 v185, v185, v31
  v_accvgpr_read_b32 v216, a200
  v_accvgpr_read_b32 v28, a201
  v_accvgpr_read_b32 v217, a202
  v_accvgpr_read_b32 v29, a203
  v_cvt_pk_bf16_f32 v216, v216, v28
  v_cvt_pk_bf16_f32 v217, v217, v29
  v_accvgpr_read_b32 v248, a204
  v_accvgpr_read_b32 v30, a205
  v_accvgpr_read_b32 v249, a206
  v_accvgpr_read_b32 v31, a207
  v_cvt_pk_bf16_f32 v248, v248, v30
  v_cvt_pk_bf16_f32 v249, v249, v31
  v_accvgpr_read_b32 v154, a208
  v_accvgpr_read_b32 v28, a209
  v_accvgpr_read_b32 v155, a210
  v_accvgpr_read_b32 v29, a211
  v_cvt_pk_bf16_f32 v154, v154, v28
  v_cvt_pk_bf16_f32 v155, v155, v29
  v_accvgpr_read_b32 v186, a212
  v_accvgpr_read_b32 v30, a213
  v_accvgpr_read_b32 v187, a214
  v_accvgpr_read_b32 v31, a215
  v_cvt_pk_bf16_f32 v186, v186, v30
  v_cvt_pk_bf16_f32 v187, v187, v31
  v_accvgpr_read_b32 v218, a216
  v_accvgpr_read_b32 v28, a217
  v_accvgpr_read_b32 v219, a218
  v_accvgpr_read_b32 v29, a219
  v_cvt_pk_bf16_f32 v218, v218, v28
  v_cvt_pk_bf16_f32 v219, v219, v29
  v_accvgpr_read_b32 v250, a220
  v_accvgpr_read_b32 v30, a221
  v_accvgpr_read_b32 v251, a222
  v_accvgpr_read_b32 v31, a223
  v_cvt_pk_bf16_f32 v250, v250, v30
  v_cvt_pk_bf16_f32 v251, v251, v31
  v_accvgpr_read_b32 v156, a224
  v_accvgpr_read_b32 v28, a225
  v_accvgpr_read_b32 v157, a226
  v_accvgpr_read_b32 v29, a227
  v_cvt_pk_bf16_f32 v156, v156, v28
  v_cvt_pk_bf16_f32 v157, v157, v29
  v_accvgpr_read_b32 v188, a228
  v_accvgpr_read_b32 v30, a229
  v_accvgpr_read_b32 v189, a230
  v_accvgpr_read_b32 v31, a231
  v_cvt_pk_bf16_f32 v188, v188, v30
  v_cvt_pk_bf16_f32 v189, v189, v31
  v_accvgpr_read_b32 v220, a232
  v_accvgpr_read_b32 v28, a233
  v_accvgpr_read_b32 v221, a234
  v_accvgpr_read_b32 v29, a235
  v_cvt_pk_bf16_f32 v220, v220, v28
  v_cvt_pk_bf16_f32 v221, v221, v29
  v_accvgpr_read_b32 v252, a236
  v_accvgpr_read_b32 v30, a237
  v_accvgpr_read_b32 v253, a238
  v_accvgpr_read_b32 v31, a239
  v_cvt_pk_bf16_f32 v252, v252, v30
  v_cvt_pk_bf16_f32 v253, v253, v31
  v_accvgpr_read_b32 v158, a240
  v_accvgpr_read_b32 v28, a241
  v_accvgpr_read_b32 v159, a242
  v_accvgpr_read_b32 v29, a243
  v_cvt_pk_bf16_f32 v158, v158, v28
  v_cvt_pk_bf16_f32 v159, v159, v29
  v_accvgpr_read_b32 v190, a244
  v_accvgpr_read_b32 v30, a245
  v_accvgpr_read_b32 v191, a246
  v_accvgpr_read_b32 v31, a247
  v_cvt_pk_bf16_f32 v190, v190, v30
  v_cvt_pk_bf16_f32 v191, v191, v31
  v_accvgpr_read_b32 v222, a248
  v_accvgpr_read_b32 v28, a249
  v_accvgpr_read_b32 v223, a250
  v_accvgpr_read_b32 v29, a251
  v_cvt_pk_bf16_f32 v222, v222, v28
  v_cvt_pk_bf16_f32 v223, v223, v29
  v_accvgpr_read_b32 v254, a252
  v_accvgpr_read_b32 v30, a253
  v_accvgpr_read_b32 v255, a254
  v_accvgpr_read_b32 v31, a255
  v_cvt_pk_bf16_f32 v254, v254, v30
  v_cvt_pk_bf16_f32 v255, v255, v31
  v_lshrrev_b32 v1, 3, v0
  v_and_b32 v2, 7, v0
  v_lshl_add_u32 v3, s32, 3, v1
  v_bfe_u32 v1, v1, 1, 2
  v_lshlrev_b32 v1, 1, v1
  v_xor_b32 v1, v1, v2
  v_lshlrev_b32 v1, 4, v1
  v_mul_u32_u24 v3, 896, v3
  v_add_u32 v3, v3, v1
  s_lshl_b32 s67, s71, 4
  v_and_b32 v26, 3, v0
  v_lshlrev_b32 v26, 2, v26
  v_add_u32 v26, s67, v26
  s_nop 1
  buffer_load_dword v24, v26, s[40:43], 0 offen sc1
  s_mul_i32 s50, s71, 1048576
  s_lshl_b32 s51, s32, 16
  s_add_u32 s60, s50, s51
  s_lshl_b32 s51, s72, 10
  s_add_u32 s60, s60, s51
  s_lshl_b32 s51, s72, 14
  s_add_u32 s61, s50, s51
  s_mul_i32 s50, s71, 896
  s_lshl_b32 s51, s32, 4
  s_add_u32 s75, s50, s51
  s_add_u32 s75, s75, s72
  s_add_u32 s76, s50, s51
  s_add_u32 s76, s76, 16384
  s_lshr_b32 s51, s72, 2
  s_lshl_b32 s51, s51, 4
  s_add_u32 s78, s50, s51
  s_lshl_b32 s51, s72, 2
  s_add_u32 s79, s50, s51
  s_add_u32 s79, s79, s32
  s_add_u32 s79, s79, 16384
  s_mov_b32 s67, 0
  s_add_u32 m0, s33, 131072
  s_nop 0
  buffer_load_dwordx4 v3, s[20:23], s67 offen nt lds
  s_mov_b32 s68, 28672
  s_add_u32 m0, s33, 135168
  s_nop 0
  buffer_load_dwordx4 v3, s[20:23], s68 offen nt lds
  s_mov_b32 s67, 57344
  s_add_u32 m0, s33, 139264
  s_nop 0
  buffer_load_dwordx4 v3, s[20:23], s67 offen nt lds
  s_mov_b32 s68, 86016
  s_add_u32 m0, s33, 143360
  s_nop 0
  buffer_load_dwordx4 v3, s[20:23], s68 offen nt lds
  s_mov_b32 s67, 114688
  s_add_u32 m0, s33, 147456
  s_nop 0
  buffer_load_dwordx4 v3, s[20:23], s67 offen nt lds
  s_mov_b32 s68, 143360
  s_add_u32 m0, s33, 151552
  s_nop 0
  buffer_load_dwordx4 v3, s[20:23], s68 offen nt lds
  s_mov_b32 s67, 172032
  s_add_u32 m0, s33, 155648
  s_nop 0
  buffer_load_dwordx4 v3, s[20:23], s67 offen nt lds
  s_mov_b32 s68, 200704
  s_add_u32 m0, s33, 159744
  s_nop 0
  buffer_load_dwordx4 v3, s[20:23], s68 offen nt lds
  s_mov_b32 s67, 128
  s_add_u32 m0, s33, 0
  s_nop 0
  buffer_load_dwordx4 v3, s[20:23], s67 offen nt lds
  s_mov_b32 s68, 28800
  s_add_u32 m0, s33, 4096
  s_nop 0
  buffer_load_dwordx4 v3, s[20:23], s68 offen nt lds
  s_mov_b32 s67, 57472
  s_add_u32 m0, s33, 8192
  s_nop 0
  buffer_load_dwordx4 v3, s[20:23], s67 offen nt lds
  s_mov_b32 s68, 86144
  s_add_u32 m0, s33, 12288
  s_nop 0
  buffer_load_dwordx4 v3, s[20:23], s68 offen nt lds
  s_mov_b32 s67, 114816
  s_add_u32 m0, s33, 16384
  s_nop 0
  buffer_load_dwordx4 v3, s[20:23], s67 offen nt lds
  s_mov_b32 s68, 143488
  s_add_u32 m0, s33, 20480
  s_nop 0
  buffer_load_dwordx4 v3, s[20:23], s68 offen nt lds
  s_mov_b32 s67, 172160
  s_add_u32 m0, s33, 24576
  s_nop 0
  buffer_load_dwordx4 v3, s[20:23], s67 offen nt lds
  s_mov_b32 s68, 200832
  s_add_u32 m0, s33, 28672
  s_nop 0
  buffer_load_dwordx4 v3, s[20:23], s68 offen nt lds
  s_mov_b32 s67, 256
  s_add_u32 m0, s33, 32768
  s_nop 0
  buffer_load_dwordx4 v3, s[20:23], s67 offen nt lds
  s_mov_b32 s68, 28928
  s_add_u32 m0, s33, 36864
  s_nop 0
  buffer_load_dwordx4 v3, s[20:23], s68 offen nt lds
  s_mov_b32 s67, 57600
  s_add_u32 m0, s33, 40960
  s_nop 0
  buffer_load_dwordx4 v3, s[20:23], s67 offen nt lds
  s_mov_b32 s68, 86272
  s_add_u32 m0, s33, 45056
  s_nop 0
  buffer_load_dwordx4 v3, s[20:23], s68 offen nt lds
  s_mov_b32 s67, 114944
  s_add_u32 m0, s33, 49152
  s_nop 0
  buffer_load_dwordx4 v3, s[20:23], s67 offen nt lds
  s_mov_b32 s68, 143616
  s_add_u32 m0, s33, 53248
  s_nop 0
  buffer_load_dwordx4 v3, s[20:23], s68 offen nt lds
  s_mov_b32 s67, 172288
  s_add_u32 m0, s33, 57344
  s_nop 0
  buffer_load_dwordx4 v3, s[20:23], s67 offen nt lds
  s_mov_b32 s68, 200960
  s_add_u32 m0, s33, 61440
  s_nop 0
  buffer_load_dwordx4 v3, s[20:23], s68 offen nt lds
  s_mov_b32 s67, 384
  s_add_u32 m0, s33, 65536
  s_nop 0
  buffer_load_dwordx4 v3, s[20:23], s67 offen nt lds
  s_mov_b32 s68, 29056
  s_add_u32 m0, s33, 69632
  s_nop 0
  buffer_load_dwordx4 v3, s[20:23], s68 offen nt lds
  s_mov_b32 s67, 57728
  s_add_u32 m0, s33, 73728
  s_nop 0
  buffer_load_dwordx4 v3, s[20:23], s67 offen nt lds
  s_mov_b32 s68, 86400
  s_add_u32 m0, s33, 77824
  s_nop 0
  buffer_load_dwordx4 v3, s[20:23], s68 offen nt lds
  s_mov_b32 s67, 115072
  s_add_u32 m0, s33, 81920
  s_nop 0
  buffer_load_dwordx4 v3, s[20:23], s67 offen nt lds
  s_mov_b32 s68, 143744
  s_add_u32 m0, s33, 86016
  s_nop 0
  buffer_load_dwordx4 v3, s[20:23], s68 offen nt lds
  s_mov_b32 s67, 172416
  s_add_u32 m0, s33, 90112
  s_nop 0
  buffer_load_dwordx4 v3, s[20:23], s67 offen nt lds
  s_mov_b32 s68, 201088
  s_add_u32 m0, s33, 94208
  s_nop 0
  buffer_load_dwordx4 v3, s[20:23], s68 offen nt lds
  s_waitcnt vmcnt(0)
  s_branch L_p3_entry
.section .rodata,"a"
.p2align 6
.amdhsa_kernel concat_heads__mha_block_cached__mha_block_cached__near_ridge_kernel
  .amdhsa_next_free_vgpr 512
  .amdhsa_next_free_sgpr 102
  .amdhsa_accum_offset 256
  .amdhsa_group_segment_fixed_size 0
  .amdhsa_kernarg_size 104
  .amdhsa_user_sgpr_count 2
  .amdhsa_user_sgpr_kernarg_segment_ptr 1
  .amdhsa_system_sgpr_workgroup_id_x 1
.end_amdhsa_kernel
```
